```python
import torch

def _softmax(x, axis=-1):
    return torch.softmax(x, dim=axis)
def _gelu(x):
    return torch.nn.functional.gelu(x, approximate="tanh")
def _silu(x):
    return torch.nn.functional.silu(x)
def _sigmoid(x):
    return torch.sigmoid(x)
def _layernorm(x, axis=-1, eps=1e-5):
    m = x.mean(dim=axis, keepdim=True)
    v = x.var(dim=axis, keepdim=True, unbiased=False)
    return (x - m) / torch.sqrt(v + eps)
def _scatter_add(tgt, idx, src, axis=0):
    return tgt.clone().index_add_(axis, idx, src)
def _segment_sum(src, seg, n):
    out = torch.zeros((n,) + src.shape[1:], dtype=src.dtype)
    return out.index_add_(0, seg, src)
def _pad(x, pw):
    flat = tuple(v for pair in reversed(pw) for v in pair)
    return torch.nn.functional.pad(x, flat)

kernel_name = 'gated_mix__compressed_kv_cla__geglu_ffn__prompt'

def setup_inputs():

    _w = (lambda a: (lambda t: t.to(torch.bfloat16) if t.is_floating_point() else t)(torch.as_tensor(a)))
    def _A_setup():
        B, H, Sq, Sk, D, M = 1, 32, 2048, 2048, 128, 640
        Dc = 4 * D
        return {
            "x": _w((lambda *s: torch.randn(*s, dtype=torch.bfloat16) * 0.05)(B, Sq, M)),
            "c_kv": _w((lambda *s: torch.randn(*s, dtype=torch.bfloat16) * 0.4)(B, Sk, Dc)),
            "w_q": _w((lambda *s: torch.randn(*s, dtype=torch.bfloat16) * 6.4)(M, H, D) * (M ** -0.5)),
            "w_uk": _w((lambda *s: torch.randn(*s, dtype=torch.bfloat16) * 6.4)(Dc, H, D) * (Dc ** -0.5)),
            "w_uv": _w((lambda *s: torch.randn(*s, dtype=torch.bfloat16) * 0.4)(Dc, H, D) * (Dc ** -0.5)),
            "w_o": _w((lambda *s: torch.randn(*s, dtype=torch.bfloat16) * 0.4)(H, D, M) * ((H * D) ** -0.5)),
        }
    _A_in = _A_setup()

    def _B_setup():
        B, S, D, F = 1, 2048, 640, 1728
        return {
            "x": _w((lambda *s: torch.randn(*s, dtype=torch.bfloat16) * 0.05)(B, S, D)),
            "w_gate": _w((lambda *s: torch.randn(*s, dtype=torch.bfloat16) * 0.05)(D, F)),
            "w_up": _w((lambda *s: torch.randn(*s, dtype=torch.bfloat16) * 0.05)(D, F)),
            "w_down": _w((lambda *s: torch.randn(*s, dtype=torch.bfloat16) * 0.05)(F, D)),
        }
    _B_in = _B_setup()

    return {
        "A_x": _A_in["x"],
        "A_c_kv": _A_in["c_kv"],
        "A_w_q": _A_in["w_q"],
        "A_w_uk": _A_in["w_uk"],
        "A_w_uv": _A_in["w_uv"],
        "A_w_o": _A_in["w_o"],
        "B_x": _B_in["x"],
        "B_w_gate": _B_in["w_gate"],
        "B_w_up": _B_in["w_up"],
        "B_w_down": _B_in["w_down"],
        "gate_w": _w((lambda *s: torch.randn(*s, dtype=torch.bfloat16) * 0.05)(640) * 16.0),
    }

def reference(A_x, A_c_kv, A_w_q, A_w_uk, A_w_uv, A_w_o, B_x, B_w_gate, B_w_up, B_w_down, gate_w):
    def _A_ref(x, c_kv, w_q, w_uk, w_uv, w_o):
        B, Sq, M = x.shape[0], x.shape[1], x.shape[2]
        Sk = c_kv.shape[1]
        H, D = w_q.shape[1], w_q.shape[2]
        q = torch.einsum("bqm,mhd->bhqd", x, w_q)
        k = torch.einsum("bkc,chd->bhkd", c_kv, w_uk)
        v = torch.einsum("bkc,chd->bhkd", c_kv, w_uv)
        scores = torch.einsum("bhqd,bhkd->bhqk", q, k) * (D ** -0.5)
        off = Sk - Sq
        qi = torch.arange(Sq)[:, None]
        kj = torch.arange(Sk)[None, :]
        cmask = kj <= (qi + off)
        scores = torch.where(cmask[None, None], scores, -1e9)
        p = _softmax(scores, axis=-1)
        ctx = torch.einsum("bhqk,bhkd->bhqd", p, v)
        return torch.einsum("bhqd,hdm->bqm", ctx, w_o)

    def _B_ref(x, w_gate, w_up, w_down):
        return (_gelu(x @ w_gate) * (x @ w_up)) @ w_down

    x = A_x
    g = _sigmoid((x * gate_w).sum(-1, keepdims=True))
    a = _A_ref(x, A_c_kv, A_w_q, A_w_uk, A_w_uv, A_w_o)
    b = _B_ref(x, B_w_gate, B_w_up, B_w_down)
    return g * a + (1 - g) * b
```

```asm
; @launch grid=(256,1,1) block=(512,1,1) lds=163840
.amdgcn_target "amdgcn-amd-amdhsa--gfx950"
.text
.globl gated_mix__compressed_kv_cla__geglu_ffn__prompt_kernel
.p2align 8
.type gated_mix__compressed_kv_cla__geglu_ffn__prompt_kernel,@function
gated_mix__compressed_kv_cla__geglu_ffn__prompt_kernel:
    s_cmp_lt_u32 s2, 256
    s_cbranch_scc1 K_GO
    s_endpgm
K_GO:
    s_load_dwordx4 s[80:83], s[0:1], 0
    s_load_dwordx4 s[84:87], s[0:1], 24
    s_load_dwordx2 s[88:89], s[0:1], 104
    s_load_dwordx2 s[90:91], s[0:1], 16
    s_load_dwordx4 s[92:95], s[0:1], 56
    s_load_dwordx4 s[96:99], s[0:1], 72
    s_load_dwordx2 s[12:13], s[0:1], 96
    s_load_dwordx2 s[20:21], s[0:1], 40
    s_load_dwordx2 s[42:43], s[0:1], 88
    s_memrealtime s[44:45]
    v_lshrrev_b32 v31, 6, v0
    v_and_b32 v1, 63, v0
    v_readfirstlane_b32 s3, v31
    v_and_b32 v2, 15, v0
    v_lshrrev_b32 v3, 4, v1
    v_lshlrev_b32 v4, 4, v1
    s_and_b32 s4, s2, 7
    s_lshr_b32 s5, s2, 3
    s_and_b32 s24, s5, 3
    s_lshl_b32 s6, s4, 2
    s_add_u32 s6, s6, s24
    s_lshr_b32 s7, s5, 2
    s_lshr_b32 s28, s3, 2
    s_lshl_b32 s36, s3, 12
    s_add_u32 s37, s36, 32768
    v_lshrrev_b32 v32, 3, v1
    v_and_b32 v33, 7, v1
    v_xor_b32 v34, v3, v33
    v_lshlrev_b32 v34, 4, v34
    v_xor_b32 v35, 64, v34
    v_lshl_add_u32 v5, v32, 10, v34
    v_lshl_add_u32 v6, v32, 10, v35
    v_add_u32 v6, 7168, v6
    v_add_u32 v7, 14336, v5
    v_add_u32 v30, 14336, v6
    v_lshrrev_b32 v33, 1, v2
    v_xor_b32 v33, v33, v3
    v_lshlrev_b32 v33, 5, v33
    v_and_b32 v9, 1, v1
    v_lshl_add_u32 v33, v9, 4, v33
    v_lshl_add_u32 v8, v3, 13, v33
    v_xor_b32 v10, 128, v8
    v_add_u32 v9, 31744, v8
    v_add_u32 v11, 95232, v10
    v_add_u32 v10, 63488, v10
    s_lshl_b32 s24, s7, 8
    s_lshl_b32 s25, s3, 5
    s_add_u32 s24, s24, s25
    s_lshl_b32 s32, s24, 10
    s_and_b32 s24, s3, 3
    s_lshl_b32 s33, s24, 17
    s_lshl_b32 s25, s6, 8
    s_add_u32 s33, s33, s25
    s_waitcnt lgkmcnt(0)
    s_mov_b32 s64, s82
    s_and_b32 s65, s83, 0xffff
    s_mov_b32 s66, 0x200000
    s_mov_b32 s67, 0x20000
    s_cmp_lt_u32 s3, 4
    s_cselect_b32 s84, s84, s86
    s_cselect_b32 s85, s85, s87
    s_mov_b32 s68, s84
    s_and_b32 s69, s85, 0xffff
    s_mov_b32 s70, 0x400000
    s_mov_b32 s71, 0x20000
    s_add_u32 m0, s36, 0
    s_nop 0
    buffer_load_dwordx4 v5, s[64:67], s32 offen offset:0 lds
    buffer_load_dwordx4 v6, s[64:67], s32 offen offset:1024 lds
    buffer_load_dwordx4 v7, s[64:67], s32 offen offset:2048 lds
    buffer_load_dwordx4 v30, s[64:67], s32 offen offset:3072 lds
    s_add_u32 s32, s32, 128
    s_add_u32 m0, s37, 0
    s_nop 0
    buffer_load_dwordx4 v8, s[68:71], s33 offen offset:0 lds
    buffer_load_dwordx4 v9, s[68:71], s33 offen offset:1024 lds
    buffer_load_dwordx4 v10, s[68:71], s33 offen offset:2048 lds
    buffer_load_dwordx4 v11, s[68:71], s33 offen offset:3072 lds
    s_add_u32 s33, s33, 524288
    v_mul_u32_u24 v32, 1280, v32
    v_add_u32 v24, v32, v34
    v_add_u32 v25, v32, v35
    v_add_u32 v25, 9216, v25
    v_add_u32 v26, 18432, v24
    v_add_u32 v27, 18432, v25
    s_mov_b32 s60, s80
    s_and_b32 s61, s81, 0xffff
    s_mov_b32 s62, 0x280000
    s_mov_b32 s63, 0x20000
    s_mov_b32 s8, s88
    s_and_b32 s9, s89, 0xffff
    s_mov_b32 s10, 0x10000000
    s_mov_b32 s11, 0x20000
    s_mov_b32 s76, s98
    s_and_b32 s77, s99, 0xffff
    s_mov_b32 s78, 0x500
    s_mov_b32 s79, 0x20000
    s_mov_b32 s16, s96
    s_and_b32 s17, s97, 0xffff
    s_mov_b32 s18, 0x21c000
    s_mov_b32 s19, 0x20000
    s_and_b32 s13, s13, 0xffff
    s_mov_b32 s14, 256
    s_mov_b32 s15, 0x20000
    s_and_b32 s21, s21, 0xffff
    s_mov_b32 s22, 0x500000
    s_mov_b32 s23, 0x20000
    s_lshl_b32 s29, s6, 3
    s_add_u32 s29, s29, s7
    s_lshl_b32 s29, s29, 8
    s_add_u32 s29, s29, 0x3900000
    s_and_b32 s24, s5, 3
    s_lshl_b32 s39, s24, 3
    s_add_u32 s39, s39, s4
    s_mul_i32 s25, s4, 3
    s_sub_u32 s26, s7, s25
    s_and_b32 s26, s26, 7
    s_add_u32 s25, s25, s26
    s_lshr_b32 s25, s25, 3
    s_add_u32 s25, s25, 24
    s_mul_i32 s41, s4, 5
    s_add_u32 s41, s41, s26
    s_sub_u32 s41, s41, 3
    s_cmp_lt_u32 s26, 3
    s_cselect_b32 s31, 1, 0
    s_cmp_lt_u32 s24, 3
    s_cselect_b32 s31, 1, s31
    s_cselect_b32 s39, s39, s25
    s_cmp_eq_u32 s7, 0
    s_cselect_b64 vcc, -1, 0
    s_or_b32 s24, s2, s3
    s_cmp_lg_u32 s24, 0
    s_cbranch_scc1 NOTAG
    s_lshl_b32 s44, s44, 3
    s_bitset1_b32 s44, 31
    v_mov_b32 v254, s44
    s_mov_b64 exec, 1
    buffer_store_dword v254, off, s[12:15], 0 sc1
    s_mov_b64 exec, -1
NOTAG:
    s_cmp_lt_u32 s3, 2
    s_cselect_b32 s92, s92, s94
    s_cselect_b32 s93, s93, s95
    s_cmp_lt_u32 s3, 4
    s_cselect_b32 s72, s92, s90
    s_cselect_b32 s73, s93, s91
    s_mov_b32 s24, 0x21c000
    s_cselect_b32 s74, s24, 0x500000
    s_and_b32 s73, s73, 0xffff
    s_mov_b32 s75, 0x20000
    s_sub_u32 s24, 15, s7
    s_cmp_lt_u32 s3, 4
    s_cselect_b32 s25, s24, s7
    s_lshl_b32 s25, s25, 7
    s_and_b32 s26, s3, 3
    s_lshl_b32 s26, s26, 5
    s_add_u32 s25, s25, s26
    s_mul_i32 s34, s25, 1280
    s_and_b32 s24, s3, 1
    s_mul_i32 s24, s24, 110592
    s_lshl_b32 s25, s39, 7
    s_add_u32 s24, s24, s25
    s_and_b32 s25, s3, 3
    s_lshl_b32 s25, s25, 17
    s_lshl_b32 s26, s6, 8
    s_add_u32 s25, s25, s26
    s_cmp_lt_u32 s3, 4
    s_cselect_b32 s35, s24, s25
    s_add_u32 m0, s36, 65536
    s_nop 0
    buffer_load_dwordx4 v5, s[64:67], s32 offen offset:0 lds
    buffer_load_dwordx4 v6, s[64:67], s32 offen offset:1024 lds
    buffer_load_dwordx4 v7, s[64:67], s32 offen offset:2048 lds
    buffer_load_dwordx4 v30, s[64:67], s32 offen offset:3072 lds
    s_add_u32 s32, s32, 128
    s_add_u32 m0, s37, 65536
    s_nop 0
    buffer_load_dwordx4 v8, s[68:71], s33 offen offset:0 lds
    buffer_load_dwordx4 v9, s[68:71], s33 offen offset:1024 lds
    buffer_load_dwordx4 v10, s[68:71], s33 offen offset:2048 lds
    buffer_load_dwordx4 v11, s[68:71], s33 offen offset:3072 lds
    s_add_u32 s33, s33, 524288
    s_cmp_lg_u32 s3, 7
    s_cbranch_scc1 NOPFC
    s_getpc_b64 s[24:25]
PFC_REF:
    s_mul_i32 s26, s5, 3584
    v_min_u32 v250, 27, v1
    v_lshlrev_b32 v250, 7, v250
    v_add_u32 v250, s26, v250
    v_min_u32 v250, K_END-PFC_REF, v250
    v_mov_b32 v251, s25
    v_add_co_u32 v250, s[26:27], s24, v250
    s_nop 1
    v_addc_co_u32 v251, s[26:27], 0, v251, s[26:27]
    global_load_dword v28, v[250:251], off
NOPFC:
    s_lshr_b32 s24, s3, 1
    s_and_b32 s24, s24, 1
    s_lshl_b32 s24, s24, 14
    v_lshrrev_b32 v32, 1, v2
    v_xor_b32 v32, v32, v3
    v_lshlrev_b32 v32, 4, v32
    v_lshl_add_u32 v32, v2, 7, v32
    v_add_u32 v12, s24, v32
    v_xor_b32 v13, 64, v12
    v_add_u32 v14, 0x10000, v12
    v_add_u32 v15, 0x10000, v13
    s_lshl_b32 s24, s28, 14
    s_add_u32 s24, s24, 32768
    s_and_b32 s25, s3, 1
    s_lshl_b32 s25, s25, 2
    v_lshrrev_b32 v32, 2, v2
    v_and_b32 v33, 1, v3
    v_lshl_add_u32 v33, v33, 2, v32
    v_xor_b32 v33, s25, v33
    v_lshl_add_u32 v32, v3, 3, v32
    v_lshlrev_b32 v32, 8, v32
    v_and_b32 v34, 3, v2
    v_lshl_add_u32 v32, v34, 3, v32
    v_add_u32 v32, s24, v32
    v_xor_b32 v34, 0, v33
    v_lshl_add_u32 v16, v34, 5, v32
    v_add_u32 v20, 0x10000, v16
    v_xor_b32 v34, 1, v33
    v_lshl_add_u32 v17, v34, 5, v32
    v_add_u32 v21, 0x10000, v17
    v_xor_b32 v34, 2, v33
    v_lshl_add_u32 v18, v34, 5, v32
    v_add_u32 v22, 0x10000, v18
    v_xor_b32 v34, 3, v33
    v_lshl_add_u32 v19, v34, 5, v32
    v_add_u32 v23, 0x10000, v19
    s_waitcnt vmcnt(8)
    s_barrier
    ds_read_b64_tr_b16 v[64:65], v16 offset:0
    ds_read_b64_tr_b16 v[66:67], v16 offset:1024
    ds_read_b128 v[32:35], v12 offset:0
    ds_read_b64_tr_b16 v[68:69], v17 offset:0
    ds_read_b64_tr_b16 v[70:71], v17 offset:1024
    ds_read_b64_tr_b16 v[72:73], v18 offset:0
    ds_read_b64_tr_b16 v[74:75], v18 offset:1024
    ds_read_b64_tr_b16 v[76:77], v19 offset:0
    ds_read_b64_tr_b16 v[78:79], v19 offset:1024
    ds_read_b128 v[36:39], v12 offset:2048
    ds_read_b128 v[40:43], v12 offset:4096
    ds_read_b128 v[44:47], v12 offset:6144
    ds_read_b128 v[48:51], v12 offset:8192
    ds_read_b128 v[52:55], v12 offset:10240
    ds_read_b128 v[56:59], v12 offset:12288
    ds_read_b128 v[60:63], v12 offset:14336
    s_cmp_ge_u32 s3, 4
    s_cbranch_scc1 K_V
    s_cmp_eq_u32 s31, 0
    s_cbranch_scc1 K_G
    s_waitcnt lgkmcnt(12)
    v_mfma_f32_16x16x32_bf16 v[128:131], v[64:67], v[32:35], 0
    ds_read_b64_tr_b16 v[112:113], v16 offset:8192
    s_lshl_b32 s24, s2, 2
    s_waitcnt lgkmcnt(11)
    v_mfma_f32_16x16x32_bf16 v[132:135], v[68:71], v[32:35], 0
    ds_read_b64_tr_b16 v[114:115], v16 offset:9216
    s_and_b32 s25, s3, 3
    s_waitcnt lgkmcnt(10)
    v_mfma_f32_16x16x32_bf16 v[136:139], v[72:75], v[32:35], 0
    s_add_u32 s24, s24, s25
    s_waitcnt lgkmcnt(8)
    v_mfma_f32_16x16x32_bf16 v[140:143], v[76:79], v[32:35], 0
    ds_read_b128 v[80:83], v13 offset:0
    s_mul_i32 s24, s24, 1536
    v_mfma_f32_16x16x32_bf16 v[144:147], v[64:67], v[36:39], 0
    ds_read_b64_tr_b16 v[116:117], v17 offset:8192
    s_add_u32 s24, s24, 1048576
    v_mfma_f32_16x16x32_bf16 v[148:151], v[68:71], v[36:39], 0
    v_min_u32 v29, 11, v1
    v_mfma_f32_16x16x32_bf16 v[152:155], v[72:75], v[36:39], 0
    ds_read_b64_tr_b16 v[118:119], v17 offset:9216
    v_lshlrev_b32 v29, 7, v29
    v_mfma_f32_16x16x32_bf16 v[156:159], v[76:79], v[36:39], 0
    ds_read_b64_tr_b16 v[120:121], v18 offset:8192
    buffer_load_dword v28, v29, s[68:71], s24 offen
    s_waitcnt lgkmcnt(10)
    v_mfma_f32_16x16x32_bf16 v[160:163], v[64:67], v[40:43], 0
    s_lshl_b32 s24, s2, 3
    v_mfma_f32_16x16x32_bf16 v[164:167], v[68:71], v[40:43], 0
    ds_read_b64_tr_b16 v[122:123], v18 offset:9216
    s_add_u32 s24, s24, s3
    v_mfma_f32_16x16x32_bf16 v[168:171], v[72:75], v[40:43], 0
    ds_read_b64_tr_b16 v[124:125], v19 offset:8192
    s_lshl_b32 s24, s24, 10
    v_mfma_f32_16x16x32_bf16 v[172:175], v[76:79], v[40:43], 0
    v_min_u32 v29, 2, v1
    v_mfma_f32_16x16x32_bf16 v[176:179], v[64:67], v[44:47], 0
    ds_read_b64_tr_b16 v[126:127], v19 offset:9216
    v_lshlrev_b32 v29, 7, v29
    v_mfma_f32_16x16x32_bf16 v[180:183], v[68:71], v[44:47], 0
    ds_read_b128 v[84:87], v13 offset:2048
    buffer_load_dword v28, v29, s[64:67], s24 offen offset:256
    v_mfma_f32_16x16x32_bf16 v[184:187], v[72:75], v[44:47], 0
    v_mfma_f32_16x16x32_bf16 v[188:191], v[76:79], v[44:47], 0
    ds_read_b128 v[88:91], v13 offset:4096
    s_waitcnt lgkmcnt(13)
    v_mfma_f32_16x16x32_bf16 v[192:195], v[64:67], v[48:51], 0
    ds_read_b128 v[92:95], v13 offset:6144
    v_mfma_f32_16x16x32_bf16 v[196:199], v[68:71], v[48:51], 0
    v_mfma_f32_16x16x32_bf16 v[200:203], v[72:75], v[48:51], 0
    ds_read_b128 v[96:99], v13 offset:8192
    v_mfma_f32_16x16x32_bf16 v[204:207], v[76:79], v[48:51], 0
    ds_read_b128 v[100:103], v13 offset:10240
    v_mfma_f32_16x16x32_bf16 v[208:211], v[64:67], v[52:55], 0
    v_mfma_f32_16x16x32_bf16 v[212:215], v[68:71], v[52:55], 0
    ds_read_b128 v[104:107], v13 offset:12288
    v_mfma_f32_16x16x32_bf16 v[216:219], v[72:75], v[52:55], 0
    ds_read_b128 v[108:111], v13 offset:14336
    v_mfma_f32_16x16x32_bf16 v[220:223], v[76:79], v[52:55], 0
    s_waitcnt lgkmcnt(15)
    v_mfma_f32_16x16x32_bf16 v[224:227], v[64:67], v[56:59], 0
    v_mfma_f32_16x16x32_bf16 v[228:231], v[68:71], v[56:59], 0
    v_mfma_f32_16x16x32_bf16 v[232:235], v[72:75], v[56:59], 0
    v_mfma_f32_16x16x32_bf16 v[236:239], v[76:79], v[56:59], 0
    v_mfma_f32_16x16x32_bf16 v[240:243], v[64:67], v[60:63], 0
    v_mfma_f32_16x16x32_bf16 v[244:247], v[68:71], v[60:63], 0
    v_mfma_f32_16x16x32_bf16 v[248:251], v[72:75], v[60:63], 0
    v_mfma_f32_16x16x32_bf16 v[252:255], v[76:79], v[60:63], 0
    s_waitcnt vmcnt(2) lgkmcnt(0)
    s_barrier
    v_mfma_f32_16x16x32_bf16 v[128:131], v[112:115], v[80:83], v[128:131]
    ds_read_b64_tr_b16 v[64:65], v20 offset:0
    v_mfma_f32_16x16x32_bf16 v[132:135], v[116:119], v[80:83], v[132:135]
    ds_read_b64_tr_b16 v[66:67], v20 offset:1024
    s_add_u32 m0, s36, 0
    s_nop 0
    buffer_load_dwordx4 v5, s[64:67], s32 offen offset:0 lds
    v_mfma_f32_16x16x32_bf16 v[136:139], v[120:123], v[80:83], v[136:139]
    v_mfma_f32_16x16x32_bf16 v[140:143], v[124:127], v[80:83], v[140:143]
    ds_read_b128 v[32:35], v14 offset:0
    v_mfma_f32_16x16x32_bf16 v[144:147], v[112:115], v[84:87], v[144:147]
    ds_read_b64_tr_b16 v[68:69], v21 offset:0
    buffer_load_dwordx4 v6, s[64:67], s32 offen offset:1024 lds
    v_mfma_f32_16x16x32_bf16 v[148:151], v[116:119], v[84:87], v[148:151]
    v_mfma_f32_16x16x32_bf16 v[152:155], v[120:123], v[84:87], v[152:155]
    ds_read_b64_tr_b16 v[70:71], v21 offset:1024
    v_mfma_f32_16x16x32_bf16 v[156:159], v[124:127], v[84:87], v[156:159]
    ds_read_b64_tr_b16 v[72:73], v22 offset:0
    buffer_load_dwordx4 v7, s[64:67], s32 offen offset:2048 lds
    v_mfma_f32_16x16x32_bf16 v[160:163], v[112:115], v[88:91], v[160:163]
    v_mfma_f32_16x16x32_bf16 v[164:167], v[116:119], v[88:91], v[164:167]
    ds_read_b64_tr_b16 v[74:75], v22 offset:1024
    v_mfma_f32_16x16x32_bf16 v[168:171], v[120:123], v[88:91], v[168:171]
    ds_read_b64_tr_b16 v[76:77], v23 offset:0
    buffer_load_dwordx4 v30, s[64:67], s32 offen offset:3072 lds
    s_add_u32 s32, s32, 128
    v_mfma_f32_16x16x32_bf16 v[172:175], v[124:127], v[88:91], v[172:175]
    v_mfma_f32_16x16x32_bf16 v[176:179], v[112:115], v[92:95], v[176:179]
    ds_read_b64_tr_b16 v[78:79], v23 offset:1024
    v_mfma_f32_16x16x32_bf16 v[180:183], v[116:119], v[92:95], v[180:183]
    ds_read_b128 v[36:39], v14 offset:2048
    s_add_u32 m0, s37, 0
    s_nop 0
    buffer_load_dwordx4 v8, s[68:71], s33 offen offset:0 lds
    v_mfma_f32_16x16x32_bf16 v[184:187], v[120:123], v[92:95], v[184:187]
    v_mfma_f32_16x16x32_bf16 v[188:191], v[124:127], v[92:95], v[188:191]
    ds_read_b128 v[40:43], v14 offset:4096
    v_mfma_f32_16x16x32_bf16 v[192:195], v[112:115], v[96:99], v[192:195]
    ds_read_b128 v[44:47], v14 offset:6144
    buffer_load_dwordx4 v9, s[68:71], s33 offen offset:1024 lds
    v_mfma_f32_16x16x32_bf16 v[196:199], v[116:119], v[96:99], v[196:199]
    v_mfma_f32_16x16x32_bf16 v[200:203], v[120:123], v[96:99], v[200:203]
    ds_read_b128 v[48:51], v14 offset:8192
    v_mfma_f32_16x16x32_bf16 v[204:207], v[124:127], v[96:99], v[204:207]
    ds_read_b128 v[52:55], v14 offset:10240
    buffer_load_dwordx4 v10, s[68:71], s33 offen offset:2048 lds
    v_mfma_f32_16x16x32_bf16 v[208:211], v[112:115], v[100:103], v[208:211]
    v_mfma_f32_16x16x32_bf16 v[212:215], v[116:119], v[100:103], v[212:215]
    ds_read_b128 v[56:59], v14 offset:12288
    v_mfma_f32_16x16x32_bf16 v[216:219], v[120:123], v[100:103], v[216:219]
    ds_read_b128 v[60:63], v14 offset:14336
    buffer_load_dwordx4 v11, s[68:71], s33 offen offset:3072 lds
    s_add_u32 s33, s33, 524288
    v_mfma_f32_16x16x32_bf16 v[220:223], v[124:127], v[100:103], v[220:223]
    v_mfma_f32_16x16x32_bf16 v[224:227], v[112:115], v[104:107], v[224:227]
    v_mfma_f32_16x16x32_bf16 v[228:231], v[116:119], v[104:107], v[228:231]
    s_lshl_b32 s24, s2, 2
    s_and_b32 s25, s3, 3
    s_add_u32 s24, s24, s25
    v_mfma_f32_16x16x32_bf16 v[232:235], v[120:123], v[104:107], v[232:235]
    s_mul_i32 s24, s24, 1536
    s_add_u32 s24, s24, 2621440
    v_mfma_f32_16x16x32_bf16 v[236:239], v[124:127], v[104:107], v[236:239]
    v_min_u32 v29, 11, v1
    v_lshlrev_b32 v29, 7, v29
    v_mfma_f32_16x16x32_bf16 v[240:243], v[112:115], v[108:111], v[240:243]
    buffer_load_dword v28, v29, s[68:71], s24 offen
    s_lshl_b32 s24, s2, 3
    s_add_u32 s24, s24, s3
    v_mfma_f32_16x16x32_bf16 v[244:247], v[116:119], v[108:111], v[244:247]
    s_lshl_b32 s24, s24, 10
    v_min_u32 v29, 2, v1
    v_mfma_f32_16x16x32_bf16 v[248:251], v[120:123], v[108:111], v[248:251]
    v_lshlrev_b32 v29, 7, v29
    buffer_load_dword v28, v29, s[64:67], s24 offen offset:640
    v_mfma_f32_16x16x32_bf16 v[252:255], v[124:127], v[108:111], v[252:255]
    s_waitcnt lgkmcnt(12)
    v_mfma_f32_16x16x32_bf16 v[128:131], v[64:67], v[32:35], v[128:131]
    ds_read_b64_tr_b16 v[112:113], v20 offset:8192
    s_waitcnt lgkmcnt(11)
    v_mfma_f32_16x16x32_bf16 v[132:135], v[68:71], v[32:35], v[132:135]
    ds_read_b64_tr_b16 v[114:115], v20 offset:9216
    s_waitcnt lgkmcnt(10)
    v_mfma_f32_16x16x32_bf16 v[136:139], v[72:75], v[32:35], v[136:139]
    s_waitcnt lgkmcnt(8)
    v_mfma_f32_16x16x32_bf16 v[140:143], v[76:79], v[32:35], v[140:143]
    ds_read_b128 v[80:83], v15 offset:0
    v_mfma_f32_16x16x32_bf16 v[144:147], v[64:67], v[36:39], v[144:147]
    ds_read_b64_tr_b16 v[116:117], v21 offset:8192
    v_mfma_f32_16x16x32_bf16 v[148:151], v[68:71], v[36:39], v[148:151]
    v_mfma_f32_16x16x32_bf16 v[152:155], v[72:75], v[36:39], v[152:155]
    ds_read_b64_tr_b16 v[118:119], v21 offset:9216
    v_mfma_f32_16x16x32_bf16 v[156:159], v[76:79], v[36:39], v[156:159]
    ds_read_b64_tr_b16 v[120:121], v22 offset:8192
    s_waitcnt lgkmcnt(10)
    v_mfma_f32_16x16x32_bf16 v[160:163], v[64:67], v[40:43], v[160:163]
    v_mfma_f32_16x16x32_bf16 v[164:167], v[68:71], v[40:43], v[164:167]
    ds_read_b64_tr_b16 v[122:123], v22 offset:9216
    v_mfma_f32_16x16x32_bf16 v[168:171], v[72:75], v[40:43], v[168:171]
    ds_read_b64_tr_b16 v[124:125], v23 offset:8192
    v_mfma_f32_16x16x32_bf16 v[172:175], v[76:79], v[40:43], v[172:175]
    v_mfma_f32_16x16x32_bf16 v[176:179], v[64:67], v[44:47], v[176:179]
    ds_read_b64_tr_b16 v[126:127], v23 offset:9216
    v_mfma_f32_16x16x32_bf16 v[180:183], v[68:71], v[44:47], v[180:183]
    ds_read_b128 v[84:87], v15 offset:2048
    v_mfma_f32_16x16x32_bf16 v[184:187], v[72:75], v[44:47], v[184:187]
    v_mfma_f32_16x16x32_bf16 v[188:191], v[76:79], v[44:47], v[188:191]
    ds_read_b128 v[88:91], v15 offset:4096
    s_waitcnt lgkmcnt(13)
    v_mfma_f32_16x16x32_bf16 v[192:195], v[64:67], v[48:51], v[192:195]
    ds_read_b128 v[92:95], v15 offset:6144
    v_mfma_f32_16x16x32_bf16 v[196:199], v[68:71], v[48:51], v[196:199]
    v_mfma_f32_16x16x32_bf16 v[200:203], v[72:75], v[48:51], v[200:203]
    ds_read_b128 v[96:99], v15 offset:8192
    v_mfma_f32_16x16x32_bf16 v[204:207], v[76:79], v[48:51], v[204:207]
    ds_read_b128 v[100:103], v15 offset:10240
    v_mfma_f32_16x16x32_bf16 v[208:211], v[64:67], v[52:55], v[208:211]
    v_mfma_f32_16x16x32_bf16 v[212:215], v[68:71], v[52:55], v[212:215]
    ds_read_b128 v[104:107], v15 offset:12288
    v_mfma_f32_16x16x32_bf16 v[216:219], v[72:75], v[52:55], v[216:219]
    ds_read_b128 v[108:111], v15 offset:14336
    v_mfma_f32_16x16x32_bf16 v[220:223], v[76:79], v[52:55], v[220:223]
    s_waitcnt lgkmcnt(15)
    v_mfma_f32_16x16x32_bf16 v[224:227], v[64:67], v[56:59], v[224:227]
    v_mfma_f32_16x16x32_bf16 v[228:231], v[68:71], v[56:59], v[228:231]
    v_mfma_f32_16x16x32_bf16 v[232:235], v[72:75], v[56:59], v[232:235]
    v_mfma_f32_16x16x32_bf16 v[236:239], v[76:79], v[56:59], v[236:239]
    v_mfma_f32_16x16x32_bf16 v[240:243], v[64:67], v[60:63], v[240:243]
    v_mfma_f32_16x16x32_bf16 v[244:247], v[68:71], v[60:63], v[244:247]
    v_mfma_f32_16x16x32_bf16 v[248:251], v[72:75], v[60:63], v[248:251]
    v_mfma_f32_16x16x32_bf16 v[252:255], v[76:79], v[60:63], v[252:255]
    s_waitcnt vmcnt(2) lgkmcnt(0)
    s_barrier
    v_mfma_f32_16x16x32_bf16 v[128:131], v[112:115], v[80:83], v[128:131]
    ds_read_b64_tr_b16 v[64:65], v16 offset:0
    v_mfma_f32_16x16x32_bf16 v[132:135], v[116:119], v[80:83], v[132:135]
    ds_read_b64_tr_b16 v[66:67], v16 offset:1024
    s_add_u32 m0, s36, 65536
    s_nop 0
    buffer_load_dwordx4 v5, s[64:67], s32 offen offset:0 lds
    v_mfma_f32_16x16x32_bf16 v[136:139], v[120:123], v[80:83], v[136:139]
    v_mfma_f32_16x16x32_bf16 v[140:143], v[124:127], v[80:83], v[140:143]
    ds_read_b128 v[32:35], v12 offset:0
    v_mfma_f32_16x16x32_bf16 v[144:147], v[112:115], v[84:87], v[144:147]
    ds_read_b64_tr_b16 v[68:69], v17 offset:0
    buffer_load_dwordx4 v6, s[64:67], s32 offen offset:1024 lds
    v_mfma_f32_16x16x32_bf16 v[148:151], v[116:119], v[84:87], v[148:151]
    v_mfma_f32_16x16x32_bf16 v[152:155], v[120:123], v[84:87], v[152:155]
    ds_read_b64_tr_b16 v[70:71], v17 offset:1024
    v_mfma_f32_16x16x32_bf16 v[156:159], v[124:127], v[84:87], v[156:159]
    ds_read_b64_tr_b16 v[72:73], v18 offset:0
    buffer_load_dwordx4 v7, s[64:67], s32 offen offset:2048 lds
    v_mfma_f32_16x16x32_bf16 v[160:163], v[112:115], v[88:91], v[160:163]
    v_mfma_f32_16x16x32_bf16 v[164:167], v[116:119], v[88:91], v[164:167]
    ds_read_b64_tr_b16 v[74:75], v18 offset:1024
    v_mfma_f32_16x16x32_bf16 v[168:171], v[120:123], v[88:91], v[168:171]
    ds_read_b64_tr_b16 v[76:77], v19 offset:0
    buffer_load_dwordx4 v30, s[64:67], s32 offen offset:3072 lds
    s_add_u32 s32, s32, 128
    v_mfma_f32_16x16x32_bf16 v[172:175], v[124:127], v[88:91], v[172:175]
    v_mfma_f32_16x16x32_bf16 v[176:179], v[112:115], v[92:95], v[176:179]
    ds_read_b64_tr_b16 v[78:79], v19 offset:1024
    v_mfma_f32_16x16x32_bf16 v[180:183], v[116:119], v[92:95], v[180:183]
    ds_read_b128 v[36:39], v12 offset:2048
    s_add_u32 m0, s37, 65536
    s_nop 0
    buffer_load_dwordx4 v8, s[68:71], s33 offen offset:0 lds
    v_mfma_f32_16x16x32_bf16 v[184:187], v[120:123], v[92:95], v[184:187]
    v_mfma_f32_16x16x32_bf16 v[188:191], v[124:127], v[92:95], v[188:191]
    ds_read_b128 v[40:43], v12 offset:4096
    v_mfma_f32_16x16x32_bf16 v[192:195], v[112:115], v[96:99], v[192:195]
    ds_read_b128 v[44:47], v12 offset:6144
    buffer_load_dwordx4 v9, s[68:71], s33 offen offset:1024 lds
    v_mfma_f32_16x16x32_bf16 v[196:199], v[116:119], v[96:99], v[196:199]
    v_mfma_f32_16x16x32_bf16 v[200:203], v[120:123], v[96:99], v[200:203]
    ds_read_b128 v[48:51], v12 offset:8192
    v_mfma_f32_16x16x32_bf16 v[204:207], v[124:127], v[96:99], v[204:207]
    ds_read_b128 v[52:55], v12 offset:10240
    buffer_load_dwordx4 v10, s[68:71], s33 offen offset:2048 lds
    v_mfma_f32_16x16x32_bf16 v[208:211], v[112:115], v[100:103], v[208:211]
    v_mfma_f32_16x16x32_bf16 v[212:215], v[116:119], v[100:103], v[212:215]
    ds_read_b128 v[56:59], v12 offset:12288
    v_mfma_f32_16x16x32_bf16 v[216:219], v[120:123], v[100:103], v[216:219]
    ds_read_b128 v[60:63], v12 offset:14336
    buffer_load_dwordx4 v11, s[68:71], s33 offen offset:3072 lds
    s_add_u32 s33, s33, 524288
    v_mfma_f32_16x16x32_bf16 v[220:223], v[124:127], v[100:103], v[220:223]
    v_mfma_f32_16x16x32_bf16 v[224:227], v[112:115], v[104:107], v[224:227]
    v_mfma_f32_16x16x32_bf16 v[228:231], v[116:119], v[104:107], v[228:231]
    s_lshl_b32 s24, s2, 3
    v_mfma_f32_16x16x32_bf16 v[232:235], v[120:123], v[104:107], v[232:235]
    s_add_u32 s24, s24, s3
    v_mfma_f32_16x16x32_bf16 v[236:239], v[124:127], v[104:107], v[236:239]
    s_mul_i32 s24, s24, 1280
    v_mfma_f32_16x16x32_bf16 v[240:243], v[112:115], v[108:111], v[240:243]
    v_min_u32 v29, 9, v1
    v_mfma_f32_16x16x32_bf16 v[244:247], v[116:119], v[108:111], v[244:247]
    v_lshlrev_b32 v29, 7, v29
    v_mfma_f32_16x16x32_bf16 v[248:251], v[120:123], v[108:111], v[248:251]
    buffer_load_dword v28, v29, s[60:63], s24 offen
    v_mfma_f32_16x16x32_bf16 v[252:255], v[124:127], v[108:111], v[252:255]
    s_waitcnt lgkmcnt(12)
    v_mfma_f32_16x16x32_bf16 v[128:131], v[64:67], v[32:35], v[128:131]
    ds_read_b64_tr_b16 v[112:113], v16 offset:8192
    s_waitcnt lgkmcnt(11)
    v_mfma_f32_16x16x32_bf16 v[132:135], v[68:71], v[32:35], v[132:135]
    ds_read_b64_tr_b16 v[114:115], v16 offset:9216
    s_waitcnt lgkmcnt(10)
    v_mfma_f32_16x16x32_bf16 v[136:139], v[72:75], v[32:35], v[136:139]
    s_waitcnt lgkmcnt(8)
    v_mfma_f32_16x16x32_bf16 v[140:143], v[76:79], v[32:35], v[140:143]
    ds_read_b128 v[80:83], v13 offset:0
    v_mfma_f32_16x16x32_bf16 v[144:147], v[64:67], v[36:39], v[144:147]
    ds_read_b64_tr_b16 v[116:117], v17 offset:8192
    buffer_load_dword v31, off, s[12:15], 0 sc1
    v_mfma_f32_16x16x32_bf16 v[148:151], v[68:71], v[36:39], v[148:151]
    v_mfma_f32_16x16x32_bf16 v[152:155], v[72:75], v[36:39], v[152:155]
    ds_read_b64_tr_b16 v[118:119], v17 offset:9216
    v_mfma_f32_16x16x32_bf16 v[156:159], v[76:79], v[36:39], v[156:159]
    ds_read_b64_tr_b16 v[120:121], v18 offset:8192
    s_waitcnt lgkmcnt(10)
    v_mfma_f32_16x16x32_bf16 v[160:163], v[64:67], v[40:43], v[160:163]
    v_mfma_f32_16x16x32_bf16 v[164:167], v[68:71], v[40:43], v[164:167]
    ds_read_b64_tr_b16 v[122:123], v18 offset:9216
    v_mfma_f32_16x16x32_bf16 v[168:171], v[72:75], v[40:43], v[168:171]
    ds_read_b64_tr_b16 v[124:125], v19 offset:8192
    v_mfma_f32_16x16x32_bf16 v[172:175], v[76:79], v[40:43], v[172:175]
    v_mfma_f32_16x16x32_bf16 v[176:179], v[64:67], v[44:47], v[176:179]
    ds_read_b64_tr_b16 v[126:127], v19 offset:9216
    v_mfma_f32_16x16x32_bf16 v[180:183], v[68:71], v[44:47], v[180:183]
    ds_read_b128 v[84:87], v13 offset:2048
    v_mfma_f32_16x16x32_bf16 v[184:187], v[72:75], v[44:47], v[184:187]
    v_mfma_f32_16x16x32_bf16 v[188:191], v[76:79], v[44:47], v[188:191]
    ds_read_b128 v[88:91], v13 offset:4096
    s_waitcnt lgkmcnt(13)
    v_mfma_f32_16x16x32_bf16 v[192:195], v[64:67], v[48:51], v[192:195]
    ds_read_b128 v[92:95], v13 offset:6144
    v_mfma_f32_16x16x32_bf16 v[196:199], v[68:71], v[48:51], v[196:199]
    v_mfma_f32_16x16x32_bf16 v[200:203], v[72:75], v[48:51], v[200:203]
    ds_read_b128 v[96:99], v13 offset:8192
    v_mfma_f32_16x16x32_bf16 v[204:207], v[76:79], v[48:51], v[204:207]
    ds_read_b128 v[100:103], v13 offset:10240
    v_mfma_f32_16x16x32_bf16 v[208:211], v[64:67], v[52:55], v[208:211]
    v_mfma_f32_16x16x32_bf16 v[212:215], v[68:71], v[52:55], v[212:215]
    ds_read_b128 v[104:107], v13 offset:12288
    v_mfma_f32_16x16x32_bf16 v[216:219], v[72:75], v[52:55], v[216:219]
    ds_read_b128 v[108:111], v13 offset:14336
    v_mfma_f32_16x16x32_bf16 v[220:223], v[76:79], v[52:55], v[220:223]
    s_waitcnt lgkmcnt(15)
    v_mfma_f32_16x16x32_bf16 v[224:227], v[64:67], v[56:59], v[224:227]
    v_mfma_f32_16x16x32_bf16 v[228:231], v[68:71], v[56:59], v[228:231]
    v_mfma_f32_16x16x32_bf16 v[232:235], v[72:75], v[56:59], v[232:235]
    v_mfma_f32_16x16x32_bf16 v[236:239], v[76:79], v[56:59], v[236:239]
    v_mfma_f32_16x16x32_bf16 v[240:243], v[64:67], v[60:63], v[240:243]
    v_mfma_f32_16x16x32_bf16 v[244:247], v[68:71], v[60:63], v[244:247]
    v_mfma_f32_16x16x32_bf16 v[248:251], v[72:75], v[60:63], v[248:251]
    v_mfma_f32_16x16x32_bf16 v[252:255], v[76:79], v[60:63], v[252:255]
    s_waitcnt vmcnt(2) lgkmcnt(0)
    s_barrier
    v_mfma_f32_16x16x32_bf16 v[128:131], v[112:115], v[80:83], v[128:131]
    ds_read_b64_tr_b16 v[64:65], v20 offset:0
    v_mfma_f32_16x16x32_bf16 v[132:135], v[116:119], v[80:83], v[132:135]
    ds_read_b64_tr_b16 v[66:67], v20 offset:1024
    s_add_u32 m0, s36, 0
    s_nop 0
    buffer_load_dwordx4 v5, s[64:67], s32 offen offset:0 lds
    v_mfma_f32_16x16x32_bf16 v[136:139], v[120:123], v[80:83], v[136:139]
    v_mfma_f32_16x16x32_bf16 v[140:143], v[124:127], v[80:83], v[140:143]
    ds_read_b128 v[32:35], v14 offset:0
    v_mfma_f32_16x16x32_bf16 v[144:147], v[112:115], v[84:87], v[144:147]
    ds_read_b64_tr_b16 v[68:69], v21 offset:0
    buffer_load_dwordx4 v6, s[64:67], s32 offen offset:1024 lds
    v_mfma_f32_16x16x32_bf16 v[148:151], v[116:119], v[84:87], v[148:151]
    v_mfma_f32_16x16x32_bf16 v[152:155], v[120:123], v[84:87], v[152:155]
    ds_read_b64_tr_b16 v[70:71], v21 offset:1024
    v_mfma_f32_16x16x32_bf16 v[156:159], v[124:127], v[84:87], v[156:159]
    ds_read_b64_tr_b16 v[72:73], v22 offset:0
    buffer_load_dwordx4 v7, s[64:67], s32 offen offset:2048 lds
    v_mfma_f32_16x16x32_bf16 v[160:163], v[112:115], v[88:91], v[160:163]
    v_mfma_f32_16x16x32_bf16 v[164:167], v[116:119], v[88:91], v[164:167]
    ds_read_b64_tr_b16 v[74:75], v22 offset:1024
    v_mfma_f32_16x16x32_bf16 v[168:171], v[120:123], v[88:91], v[168:171]
    ds_read_b64_tr_b16 v[76:77], v23 offset:0
    buffer_load_dwordx4 v30, s[64:67], s32 offen offset:3072 lds
    s_add_u32 s32, s32, 128
    v_mfma_f32_16x16x32_bf16 v[172:175], v[124:127], v[88:91], v[172:175]
    v_mfma_f32_16x16x32_bf16 v[176:179], v[112:115], v[92:95], v[176:179]
    ds_read_b64_tr_b16 v[78:79], v23 offset:1024
    v_mfma_f32_16x16x32_bf16 v[180:183], v[116:119], v[92:95], v[180:183]
    ds_read_b128 v[36:39], v14 offset:2048
    s_add_u32 m0, s37, 0
    s_nop 0
    buffer_load_dwordx4 v8, s[68:71], s33 offen offset:0 lds
    v_mfma_f32_16x16x32_bf16 v[184:187], v[120:123], v[92:95], v[184:187]
    v_mfma_f32_16x16x32_bf16 v[188:191], v[124:127], v[92:95], v[188:191]
    ds_read_b128 v[40:43], v14 offset:4096
    v_mfma_f32_16x16x32_bf16 v[192:195], v[112:115], v[96:99], v[192:195]
    ds_read_b128 v[44:47], v14 offset:6144
    buffer_load_dwordx4 v9, s[68:71], s33 offen offset:1024 lds
    v_mfma_f32_16x16x32_bf16 v[196:199], v[116:119], v[96:99], v[196:199]
    v_mfma_f32_16x16x32_bf16 v[200:203], v[120:123], v[96:99], v[200:203]
    ds_read_b128 v[48:51], v14 offset:8192
    v_mfma_f32_16x16x32_bf16 v[204:207], v[124:127], v[96:99], v[204:207]
    ds_read_b128 v[52:55], v14 offset:10240
    buffer_load_dwordx4 v10, s[68:71], s33 offen offset:2048 lds
    v_mfma_f32_16x16x32_bf16 v[208:211], v[112:115], v[100:103], v[208:211]
    v_mfma_f32_16x16x32_bf16 v[212:215], v[116:119], v[100:103], v[212:215]
    ds_read_b128 v[56:59], v14 offset:12288
    v_mfma_f32_16x16x32_bf16 v[216:219], v[120:123], v[100:103], v[216:219]
    ds_read_b128 v[60:63], v14 offset:14336
    buffer_load_dwordx4 v11, s[68:71], s33 offen offset:3072 lds
    s_add_u32 s33, s33, 524288
    v_mfma_f32_16x16x32_bf16 v[220:223], v[124:127], v[100:103], v[220:223]
    v_mfma_f32_16x16x32_bf16 v[224:227], v[112:115], v[104:107], v[224:227]
    v_mfma_f32_16x16x32_bf16 v[228:231], v[116:119], v[104:107], v[228:231]
    s_lshl_b32 s24, s2, 1
    s_and_b32 s25, s3, 1
    v_mfma_f32_16x16x32_bf16 v[232:235], v[120:123], v[104:107], v[232:235]
    s_add_u32 s24, s24, s25
    v_mfma_f32_16x16x32_bf16 v[236:239], v[124:127], v[104:107], v[236:239]
    s_add_u32 s24, s24, 0
    v_mfma_f32_16x16x32_bf16 v[240:243], v[112:115], v[108:111], v[240:243]
    s_mul_i32 s24, s24, 2176
    v_min_u32 v29, 16, v1
    v_mfma_f32_16x16x32_bf16 v[244:247], v[116:119], v[108:111], v[244:247]
    v_lshlrev_b32 v29, 7, v29
    v_mfma_f32_16x16x32_bf16 v[248:251], v[120:123], v[108:111], v[248:251]
    buffer_load_dword v28, v29, s[72:75], s24 offen
    v_mfma_f32_16x16x32_bf16 v[252:255], v[124:127], v[108:111], v[252:255]
    s_waitcnt lgkmcnt(12)
    v_mfma_f32_16x16x32_bf16 v[128:131], v[64:67], v[32:35], v[128:131]
    ds_read_b64_tr_b16 v[112:113], v20 offset:8192
    s_waitcnt lgkmcnt(11)
    v_mfma_f32_16x16x32_bf16 v[132:135], v[68:71], v[32:35], v[132:135]
    ds_read_b64_tr_b16 v[114:115], v20 offset:9216
    s_waitcnt lgkmcnt(10)
    v_mfma_f32_16x16x32_bf16 v[136:139], v[72:75], v[32:35], v[136:139]
    s_waitcnt lgkmcnt(8)
    v_mfma_f32_16x16x32_bf16 v[140:143], v[76:79], v[32:35], v[140:143]
    ds_read_b128 v[80:83], v15 offset:0
    v_mfma_f32_16x16x32_bf16 v[144:147], v[64:67], v[36:39], v[144:147]
    ds_read_b64_tr_b16 v[116:117], v21 offset:8192
    v_mfma_f32_16x16x32_bf16 v[148:151], v[68:71], v[36:39], v[148:151]
    v_mfma_f32_16x16x32_bf16 v[152:155], v[72:75], v[36:39], v[152:155]
    ds_read_b64_tr_b16 v[118:119], v21 offset:9216
    v_mfma_f32_16x16x32_bf16 v[156:159], v[76:79], v[36:39], v[156:159]
    ds_read_b64_tr_b16 v[120:121], v22 offset:8192
    s_waitcnt lgkmcnt(10)
    v_mfma_f32_16x16x32_bf16 v[160:163], v[64:67], v[40:43], v[160:163]
    v_mfma_f32_16x16x32_bf16 v[164:167], v[68:71], v[40:43], v[164:167]
    ds_read_b64_tr_b16 v[122:123], v22 offset:9216
    v_mfma_f32_16x16x32_bf16 v[168:171], v[72:75], v[40:43], v[168:171]
    ds_read_b64_tr_b16 v[124:125], v23 offset:8192
    v_mfma_f32_16x16x32_bf16 v[172:175], v[76:79], v[40:43], v[172:175]
    v_mfma_f32_16x16x32_bf16 v[176:179], v[64:67], v[44:47], v[176:179]
    ds_read_b64_tr_b16 v[126:127], v23 offset:9216
    v_mfma_f32_16x16x32_bf16 v[180:183], v[68:71], v[44:47], v[180:183]
    ds_read_b128 v[84:87], v15 offset:2048
    v_mfma_f32_16x16x32_bf16 v[184:187], v[72:75], v[44:47], v[184:187]
    v_mfma_f32_16x16x32_bf16 v[188:191], v[76:79], v[44:47], v[188:191]
    ds_read_b128 v[88:91], v15 offset:4096
    s_waitcnt lgkmcnt(13)
    v_mfma_f32_16x16x32_bf16 v[192:195], v[64:67], v[48:51], v[192:195]
    ds_read_b128 v[92:95], v15 offset:6144
    v_mfma_f32_16x16x32_bf16 v[196:199], v[68:71], v[48:51], v[196:199]
    v_mfma_f32_16x16x32_bf16 v[200:203], v[72:75], v[48:51], v[200:203]
    ds_read_b128 v[96:99], v15 offset:8192
    v_mfma_f32_16x16x32_bf16 v[204:207], v[76:79], v[48:51], v[204:207]
    ds_read_b128 v[100:103], v15 offset:10240
    v_mfma_f32_16x16x32_bf16 v[208:211], v[64:67], v[52:55], v[208:211]
    v_mfma_f32_16x16x32_bf16 v[212:215], v[68:71], v[52:55], v[212:215]
    ds_read_b128 v[104:107], v15 offset:12288
    v_mfma_f32_16x16x32_bf16 v[216:219], v[72:75], v[52:55], v[216:219]
    ds_read_b128 v[108:111], v15 offset:14336
    v_mfma_f32_16x16x32_bf16 v[220:223], v[76:79], v[52:55], v[220:223]
    s_waitcnt lgkmcnt(15)
    v_mfma_f32_16x16x32_bf16 v[224:227], v[64:67], v[56:59], v[224:227]
    v_mfma_f32_16x16x32_bf16 v[228:231], v[68:71], v[56:59], v[228:231]
    v_mfma_f32_16x16x32_bf16 v[232:235], v[72:75], v[56:59], v[232:235]
    v_mfma_f32_16x16x32_bf16 v[236:239], v[76:79], v[56:59], v[236:239]
    v_mfma_f32_16x16x32_bf16 v[240:243], v[64:67], v[60:63], v[240:243]
    v_mfma_f32_16x16x32_bf16 v[244:247], v[68:71], v[60:63], v[244:247]
    v_mfma_f32_16x16x32_bf16 v[248:251], v[72:75], v[60:63], v[248:251]
    v_mfma_f32_16x16x32_bf16 v[252:255], v[76:79], v[60:63], v[252:255]
    s_waitcnt vmcnt(1) lgkmcnt(0)
    s_barrier
    s_waitcnt vmcnt(9)
    v_readfirstlane_b32 s38, v31
    s_cmp_eq_u32 s38, 0
    s_cbranch_scc1 TAG0_S
TAG0_C:
    v_mfma_f32_16x16x32_bf16 v[128:131], v[112:115], v[80:83], v[128:131]
    ds_read_b64_tr_b16 v[64:65], v16 offset:0
    v_mfma_f32_16x16x32_bf16 v[132:135], v[116:119], v[80:83], v[132:135]
    ds_read_b64_tr_b16 v[66:67], v16 offset:1024
    s_add_u32 m0, s36, 65536
    s_nop 0
    buffer_load_dwordx4 v5, s[64:67], s32 offen offset:0 lds
    v_mfma_f32_16x16x32_bf16 v[136:139], v[120:123], v[80:83], v[136:139]
    v_mfma_f32_16x16x32_bf16 v[140:143], v[124:127], v[80:83], v[140:143]
    ds_read_b128 v[32:35], v12 offset:0
    v_mfma_f32_16x16x32_bf16 v[144:147], v[112:115], v[84:87], v[144:147]
    ds_read_b64_tr_b16 v[68:69], v17 offset:0
    buffer_load_dwordx4 v6, s[64:67], s32 offen offset:1024 lds
    v_mfma_f32_16x16x32_bf16 v[148:151], v[116:119], v[84:87], v[148:151]
    v_mfma_f32_16x16x32_bf16 v[152:155], v[120:123], v[84:87], v[152:155]
    ds_read_b64_tr_b16 v[70:71], v17 offset:1024
    v_mfma_f32_16x16x32_bf16 v[156:159], v[124:127], v[84:87], v[156:159]
    ds_read_b64_tr_b16 v[72:73], v18 offset:0
    buffer_load_dwordx4 v7, s[64:67], s32 offen offset:2048 lds
    v_mfma_f32_16x16x32_bf16 v[160:163], v[112:115], v[88:91], v[160:163]
    v_mfma_f32_16x16x32_bf16 v[164:167], v[116:119], v[88:91], v[164:167]
    ds_read_b64_tr_b16 v[74:75], v18 offset:1024
    v_mfma_f32_16x16x32_bf16 v[168:171], v[120:123], v[88:91], v[168:171]
    ds_read_b64_tr_b16 v[76:77], v19 offset:0
    buffer_load_dwordx4 v30, s[64:67], s32 offen offset:3072 lds
    s_add_u32 s32, s32, 128
    v_mfma_f32_16x16x32_bf16 v[172:175], v[124:127], v[88:91], v[172:175]
    v_mfma_f32_16x16x32_bf16 v[176:179], v[112:115], v[92:95], v[176:179]
    ds_read_b64_tr_b16 v[78:79], v19 offset:1024
    v_mfma_f32_16x16x32_bf16 v[180:183], v[116:119], v[92:95], v[180:183]
    ds_read_b128 v[36:39], v12 offset:2048
    s_add_u32 m0, s37, 65536
    s_nop 0
    buffer_load_dwordx4 v8, s[68:71], s33 offen offset:0 lds
    v_mfma_f32_16x16x32_bf16 v[184:187], v[120:123], v[92:95], v[184:187]
    v_mfma_f32_16x16x32_bf16 v[188:191], v[124:127], v[92:95], v[188:191]
    ds_read_b128 v[40:43], v12 offset:4096
    v_mfma_f32_16x16x32_bf16 v[192:195], v[112:115], v[96:99], v[192:195]
    ds_read_b128 v[44:47], v12 offset:6144
    buffer_load_dwordx4 v9, s[68:71], s33 offen offset:1024 lds
    v_mfma_f32_16x16x32_bf16 v[196:199], v[116:119], v[96:99], v[196:199]
    v_mfma_f32_16x16x32_bf16 v[200:203], v[120:123], v[96:99], v[200:203]
    ds_read_b128 v[48:51], v12 offset:8192
    v_mfma_f32_16x16x32_bf16 v[204:207], v[124:127], v[96:99], v[204:207]
    ds_read_b128 v[52:55], v12 offset:10240
    buffer_load_dwordx4 v10, s[68:71], s33 offen offset:2048 lds
    v_mfma_f32_16x16x32_bf16 v[208:211], v[112:115], v[100:103], v[208:211]
    v_mfma_f32_16x16x32_bf16 v[212:215], v[116:119], v[100:103], v[212:215]
    ds_read_b128 v[56:59], v12 offset:12288
    v_mfma_f32_16x16x32_bf16 v[216:219], v[120:123], v[100:103], v[216:219]
    ds_read_b128 v[60:63], v12 offset:14336
    buffer_load_dwordx4 v11, s[68:71], s33 offen offset:3072 lds
    s_add_u32 s33, s33, 524288
    v_mfma_f32_16x16x32_bf16 v[220:223], v[124:127], v[100:103], v[220:223]
    v_mfma_f32_16x16x32_bf16 v[224:227], v[112:115], v[104:107], v[224:227]
    v_mfma_f32_16x16x32_bf16 v[228:231], v[116:119], v[104:107], v[228:231]
    s_lshl_b32 s24, s2, 1
    s_and_b32 s25, s3, 1
    v_mfma_f32_16x16x32_bf16 v[232:235], v[120:123], v[104:107], v[232:235]
    s_add_u32 s24, s24, s25
    v_mfma_f32_16x16x32_bf16 v[236:239], v[124:127], v[104:107], v[236:239]
    s_add_u32 s24, s24, 512
    v_mfma_f32_16x16x32_bf16 v[240:243], v[112:115], v[108:111], v[240:243]
    s_mul_i32 s24, s24, 2176
    v_min_u32 v29, 16, v1
    v_mfma_f32_16x16x32_bf16 v[244:247], v[116:119], v[108:111], v[244:247]
    v_lshlrev_b32 v29, 7, v29
    v_mfma_f32_16x16x32_bf16 v[248:251], v[120:123], v[108:111], v[248:251]
    buffer_load_dword v28, v29, s[72:75], s24 offen
    v_mfma_f32_16x16x32_bf16 v[252:255], v[124:127], v[108:111], v[252:255]
    s_waitcnt lgkmcnt(12)
    v_mfma_f32_16x16x32_bf16 v[128:131], v[64:67], v[32:35], v[128:131]
    ds_read_b64_tr_b16 v[112:113], v16 offset:8192
    s_waitcnt lgkmcnt(11)
    v_mfma_f32_16x16x32_bf16 v[132:135], v[68:71], v[32:35], v[132:135]
    ds_read_b64_tr_b16 v[114:115], v16 offset:9216
    s_waitcnt lgkmcnt(10)
    v_mfma_f32_16x16x32_bf16 v[136:139], v[72:75], v[32:35], v[136:139]
    s_waitcnt lgkmcnt(8)
    v_mfma_f32_16x16x32_bf16 v[140:143], v[76:79], v[32:35], v[140:143]
    ds_read_b128 v[80:83], v13 offset:0
    v_mfma_f32_16x16x32_bf16 v[144:147], v[64:67], v[36:39], v[144:147]
    ds_read_b64_tr_b16 v[116:117], v17 offset:8192
    v_mfma_f32_16x16x32_bf16 v[148:151], v[68:71], v[36:39], v[148:151]
    v_mfma_f32_16x16x32_bf16 v[152:155], v[72:75], v[36:39], v[152:155]
    ds_read_b64_tr_b16 v[118:119], v17 offset:9216
    v_mfma_f32_16x16x32_bf16 v[156:159], v[76:79], v[36:39], v[156:159]
    ds_read_b64_tr_b16 v[120:121], v18 offset:8192
    s_waitcnt lgkmcnt(10)
    v_mfma_f32_16x16x32_bf16 v[160:163], v[64:67], v[40:43], v[160:163]
    v_mfma_f32_16x16x32_bf16 v[164:167], v[68:71], v[40:43], v[164:167]
    ds_read_b64_tr_b16 v[122:123], v18 offset:9216
    v_mfma_f32_16x16x32_bf16 v[168:171], v[72:75], v[40:43], v[168:171]
    ds_read_b64_tr_b16 v[124:125], v19 offset:8192
    v_mfma_f32_16x16x32_bf16 v[172:175], v[76:79], v[40:43], v[172:175]
    v_mfma_f32_16x16x32_bf16 v[176:179], v[64:67], v[44:47], v[176:179]
    ds_read_b64_tr_b16 v[126:127], v19 offset:9216
    v_mfma_f32_16x16x32_bf16 v[180:183], v[68:71], v[44:47], v[180:183]
    ds_read_b128 v[84:87], v13 offset:2048
    v_mfma_f32_16x16x32_bf16 v[184:187], v[72:75], v[44:47], v[184:187]
    v_mfma_f32_16x16x32_bf16 v[188:191], v[76:79], v[44:47], v[188:191]
    ds_read_b128 v[88:91], v13 offset:4096
    s_waitcnt lgkmcnt(13)
    v_mfma_f32_16x16x32_bf16 v[192:195], v[64:67], v[48:51], v[192:195]
    ds_read_b128 v[92:95], v13 offset:6144
    v_mfma_f32_16x16x32_bf16 v[196:199], v[68:71], v[48:51], v[196:199]
    v_mfma_f32_16x16x32_bf16 v[200:203], v[72:75], v[48:51], v[200:203]
    ds_read_b128 v[96:99], v13 offset:8192
    v_mfma_f32_16x16x32_bf16 v[204:207], v[76:79], v[48:51], v[204:207]
    ds_read_b128 v[100:103], v13 offset:10240
    v_mfma_f32_16x16x32_bf16 v[208:211], v[64:67], v[52:55], v[208:211]
    v_mfma_f32_16x16x32_bf16 v[212:215], v[68:71], v[52:55], v[212:215]
    ds_read_b128 v[104:107], v13 offset:12288
    v_mfma_f32_16x16x32_bf16 v[216:219], v[72:75], v[52:55], v[216:219]
    ds_read_b128 v[108:111], v13 offset:14336
    v_mfma_f32_16x16x32_bf16 v[220:223], v[76:79], v[52:55], v[220:223]
    s_waitcnt lgkmcnt(15)
    v_mfma_f32_16x16x32_bf16 v[224:227], v[64:67], v[56:59], v[224:227]
    v_mfma_f32_16x16x32_bf16 v[228:231], v[68:71], v[56:59], v[228:231]
    v_mfma_f32_16x16x32_bf16 v[232:235], v[72:75], v[56:59], v[232:235]
    v_mfma_f32_16x16x32_bf16 v[236:239], v[76:79], v[56:59], v[236:239]
    v_mfma_f32_16x16x32_bf16 v[240:243], v[64:67], v[60:63], v[240:243]
    v_mfma_f32_16x16x32_bf16 v[244:247], v[68:71], v[60:63], v[244:247]
    v_mfma_f32_16x16x32_bf16 v[248:251], v[72:75], v[60:63], v[248:251]
    v_mfma_f32_16x16x32_bf16 v[252:255], v[76:79], v[60:63], v[252:255]
    s_waitcnt vmcnt(1) lgkmcnt(0)
    s_barrier
    v_mfma_f32_16x16x32_bf16 v[128:131], v[112:115], v[80:83], v[128:131]
    ds_read_b64_tr_b16 v[64:65], v20 offset:0
    v_mfma_f32_16x16x32_bf16 v[132:135], v[116:119], v[80:83], v[132:135]
    ds_read_b64_tr_b16 v[66:67], v20 offset:1024
    s_add_u32 m0, s36, 0
    s_nop 0
    buffer_load_dwordx4 v5, s[64:67], s32 offen offset:0 lds
    v_mfma_f32_16x16x32_bf16 v[136:139], v[120:123], v[80:83], v[136:139]
    v_mfma_f32_16x16x32_bf16 v[140:143], v[124:127], v[80:83], v[140:143]
    ds_read_b128 v[32:35], v14 offset:0
    v_mfma_f32_16x16x32_bf16 v[144:147], v[112:115], v[84:87], v[144:147]
    ds_read_b64_tr_b16 v[68:69], v21 offset:0
    buffer_load_dwordx4 v6, s[64:67], s32 offen offset:1024 lds
    v_mfma_f32_16x16x32_bf16 v[148:151], v[116:119], v[84:87], v[148:151]
    v_mfma_f32_16x16x32_bf16 v[152:155], v[120:123], v[84:87], v[152:155]
    ds_read_b64_tr_b16 v[70:71], v21 offset:1024
    v_mfma_f32_16x16x32_bf16 v[156:159], v[124:127], v[84:87], v[156:159]
    ds_read_b64_tr_b16 v[72:73], v22 offset:0
    buffer_load_dwordx4 v7, s[64:67], s32 offen offset:2048 lds
    v_mfma_f32_16x16x32_bf16 v[160:163], v[112:115], v[88:91], v[160:163]
    v_mfma_f32_16x16x32_bf16 v[164:167], v[116:119], v[88:91], v[164:167]
    ds_read_b64_tr_b16 v[74:75], v22 offset:1024
    v_mfma_f32_16x16x32_bf16 v[168:171], v[120:123], v[88:91], v[168:171]
    ds_read_b64_tr_b16 v[76:77], v23 offset:0
    buffer_load_dwordx4 v30, s[64:67], s32 offen offset:3072 lds
    s_add_u32 s32, s32, 128
    v_mfma_f32_16x16x32_bf16 v[172:175], v[124:127], v[88:91], v[172:175]
    v_mfma_f32_16x16x32_bf16 v[176:179], v[112:115], v[92:95], v[176:179]
    ds_read_b64_tr_b16 v[78:79], v23 offset:1024
    v_mfma_f32_16x16x32_bf16 v[180:183], v[116:119], v[92:95], v[180:183]
    ds_read_b128 v[36:39], v14 offset:2048
    s_add_u32 m0, s37, 0
    s_nop 0
    buffer_load_dwordx4 v8, s[68:71], s33 offen offset:0 lds
    v_mfma_f32_16x16x32_bf16 v[184:187], v[120:123], v[92:95], v[184:187]
    v_mfma_f32_16x16x32_bf16 v[188:191], v[124:127], v[92:95], v[188:191]
    ds_read_b128 v[40:43], v14 offset:4096
    v_mfma_f32_16x16x32_bf16 v[192:195], v[112:115], v[96:99], v[192:195]
    ds_read_b128 v[44:47], v14 offset:6144
    buffer_load_dwordx4 v9, s[68:71], s33 offen offset:1024 lds
    v_mfma_f32_16x16x32_bf16 v[196:199], v[116:119], v[96:99], v[196:199]
    v_mfma_f32_16x16x32_bf16 v[200:203], v[120:123], v[96:99], v[200:203]
    ds_read_b128 v[48:51], v14 offset:8192
    v_mfma_f32_16x16x32_bf16 v[204:207], v[124:127], v[96:99], v[204:207]
    ds_read_b128 v[52:55], v14 offset:10240
    buffer_load_dwordx4 v10, s[68:71], s33 offen offset:2048 lds
    v_mfma_f32_16x16x32_bf16 v[208:211], v[112:115], v[100:103], v[208:211]
    v_mfma_f32_16x16x32_bf16 v[212:215], v[116:119], v[100:103], v[212:215]
    ds_read_b128 v[56:59], v14 offset:12288
    v_mfma_f32_16x16x32_bf16 v[216:219], v[120:123], v[100:103], v[216:219]
    ds_read_b128 v[60:63], v14 offset:14336
    buffer_load_dwordx4 v11, s[68:71], s33 offen offset:3072 lds
    s_add_u32 s33, s33, 524288
    v_mfma_f32_16x16x32_bf16 v[220:223], v[124:127], v[100:103], v[220:223]
    v_mfma_f32_16x16x32_bf16 v[224:227], v[112:115], v[104:107], v[224:227]
    v_mfma_f32_16x16x32_bf16 v[228:231], v[116:119], v[104:107], v[228:231]
    v_mfma_f32_16x16x32_bf16 v[232:235], v[120:123], v[104:107], v[232:235]
    v_mfma_f32_16x16x32_bf16 v[236:239], v[124:127], v[104:107], v[236:239]
    v_mfma_f32_16x16x32_bf16 v[240:243], v[112:115], v[108:111], v[240:243]
    v_mfma_f32_16x16x32_bf16 v[244:247], v[116:119], v[108:111], v[244:247]
    v_mfma_f32_16x16x32_bf16 v[248:251], v[120:123], v[108:111], v[248:251]
    v_mfma_f32_16x16x32_bf16 v[252:255], v[124:127], v[108:111], v[252:255]
    s_waitcnt lgkmcnt(12)
    v_mfma_f32_16x16x32_bf16 v[128:131], v[64:67], v[32:35], v[128:131]
    ds_read_b64_tr_b16 v[112:113], v20 offset:8192
    s_waitcnt lgkmcnt(11)
    v_mfma_f32_16x16x32_bf16 v[132:135], v[68:71], v[32:35], v[132:135]
    ds_read_b64_tr_b16 v[114:115], v20 offset:9216
    s_waitcnt lgkmcnt(10)
    v_mfma_f32_16x16x32_bf16 v[136:139], v[72:75], v[32:35], v[136:139]
    s_waitcnt lgkmcnt(8)
    v_mfma_f32_16x16x32_bf16 v[140:143], v[76:79], v[32:35], v[140:143]
    ds_read_b128 v[80:83], v15 offset:0
    v_mfma_f32_16x16x32_bf16 v[144:147], v[64:67], v[36:39], v[144:147]
    ds_read_b64_tr_b16 v[116:117], v21 offset:8192
    v_mfma_f32_16x16x32_bf16 v[148:151], v[68:71], v[36:39], v[148:151]
    v_mfma_f32_16x16x32_bf16 v[152:155], v[72:75], v[36:39], v[152:155]
    ds_read_b64_tr_b16 v[118:119], v21 offset:9216
    v_mfma_f32_16x16x32_bf16 v[156:159], v[76:79], v[36:39], v[156:159]
    ds_read_b64_tr_b16 v[120:121], v22 offset:8192
    s_waitcnt lgkmcnt(10)
    v_mfma_f32_16x16x32_bf16 v[160:163], v[64:67], v[40:43], v[160:163]
    v_mfma_f32_16x16x32_bf16 v[164:167], v[68:71], v[40:43], v[164:167]
    ds_read_b64_tr_b16 v[122:123], v22 offset:9216
    v_mfma_f32_16x16x32_bf16 v[168:171], v[72:75], v[40:43], v[168:171]
    ds_read_b64_tr_b16 v[124:125], v23 offset:8192
    v_mfma_f32_16x16x32_bf16 v[172:175], v[76:79], v[40:43], v[172:175]
    v_mfma_f32_16x16x32_bf16 v[176:179], v[64:67], v[44:47], v[176:179]
    ds_read_b64_tr_b16 v[126:127], v23 offset:9216
    v_mfma_f32_16x16x32_bf16 v[180:183], v[68:71], v[44:47], v[180:183]
    ds_read_b128 v[84:87], v15 offset:2048
    v_mfma_f32_16x16x32_bf16 v[184:187], v[72:75], v[44:47], v[184:187]
    v_mfma_f32_16x16x32_bf16 v[188:191], v[76:79], v[44:47], v[188:191]
    ds_read_b128 v[88:91], v15 offset:4096
    s_waitcnt lgkmcnt(13)
    v_mfma_f32_16x16x32_bf16 v[192:195], v[64:67], v[48:51], v[192:195]
    ds_read_b128 v[92:95], v15 offset:6144
    v_mfma_f32_16x16x32_bf16 v[196:199], v[68:71], v[48:51], v[196:199]
    v_mfma_f32_16x16x32_bf16 v[200:203], v[72:75], v[48:51], v[200:203]
    ds_read_b128 v[96:99], v15 offset:8192
    v_mfma_f32_16x16x32_bf16 v[204:207], v[76:79], v[48:51], v[204:207]
    ds_read_b128 v[100:103], v15 offset:10240
    v_mfma_f32_16x16x32_bf16 v[208:211], v[64:67], v[52:55], v[208:211]
    v_mfma_f32_16x16x32_bf16 v[212:215], v[68:71], v[52:55], v[212:215]
    ds_read_b128 v[104:107], v15 offset:12288
    v_mfma_f32_16x16x32_bf16 v[216:219], v[72:75], v[52:55], v[216:219]
    ds_read_b128 v[108:111], v15 offset:14336
    v_mfma_f32_16x16x32_bf16 v[220:223], v[76:79], v[52:55], v[220:223]
    s_waitcnt lgkmcnt(15)
    v_mfma_f32_16x16x32_bf16 v[224:227], v[64:67], v[56:59], v[224:227]
    v_mfma_f32_16x16x32_bf16 v[228:231], v[68:71], v[56:59], v[228:231]
    v_mfma_f32_16x16x32_bf16 v[232:235], v[72:75], v[56:59], v[232:235]
    v_mfma_f32_16x16x32_bf16 v[236:239], v[76:79], v[56:59], v[236:239]
    v_mfma_f32_16x16x32_bf16 v[240:243], v[64:67], v[60:63], v[240:243]
    v_mfma_f32_16x16x32_bf16 v[244:247], v[68:71], v[60:63], v[244:247]
    v_mfma_f32_16x16x32_bf16 v[248:251], v[72:75], v[60:63], v[248:251]
    v_mfma_f32_16x16x32_bf16 v[252:255], v[76:79], v[60:63], v[252:255]
    s_waitcnt vmcnt(0) lgkmcnt(0)
    s_barrier
    v_mfma_f32_16x16x32_bf16 v[128:131], v[112:115], v[80:83], v[128:131]
    ds_read_b64_tr_b16 v[64:65], v16 offset:0
    v_mfma_f32_16x16x32_bf16 v[132:135], v[116:119], v[80:83], v[132:135]
    ds_read_b64_tr_b16 v[66:67], v16 offset:1024
    s_add_u32 m0, s36, 65536
    s_nop 0
    buffer_load_dwordx4 v5, s[64:67], s32 offen offset:0 lds
    v_mfma_f32_16x16x32_bf16 v[136:139], v[120:123], v[80:83], v[136:139]
    v_mfma_f32_16x16x32_bf16 v[140:143], v[124:127], v[80:83], v[140:143]
    ds_read_b128 v[32:35], v12 offset:0
    v_mfma_f32_16x16x32_bf16 v[144:147], v[112:115], v[84:87], v[144:147]
    ds_read_b64_tr_b16 v[68:69], v17 offset:0
    buffer_load_dwordx4 v6, s[64:67], s32 offen offset:1024 lds
    v_mfma_f32_16x16x32_bf16 v[148:151], v[116:119], v[84:87], v[148:151]
    v_mfma_f32_16x16x32_bf16 v[152:155], v[120:123], v[84:87], v[152:155]
    ds_read_b64_tr_b16 v[70:71], v17 offset:1024
    v_mfma_f32_16x16x32_bf16 v[156:159], v[124:127], v[84:87], v[156:159]
    ds_read_b64_tr_b16 v[72:73], v18 offset:0
    buffer_load_dwordx4 v7, s[64:67], s32 offen offset:2048 lds
    v_mfma_f32_16x16x32_bf16 v[160:163], v[112:115], v[88:91], v[160:163]
    v_mfma_f32_16x16x32_bf16 v[164:167], v[116:119], v[88:91], v[164:167]
    ds_read_b64_tr_b16 v[74:75], v18 offset:1024
    v_mfma_f32_16x16x32_bf16 v[168:171], v[120:123], v[88:91], v[168:171]
    ds_read_b64_tr_b16 v[76:77], v19 offset:0
    buffer_load_dwordx4 v30, s[64:67], s32 offen offset:3072 lds
    s_add_u32 s32, s32, 128
    v_mfma_f32_16x16x32_bf16 v[172:175], v[124:127], v[88:91], v[172:175]
    v_mfma_f32_16x16x32_bf16 v[176:179], v[112:115], v[92:95], v[176:179]
    ds_read_b64_tr_b16 v[78:79], v19 offset:1024
    v_mfma_f32_16x16x32_bf16 v[180:183], v[116:119], v[92:95], v[180:183]
    ds_read_b128 v[36:39], v12 offset:2048
    s_add_u32 m0, s37, 65536
    s_nop 0
    buffer_load_dwordx4 v8, s[68:71], s33 offen offset:0 lds
    v_mfma_f32_16x16x32_bf16 v[184:187], v[120:123], v[92:95], v[184:187]
    v_mfma_f32_16x16x32_bf16 v[188:191], v[124:127], v[92:95], v[188:191]
    ds_read_b128 v[40:43], v12 offset:4096
    v_mfma_f32_16x16x32_bf16 v[192:195], v[112:115], v[96:99], v[192:195]
    ds_read_b128 v[44:47], v12 offset:6144
    buffer_load_dwordx4 v9, s[68:71], s33 offen offset:1024 lds
    v_mfma_f32_16x16x32_bf16 v[196:199], v[116:119], v[96:99], v[196:199]
    v_mfma_f32_16x16x32_bf16 v[200:203], v[120:123], v[96:99], v[200:203]
    ds_read_b128 v[48:51], v12 offset:8192
    v_mfma_f32_16x16x32_bf16 v[204:207], v[124:127], v[96:99], v[204:207]
    ds_read_b128 v[52:55], v12 offset:10240
    buffer_load_dwordx4 v10, s[68:71], s33 offen offset:2048 lds
    v_mfma_f32_16x16x32_bf16 v[208:211], v[112:115], v[100:103], v[208:211]
    v_mfma_f32_16x16x32_bf16 v[212:215], v[116:119], v[100:103], v[212:215]
    ds_read_b128 v[56:59], v12 offset:12288
    v_mfma_f32_16x16x32_bf16 v[216:219], v[120:123], v[100:103], v[216:219]
    ds_read_b128 v[60:63], v12 offset:14336
    buffer_load_dwordx4 v11, s[68:71], s33 offen offset:3072 lds
    s_add_u32 s33, s33, 524288
    v_mfma_f32_16x16x32_bf16 v[220:223], v[124:127], v[100:103], v[220:223]
    v_mfma_f32_16x16x32_bf16 v[224:227], v[112:115], v[104:107], v[224:227]
    v_mfma_f32_16x16x32_bf16 v[228:231], v[116:119], v[104:107], v[228:231]
    v_mfma_f32_16x16x32_bf16 v[232:235], v[120:123], v[104:107], v[232:235]
    v_mfma_f32_16x16x32_bf16 v[236:239], v[124:127], v[104:107], v[236:239]
    v_mfma_f32_16x16x32_bf16 v[240:243], v[112:115], v[108:111], v[240:243]
    v_mfma_f32_16x16x32_bf16 v[244:247], v[116:119], v[108:111], v[244:247]
    v_mfma_f32_16x16x32_bf16 v[248:251], v[120:123], v[108:111], v[248:251]
    v_mfma_f32_16x16x32_bf16 v[252:255], v[124:127], v[108:111], v[252:255]
    s_waitcnt lgkmcnt(12)
    v_mfma_f32_16x16x32_bf16 v[128:131], v[64:67], v[32:35], v[128:131]
    ds_read_b64_tr_b16 v[112:113], v16 offset:8192
    s_waitcnt lgkmcnt(11)
    v_mfma_f32_16x16x32_bf16 v[132:135], v[68:71], v[32:35], v[132:135]
    ds_read_b64_tr_b16 v[114:115], v16 offset:9216
    s_waitcnt lgkmcnt(10)
    v_mfma_f32_16x16x32_bf16 v[136:139], v[72:75], v[32:35], v[136:139]
    s_waitcnt lgkmcnt(8)
    v_mfma_f32_16x16x32_bf16 v[140:143], v[76:79], v[32:35], v[140:143]
    ds_read_b128 v[80:83], v13 offset:0
    v_mfma_f32_16x16x32_bf16 v[144:147], v[64:67], v[36:39], v[144:147]
    ds_read_b64_tr_b16 v[116:117], v17 offset:8192
    v_bfe_u32 v29, v1, 1, 2
    v_and_b32 v31, 1, v3
    v_mfma_f32_16x16x32_bf16 v[148:151], v[68:71], v[36:39], v[148:151]
    v_xor_b32 v29, v29, v31
    v_xor_b32 v29, 0, v29
    v_mfma_f32_16x16x32_bf16 v[152:155], v[72:75], v[36:39], v[152:155]
    ds_read_b64_tr_b16 v[118:119], v17 offset:9216
    v_lshlrev_b32 v29, 5, v29
    v_and_b32 v31, 1, v1
    v_mfma_f32_16x16x32_bf16 v[156:159], v[76:79], v[36:39], v[156:159]
    ds_read_b64_tr_b16 v[120:121], v18 offset:8192
    v_lshl_add_u32 v29, v31, 4, v29
    v_lshrrev_b32 v31, 3, v1
    s_waitcnt lgkmcnt(10)
    v_mfma_f32_16x16x32_bf16 v[160:163], v[64:67], v[40:43], v[160:163]
    v_add_u32 v31, 0, v31
    v_mul_u32_u24 v31, 3456, v31
    v_mfma_f32_16x16x32_bf16 v[164:167], v[68:71], v[40:43], v[164:167]
    ds_read_b64_tr_b16 v[122:123], v18 offset:9216
    v_add_u32 v8, v31, v29
    v_subrev_u32 v8, 0, v8
    v_mfma_f32_16x16x32_bf16 v[168:171], v[72:75], v[40:43], v[168:171]
    ds_read_b64_tr_b16 v[124:125], v19 offset:8192
    v_bfe_u32 v29, v1, 1, 2
    v_mfma_f32_16x16x32_bf16 v[172:175], v[76:79], v[40:43], v[172:175]
    v_and_b32 v31, 1, v3
    v_xor_b32 v29, v29, v31
    v_mfma_f32_16x16x32_bf16 v[176:179], v[64:67], v[44:47], v[176:179]
    ds_read_b64_tr_b16 v[126:127], v19 offset:9216
    v_xor_b32 v29, 2, v29
    v_lshlrev_b32 v29, 5, v29
    v_mfma_f32_16x16x32_bf16 v[180:183], v[68:71], v[44:47], v[180:183]
    ds_read_b128 v[84:87], v13 offset:2048
    v_and_b32 v31, 1, v1
    v_lshl_add_u32 v29, v31, 4, v29
    v_mfma_f32_16x16x32_bf16 v[184:187], v[72:75], v[44:47], v[184:187]
    v_lshrrev_b32 v31, 3, v1
    v_add_u32 v31, 8, v31
    v_mfma_f32_16x16x32_bf16 v[188:191], v[76:79], v[44:47], v[188:191]
    ds_read_b128 v[88:91], v13 offset:4096
    v_mul_u32_u24 v31, 3456, v31
    v_add_u32 v9, v31, v29
    s_waitcnt lgkmcnt(13)
    v_mfma_f32_16x16x32_bf16 v[192:195], v[64:67], v[48:51], v[192:195]
    ds_read_b128 v[92:95], v13 offset:6144
    v_subrev_u32 v9, 1024, v9
    v_mfma_f32_16x16x32_bf16 v[196:199], v[68:71], v[48:51], v[196:199]
    v_bfe_u32 v29, v1, 1, 2
    v_and_b32 v31, 1, v3
    v_mfma_f32_16x16x32_bf16 v[200:203], v[72:75], v[48:51], v[200:203]
    ds_read_b128 v[96:99], v13 offset:8192
    v_xor_b32 v29, v29, v31
    v_xor_b32 v29, 0, v29
    v_mfma_f32_16x16x32_bf16 v[204:207], v[76:79], v[48:51], v[204:207]
    ds_read_b128 v[100:103], v13 offset:10240
    v_lshlrev_b32 v29, 5, v29
    v_and_b32 v31, 1, v1
    v_mfma_f32_16x16x32_bf16 v[208:211], v[64:67], v[52:55], v[208:211]
    v_lshl_add_u32 v29, v31, 4, v29
    v_lshrrev_b32 v31, 3, v1
    v_mfma_f32_16x16x32_bf16 v[212:215], v[68:71], v[52:55], v[212:215]
    ds_read_b128 v[104:107], v13 offset:12288
    v_add_u32 v31, 16, v31
    v_mul_u32_u24 v31, 3456, v31
    v_mfma_f32_16x16x32_bf16 v[216:219], v[72:75], v[52:55], v[216:219]
    ds_read_b128 v[108:111], v13 offset:14336
    v_add_u32 v10, v31, v29
    v_subrev_u32 v10, 2048, v10
    v_mfma_f32_16x16x32_bf16 v[220:223], v[76:79], v[52:55], v[220:223]
    v_bfe_u32 v29, v1, 1, 2
    s_waitcnt lgkmcnt(15)
    v_mfma_f32_16x16x32_bf16 v[224:227], v[64:67], v[56:59], v[224:227]
    v_and_b32 v31, 1, v3
    v_xor_b32 v29, v29, v31
    v_mfma_f32_16x16x32_bf16 v[228:231], v[68:71], v[56:59], v[228:231]
    v_xor_b32 v29, 2, v29
    v_lshlrev_b32 v29, 5, v29
    v_mfma_f32_16x16x32_bf16 v[232:235], v[72:75], v[56:59], v[232:235]
    v_and_b32 v31, 1, v1
    v_lshl_add_u32 v29, v31, 4, v29
    v_mfma_f32_16x16x32_bf16 v[236:239], v[76:79], v[56:59], v[236:239]
    v_lshrrev_b32 v31, 3, v1
    v_add_u32 v31, 24, v31
    v_mfma_f32_16x16x32_bf16 v[240:243], v[64:67], v[60:63], v[240:243]
    v_mul_u32_u24 v31, 3456, v31
    v_add_u32 v11, v31, v29
    v_mfma_f32_16x16x32_bf16 v[244:247], v[68:71], v[60:63], v[244:247]
    v_subrev_u32 v11, 3072, v11
    v_mfma_f32_16x16x32_bf16 v[248:251], v[72:75], v[60:63], v[248:251]
    v_mfma_f32_16x16x32_bf16 v[252:255], v[76:79], v[60:63], v[252:255]
    s_waitcnt vmcnt(0) lgkmcnt(0)
    s_barrier
    v_mfma_f32_16x16x32_bf16 v[128:131], v[112:115], v[80:83], v[128:131]
    ds_read_b64_tr_b16 v[64:65], v20 offset:0
    v_mfma_f32_16x16x32_bf16 v[132:135], v[116:119], v[80:83], v[132:135]
    ds_read_b64_tr_b16 v[66:67], v20 offset:1024
    s_add_u32 m0, s36, 0
    s_nop 0
    buffer_load_dwordx4 v24, s[60:63], s34 offen offset:0 lds
    v_mfma_f32_16x16x32_bf16 v[136:139], v[120:123], v[80:83], v[136:139]
    v_mfma_f32_16x16x32_bf16 v[140:143], v[124:127], v[80:83], v[140:143]
    ds_read_b128 v[32:35], v14 offset:0
    v_mfma_f32_16x16x32_bf16 v[144:147], v[112:115], v[84:87], v[144:147]
    ds_read_b64_tr_b16 v[68:69], v21 offset:0
    buffer_load_dwordx4 v25, s[60:63], s34 offen offset:1024 lds
    v_mfma_f32_16x16x32_bf16 v[148:151], v[116:119], v[84:87], v[148:151]
    v_mfma_f32_16x16x32_bf16 v[152:155], v[120:123], v[84:87], v[152:155]
    ds_read_b64_tr_b16 v[70:71], v21 offset:1024
    v_mfma_f32_16x16x32_bf16 v[156:159], v[124:127], v[84:87], v[156:159]
    ds_read_b64_tr_b16 v[72:73], v22 offset:0
    buffer_load_dwordx4 v26, s[60:63], s34 offen offset:2048 lds
    v_mfma_f32_16x16x32_bf16 v[160:163], v[112:115], v[88:91], v[160:163]
    v_mfma_f32_16x16x32_bf16 v[164:167], v[116:119], v[88:91], v[164:167]
    ds_read_b64_tr_b16 v[74:75], v22 offset:1024
    v_mfma_f32_16x16x32_bf16 v[168:171], v[120:123], v[88:91], v[168:171]
    ds_read_b64_tr_b16 v[76:77], v23 offset:0
    buffer_load_dwordx4 v27, s[60:63], s34 offen offset:3072 lds
    s_add_u32 s34, s34, 128
    v_mfma_f32_16x16x32_bf16 v[172:175], v[124:127], v[88:91], v[172:175]
    v_mfma_f32_16x16x32_bf16 v[176:179], v[112:115], v[92:95], v[176:179]
    ds_read_b64_tr_b16 v[78:79], v23 offset:1024
    v_mfma_f32_16x16x32_bf16 v[180:183], v[116:119], v[92:95], v[180:183]
    ds_read_b128 v[36:39], v14 offset:2048
    s_add_u32 m0, s37, 0
    s_nop 0
    buffer_load_dwordx4 v8, s[72:75], s35 offen offset:0 lds
    v_mfma_f32_16x16x32_bf16 v[184:187], v[120:123], v[92:95], v[184:187]
    v_mfma_f32_16x16x32_bf16 v[188:191], v[124:127], v[92:95], v[188:191]
    ds_read_b128 v[40:43], v14 offset:4096
    v_mfma_f32_16x16x32_bf16 v[192:195], v[112:115], v[96:99], v[192:195]
    ds_read_b128 v[44:47], v14 offset:6144
    buffer_load_dwordx4 v9, s[72:75], s35 offen offset:1024 lds
    v_mfma_f32_16x16x32_bf16 v[196:199], v[116:119], v[96:99], v[196:199]
    v_mfma_f32_16x16x32_bf16 v[200:203], v[120:123], v[96:99], v[200:203]
    ds_read_b128 v[48:51], v14 offset:8192
    v_mfma_f32_16x16x32_bf16 v[204:207], v[124:127], v[96:99], v[204:207]
    ds_read_b128 v[52:55], v14 offset:10240
    buffer_load_dwordx4 v10, s[72:75], s35 offen offset:2048 lds
    v_mfma_f32_16x16x32_bf16 v[208:211], v[112:115], v[100:103], v[208:211]
    v_mfma_f32_16x16x32_bf16 v[212:215], v[116:119], v[100:103], v[212:215]
    ds_read_b128 v[56:59], v14 offset:12288
    v_mfma_f32_16x16x32_bf16 v[216:219], v[120:123], v[100:103], v[216:219]
    ds_read_b128 v[60:63], v14 offset:14336
    buffer_load_dwordx4 v11, s[72:75], s35 offen offset:3072 lds
    s_add_u32 s35, s35, 221184
    v_mfma_f32_16x16x32_bf16 v[220:223], v[124:127], v[100:103], v[220:223]
    v_mfma_f32_16x16x32_bf16 v[224:227], v[112:115], v[104:107], v[224:227]
    v_mfma_f32_16x16x32_bf16 v[228:231], v[116:119], v[104:107], v[228:231]
    v_mfma_f32_16x16x32_bf16 v[232:235], v[120:123], v[104:107], v[232:235]
    v_mfma_f32_16x16x32_bf16 v[236:239], v[124:127], v[104:107], v[236:239]
    v_mfma_f32_16x16x32_bf16 v[240:243], v[112:115], v[108:111], v[240:243]
    v_mfma_f32_16x16x32_bf16 v[244:247], v[116:119], v[108:111], v[244:247]
    v_mfma_f32_16x16x32_bf16 v[248:251], v[120:123], v[108:111], v[248:251]
    v_mfma_f32_16x16x32_bf16 v[252:255], v[124:127], v[108:111], v[252:255]
    s_waitcnt lgkmcnt(12)
    v_mfma_f32_16x16x32_bf16 v[128:131], v[64:67], v[32:35], v[128:131]
    ds_read_b64_tr_b16 v[112:113], v20 offset:8192
    s_waitcnt lgkmcnt(11)
    v_mfma_f32_16x16x32_bf16 v[132:135], v[68:71], v[32:35], v[132:135]
    ds_read_b64_tr_b16 v[114:115], v20 offset:9216
    s_waitcnt lgkmcnt(10)
    v_mfma_f32_16x16x32_bf16 v[136:139], v[72:75], v[32:35], v[136:139]
    s_waitcnt lgkmcnt(8)
    v_mfma_f32_16x16x32_bf16 v[140:143], v[76:79], v[32:35], v[140:143]
    ds_read_b128 v[80:83], v15 offset:0
    v_mfma_f32_16x16x32_bf16 v[144:147], v[64:67], v[36:39], v[144:147]
    ds_read_b64_tr_b16 v[116:117], v21 offset:8192
    v_mfma_f32_16x16x32_bf16 v[148:151], v[68:71], v[36:39], v[148:151]
    v_mfma_f32_16x16x32_bf16 v[152:155], v[72:75], v[36:39], v[152:155]
    ds_read_b64_tr_b16 v[118:119], v21 offset:9216
    v_mfma_f32_16x16x32_bf16 v[156:159], v[76:79], v[36:39], v[156:159]
    ds_read_b64_tr_b16 v[120:121], v22 offset:8192
    s_waitcnt lgkmcnt(10)
    v_mfma_f32_16x16x32_bf16 v[160:163], v[64:67], v[40:43], v[160:163]
    v_mfma_f32_16x16x32_bf16 v[164:167], v[68:71], v[40:43], v[164:167]
    ds_read_b64_tr_b16 v[122:123], v22 offset:9216
    v_mfma_f32_16x16x32_bf16 v[168:171], v[72:75], v[40:43], v[168:171]
    ds_read_b64_tr_b16 v[124:125], v23 offset:8192
    v_mfma_f32_16x16x32_bf16 v[172:175], v[76:79], v[40:43], v[172:175]
    v_mfma_f32_16x16x32_bf16 v[176:179], v[64:67], v[44:47], v[176:179]
    ds_read_b64_tr_b16 v[126:127], v23 offset:9216
    v_mfma_f32_16x16x32_bf16 v[180:183], v[68:71], v[44:47], v[180:183]
    ds_read_b128 v[84:87], v15 offset:2048
    v_mfma_f32_16x16x32_bf16 v[184:187], v[72:75], v[44:47], v[184:187]
    v_mfma_f32_16x16x32_bf16 v[188:191], v[76:79], v[44:47], v[188:191]
    ds_read_b128 v[88:91], v15 offset:4096
    s_waitcnt lgkmcnt(13)
    v_mfma_f32_16x16x32_bf16 v[192:195], v[64:67], v[48:51], v[192:195]
    ds_read_b128 v[92:95], v15 offset:6144
    v_mfma_f32_16x16x32_bf16 v[196:199], v[68:71], v[48:51], v[196:199]
    v_mfma_f32_16x16x32_bf16 v[200:203], v[72:75], v[48:51], v[200:203]
    ds_read_b128 v[96:99], v15 offset:8192
    v_mfma_f32_16x16x32_bf16 v[204:207], v[76:79], v[48:51], v[204:207]
    ds_read_b128 v[100:103], v15 offset:10240
    v_mfma_f32_16x16x32_bf16 v[208:211], v[64:67], v[52:55], v[208:211]
    v_mfma_f32_16x16x32_bf16 v[212:215], v[68:71], v[52:55], v[212:215]
    ds_read_b128 v[104:107], v15 offset:12288
    v_mfma_f32_16x16x32_bf16 v[216:219], v[72:75], v[52:55], v[216:219]
    ds_read_b128 v[108:111], v15 offset:14336
    v_mfma_f32_16x16x32_bf16 v[220:223], v[76:79], v[52:55], v[220:223]
    s_waitcnt lgkmcnt(15)
    v_mfma_f32_16x16x32_bf16 v[224:227], v[64:67], v[56:59], v[224:227]
    s_lshl_b32 s40, s6, 19
    s_add_u32 s40, s40, 0x0
    v_mfma_f32_16x16x32_bf16 v[228:231], v[68:71], v[56:59], v[228:231]
    s_lshl_b32 s24, s7, 16
    v_mfma_f32_16x16x32_bf16 v[232:235], v[72:75], v[56:59], v[232:235]
    s_add_u32 s40, s40, s24
    s_lshr_b32 s24, s3, 1
    v_mfma_f32_16x16x32_bf16 v[236:239], v[76:79], v[56:59], v[236:239]
    s_lshl_b32 s24, s24, 15
    v_mfma_f32_16x16x32_bf16 v[240:243], v[64:67], v[60:63], v[240:243]
    s_add_u32 s40, s40, s24
    s_and_b32 s24, s3, 1
    v_mfma_f32_16x16x32_bf16 v[244:247], v[68:71], v[60:63], v[244:247]
    s_lshl_b32 s24, s24, 11
    v_mfma_f32_16x16x32_bf16 v[248:251], v[72:75], v[60:63], v[248:251]
    s_add_u32 s40, s40, s24
    v_mfma_f32_16x16x32_bf16 v[252:255], v[76:79], v[60:63], v[252:255]
    s_waitcnt vmcnt(0) lgkmcnt(0)
    s_barrier
    s_and_b32 s25, s3, 1
    s_lshl_b32 s25, s25, 1
    v_lshrrev_b32 v29, 3, v2
    v_and_b32 v31, 1, v3
    v_lshl_add_u32 v29, v31, 1, v29
    v_xor_b32 v29, s25, v29
    v_lshrrev_b32 v31, 2, v2
    v_lshl_add_u32 v31, v3, 3, v31
    v_lshlrev_b32 v31, 7, v31
    v_and_b32 v17, 3, v2
    v_lshl_add_u32 v31, v17, 3, v31
    v_add_u32 v31, 0x8000, v31
    v_lshl_add_u32 v16, v29, 5, v31
    v_xor_b32 v29, 1, v29
    v_lshl_add_u32 v17, v29, 5, v31
    v_mfma_f32_16x16x32_bf16 v[240:243], v[112:115], v[108:111], v[240:243]
    v_mfma_f32_16x16x32_bf16 v[244:247], v[116:119], v[108:111], v[244:247]
    s_add_u32 m0, s36, 65536
    s_nop 0
    buffer_load_dwordx4 v24, s[60:63], s34 offen offset:0 lds
    v_mfma_f32_16x16x32_bf16 v[248:251], v[120:123], v[108:111], v[248:251]
    ds_read_b64_tr_b16 v[32:33], v16 offset:0
    v_mfma_f32_16x16x32_bf16 v[252:255], v[124:127], v[108:111], v[252:255]
    ds_read_b64_tr_b16 v[34:35], v16 offset:512
    v_mfma_f32_16x16x32_bf16 v[224:227], v[112:115], v[104:107], v[224:227]
    buffer_load_dwordx4 v25, s[60:63], s34 offen offset:1024 lds
    v_mfma_f32_16x16x32_bf16 v[228:231], v[116:119], v[104:107], v[228:231]
    ds_read_b128 v[64:67], v12 offset:0
    v_mfma_f32_16x16x32_bf16 v[232:235], v[120:123], v[104:107], v[232:235]
    v_mfma_f32_16x16x32_bf16 v[236:239], v[124:127], v[104:107], v[236:239]
    buffer_load_dwordx4 v26, s[60:63], s34 offen offset:2048 lds
    ds_read_b64_tr_b16 v[36:37], v17 offset:0
    v_mfma_f32_16x16x32_bf16 v[208:211], v[112:115], v[100:103], v[208:211]
    v_mfma_f32_16x16x32_bf16 v[212:215], v[116:119], v[100:103], v[212:215]
    ds_read_b64_tr_b16 v[38:39], v17 offset:512
    v_mfma_f32_16x16x32_bf16 v[216:219], v[120:123], v[100:103], v[216:219]
    buffer_load_dwordx4 v27, s[60:63], s34 offen offset:3072 lds
    s_add_u32 s34, s34, 128
    v_mfma_f32_16x16x32_bf16 v[220:223], v[124:127], v[100:103], v[220:223]
    ds_read_b64_tr_b16 v[40:41], v16 offset:8192
    v_mfma_f32_16x16x32_bf16 v[192:195], v[112:115], v[96:99], v[192:195]
    v_mfma_f32_16x16x32_bf16 v[196:199], v[116:119], v[96:99], v[196:199]
    s_add_u32 m0, s37, 65536
    s_nop 0
    buffer_load_dwordx4 v8, s[72:75], s35 offen offset:0 lds
    ds_read_b64_tr_b16 v[42:43], v16 offset:8704
    v_mfma_f32_16x16x32_bf16 v[200:203], v[120:123], v[96:99], v[200:203]
    ds_read_b64_tr_b16 v[44:45], v17 offset:8192
    v_mfma_f32_16x16x32_bf16 v[204:207], v[124:127], v[96:99], v[204:207]
    v_mfma_f32_16x16x32_bf16 v[176:179], v[112:115], v[92:95], v[176:179]
    buffer_load_dwordx4 v9, s[72:75], s35 offen offset:1024 lds
    ds_read_b64_tr_b16 v[46:47], v17 offset:8704
    v_mfma_f32_16x16x32_bf16 v[180:183], v[116:119], v[92:95], v[180:183]
    v_mfma_f32_16x16x32_bf16 v[184:187], v[120:123], v[92:95], v[184:187]
    ds_read_b128 v[68:71], v12 offset:2048
    v_mfma_f32_16x16x32_bf16 v[188:191], v[124:127], v[92:95], v[188:191]
    buffer_load_dwordx4 v10, s[72:75], s35 offen offset:2048 lds
    v_mfma_f32_16x16x32_bf16 v[160:163], v[112:115], v[88:91], v[160:163]
    s_and_b32 s25, s3, 1
    s_lshl_b32 s25, s25, 1
    ds_read_b128 v[72:75], v12 offset:4096
    v_mfma_f32_16x16x32_bf16 v[164:167], v[116:119], v[88:91], v[164:167]
    v_lshrrev_b32 v29, 3, v2
    v_mfma_f32_16x16x32_bf16 v[168:171], v[120:123], v[88:91], v[168:171]
    buffer_load_dwordx4 v11, s[72:75], s35 offen offset:3072 lds
    s_add_u32 s35, s35, 221184
    v_and_b32 v31, 1, v3
    v_lshl_add_u32 v29, v31, 1, v29
    ds_read_b128 v[76:79], v12 offset:6144
    v_mfma_f32_16x16x32_bf16 v[172:175], v[124:127], v[88:91], v[172:175]
    v_xor_b32 v29, s25, v29
    v_mfma_f32_16x16x32_bf16 v[144:147], v[112:115], v[84:87], v[144:147]
    v_lshrrev_b32 v31, 2, v2
    v_mfma_f32_16x16x32_bf16 v[148:151], v[116:119], v[84:87], v[148:151]
    v_lshl_add_u32 v31, v3, 3, v31
    v_lshlrev_b32 v31, 7, v31
    v_mfma_f32_16x16x32_bf16 v[152:155], v[120:123], v[84:87], v[152:155]
    v_and_b32 v21, 3, v2
    v_mfma_f32_16x16x32_bf16 v[156:159], v[124:127], v[84:87], v[156:159]
    v_lshl_add_u32 v31, v21, 3, v31
    v_mfma_f32_16x16x32_bf16 v[128:131], v[112:115], v[80:83], v[128:131]
    v_add_u32 v31, 0x18000, v31
    v_lshl_add_u32 v20, v29, 5, v31
    v_mfma_f32_16x16x32_bf16 v[132:135], v[116:119], v[80:83], v[132:135]
    v_xor_b32 v29, 1, v29
    v_mfma_f32_16x16x32_bf16 v[136:139], v[120:123], v[80:83], v[136:139]
    v_lshl_add_u32 v21, v29, 5, v31
    v_mfma_f32_16x16x32_bf16 v[140:143], v[124:127], v[80:83], v[140:143]
    s_waitcnt lgkmcnt(8)
    v_mfma_f32_16x16x32_bf16 v[80:83], v[32:35], v[64:67], 0
    v_cvt_pk_bf16_f32 v255, v254, v255
    v_cvt_pk_bf16_f32 v254, v252, v253
    v_cvt_pk_bf16_f32 v253, v250, v251
    v_cvt_pk_bf16_f32 v252, v248, v249
    v_cvt_pk_bf16_f32 v251, v246, v247
    v_cvt_pk_bf16_f32 v250, v244, v245
    s_waitcnt lgkmcnt(6)
    v_mfma_f32_16x16x32_bf16 v[84:87], v[36:39], v[64:67], 0
    v_cvt_pk_bf16_f32 v249, v242, v243
    v_cvt_pk_bf16_f32 v248, v240, v241
    v_cvt_pk_bf16_f32 v247, v238, v239
    v_cvt_pk_bf16_f32 v246, v236, v237
    v_cvt_pk_bf16_f32 v245, v234, v235
    v_cvt_pk_bf16_f32 v244, v232, v233
    s_waitcnt lgkmcnt(4)
    v_mfma_f32_16x16x32_bf16 v[88:91], v[40:43], v[64:67], 0
    v_cvt_pk_bf16_f32 v243, v230, v231
    v_cvt_pk_bf16_f32 v242, v228, v229
    v_cvt_pk_bf16_f32 v241, v226, v227
    v_cvt_pk_bf16_f32 v240, v224, v225
    v_cvt_pk_bf16_f32 v239, v222, v223
    v_cvt_pk_bf16_f32 v238, v220, v221
    s_waitcnt lgkmcnt(2)
    v_mfma_f32_16x16x32_bf16 v[92:95], v[44:47], v[64:67], 0
    ds_read_b128 v[64:67], v12 offset:8192
    v_cvt_pk_bf16_f32 v237, v218, v219
    v_cvt_pk_bf16_f32 v236, v216, v217
    v_cvt_pk_bf16_f32 v235, v214, v215
    v_cvt_pk_bf16_f32 v234, v212, v213
    v_cvt_pk_bf16_f32 v233, v210, v211
    v_cvt_pk_bf16_f32 v232, v208, v209
    v_mfma_f32_16x16x32_bf16 v[96:99], v[32:35], v[68:71], 0
    v_cvt_pk_bf16_f32 v231, v206, v207
    v_cvt_pk_bf16_f32 v230, v204, v205
    v_cvt_pk_bf16_f32 v229, v202, v203
    v_cvt_pk_bf16_f32 v228, v200, v201
    v_cvt_pk_bf16_f32 v227, v198, v199
    v_cvt_pk_bf16_f32 v226, v196, v197
    v_mfma_f32_16x16x32_bf16 v[100:103], v[36:39], v[68:71], 0
    ds_read_b64_tr_b16 v[48:49], v16 offset:4096
    v_cvt_pk_bf16_f32 v225, v194, v195
    v_cvt_pk_bf16_f32 v224, v192, v193
    v_cvt_pk_bf16_f32 v223, v190, v191
    v_cvt_pk_bf16_f32 v222, v188, v189
    v_cvt_pk_bf16_f32 v221, v186, v187
    v_mfma_f32_16x16x32_bf16 v[104:107], v[40:43], v[68:71], 0
    v_cvt_pk_bf16_f32 v220, v184, v185
    v_cvt_pk_bf16_f32 v219, v182, v183
    v_cvt_pk_bf16_f32 v218, v180, v181
    v_cvt_pk_bf16_f32 v217, v178, v179
    v_cvt_pk_bf16_f32 v216, v176, v177
    v_cvt_pk_bf16_f32 v215, v174, v175
    v_mfma_f32_16x16x32_bf16 v[108:111], v[44:47], v[68:71], 0
    ds_read_b128 v[68:71], v12 offset:10240
    v_cvt_pk_bf16_f32 v214, v172, v173
    v_cvt_pk_bf16_f32 v213, v170, v171
    v_cvt_pk_bf16_f32 v212, v168, v169
    v_cvt_pk_bf16_f32 v211, v166, v167
    v_cvt_pk_bf16_f32 v210, v164, v165
    v_cvt_pk_bf16_f32 v209, v162, v163
    s_waitcnt lgkmcnt(3)
    v_mfma_f32_16x16x32_bf16 v[112:115], v[32:35], v[72:75], 0
    ds_read_b64_tr_b16 v[50:51], v16 offset:4608
    v_cvt_pk_bf16_f32 v208, v160, v161
    v_cvt_pk_bf16_f32 v207, v158, v159
    v_cvt_pk_bf16_f32 v206, v156, v157
    v_cvt_pk_bf16_f32 v205, v154, v155
    v_cvt_pk_bf16_f32 v204, v152, v153
    v_cvt_pk_bf16_f32 v203, v150, v151
    v_mfma_f32_16x16x32_bf16 v[116:119], v[36:39], v[72:75], 0
    v_cvt_pk_bf16_f32 v202, v148, v149
    v_cvt_pk_bf16_f32 v201, v146, v147
    v_cvt_pk_bf16_f32 v200, v144, v145
    v_cvt_pk_bf16_f32 v199, v142, v143
    v_cvt_pk_bf16_f32 v198, v140, v141
    v_cvt_pk_bf16_f32 v197, v138, v139
    v_mfma_f32_16x16x32_bf16 v[120:123], v[40:43], v[72:75], 0
    v_cvt_pk_bf16_f32 v196, v136, v137
    v_cvt_pk_bf16_f32 v195, v134, v135
    v_cvt_pk_bf16_f32 v194, v132, v133
    v_cvt_pk_bf16_f32 v193, v130, v131
    v_cvt_pk_bf16_f32 v192, v128, v129
    v_mfma_f32_16x16x32_bf16 v[124:127], v[44:47], v[72:75], 0
    ds_read_b128 v[72:75], v12 offset:12288
    ds_read_b64_tr_b16 v[52:53], v17 offset:4096
    v_mfma_f32_16x16x32_bf16 v[128:131], v[32:35], v[76:79], 0
    buffer_store_dwordx4 v[192:195], v4, s[8:11], s40 offen offset:0 sc1
    v_mfma_f32_16x16x32_bf16 v[132:135], v[36:39], v[76:79], 0
    v_mfma_f32_16x16x32_bf16 v[136:139], v[40:43], v[76:79], 0
    ds_read_b64_tr_b16 v[54:55], v17 offset:4608
    v_mfma_f32_16x16x32_bf16 v[140:143], v[44:47], v[76:79], 0
    ds_read_b128 v[76:79], v12 offset:14336
    s_waitcnt lgkmcnt(6)
    v_mfma_f32_16x16x32_bf16 v[144:147], v[32:35], v[64:67], 0
    buffer_store_dwordx4 v[196:199], v4, s[8:11], s40 offen offset:1024 sc1
    s_add_u32 s40, s40, 4096
    v_mfma_f32_16x16x32_bf16 v[148:151], v[36:39], v[64:67], 0
    ds_read_b64_tr_b16 v[56:57], v16 offset:12288
    v_mfma_f32_16x16x32_bf16 v[152:155], v[40:43], v[64:67], 0
    v_mfma_f32_16x16x32_bf16 v[156:159], v[44:47], v[64:67], 0
    ds_read_b128 v[64:67], v13 offset:0
    s_waitcnt lgkmcnt(6)
    v_mfma_f32_16x16x32_bf16 v[160:163], v[32:35], v[68:71], 0
    ds_read_b64_tr_b16 v[58:59], v16 offset:12800
    buffer_store_dwordx4 v[200:203], v4, s[8:11], s40 offen offset:0 sc1
    v_mfma_f32_16x16x32_bf16 v[164:167], v[36:39], v[68:71], 0
    v_mfma_f32_16x16x32_bf16 v[168:171], v[40:43], v[68:71], 0
    v_mfma_f32_16x16x32_bf16 v[172:175], v[44:47], v[68:71], 0
    ds_read_b128 v[68:71], v13 offset:2048
    ds_read_b64_tr_b16 v[60:61], v17 offset:12288
    s_waitcnt lgkmcnt(7)
    v_mfma_f32_16x16x32_bf16 v[176:179], v[32:35], v[72:75], 0
    buffer_store_dwordx4 v[204:207], v4, s[8:11], s40 offen offset:1024 sc1
    s_add_u32 s40, s40, 4096
    v_mfma_f32_16x16x32_bf16 v[180:183], v[36:39], v[72:75], 0
    v_mfma_f32_16x16x32_bf16 v[184:187], v[40:43], v[72:75], 0
    ds_read_b64_tr_b16 v[62:63], v17 offset:12800
    v_mfma_f32_16x16x32_bf16 v[188:191], v[44:47], v[72:75], 0
    ds_read_b128 v[72:75], v13 offset:4096
    s_waitcnt lgkmcnt(6)
    v_mfma_f32_16x16x32_bf16 v[192:195], v[32:35], v[76:79], 0
    v_mfma_f32_16x16x32_bf16 v[196:199], v[36:39], v[76:79], 0
    v_mfma_f32_16x16x32_bf16 v[200:203], v[40:43], v[76:79], 0
    s_cbranch_vccz VR1
    buffer_store_dwordx4 v[208:211], v4, s[8:11], s40 offen offset:0 sc1
VR1:
    v_mfma_f32_16x16x32_bf16 v[204:207], v[44:47], v[76:79], 0
    ds_read_b128 v[76:79], v13 offset:6144
    s_waitcnt lgkmcnt(5)
    v_mfma_f32_16x16x32_bf16 v[80:83], v[48:51], v[64:67], v[80:83]
    v_mfma_f32_16x16x32_bf16 v[84:87], v[52:55], v[64:67], v[84:87]
    v_mfma_f32_16x16x32_bf16 v[88:91], v[56:59], v[64:67], v[88:91]
    s_waitcnt lgkmcnt(1)
    v_mfma_f32_16x16x32_bf16 v[92:95], v[60:63], v[64:67], v[92:95]
    ds_read_b128 v[64:67], v13 offset:8192
    v_mfma_f32_16x16x32_bf16 v[96:99], v[48:51], v[68:71], v[96:99]
    v_mfma_f32_16x16x32_bf16 v[100:103], v[52:55], v[68:71], v[100:103]
    v_mfma_f32_16x16x32_bf16 v[104:107], v[56:59], v[68:71], v[104:107]
    s_cbranch_vccz VR2
    buffer_store_dwordx4 v[212:215], v4, s[8:11], s40 offen offset:1024 sc1
    s_add_u32 s40, s40, 4096
VR2:
    v_mfma_f32_16x16x32_bf16 v[108:111], v[60:63], v[68:71], v[108:111]
    ds_read_b128 v[68:71], v13 offset:10240
    v_mfma_f32_16x16x32_bf16 v[112:115], v[48:51], v[72:75], v[112:115]
    v_mfma_f32_16x16x32_bf16 v[116:119], v[52:55], v[72:75], v[116:119]
    v_mfma_f32_16x16x32_bf16 v[120:123], v[56:59], v[72:75], v[120:123]
    v_mfma_f32_16x16x32_bf16 v[124:127], v[60:63], v[72:75], v[124:127]
    ds_read_b128 v[72:75], v13 offset:12288
    s_waitcnt lgkmcnt(2)
    v_mfma_f32_16x16x32_bf16 v[128:131], v[48:51], v[76:79], v[128:131]
    v_mfma_f32_16x16x32_bf16 v[132:135], v[52:55], v[76:79], v[132:135]
    v_mfma_f32_16x16x32_bf16 v[136:139], v[56:59], v[76:79], v[136:139]
    s_cbranch_vccz VR3
    buffer_store_dwordx4 v[216:219], v4, s[8:11], s40 offen offset:0 sc1
VR3:
    v_mfma_f32_16x16x32_bf16 v[140:143], v[60:63], v[76:79], v[140:143]
    ds_read_b128 v[76:79], v13 offset:14336
    v_mfma_f32_16x16x32_bf16 v[144:147], v[48:51], v[64:67], v[144:147]
    v_mfma_f32_16x16x32_bf16 v[148:151], v[52:55], v[64:67], v[148:151]
    v_mfma_f32_16x16x32_bf16 v[152:155], v[56:59], v[64:67], v[152:155]
    v_mfma_f32_16x16x32_bf16 v[156:159], v[60:63], v[64:67], v[156:159]
    s_waitcnt lgkmcnt(1)
    v_mfma_f32_16x16x32_bf16 v[160:163], v[48:51], v[68:71], v[160:163]
    s_waitcnt vmcnt(7) lgkmcnt(0)
    s_cbranch_vccnz VR26
    s_waitcnt vmcnt(4)
VR26:
    s_barrier
    ds_read_b64_tr_b16 v[32:33], v20 offset:0
    ds_read_b64_tr_b16 v[34:35], v20 offset:512
    ds_read_b128 v[64:67], v14 offset:0
    v_mfma_f32_16x16x32_bf16 v[164:167], v[52:55], v[68:71], v[164:167]
    ds_read_b64_tr_b16 v[36:37], v21 offset:0
    v_mfma_f32_16x16x32_bf16 v[168:171], v[56:59], v[68:71], v[168:171]
    ds_read_b64_tr_b16 v[38:39], v21 offset:512
    s_add_u32 m0, s36, 0
    s_nop 0
    buffer_load_dwordx4 v24, s[60:63], s34 offen offset:0 lds
    v_mfma_f32_16x16x32_bf16 v[172:175], v[60:63], v[68:71], v[172:175]
    ds_read_b64_tr_b16 v[40:41], v20 offset:8192
    ds_read_b128 v[68:71], v14 offset:2048
    v_mfma_f32_16x16x32_bf16 v[176:179], v[48:51], v[72:75], v[176:179]
    ds_read_b64_tr_b16 v[42:43], v20 offset:8704
    v_mfma_f32_16x16x32_bf16 v[180:183], v[52:55], v[72:75], v[180:183]
    ds_read_b64_tr_b16 v[44:45], v21 offset:8192
    buffer_load_dwordx4 v25, s[60:63], s34 offen offset:1024 lds
    v_mfma_f32_16x16x32_bf16 v[184:187], v[56:59], v[72:75], v[184:187]
    ds_read_b64_tr_b16 v[46:47], v21 offset:8704
    v_mfma_f32_16x16x32_bf16 v[188:191], v[60:63], v[72:75], v[188:191]
    ds_read_b128 v[72:75], v14 offset:4096
    v_mfma_f32_16x16x32_bf16 v[192:195], v[48:51], v[76:79], v[192:195]
    buffer_load_dwordx4 v26, s[60:63], s34 offen offset:2048 lds
    v_mfma_f32_16x16x32_bf16 v[196:199], v[52:55], v[76:79], v[196:199]
    v_mfma_f32_16x16x32_bf16 v[200:203], v[56:59], v[76:79], v[200:203]
    v_mfma_f32_16x16x32_bf16 v[204:207], v[60:63], v[76:79], v[204:207]
    ds_read_b128 v[76:79], v14 offset:6144
    s_waitcnt lgkmcnt(8)
    v_mfma_f32_16x16x32_bf16 v[80:83], v[32:35], v[64:67], v[80:83]
    buffer_load_dwordx4 v27, s[60:63], s34 offen offset:3072 lds
    s_add_u32 s34, s34, 128
    s_waitcnt lgkmcnt(6)
    v_mfma_f32_16x16x32_bf16 v[84:87], v[36:39], v[64:67], v[84:87]
    s_waitcnt lgkmcnt(3)
    v_mfma_f32_16x16x32_bf16 v[88:91], v[40:43], v[64:67], v[88:91]
    s_waitcnt lgkmcnt(1)
    v_mfma_f32_16x16x32_bf16 v[92:95], v[44:47], v[64:67], v[92:95]
    ds_read_b128 v[64:67], v14 offset:8192
    v_mfma_f32_16x16x32_bf16 v[96:99], v[32:35], v[68:71], v[96:99]
    s_add_u32 m0, s37, 0
    s_nop 0
    buffer_load_dwordx4 v8, s[72:75], s35 offen offset:0 lds
    v_mfma_f32_16x16x32_bf16 v[100:103], v[36:39], v[68:71], v[100:103]
    ds_read_b64_tr_b16 v[48:49], v20 offset:4096
    v_mfma_f32_16x16x32_bf16 v[104:107], v[40:43], v[68:71], v[104:107]
    v_mfma_f32_16x16x32_bf16 v[108:111], v[44:47], v[68:71], v[108:111]
    ds_read_b128 v[68:71], v14 offset:10240
    v_mfma_f32_16x16x32_bf16 v[112:115], v[32:35], v[72:75], v[112:115]
    buffer_load_dwordx4 v9, s[72:75], s35 offen offset:1024 lds
    ds_read_b64_tr_b16 v[50:51], v20 offset:4608
    v_mfma_f32_16x16x32_bf16 v[116:119], v[36:39], v[72:75], v[116:119]
    v_mfma_f32_16x16x32_bf16 v[120:123], v[40:43], v[72:75], v[120:123]
    v_mfma_f32_16x16x32_bf16 v[124:127], v[44:47], v[72:75], v[124:127]
    ds_read_b128 v[72:75], v14 offset:12288
    ds_read_b64_tr_b16 v[52:53], v21 offset:4096
    s_waitcnt lgkmcnt(5)
    v_mfma_f32_16x16x32_bf16 v[128:131], v[32:35], v[76:79], v[128:131]
    buffer_load_dwordx4 v10, s[72:75], s35 offen offset:2048 lds
    v_mfma_f32_16x16x32_bf16 v[132:135], v[36:39], v[76:79], v[132:135]
    v_mfma_f32_16x16x32_bf16 v[136:139], v[40:43], v[76:79], v[136:139]
    ds_read_b64_tr_b16 v[54:55], v21 offset:4608
    v_mfma_f32_16x16x32_bf16 v[140:143], v[44:47], v[76:79], v[140:143]
    ds_read_b128 v[76:79], v14 offset:14336
    v_mfma_f32_16x16x32_bf16 v[144:147], v[32:35], v[64:67], v[144:147]
    buffer_load_dwordx4 v11, s[72:75], s35 offen offset:3072 lds
    s_add_u32 s35, s35, 221184
    v_mfma_f32_16x16x32_bf16 v[148:151], v[36:39], v[64:67], v[148:151]
    ds_read_b64_tr_b16 v[56:57], v20 offset:12288
    v_mfma_f32_16x16x32_bf16 v[152:155], v[40:43], v[64:67], v[152:155]
    v_mfma_f32_16x16x32_bf16 v[156:159], v[44:47], v[64:67], v[156:159]
    ds_read_b128 v[64:67], v15 offset:0
    s_waitcnt lgkmcnt(6)
    v_mfma_f32_16x16x32_bf16 v[160:163], v[32:35], v[68:71], v[160:163]
    ds_read_b64_tr_b16 v[58:59], v20 offset:12800
    v_mfma_f32_16x16x32_bf16 v[164:167], v[36:39], v[68:71], v[164:167]
    s_cbranch_vccnz VR7
    buffer_store_dwordx4 v[208:211], v4, s[8:11], s40 offen offset:0 sc1
VR7:
    v_mfma_f32_16x16x32_bf16 v[168:171], v[40:43], v[68:71], v[168:171]
    s_cbranch_vccz VR4
    buffer_store_dwordx4 v[220:223], v4, s[8:11], s40 offen offset:1024 sc1
    s_add_u32 s40, s40, 4096
VR4:
    v_mfma_f32_16x16x32_bf16 v[172:175], v[44:47], v[68:71], v[172:175]
    ds_read_b128 v[68:71], v15 offset:2048
    ds_read_b64_tr_b16 v[60:61], v21 offset:12288
    s_waitcnt lgkmcnt(7)
    v_mfma_f32_16x16x32_bf16 v[176:179], v[32:35], v[72:75], v[176:179]
    v_mfma_f32_16x16x32_bf16 v[180:183], v[36:39], v[72:75], v[180:183]
    v_mfma_f32_16x16x32_bf16 v[184:187], v[40:43], v[72:75], v[184:187]
    ds_read_b64_tr_b16 v[62:63], v21 offset:12800
    v_mfma_f32_16x16x32_bf16 v[188:191], v[44:47], v[72:75], v[188:191]
    ds_read_b128 v[72:75], v15 offset:4096
    s_waitcnt lgkmcnt(6)
    v_mfma_f32_16x16x32_bf16 v[192:195], v[32:35], v[76:79], v[192:195]
    v_mfma_f32_16x16x32_bf16 v[196:199], v[36:39], v[76:79], v[196:199]
    v_mfma_f32_16x16x32_bf16 v[200:203], v[40:43], v[76:79], v[200:203]
    v_mfma_f32_16x16x32_bf16 v[204:207], v[44:47], v[76:79], v[204:207]
    ds_read_b128 v[76:79], v15 offset:6144
    s_waitcnt lgkmcnt(5)
    v_mfma_f32_16x16x32_bf16 v[80:83], v[48:51], v[64:67], v[80:83]
    s_cbranch_vccz VR5
    buffer_store_dwordx4 v[224:227], v4, s[8:11], s40 offen offset:0 sc1
VR5:
    v_mfma_f32_16x16x32_bf16 v[84:87], v[52:55], v[64:67], v[84:87]
    v_mfma_f32_16x16x32_bf16 v[88:91], v[56:59], v[64:67], v[88:91]
    s_waitcnt lgkmcnt(1)
    v_mfma_f32_16x16x32_bf16 v[92:95], v[60:63], v[64:67], v[92:95]
    ds_read_b128 v[64:67], v15 offset:8192
    v_mfma_f32_16x16x32_bf16 v[96:99], v[48:51], v[68:71], v[96:99]
    v_mfma_f32_16x16x32_bf16 v[100:103], v[52:55], v[68:71], v[100:103]
    s_cbranch_vccnz VR8
    buffer_store_dwordx4 v[212:215], v4, s[8:11], s40 offen offset:1024 sc1
    s_add_u32 s40, s40, 4096
VR8:
    v_mfma_f32_16x16x32_bf16 v[104:107], v[56:59], v[68:71], v[104:107]
    v_mfma_f32_16x16x32_bf16 v[108:111], v[60:63], v[68:71], v[108:111]
    ds_read_b128 v[68:71], v15 offset:10240
    v_mfma_f32_16x16x32_bf16 v[112:115], v[48:51], v[72:75], v[112:115]
    v_mfma_f32_16x16x32_bf16 v[116:119], v[52:55], v[72:75], v[116:119]
    v_mfma_f32_16x16x32_bf16 v[120:123], v[56:59], v[72:75], v[120:123]
    s_cbranch_vccz VR6
    buffer_store_dwordx4 v[228:231], v4, s[8:11], s40 offen offset:1024 sc1
    s_add_u32 s40, s40, 4096
VR6:
    v_mfma_f32_16x16x32_bf16 v[124:127], v[60:63], v[72:75], v[124:127]
    ds_read_b128 v[72:75], v15 offset:12288
    s_waitcnt lgkmcnt(2)
    v_mfma_f32_16x16x32_bf16 v[128:131], v[48:51], v[76:79], v[128:131]
    v_mfma_f32_16x16x32_bf16 v[132:135], v[52:55], v[76:79], v[132:135]
    v_mfma_f32_16x16x32_bf16 v[136:139], v[56:59], v[76:79], v[136:139]
    v_mfma_f32_16x16x32_bf16 v[140:143], v[60:63], v[76:79], v[140:143]
    ds_read_b128 v[76:79], v15 offset:14336
    v_mfma_f32_16x16x32_bf16 v[144:147], v[48:51], v[64:67], v[144:147]
    v_mfma_f32_16x16x32_bf16 v[148:151], v[52:55], v[64:67], v[148:151]
    v_mfma_f32_16x16x32_bf16 v[152:155], v[56:59], v[64:67], v[152:155]
    v_mfma_f32_16x16x32_bf16 v[156:159], v[60:63], v[64:67], v[156:159]
    s_waitcnt lgkmcnt(1)
    v_mfma_f32_16x16x32_bf16 v[160:163], v[48:51], v[68:71], v[160:163]
    s_waitcnt vmcnt(3) lgkmcnt(0)
    s_cbranch_vccnz VR27
    s_waitcnt vmcnt(2)
VR27:
    s_barrier
    ds_read_b64_tr_b16 v[32:33], v16 offset:0
    ds_read_b64_tr_b16 v[34:35], v16 offset:512
    ds_read_b128 v[64:67], v12 offset:0
    v_mfma_f32_16x16x32_bf16 v[164:167], v[52:55], v[68:71], v[164:167]
    ds_read_b64_tr_b16 v[36:37], v17 offset:0
    v_mfma_f32_16x16x32_bf16 v[168:171], v[56:59], v[68:71], v[168:171]
    ds_read_b64_tr_b16 v[38:39], v17 offset:512
    s_add_u32 m0, s36, 65536
    s_nop 0
    buffer_load_dwordx4 v24, s[60:63], s34 offen offset:0 lds
    v_mfma_f32_16x16x32_bf16 v[172:175], v[60:63], v[68:71], v[172:175]
    ds_read_b64_tr_b16 v[40:41], v16 offset:8192
    ds_read_b128 v[68:71], v12 offset:2048
    v_mfma_f32_16x16x32_bf16 v[176:179], v[48:51], v[72:75], v[176:179]
    ds_read_b64_tr_b16 v[42:43], v16 offset:8704
    v_mfma_f32_16x16x32_bf16 v[180:183], v[52:55], v[72:75], v[180:183]
    ds_read_b64_tr_b16 v[44:45], v17 offset:8192
    buffer_load_dwordx4 v25, s[60:63], s34 offen offset:1024 lds
    v_mfma_f32_16x16x32_bf16 v[184:187], v[56:59], v[72:75], v[184:187]
    ds_read_b64_tr_b16 v[46:47], v17 offset:8704
    v_mfma_f32_16x16x32_bf16 v[188:191], v[60:63], v[72:75], v[188:191]
    ds_read_b128 v[72:75], v12 offset:4096
    v_mfma_f32_16x16x32_bf16 v[192:195], v[48:51], v[76:79], v[192:195]
    buffer_load_dwordx4 v26, s[60:63], s34 offen offset:2048 lds
    v_mfma_f32_16x16x32_bf16 v[196:199], v[52:55], v[76:79], v[196:199]
    v_mfma_f32_16x16x32_bf16 v[200:203], v[56:59], v[76:79], v[200:203]
    v_mfma_f32_16x16x32_bf16 v[204:207], v[60:63], v[76:79], v[204:207]
    ds_read_b128 v[76:79], v12 offset:6144
    s_waitcnt lgkmcnt(8)
    v_mfma_f32_16x16x32_bf16 v[80:83], v[32:35], v[64:67], v[80:83]
    buffer_load_dwordx4 v27, s[60:63], s34 offen offset:3072 lds
    s_add_u32 s34, s34, 128
    s_waitcnt lgkmcnt(6)
    v_mfma_f32_16x16x32_bf16 v[84:87], v[36:39], v[64:67], v[84:87]
    s_waitcnt lgkmcnt(3)
    v_mfma_f32_16x16x32_bf16 v[88:91], v[40:43], v[64:67], v[88:91]
    s_waitcnt lgkmcnt(1)
    v_mfma_f32_16x16x32_bf16 v[92:95], v[44:47], v[64:67], v[92:95]
    ds_read_b128 v[64:67], v12 offset:8192
    v_mfma_f32_16x16x32_bf16 v[96:99], v[32:35], v[68:71], v[96:99]
    s_add_u32 m0, s37, 65536
    s_nop 0
    buffer_load_dwordx4 v8, s[72:75], s35 offen offset:0 lds
    v_mfma_f32_16x16x32_bf16 v[100:103], v[36:39], v[68:71], v[100:103]
    ds_read_b64_tr_b16 v[48:49], v16 offset:4096
    v_mfma_f32_16x16x32_bf16 v[104:107], v[40:43], v[68:71], v[104:107]
    v_mfma_f32_16x16x32_bf16 v[108:111], v[44:47], v[68:71], v[108:111]
    ds_read_b128 v[68:71], v12 offset:10240
    v_mfma_f32_16x16x32_bf16 v[112:115], v[32:35], v[72:75], v[112:115]
    buffer_load_dwordx4 v9, s[72:75], s35 offen offset:1024 lds
    ds_read_b64_tr_b16 v[50:51], v16 offset:4608
    v_mfma_f32_16x16x32_bf16 v[116:119], v[36:39], v[72:75], v[116:119]
    v_mfma_f32_16x16x32_bf16 v[120:123], v[40:43], v[72:75], v[120:123]
    v_mfma_f32_16x16x32_bf16 v[124:127], v[44:47], v[72:75], v[124:127]
    ds_read_b128 v[72:75], v12 offset:12288
    ds_read_b64_tr_b16 v[52:53], v17 offset:4096
    s_waitcnt lgkmcnt(5)
    v_mfma_f32_16x16x32_bf16 v[128:131], v[32:35], v[76:79], v[128:131]
    buffer_load_dwordx4 v10, s[72:75], s35 offen offset:2048 lds
    v_mfma_f32_16x16x32_bf16 v[132:135], v[36:39], v[76:79], v[132:135]
    v_mfma_f32_16x16x32_bf16 v[136:139], v[40:43], v[76:79], v[136:139]
    ds_read_b64_tr_b16 v[54:55], v17 offset:4608
    v_mfma_f32_16x16x32_bf16 v[140:143], v[44:47], v[76:79], v[140:143]
    ds_read_b128 v[76:79], v12 offset:14336
    v_mfma_f32_16x16x32_bf16 v[144:147], v[32:35], v[64:67], v[144:147]
    buffer_load_dwordx4 v11, s[72:75], s35 offen offset:3072 lds
    s_add_u32 s35, s35, 221184
    v_mfma_f32_16x16x32_bf16 v[148:151], v[36:39], v[64:67], v[148:151]
    ds_read_b64_tr_b16 v[56:57], v16 offset:12288
    v_mfma_f32_16x16x32_bf16 v[152:155], v[40:43], v[64:67], v[152:155]
    v_mfma_f32_16x16x32_bf16 v[156:159], v[44:47], v[64:67], v[156:159]
    ds_read_b128 v[64:67], v13 offset:0
    s_waitcnt lgkmcnt(6)
    v_mfma_f32_16x16x32_bf16 v[160:163], v[32:35], v[68:71], v[160:163]
    ds_read_b64_tr_b16 v[58:59], v16 offset:12800
    v_mfma_f32_16x16x32_bf16 v[164:167], v[36:39], v[68:71], v[164:167]
    s_cbranch_vccnz VR12
    buffer_store_dwordx4 v[216:219], v4, s[8:11], s40 offen offset:0 sc1
VR12:
    v_mfma_f32_16x16x32_bf16 v[168:171], v[40:43], v[68:71], v[168:171]
    s_cbranch_vccz VR9
    buffer_store_dwordx4 v[232:235], v4, s[8:11], s40 offen offset:0 sc1
VR9:
    v_mfma_f32_16x16x32_bf16 v[172:175], v[44:47], v[68:71], v[172:175]
    ds_read_b128 v[68:71], v13 offset:2048
    ds_read_b64_tr_b16 v[60:61], v17 offset:12288
    s_waitcnt lgkmcnt(7)
    v_mfma_f32_16x16x32_bf16 v[176:179], v[32:35], v[72:75], v[176:179]
    v_mfma_f32_16x16x32_bf16 v[180:183], v[36:39], v[72:75], v[180:183]
    v_mfma_f32_16x16x32_bf16 v[184:187], v[40:43], v[72:75], v[184:187]
    ds_read_b64_tr_b16 v[62:63], v17 offset:12800
    v_mfma_f32_16x16x32_bf16 v[188:191], v[44:47], v[72:75], v[188:191]
    ds_read_b128 v[72:75], v13 offset:4096
    s_waitcnt lgkmcnt(6)
    v_mfma_f32_16x16x32_bf16 v[192:195], v[32:35], v[76:79], v[192:195]
    v_mfma_f32_16x16x32_bf16 v[196:199], v[36:39], v[76:79], v[196:199]
    v_mfma_f32_16x16x32_bf16 v[200:203], v[40:43], v[76:79], v[200:203]
    v_mfma_f32_16x16x32_bf16 v[204:207], v[44:47], v[76:79], v[204:207]
    ds_read_b128 v[76:79], v13 offset:6144
    s_waitcnt lgkmcnt(5)
    v_mfma_f32_16x16x32_bf16 v[80:83], v[48:51], v[64:67], v[80:83]
    s_cbranch_vccz VR10
    buffer_store_dwordx4 v[236:239], v4, s[8:11], s40 offen offset:1024 sc1
    s_add_u32 s40, s40, 4096
VR10:
    v_mfma_f32_16x16x32_bf16 v[84:87], v[52:55], v[64:67], v[84:87]
    v_mfma_f32_16x16x32_bf16 v[88:91], v[56:59], v[64:67], v[88:91]
    s_waitcnt lgkmcnt(1)
    v_mfma_f32_16x16x32_bf16 v[92:95], v[60:63], v[64:67], v[92:95]
    ds_read_b128 v[64:67], v13 offset:8192
    v_mfma_f32_16x16x32_bf16 v[96:99], v[48:51], v[68:71], v[96:99]
    v_mfma_f32_16x16x32_bf16 v[100:103], v[52:55], v[68:71], v[100:103]
    s_cbranch_vccnz VR13
    buffer_store_dwordx4 v[220:223], v4, s[8:11], s40 offen offset:1024 sc1
    s_add_u32 s40, s40, 4096
VR13:
    v_mfma_f32_16x16x32_bf16 v[104:107], v[56:59], v[68:71], v[104:107]
    v_mfma_f32_16x16x32_bf16 v[108:111], v[60:63], v[68:71], v[108:111]
    ds_read_b128 v[68:71], v13 offset:10240
    v_mfma_f32_16x16x32_bf16 v[112:115], v[48:51], v[72:75], v[112:115]
    v_mfma_f32_16x16x32_bf16 v[116:119], v[52:55], v[72:75], v[116:119]
    v_mfma_f32_16x16x32_bf16 v[120:123], v[56:59], v[72:75], v[120:123]
    s_cbranch_vccz VR11
    buffer_store_dwordx4 v[240:243], v4, s[8:11], s40 offen offset:0 sc1
VR11:
    v_mfma_f32_16x16x32_bf16 v[124:127], v[60:63], v[72:75], v[124:127]
    ds_read_b128 v[72:75], v13 offset:12288
    s_waitcnt lgkmcnt(2)
    v_mfma_f32_16x16x32_bf16 v[128:131], v[48:51], v[76:79], v[128:131]
    v_mfma_f32_16x16x32_bf16 v[132:135], v[52:55], v[76:79], v[132:135]
    v_mfma_f32_16x16x32_bf16 v[136:139], v[56:59], v[76:79], v[136:139]
    v_mfma_f32_16x16x32_bf16 v[140:143], v[60:63], v[76:79], v[140:143]
    ds_read_b128 v[76:79], v13 offset:14336
    v_mfma_f32_16x16x32_bf16 v[144:147], v[48:51], v[64:67], v[144:147]
    v_mfma_f32_16x16x32_bf16 v[148:151], v[52:55], v[64:67], v[148:151]
    v_mfma_f32_16x16x32_bf16 v[152:155], v[56:59], v[64:67], v[152:155]
    v_mfma_f32_16x16x32_bf16 v[156:159], v[60:63], v[64:67], v[156:159]
    s_waitcnt lgkmcnt(1)
    v_mfma_f32_16x16x32_bf16 v[160:163], v[48:51], v[68:71], v[160:163]
    s_waitcnt vmcnt(3) lgkmcnt(0)
    s_cbranch_vccnz VR28
    s_waitcnt vmcnt(2)
VR28:
    s_barrier
    ds_read_b64_tr_b16 v[32:33], v20 offset:0
    ds_read_b64_tr_b16 v[34:35], v20 offset:512
    ds_read_b128 v[64:67], v14 offset:0
    v_mfma_f32_16x16x32_bf16 v[164:167], v[52:55], v[68:71], v[164:167]
    ds_read_b64_tr_b16 v[36:37], v21 offset:0
    v_mfma_f32_16x16x32_bf16 v[168:171], v[56:59], v[68:71], v[168:171]
    ds_read_b64_tr_b16 v[38:39], v21 offset:512
    s_add_u32 m0, s36, 0
    s_nop 0
    buffer_load_dwordx4 v24, s[60:63], s34 offen offset:0 lds
    v_mfma_f32_16x16x32_bf16 v[172:175], v[60:63], v[68:71], v[172:175]
    ds_read_b64_tr_b16 v[40:41], v20 offset:8192
    ds_read_b128 v[68:71], v14 offset:2048
    v_mfma_f32_16x16x32_bf16 v[176:179], v[48:51], v[72:75], v[176:179]
    ds_read_b64_tr_b16 v[42:43], v20 offset:8704
    v_mfma_f32_16x16x32_bf16 v[180:183], v[52:55], v[72:75], v[180:183]
    ds_read_b64_tr_b16 v[44:45], v21 offset:8192
    buffer_load_dwordx4 v25, s[60:63], s34 offen offset:1024 lds
    v_mfma_f32_16x16x32_bf16 v[184:187], v[56:59], v[72:75], v[184:187]
    ds_read_b64_tr_b16 v[46:47], v21 offset:8704
    v_mfma_f32_16x16x32_bf16 v[188:191], v[60:63], v[72:75], v[188:191]
    ds_read_b128 v[72:75], v14 offset:4096
    v_mfma_f32_16x16x32_bf16 v[192:195], v[48:51], v[76:79], v[192:195]
    buffer_load_dwordx4 v26, s[60:63], s34 offen offset:2048 lds
    v_mfma_f32_16x16x32_bf16 v[196:199], v[52:55], v[76:79], v[196:199]
    v_mfma_f32_16x16x32_bf16 v[200:203], v[56:59], v[76:79], v[200:203]
    v_mfma_f32_16x16x32_bf16 v[204:207], v[60:63], v[76:79], v[204:207]
    ds_read_b128 v[76:79], v14 offset:6144
    s_waitcnt lgkmcnt(8)
    v_mfma_f32_16x16x32_bf16 v[80:83], v[32:35], v[64:67], v[80:83]
    buffer_load_dwordx4 v27, s[60:63], s34 offen offset:3072 lds
    s_add_u32 s34, s34, 128
    s_waitcnt lgkmcnt(6)
    v_mfma_f32_16x16x32_bf16 v[84:87], v[36:39], v[64:67], v[84:87]
    s_waitcnt lgkmcnt(3)
    v_mfma_f32_16x16x32_bf16 v[88:91], v[40:43], v[64:67], v[88:91]
    s_waitcnt lgkmcnt(1)
    v_mfma_f32_16x16x32_bf16 v[92:95], v[44:47], v[64:67], v[92:95]
    ds_read_b128 v[64:67], v14 offset:8192
    v_mfma_f32_16x16x32_bf16 v[96:99], v[32:35], v[68:71], v[96:99]
    s_add_u32 m0, s37, 0
    s_nop 0
    buffer_load_dwordx4 v8, s[72:75], s35 offen offset:0 lds
    v_mfma_f32_16x16x32_bf16 v[100:103], v[36:39], v[68:71], v[100:103]
    ds_read_b64_tr_b16 v[48:49], v20 offset:4096
    v_mfma_f32_16x16x32_bf16 v[104:107], v[40:43], v[68:71], v[104:107]
    v_mfma_f32_16x16x32_bf16 v[108:111], v[44:47], v[68:71], v[108:111]
    ds_read_b128 v[68:71], v14 offset:10240
    v_mfma_f32_16x16x32_bf16 v[112:115], v[32:35], v[72:75], v[112:115]
    buffer_load_dwordx4 v9, s[72:75], s35 offen offset:1024 lds
    ds_read_b64_tr_b16 v[50:51], v20 offset:4608
    v_mfma_f32_16x16x32_bf16 v[116:119], v[36:39], v[72:75], v[116:119]
    v_mfma_f32_16x16x32_bf16 v[120:123], v[40:43], v[72:75], v[120:123]
    v_mfma_f32_16x16x32_bf16 v[124:127], v[44:47], v[72:75], v[124:127]
    ds_read_b128 v[72:75], v14 offset:12288
    ds_read_b64_tr_b16 v[52:53], v21 offset:4096
    s_waitcnt lgkmcnt(5)
    v_mfma_f32_16x16x32_bf16 v[128:131], v[32:35], v[76:79], v[128:131]
    buffer_load_dwordx4 v10, s[72:75], s35 offen offset:2048 lds
    v_mfma_f32_16x16x32_bf16 v[132:135], v[36:39], v[76:79], v[132:135]
    v_mfma_f32_16x16x32_bf16 v[136:139], v[40:43], v[76:79], v[136:139]
    ds_read_b64_tr_b16 v[54:55], v21 offset:4608
    v_mfma_f32_16x16x32_bf16 v[140:143], v[44:47], v[76:79], v[140:143]
    ds_read_b128 v[76:79], v14 offset:14336
    v_mfma_f32_16x16x32_bf16 v[144:147], v[32:35], v[64:67], v[144:147]
    buffer_load_dwordx4 v11, s[72:75], s35 offen offset:3072 lds
    s_add_u32 s35, s35, 221184
    v_mfma_f32_16x16x32_bf16 v[148:151], v[36:39], v[64:67], v[148:151]
    ds_read_b64_tr_b16 v[56:57], v20 offset:12288
    v_mfma_f32_16x16x32_bf16 v[152:155], v[40:43], v[64:67], v[152:155]
    v_mfma_f32_16x16x32_bf16 v[156:159], v[44:47], v[64:67], v[156:159]
    ds_read_b128 v[64:67], v15 offset:0
    s_waitcnt lgkmcnt(6)
    v_mfma_f32_16x16x32_bf16 v[160:163], v[32:35], v[68:71], v[160:163]
    ds_read_b64_tr_b16 v[58:59], v20 offset:12800
    v_mfma_f32_16x16x32_bf16 v[164:167], v[36:39], v[68:71], v[164:167]
    s_cbranch_vccnz VR17
    buffer_store_dwordx4 v[224:227], v4, s[8:11], s40 offen offset:0 sc1
VR17:
    v_mfma_f32_16x16x32_bf16 v[168:171], v[40:43], v[68:71], v[168:171]
    s_cbranch_vccz VR14
    buffer_store_dwordx4 v[244:247], v4, s[8:11], s40 offen offset:1024 sc1
    s_add_u32 s40, s40, 4096
VR14:
    v_mfma_f32_16x16x32_bf16 v[172:175], v[44:47], v[68:71], v[172:175]
    ds_read_b128 v[68:71], v15 offset:2048
    ds_read_b64_tr_b16 v[60:61], v21 offset:12288
    s_waitcnt lgkmcnt(7)
    v_mfma_f32_16x16x32_bf16 v[176:179], v[32:35], v[72:75], v[176:179]
    v_mfma_f32_16x16x32_bf16 v[180:183], v[36:39], v[72:75], v[180:183]
    v_mfma_f32_16x16x32_bf16 v[184:187], v[40:43], v[72:75], v[184:187]
    ds_read_b64_tr_b16 v[62:63], v21 offset:12800
    v_mfma_f32_16x16x32_bf16 v[188:191], v[44:47], v[72:75], v[188:191]
    ds_read_b128 v[72:75], v15 offset:4096
    s_waitcnt lgkmcnt(6)
    v_mfma_f32_16x16x32_bf16 v[192:195], v[32:35], v[76:79], v[192:195]
    v_mfma_f32_16x16x32_bf16 v[196:199], v[36:39], v[76:79], v[196:199]
    v_mfma_f32_16x16x32_bf16 v[200:203], v[40:43], v[76:79], v[200:203]
    v_mfma_f32_16x16x32_bf16 v[204:207], v[44:47], v[76:79], v[204:207]
    ds_read_b128 v[76:79], v15 offset:6144
    s_waitcnt lgkmcnt(5)
    v_mfma_f32_16x16x32_bf16 v[80:83], v[48:51], v[64:67], v[80:83]
    s_cbranch_vccz VR15
    buffer_store_dwordx4 v[248:251], v4, s[8:11], s40 offen offset:0 sc1
VR15:
    v_mfma_f32_16x16x32_bf16 v[84:87], v[52:55], v[64:67], v[84:87]
    v_mfma_f32_16x16x32_bf16 v[88:91], v[56:59], v[64:67], v[88:91]
    s_waitcnt lgkmcnt(1)
    v_mfma_f32_16x16x32_bf16 v[92:95], v[60:63], v[64:67], v[92:95]
    ds_read_b128 v[64:67], v15 offset:8192
    v_mfma_f32_16x16x32_bf16 v[96:99], v[48:51], v[68:71], v[96:99]
    v_mfma_f32_16x16x32_bf16 v[100:103], v[52:55], v[68:71], v[100:103]
    s_cbranch_vccnz VR18
    buffer_store_dwordx4 v[228:231], v4, s[8:11], s40 offen offset:1024 sc1
    s_add_u32 s40, s40, 4096
VR18:
    v_mfma_f32_16x16x32_bf16 v[104:107], v[56:59], v[68:71], v[104:107]
    v_mfma_f32_16x16x32_bf16 v[108:111], v[60:63], v[68:71], v[108:111]
    ds_read_b128 v[68:71], v15 offset:10240
    v_mfma_f32_16x16x32_bf16 v[112:115], v[48:51], v[72:75], v[112:115]
    v_mfma_f32_16x16x32_bf16 v[116:119], v[52:55], v[72:75], v[116:119]
    v_mfma_f32_16x16x32_bf16 v[120:123], v[56:59], v[72:75], v[120:123]
    s_cbranch_vccz VR16
    buffer_store_dwordx4 v[252:255], v4, s[8:11], s40 offen offset:1024 sc1
    s_add_u32 s40, s40, 4096
VR16:
    v_mfma_f32_16x16x32_bf16 v[124:127], v[60:63], v[72:75], v[124:127]
    ds_read_b128 v[72:75], v15 offset:12288
    s_waitcnt lgkmcnt(2)
    v_mfma_f32_16x16x32_bf16 v[128:131], v[48:51], v[76:79], v[128:131]
    v_mfma_f32_16x16x32_bf16 v[132:135], v[52:55], v[76:79], v[132:135]
    v_mfma_f32_16x16x32_bf16 v[136:139], v[56:59], v[76:79], v[136:139]
    v_mfma_f32_16x16x32_bf16 v[140:143], v[60:63], v[76:79], v[140:143]
    ds_read_b128 v[76:79], v15 offset:14336
    v_mfma_f32_16x16x32_bf16 v[144:147], v[48:51], v[64:67], v[144:147]
    v_mfma_f32_16x16x32_bf16 v[148:151], v[52:55], v[64:67], v[148:151]
    v_mfma_f32_16x16x32_bf16 v[152:155], v[56:59], v[64:67], v[152:155]
    v_mfma_f32_16x16x32_bf16 v[156:159], v[60:63], v[64:67], v[156:159]
    s_waitcnt lgkmcnt(1)
    v_mfma_f32_16x16x32_bf16 v[160:163], v[48:51], v[68:71], v[160:163]
    s_waitcnt vmcnt(3) lgkmcnt(0)
    s_cbranch_vccnz VR29
    s_waitcnt vmcnt(2)
VR29:
    s_barrier
    ds_read_b64_tr_b16 v[32:33], v16 offset:0
    ds_read_b64_tr_b16 v[34:35], v16 offset:512
    ds_read_b128 v[64:67], v12 offset:0
    v_mfma_f32_16x16x32_bf16 v[164:167], v[52:55], v[68:71], v[164:167]
    ds_read_b64_tr_b16 v[36:37], v17 offset:0
    v_mfma_f32_16x16x32_bf16 v[168:171], v[56:59], v[68:71], v[168:171]
    ds_read_b64_tr_b16 v[38:39], v17 offset:512
    s_add_u32 m0, s36, 65536
    s_nop 0
    buffer_load_dwordx4 v24, s[60:63], s34 offen offset:0 lds
    v_mfma_f32_16x16x32_bf16 v[172:175], v[60:63], v[68:71], v[172:175]
    ds_read_b64_tr_b16 v[40:41], v16 offset:8192
    ds_read_b128 v[68:71], v12 offset:2048
    v_mfma_f32_16x16x32_bf16 v[176:179], v[48:51], v[72:75], v[176:179]
    ds_read_b64_tr_b16 v[42:43], v16 offset:8704
    v_mfma_f32_16x16x32_bf16 v[180:183], v[52:55], v[72:75], v[180:183]
    ds_read_b64_tr_b16 v[44:45], v17 offset:8192
    buffer_load_dwordx4 v25, s[60:63], s34 offen offset:1024 lds
    v_mfma_f32_16x16x32_bf16 v[184:187], v[56:59], v[72:75], v[184:187]
    ds_read_b64_tr_b16 v[46:47], v17 offset:8704
    v_mfma_f32_16x16x32_bf16 v[188:191], v[60:63], v[72:75], v[188:191]
    ds_read_b128 v[72:75], v12 offset:4096
    v_mfma_f32_16x16x32_bf16 v[192:195], v[48:51], v[76:79], v[192:195]
    buffer_load_dwordx4 v26, s[60:63], s34 offen offset:2048 lds
    v_mfma_f32_16x16x32_bf16 v[196:199], v[52:55], v[76:79], v[196:199]
    v_mfma_f32_16x16x32_bf16 v[200:203], v[56:59], v[76:79], v[200:203]
    v_mfma_f32_16x16x32_bf16 v[204:207], v[60:63], v[76:79], v[204:207]
    ds_read_b128 v[76:79], v12 offset:6144
    s_waitcnt lgkmcnt(8)
    v_mfma_f32_16x16x32_bf16 v[80:83], v[32:35], v[64:67], v[80:83]
    buffer_load_dwordx4 v27, s[60:63], s34 offen offset:3072 lds
    s_add_u32 s34, s34, 128
    s_waitcnt lgkmcnt(6)
    v_mfma_f32_16x16x32_bf16 v[84:87], v[36:39], v[64:67], v[84:87]
    s_waitcnt lgkmcnt(3)
    v_mfma_f32_16x16x32_bf16 v[88:91], v[40:43], v[64:67], v[88:91]
    s_waitcnt lgkmcnt(1)
    v_mfma_f32_16x16x32_bf16 v[92:95], v[44:47], v[64:67], v[92:95]
    ds_read_b128 v[64:67], v12 offset:8192
    v_mfma_f32_16x16x32_bf16 v[96:99], v[32:35], v[68:71], v[96:99]
    s_add_u32 m0, s37, 65536
    s_nop 0
    buffer_load_dwordx4 v8, s[72:75], s35 offen offset:0 lds
    v_mfma_f32_16x16x32_bf16 v[100:103], v[36:39], v[68:71], v[100:103]
    ds_read_b64_tr_b16 v[48:49], v16 offset:4096
    v_mfma_f32_16x16x32_bf16 v[104:107], v[40:43], v[68:71], v[104:107]
    v_mfma_f32_16x16x32_bf16 v[108:111], v[44:47], v[68:71], v[108:111]
    ds_read_b128 v[68:71], v12 offset:10240
    v_mfma_f32_16x16x32_bf16 v[112:115], v[32:35], v[72:75], v[112:115]
    buffer_load_dwordx4 v9, s[72:75], s35 offen offset:1024 lds
    ds_read_b64_tr_b16 v[50:51], v16 offset:4608
    v_mfma_f32_16x16x32_bf16 v[116:119], v[36:39], v[72:75], v[116:119]
    v_mfma_f32_16x16x32_bf16 v[120:123], v[40:43], v[72:75], v[120:123]
    v_mfma_f32_16x16x32_bf16 v[124:127], v[44:47], v[72:75], v[124:127]
    ds_read_b128 v[72:75], v12 offset:12288
    ds_read_b64_tr_b16 v[52:53], v17 offset:4096
    s_waitcnt lgkmcnt(5)
    v_mfma_f32_16x16x32_bf16 v[128:131], v[32:35], v[76:79], v[128:131]
    buffer_load_dwordx4 v10, s[72:75], s35 offen offset:2048 lds
    v_mfma_f32_16x16x32_bf16 v[132:135], v[36:39], v[76:79], v[132:135]
    v_mfma_f32_16x16x32_bf16 v[136:139], v[40:43], v[76:79], v[136:139]
    ds_read_b64_tr_b16 v[54:55], v17 offset:4608
    v_mfma_f32_16x16x32_bf16 v[140:143], v[44:47], v[76:79], v[140:143]
    ds_read_b128 v[76:79], v12 offset:14336
    v_mfma_f32_16x16x32_bf16 v[144:147], v[32:35], v[64:67], v[144:147]
    buffer_load_dwordx4 v11, s[72:75], s35 offen offset:3072 lds
    s_add_u32 s35, s35, 221184
    v_mfma_f32_16x16x32_bf16 v[148:151], v[36:39], v[64:67], v[148:151]
    ds_read_b64_tr_b16 v[56:57], v16 offset:12288
    v_mfma_f32_16x16x32_bf16 v[152:155], v[40:43], v[64:67], v[152:155]
    v_mfma_f32_16x16x32_bf16 v[156:159], v[44:47], v[64:67], v[156:159]
    ds_read_b128 v[64:67], v13 offset:0
    s_waitcnt lgkmcnt(6)
    v_mfma_f32_16x16x32_bf16 v[160:163], v[32:35], v[68:71], v[160:163]
    ds_read_b64_tr_b16 v[58:59], v16 offset:12800
    v_mfma_f32_16x16x32_bf16 v[164:167], v[36:39], v[68:71], v[164:167]
    s_cbranch_vccnz VR19
    buffer_store_dwordx4 v[232:235], v4, s[8:11], s40 offen offset:0 sc1
VR19:
    v_mfma_f32_16x16x32_bf16 v[168:171], v[40:43], v[68:71], v[168:171]
    v_mfma_f32_16x16x32_bf16 v[172:175], v[44:47], v[68:71], v[172:175]
    ds_read_b128 v[68:71], v13 offset:2048
    ds_read_b64_tr_b16 v[60:61], v17 offset:12288
    s_waitcnt lgkmcnt(7)
    v_mfma_f32_16x16x32_bf16 v[176:179], v[32:35], v[72:75], v[176:179]
    v_mfma_f32_16x16x32_bf16 v[180:183], v[36:39], v[72:75], v[180:183]
    v_mfma_f32_16x16x32_bf16 v[184:187], v[40:43], v[72:75], v[184:187]
    ds_read_b64_tr_b16 v[62:63], v17 offset:12800
    v_mfma_f32_16x16x32_bf16 v[188:191], v[44:47], v[72:75], v[188:191]
    ds_read_b128 v[72:75], v13 offset:4096
    s_waitcnt lgkmcnt(6)
    v_mfma_f32_16x16x32_bf16 v[192:195], v[32:35], v[76:79], v[192:195]
    v_mfma_f32_16x16x32_bf16 v[196:199], v[36:39], v[76:79], v[196:199]
    v_mfma_f32_16x16x32_bf16 v[200:203], v[40:43], v[76:79], v[200:203]
    v_mfma_f32_16x16x32_bf16 v[204:207], v[44:47], v[76:79], v[204:207]
    ds_read_b128 v[76:79], v13 offset:6144
    s_waitcnt lgkmcnt(5)
    v_mfma_f32_16x16x32_bf16 v[80:83], v[48:51], v[64:67], v[80:83]
    v_mfma_f32_16x16x32_bf16 v[84:87], v[52:55], v[64:67], v[84:87]
    v_mfma_f32_16x16x32_bf16 v[88:91], v[56:59], v[64:67], v[88:91]
    s_waitcnt lgkmcnt(1)
    v_mfma_f32_16x16x32_bf16 v[92:95], v[60:63], v[64:67], v[92:95]
    ds_read_b128 v[64:67], v13 offset:8192
    v_mfma_f32_16x16x32_bf16 v[96:99], v[48:51], v[68:71], v[96:99]
    v_mfma_f32_16x16x32_bf16 v[100:103], v[52:55], v[68:71], v[100:103]
    s_cbranch_vccnz VR20
    buffer_store_dwordx4 v[236:239], v4, s[8:11], s40 offen offset:1024 sc1
    s_add_u32 s40, s40, 4096
VR20:
    v_mfma_f32_16x16x32_bf16 v[104:107], v[56:59], v[68:71], v[104:107]
    v_mfma_f32_16x16x32_bf16 v[108:111], v[60:63], v[68:71], v[108:111]
    ds_read_b128 v[68:71], v13 offset:10240
    v_mfma_f32_16x16x32_bf16 v[112:115], v[48:51], v[72:75], v[112:115]
    v_mfma_f32_16x16x32_bf16 v[116:119], v[52:55], v[72:75], v[116:119]
    v_mfma_f32_16x16x32_bf16 v[120:123], v[56:59], v[72:75], v[120:123]
    v_mfma_f32_16x16x32_bf16 v[124:127], v[60:63], v[72:75], v[124:127]
    ds_read_b128 v[72:75], v13 offset:12288
    s_waitcnt lgkmcnt(2)
    v_mfma_f32_16x16x32_bf16 v[128:131], v[48:51], v[76:79], v[128:131]
    v_mfma_f32_16x16x32_bf16 v[132:135], v[52:55], v[76:79], v[132:135]
    v_mfma_f32_16x16x32_bf16 v[136:139], v[56:59], v[76:79], v[136:139]
    v_mfma_f32_16x16x32_bf16 v[140:143], v[60:63], v[76:79], v[140:143]
    ds_read_b128 v[76:79], v13 offset:14336
    v_mfma_f32_16x16x32_bf16 v[144:147], v[48:51], v[64:67], v[144:147]
    v_mfma_f32_16x16x32_bf16 v[148:151], v[52:55], v[64:67], v[148:151]
    v_mfma_f32_16x16x32_bf16 v[152:155], v[56:59], v[64:67], v[152:155]
    v_mfma_f32_16x16x32_bf16 v[156:159], v[60:63], v[64:67], v[156:159]
    s_waitcnt lgkmcnt(1)
    v_mfma_f32_16x16x32_bf16 v[160:163], v[48:51], v[68:71], v[160:163]
    s_waitcnt vmcnt(2) lgkmcnt(0)
    s_cbranch_vccz VR30
    s_waitcnt vmcnt(0)
VR30:
    s_barrier
    s_cbranch_vccz VR21
    s_cmp_lg_u32 s3, 0
    s_cbranch_scc1 SIG1_0
    v_mov_b32 v28, 1
    v_add_u32 v28, s38, v28
    s_mov_b64 exec, 1
    buffer_store_dword v28, off, s[8:11], s29 sc1
    s_mov_b64 exec, -1
SIG1_0:
VR21:
    ds_read_b64_tr_b16 v[32:33], v20 offset:0
    ds_read_b64_tr_b16 v[34:35], v20 offset:512
    ds_read_b128 v[64:67], v14 offset:0
    v_mfma_f32_16x16x32_bf16 v[164:167], v[52:55], v[68:71], v[164:167]
    ds_read_b64_tr_b16 v[36:37], v21 offset:0
    v_mfma_f32_16x16x32_bf16 v[168:171], v[56:59], v[68:71], v[168:171]
    ds_read_b64_tr_b16 v[38:39], v21 offset:512
    s_add_u32 m0, s36, 0
    s_nop 0
    buffer_load_dwordx4 v24, s[60:63], s34 offen offset:0 lds
    v_mfma_f32_16x16x32_bf16 v[172:175], v[60:63], v[68:71], v[172:175]
    ds_read_b64_tr_b16 v[40:41], v20 offset:8192
    ds_read_b128 v[68:71], v14 offset:2048
    v_mfma_f32_16x16x32_bf16 v[176:179], v[48:51], v[72:75], v[176:179]
    ds_read_b64_tr_b16 v[42:43], v20 offset:8704
    v_mfma_f32_16x16x32_bf16 v[180:183], v[52:55], v[72:75], v[180:183]
    ds_read_b64_tr_b16 v[44:45], v21 offset:8192
    buffer_load_dwordx4 v25, s[60:63], s34 offen offset:1024 lds
    v_mfma_f32_16x16x32_bf16 v[184:187], v[56:59], v[72:75], v[184:187]
    ds_read_b64_tr_b16 v[46:47], v21 offset:8704
    v_mfma_f32_16x16x32_bf16 v[188:191], v[60:63], v[72:75], v[188:191]
    ds_read_b128 v[72:75], v14 offset:4096
    v_mfma_f32_16x16x32_bf16 v[192:195], v[48:51], v[76:79], v[192:195]
    buffer_load_dwordx4 v26, s[60:63], s34 offen offset:2048 lds
    v_mfma_f32_16x16x32_bf16 v[196:199], v[52:55], v[76:79], v[196:199]
    v_mfma_f32_16x16x32_bf16 v[200:203], v[56:59], v[76:79], v[200:203]
    v_mfma_f32_16x16x32_bf16 v[204:207], v[60:63], v[76:79], v[204:207]
    ds_read_b128 v[76:79], v14 offset:6144
    s_waitcnt lgkmcnt(8)
    v_mfma_f32_16x16x32_bf16 v[80:83], v[32:35], v[64:67], v[80:83]
    buffer_load_dwordx4 v27, s[60:63], s34 offen offset:3072 lds
    s_add_u32 s34, s34, 128
    s_waitcnt lgkmcnt(6)
    v_mfma_f32_16x16x32_bf16 v[84:87], v[36:39], v[64:67], v[84:87]
    s_waitcnt lgkmcnt(3)
    v_mfma_f32_16x16x32_bf16 v[88:91], v[40:43], v[64:67], v[88:91]
    s_waitcnt lgkmcnt(1)
    v_mfma_f32_16x16x32_bf16 v[92:95], v[44:47], v[64:67], v[92:95]
    ds_read_b128 v[64:67], v14 offset:8192
    v_mfma_f32_16x16x32_bf16 v[96:99], v[32:35], v[68:71], v[96:99]
    s_add_u32 m0, s37, 0
    s_nop 0
    buffer_load_dwordx4 v8, s[72:75], s35 offen offset:0 lds
    v_mfma_f32_16x16x32_bf16 v[100:103], v[36:39], v[68:71], v[100:103]
    ds_read_b64_tr_b16 v[48:49], v20 offset:4096
    v_mfma_f32_16x16x32_bf16 v[104:107], v[40:43], v[68:71], v[104:107]
    v_mfma_f32_16x16x32_bf16 v[108:111], v[44:47], v[68:71], v[108:111]
    ds_read_b128 v[68:71], v14 offset:10240
    v_mfma_f32_16x16x32_bf16 v[112:115], v[32:35], v[72:75], v[112:115]
    buffer_load_dwordx4 v9, s[72:75], s35 offen offset:1024 lds
    ds_read_b64_tr_b16 v[50:51], v20 offset:4608
    v_mfma_f32_16x16x32_bf16 v[116:119], v[36:39], v[72:75], v[116:119]
    v_mfma_f32_16x16x32_bf16 v[120:123], v[40:43], v[72:75], v[120:123]
    v_mfma_f32_16x16x32_bf16 v[124:127], v[44:47], v[72:75], v[124:127]
    ds_read_b128 v[72:75], v14 offset:12288
    ds_read_b64_tr_b16 v[52:53], v21 offset:4096
    s_waitcnt lgkmcnt(5)
    v_mfma_f32_16x16x32_bf16 v[128:131], v[32:35], v[76:79], v[128:131]
    buffer_load_dwordx4 v10, s[72:75], s35 offen offset:2048 lds
    v_mfma_f32_16x16x32_bf16 v[132:135], v[36:39], v[76:79], v[132:135]
    v_mfma_f32_16x16x32_bf16 v[136:139], v[40:43], v[76:79], v[136:139]
    ds_read_b64_tr_b16 v[54:55], v21 offset:4608
    v_mfma_f32_16x16x32_bf16 v[140:143], v[44:47], v[76:79], v[140:143]
    ds_read_b128 v[76:79], v14 offset:14336
    v_mfma_f32_16x16x32_bf16 v[144:147], v[32:35], v[64:67], v[144:147]
    buffer_load_dwordx4 v11, s[72:75], s35 offen offset:3072 lds
    s_add_u32 s35, s35, 221184
    v_mfma_f32_16x16x32_bf16 v[148:151], v[36:39], v[64:67], v[148:151]
    ds_read_b64_tr_b16 v[56:57], v20 offset:12288
    v_mfma_f32_16x16x32_bf16 v[152:155], v[40:43], v[64:67], v[152:155]
    v_mfma_f32_16x16x32_bf16 v[156:159], v[44:47], v[64:67], v[156:159]
    ds_read_b128 v[64:67], v15 offset:0
    s_waitcnt lgkmcnt(6)
    v_mfma_f32_16x16x32_bf16 v[160:163], v[32:35], v[68:71], v[160:163]
    ds_read_b64_tr_b16 v[58:59], v20 offset:12800
    v_mfma_f32_16x16x32_bf16 v[164:167], v[36:39], v[68:71], v[164:167]
    s_cbranch_vccnz VR22
    buffer_store_dwordx4 v[240:243], v4, s[8:11], s40 offen offset:0 sc1
VR22:
    v_mfma_f32_16x16x32_bf16 v[168:171], v[40:43], v[68:71], v[168:171]
    v_mfma_f32_16x16x32_bf16 v[172:175], v[44:47], v[68:71], v[172:175]
    ds_read_b128 v[68:71], v15 offset:2048
    ds_read_b64_tr_b16 v[60:61], v21 offset:12288
    s_waitcnt lgkmcnt(7)
    v_mfma_f32_16x16x32_bf16 v[176:179], v[32:35], v[72:75], v[176:179]
    v_mfma_f32_16x16x32_bf16 v[180:183], v[36:39], v[72:75], v[180:183]
    v_mfma_f32_16x16x32_bf16 v[184:187], v[40:43], v[72:75], v[184:187]
    ds_read_b64_tr_b16 v[62:63], v21 offset:12800
    v_mfma_f32_16x16x32_bf16 v[188:191], v[44:47], v[72:75], v[188:191]
    ds_read_b128 v[72:75], v15 offset:4096
    s_waitcnt lgkmcnt(6)
    v_mfma_f32_16x16x32_bf16 v[192:195], v[32:35], v[76:79], v[192:195]
    v_mfma_f32_16x16x32_bf16 v[196:199], v[36:39], v[76:79], v[196:199]
    v_mfma_f32_16x16x32_bf16 v[200:203], v[40:43], v[76:79], v[200:203]
    v_mfma_f32_16x16x32_bf16 v[204:207], v[44:47], v[76:79], v[204:207]
    ds_read_b128 v[76:79], v15 offset:6144
    s_waitcnt lgkmcnt(5)
    v_mfma_f32_16x16x32_bf16 v[80:83], v[48:51], v[64:67], v[80:83]
    v_mfma_f32_16x16x32_bf16 v[84:87], v[52:55], v[64:67], v[84:87]
    v_mfma_f32_16x16x32_bf16 v[88:91], v[56:59], v[64:67], v[88:91]
    s_waitcnt lgkmcnt(1)
    v_mfma_f32_16x16x32_bf16 v[92:95], v[60:63], v[64:67], v[92:95]
    ds_read_b128 v[64:67], v15 offset:8192
    v_mfma_f32_16x16x32_bf16 v[96:99], v[48:51], v[68:71], v[96:99]
    v_mfma_f32_16x16x32_bf16 v[100:103], v[52:55], v[68:71], v[100:103]
    s_cbranch_vccnz VR23
    buffer_store_dwordx4 v[244:247], v4, s[8:11], s40 offen offset:1024 sc1
    s_add_u32 s40, s40, 4096
VR23:
    v_mfma_f32_16x16x32_bf16 v[104:107], v[56:59], v[68:71], v[104:107]
    v_mfma_f32_16x16x32_bf16 v[108:111], v[60:63], v[68:71], v[108:111]
    ds_read_b128 v[68:71], v15 offset:10240
    v_mfma_f32_16x16x32_bf16 v[112:115], v[48:51], v[72:75], v[112:115]
    v_mfma_f32_16x16x32_bf16 v[116:119], v[52:55], v[72:75], v[116:119]
    v_mfma_f32_16x16x32_bf16 v[120:123], v[56:59], v[72:75], v[120:123]
    v_mfma_f32_16x16x32_bf16 v[124:127], v[60:63], v[72:75], v[124:127]
    ds_read_b128 v[72:75], v15 offset:12288
    s_waitcnt lgkmcnt(2)
    v_mfma_f32_16x16x32_bf16 v[128:131], v[48:51], v[76:79], v[128:131]
    v_mfma_f32_16x16x32_bf16 v[132:135], v[52:55], v[76:79], v[132:135]
    v_mfma_f32_16x16x32_bf16 v[136:139], v[56:59], v[76:79], v[136:139]
    v_mfma_f32_16x16x32_bf16 v[140:143], v[60:63], v[76:79], v[140:143]
    ds_read_b128 v[76:79], v15 offset:14336
    v_mfma_f32_16x16x32_bf16 v[144:147], v[48:51], v[64:67], v[144:147]
    v_mfma_f32_16x16x32_bf16 v[148:151], v[52:55], v[64:67], v[148:151]
    v_mfma_f32_16x16x32_bf16 v[152:155], v[56:59], v[64:67], v[152:155]
    v_mfma_f32_16x16x32_bf16 v[156:159], v[60:63], v[64:67], v[156:159]
    s_waitcnt lgkmcnt(1)
    v_mfma_f32_16x16x32_bf16 v[160:163], v[48:51], v[68:71], v[160:163]
    s_waitcnt vmcnt(2) lgkmcnt(0)
    s_cbranch_vccz VR31
    s_waitcnt vmcnt(0)
VR31:
    s_barrier
    ds_read_b64_tr_b16 v[32:33], v16 offset:0
    ds_read_b64_tr_b16 v[34:35], v16 offset:512
    ds_read_b128 v[64:67], v12 offset:0
    v_mfma_f32_16x16x32_bf16 v[164:167], v[52:55], v[68:71], v[164:167]
    ds_read_b64_tr_b16 v[36:37], v17 offset:0
    v_mfma_f32_16x16x32_bf16 v[168:171], v[56:59], v[68:71], v[168:171]
    ds_read_b64_tr_b16 v[38:39], v17 offset:512
    s_add_u32 m0, s36, 65536
    s_nop 0
    buffer_load_dwordx4 v24, s[60:63], s34 offen offset:0 lds
    v_mfma_f32_16x16x32_bf16 v[172:175], v[60:63], v[68:71], v[172:175]
    ds_read_b64_tr_b16 v[40:41], v16 offset:8192
    ds_read_b128 v[68:71], v12 offset:2048
    v_mfma_f32_16x16x32_bf16 v[176:179], v[48:51], v[72:75], v[176:179]
    ds_read_b64_tr_b16 v[42:43], v16 offset:8704
    v_mfma_f32_16x16x32_bf16 v[180:183], v[52:55], v[72:75], v[180:183]
    ds_read_b64_tr_b16 v[44:45], v17 offset:8192
    buffer_load_dwordx4 v25, s[60:63], s34 offen offset:1024 lds
    v_mfma_f32_16x16x32_bf16 v[184:187], v[56:59], v[72:75], v[184:187]
    ds_read_b64_tr_b16 v[46:47], v17 offset:8704
    v_mfma_f32_16x16x32_bf16 v[188:191], v[60:63], v[72:75], v[188:191]
    ds_read_b128 v[72:75], v12 offset:4096
    v_mfma_f32_16x16x32_bf16 v[192:195], v[48:51], v[76:79], v[192:195]
    buffer_load_dwordx4 v26, s[60:63], s34 offen offset:2048 lds
    v_mfma_f32_16x16x32_bf16 v[196:199], v[52:55], v[76:79], v[196:199]
    v_mfma_f32_16x16x32_bf16 v[200:203], v[56:59], v[76:79], v[200:203]
    v_mfma_f32_16x16x32_bf16 v[204:207], v[60:63], v[76:79], v[204:207]
    ds_read_b128 v[76:79], v12 offset:6144
    s_waitcnt lgkmcnt(8)
    v_mfma_f32_16x16x32_bf16 v[80:83], v[32:35], v[64:67], v[80:83]
    buffer_load_dwordx4 v27, s[60:63], s34 offen offset:3072 lds
    s_add_u32 s34, s34, 128
    s_waitcnt lgkmcnt(6)
    v_mfma_f32_16x16x32_bf16 v[84:87], v[36:39], v[64:67], v[84:87]
    s_waitcnt lgkmcnt(3)
    v_mfma_f32_16x16x32_bf16 v[88:91], v[40:43], v[64:67], v[88:91]
    s_waitcnt lgkmcnt(1)
    v_mfma_f32_16x16x32_bf16 v[92:95], v[44:47], v[64:67], v[92:95]
    ds_read_b128 v[64:67], v12 offset:8192
    v_mfma_f32_16x16x32_bf16 v[96:99], v[32:35], v[68:71], v[96:99]
    s_add_u32 m0, s37, 65536
    s_nop 0
    buffer_load_dwordx4 v8, s[72:75], s35 offen offset:0 lds
    v_mfma_f32_16x16x32_bf16 v[100:103], v[36:39], v[68:71], v[100:103]
    ds_read_b64_tr_b16 v[48:49], v16 offset:4096
    v_mfma_f32_16x16x32_bf16 v[104:107], v[40:43], v[68:71], v[104:107]
    v_mfma_f32_16x16x32_bf16 v[108:111], v[44:47], v[68:71], v[108:111]
    ds_read_b128 v[68:71], v12 offset:10240
    v_mfma_f32_16x16x32_bf16 v[112:115], v[32:35], v[72:75], v[112:115]
    buffer_load_dwordx4 v9, s[72:75], s35 offen offset:1024 lds
    ds_read_b64_tr_b16 v[50:51], v16 offset:4608
    v_mfma_f32_16x16x32_bf16 v[116:119], v[36:39], v[72:75], v[116:119]
    v_mfma_f32_16x16x32_bf16 v[120:123], v[40:43], v[72:75], v[120:123]
    v_mfma_f32_16x16x32_bf16 v[124:127], v[44:47], v[72:75], v[124:127]
    ds_read_b128 v[72:75], v12 offset:12288
    ds_read_b64_tr_b16 v[52:53], v17 offset:4096
    s_waitcnt lgkmcnt(5)
    v_mfma_f32_16x16x32_bf16 v[128:131], v[32:35], v[76:79], v[128:131]
    buffer_load_dwordx4 v10, s[72:75], s35 offen offset:2048 lds
    v_mfma_f32_16x16x32_bf16 v[132:135], v[36:39], v[76:79], v[132:135]
    v_mfma_f32_16x16x32_bf16 v[136:139], v[40:43], v[76:79], v[136:139]
    ds_read_b64_tr_b16 v[54:55], v17 offset:4608
    v_mfma_f32_16x16x32_bf16 v[140:143], v[44:47], v[76:79], v[140:143]
    ds_read_b128 v[76:79], v12 offset:14336
    v_mfma_f32_16x16x32_bf16 v[144:147], v[32:35], v[64:67], v[144:147]
    buffer_load_dwordx4 v11, s[72:75], s35 offen offset:3072 lds
    s_add_u32 s35, s35, 221184
    v_mfma_f32_16x16x32_bf16 v[148:151], v[36:39], v[64:67], v[148:151]
    ds_read_b64_tr_b16 v[56:57], v16 offset:12288
    v_mfma_f32_16x16x32_bf16 v[152:155], v[40:43], v[64:67], v[152:155]
    v_mfma_f32_16x16x32_bf16 v[156:159], v[44:47], v[64:67], v[156:159]
    ds_read_b128 v[64:67], v13 offset:0
    s_waitcnt lgkmcnt(6)
    v_mfma_f32_16x16x32_bf16 v[160:163], v[32:35], v[68:71], v[160:163]
    ds_read_b64_tr_b16 v[58:59], v16 offset:12800
    v_mfma_f32_16x16x32_bf16 v[164:167], v[36:39], v[68:71], v[164:167]
    s_cbranch_vccnz VR24
    buffer_store_dwordx4 v[248:251], v4, s[8:11], s40 offen offset:0 sc1
VR24:
    v_mfma_f32_16x16x32_bf16 v[168:171], v[40:43], v[68:71], v[168:171]
    v_mfma_f32_16x16x32_bf16 v[172:175], v[44:47], v[68:71], v[172:175]
    ds_read_b128 v[68:71], v13 offset:2048
    ds_read_b64_tr_b16 v[60:61], v17 offset:12288
    s_waitcnt lgkmcnt(7)
    v_mfma_f32_16x16x32_bf16 v[176:179], v[32:35], v[72:75], v[176:179]
    v_mfma_f32_16x16x32_bf16 v[180:183], v[36:39], v[72:75], v[180:183]
    v_mfma_f32_16x16x32_bf16 v[184:187], v[40:43], v[72:75], v[184:187]
    ds_read_b64_tr_b16 v[62:63], v17 offset:12800
    v_mfma_f32_16x16x32_bf16 v[188:191], v[44:47], v[72:75], v[188:191]
    ds_read_b128 v[72:75], v13 offset:4096
    s_waitcnt lgkmcnt(6)
    v_mfma_f32_16x16x32_bf16 v[192:195], v[32:35], v[76:79], v[192:195]
    v_mfma_f32_16x16x32_bf16 v[196:199], v[36:39], v[76:79], v[196:199]
    v_mfma_f32_16x16x32_bf16 v[200:203], v[40:43], v[76:79], v[200:203]
    v_mfma_f32_16x16x32_bf16 v[204:207], v[44:47], v[76:79], v[204:207]
    ds_read_b128 v[76:79], v13 offset:6144
    s_waitcnt lgkmcnt(5)
    v_mfma_f32_16x16x32_bf16 v[80:83], v[48:51], v[64:67], v[80:83]
    v_mfma_f32_16x16x32_bf16 v[84:87], v[52:55], v[64:67], v[84:87]
    v_mfma_f32_16x16x32_bf16 v[88:91], v[56:59], v[64:67], v[88:91]
    s_waitcnt lgkmcnt(1)
    v_mfma_f32_16x16x32_bf16 v[92:95], v[60:63], v[64:67], v[92:95]
    ds_read_b128 v[64:67], v13 offset:8192
    v_mfma_f32_16x16x32_bf16 v[96:99], v[48:51], v[68:71], v[96:99]
    v_mfma_f32_16x16x32_bf16 v[100:103], v[52:55], v[68:71], v[100:103]
    v_mfma_f32_16x16x32_bf16 v[104:107], v[56:59], v[68:71], v[104:107]
    v_mfma_f32_16x16x32_bf16 v[108:111], v[60:63], v[68:71], v[108:111]
    ds_read_b128 v[68:71], v13 offset:10240
    v_mfma_f32_16x16x32_bf16 v[112:115], v[48:51], v[72:75], v[112:115]
    v_mfma_f32_16x16x32_bf16 v[116:119], v[52:55], v[72:75], v[116:119]
    v_mfma_f32_16x16x32_bf16 v[120:123], v[56:59], v[72:75], v[120:123]
    v_mfma_f32_16x16x32_bf16 v[124:127], v[60:63], v[72:75], v[124:127]
    ds_read_b128 v[72:75], v13 offset:12288
    s_waitcnt lgkmcnt(2)
    v_mfma_f32_16x16x32_bf16 v[128:131], v[48:51], v[76:79], v[128:131]
    v_mfma_f32_16x16x32_bf16 v[132:135], v[52:55], v[76:79], v[132:135]
    v_mfma_f32_16x16x32_bf16 v[136:139], v[56:59], v[76:79], v[136:139]
    v_mfma_f32_16x16x32_bf16 v[140:143], v[60:63], v[76:79], v[140:143]
    ds_read_b128 v[76:79], v13 offset:14336
    v_mfma_f32_16x16x32_bf16 v[144:147], v[48:51], v[64:67], v[144:147]
    v_mfma_f32_16x16x32_bf16 v[148:151], v[52:55], v[64:67], v[148:151]
    v_mfma_f32_16x16x32_bf16 v[152:155], v[56:59], v[64:67], v[152:155]
    v_mfma_f32_16x16x32_bf16 v[156:159], v[60:63], v[64:67], v[156:159]
    s_waitcnt lgkmcnt(1)
    v_mfma_f32_16x16x32_bf16 v[160:163], v[48:51], v[68:71], v[160:163]
    s_waitcnt vmcnt(1) lgkmcnt(0)
    s_cbranch_vccz VR32
    s_waitcnt vmcnt(0)
VR32:
    s_barrier
    ds_read_b64_tr_b16 v[32:33], v20 offset:0
    ds_read_b64_tr_b16 v[34:35], v20 offset:512
    ds_read_b128 v[64:67], v14 offset:0
    v_mfma_f32_16x16x32_bf16 v[164:167], v[52:55], v[68:71], v[164:167]
    ds_read_b64_tr_b16 v[36:37], v21 offset:0
    v_mfma_f32_16x16x32_bf16 v[168:171], v[56:59], v[68:71], v[168:171]
    ds_read_b64_tr_b16 v[38:39], v21 offset:512
    s_add_u32 m0, s36, 0
    s_nop 0
    buffer_load_dwordx4 v24, s[60:63], s34 offen offset:0 lds
    v_mfma_f32_16x16x32_bf16 v[172:175], v[60:63], v[68:71], v[172:175]
    ds_read_b64_tr_b16 v[40:41], v20 offset:8192
    ds_read_b128 v[68:71], v14 offset:2048
    v_mfma_f32_16x16x32_bf16 v[176:179], v[48:51], v[72:75], v[176:179]
    ds_read_b64_tr_b16 v[42:43], v20 offset:8704
    v_mfma_f32_16x16x32_bf16 v[180:183], v[52:55], v[72:75], v[180:183]
    ds_read_b64_tr_b16 v[44:45], v21 offset:8192
    buffer_load_dwordx4 v25, s[60:63], s34 offen offset:1024 lds
    v_mfma_f32_16x16x32_bf16 v[184:187], v[56:59], v[72:75], v[184:187]
    ds_read_b64_tr_b16 v[46:47], v21 offset:8704
    v_mfma_f32_16x16x32_bf16 v[188:191], v[60:63], v[72:75], v[188:191]
    ds_read_b128 v[72:75], v14 offset:4096
    v_mfma_f32_16x16x32_bf16 v[192:195], v[48:51], v[76:79], v[192:195]
    buffer_load_dwordx4 v26, s[60:63], s34 offen offset:2048 lds
    v_mfma_f32_16x16x32_bf16 v[196:199], v[52:55], v[76:79], v[196:199]
    v_mfma_f32_16x16x32_bf16 v[200:203], v[56:59], v[76:79], v[200:203]
    v_mfma_f32_16x16x32_bf16 v[204:207], v[60:63], v[76:79], v[204:207]
    ds_read_b128 v[76:79], v14 offset:6144
    s_waitcnt lgkmcnt(8)
    v_mfma_f32_16x16x32_bf16 v[80:83], v[32:35], v[64:67], v[80:83]
    buffer_load_dwordx4 v27, s[60:63], s34 offen offset:3072 lds
    s_add_u32 s34, s34, 128
    s_waitcnt lgkmcnt(6)
    v_mfma_f32_16x16x32_bf16 v[84:87], v[36:39], v[64:67], v[84:87]
    s_waitcnt lgkmcnt(3)
    v_mfma_f32_16x16x32_bf16 v[88:91], v[40:43], v[64:67], v[88:91]
    s_waitcnt lgkmcnt(1)
    v_mfma_f32_16x16x32_bf16 v[92:95], v[44:47], v[64:67], v[92:95]
    ds_read_b128 v[64:67], v14 offset:8192
    v_mfma_f32_16x16x32_bf16 v[96:99], v[32:35], v[68:71], v[96:99]
    s_add_u32 m0, s37, 0
    s_nop 0
    buffer_load_dwordx4 v8, s[72:75], s35 offen offset:0 lds
    v_mfma_f32_16x16x32_bf16 v[100:103], v[36:39], v[68:71], v[100:103]
    ds_read_b64_tr_b16 v[48:49], v20 offset:4096
    v_mfma_f32_16x16x32_bf16 v[104:107], v[40:43], v[68:71], v[104:107]
    v_mfma_f32_16x16x32_bf16 v[108:111], v[44:47], v[68:71], v[108:111]
    ds_read_b128 v[68:71], v14 offset:10240
    v_mfma_f32_16x16x32_bf16 v[112:115], v[32:35], v[72:75], v[112:115]
    buffer_load_dwordx4 v9, s[72:75], s35 offen offset:1024 lds
    ds_read_b64_tr_b16 v[50:51], v20 offset:4608
    v_mfma_f32_16x16x32_bf16 v[116:119], v[36:39], v[72:75], v[116:119]
    v_mfma_f32_16x16x32_bf16 v[120:123], v[40:43], v[72:75], v[120:123]
    v_mfma_f32_16x16x32_bf16 v[124:127], v[44:47], v[72:75], v[124:127]
    ds_read_b128 v[72:75], v14 offset:12288
    ds_read_b64_tr_b16 v[52:53], v21 offset:4096
    s_waitcnt lgkmcnt(5)
    v_mfma_f32_16x16x32_bf16 v[128:131], v[32:35], v[76:79], v[128:131]
    buffer_load_dwordx4 v10, s[72:75], s35 offen offset:2048 lds
    v_mfma_f32_16x16x32_bf16 v[132:135], v[36:39], v[76:79], v[132:135]
    v_mfma_f32_16x16x32_bf16 v[136:139], v[40:43], v[76:79], v[136:139]
    ds_read_b64_tr_b16 v[54:55], v21 offset:4608
    v_mfma_f32_16x16x32_bf16 v[140:143], v[44:47], v[76:79], v[140:143]
    ds_read_b128 v[76:79], v14 offset:14336
    v_mfma_f32_16x16x32_bf16 v[144:147], v[32:35], v[64:67], v[144:147]
    buffer_load_dwordx4 v11, s[72:75], s35 offen offset:3072 lds
    s_add_u32 s35, s35, 221184
    v_mfma_f32_16x16x32_bf16 v[148:151], v[36:39], v[64:67], v[148:151]
    ds_read_b64_tr_b16 v[56:57], v20 offset:12288
    v_mfma_f32_16x16x32_bf16 v[152:155], v[40:43], v[64:67], v[152:155]
    v_mfma_f32_16x16x32_bf16 v[156:159], v[44:47], v[64:67], v[156:159]
    ds_read_b128 v[64:67], v15 offset:0
    s_waitcnt lgkmcnt(6)
    v_mfma_f32_16x16x32_bf16 v[160:163], v[32:35], v[68:71], v[160:163]
    ds_read_b64_tr_b16 v[58:59], v20 offset:12800
    v_mfma_f32_16x16x32_bf16 v[164:167], v[36:39], v[68:71], v[164:167]
    s_cbranch_vccnz VR25
    buffer_store_dwordx4 v[252:255], v4, s[8:11], s40 offen offset:1024 sc1
    s_add_u32 s40, s40, 4096
VR25:
    v_mfma_f32_16x16x32_bf16 v[168:171], v[40:43], v[68:71], v[168:171]
    v_mfma_f32_16x16x32_bf16 v[172:175], v[44:47], v[68:71], v[172:175]
    ds_read_b128 v[68:71], v15 offset:2048
    ds_read_b64_tr_b16 v[60:61], v21 offset:12288
    s_waitcnt lgkmcnt(7)
    v_mfma_f32_16x16x32_bf16 v[176:179], v[32:35], v[72:75], v[176:179]
    v_mfma_f32_16x16x32_bf16 v[180:183], v[36:39], v[72:75], v[180:183]
    v_mfma_f32_16x16x32_bf16 v[184:187], v[40:43], v[72:75], v[184:187]
    ds_read_b64_tr_b16 v[62:63], v21 offset:12800
    v_mfma_f32_16x16x32_bf16 v[188:191], v[44:47], v[72:75], v[188:191]
    ds_read_b128 v[72:75], v15 offset:4096
    s_waitcnt lgkmcnt(6)
    v_mfma_f32_16x16x32_bf16 v[192:195], v[32:35], v[76:79], v[192:195]
    v_mfma_f32_16x16x32_bf16 v[196:199], v[36:39], v[76:79], v[196:199]
    v_mfma_f32_16x16x32_bf16 v[200:203], v[40:43], v[76:79], v[200:203]
    v_mfma_f32_16x16x32_bf16 v[204:207], v[44:47], v[76:79], v[204:207]
    ds_read_b128 v[76:79], v15 offset:6144
    s_waitcnt lgkmcnt(5)
    v_mfma_f32_16x16x32_bf16 v[80:83], v[48:51], v[64:67], v[80:83]
    v_mfma_f32_16x16x32_bf16 v[84:87], v[52:55], v[64:67], v[84:87]
    v_mfma_f32_16x16x32_bf16 v[88:91], v[56:59], v[64:67], v[88:91]
    s_waitcnt lgkmcnt(1)
    v_mfma_f32_16x16x32_bf16 v[92:95], v[60:63], v[64:67], v[92:95]
    ds_read_b128 v[64:67], v15 offset:8192
    v_mfma_f32_16x16x32_bf16 v[96:99], v[48:51], v[68:71], v[96:99]
    v_mfma_f32_16x16x32_bf16 v[100:103], v[52:55], v[68:71], v[100:103]
    v_mfma_f32_16x16x32_bf16 v[104:107], v[56:59], v[68:71], v[104:107]
    v_mfma_f32_16x16x32_bf16 v[108:111], v[60:63], v[68:71], v[108:111]
    ds_read_b128 v[68:71], v15 offset:10240
    v_mfma_f32_16x16x32_bf16 v[112:115], v[48:51], v[72:75], v[112:115]
    s_lshl_b32 s44, s6, 19
    s_add_u32 s44, s44, s36
    s_add_u32 s44, s44, 0x0
    s_add_u32 s45, s44, 0x1000000
    s_mov_b32 s46, s36
    s_add_u32 s47, s36, 98304
    v_mfma_f32_16x16x32_bf16 v[116:119], v[52:55], v[72:75], v[116:119]
    v_mfma_f32_16x16x32_bf16 v[120:123], v[56:59], v[72:75], v[120:123]
    v_mfma_f32_16x16x32_bf16 v[124:127], v[60:63], v[72:75], v[124:127]
    ds_read_b128 v[72:75], v15 offset:12288
    s_waitcnt lgkmcnt(2)
    v_mfma_f32_16x16x32_bf16 v[128:131], v[48:51], v[76:79], v[128:131]
    v_mfma_f32_16x16x32_bf16 v[132:135], v[52:55], v[76:79], v[132:135]
    v_mfma_f32_16x16x32_bf16 v[136:139], v[56:59], v[76:79], v[136:139]
    v_mfma_f32_16x16x32_bf16 v[140:143], v[60:63], v[76:79], v[140:143]
    ds_read_b128 v[76:79], v15 offset:14336
    v_mfma_f32_16x16x32_bf16 v[144:147], v[48:51], v[64:67], v[144:147]
    v_mfma_f32_16x16x32_bf16 v[148:151], v[52:55], v[64:67], v[148:151]
    v_mfma_f32_16x16x32_bf16 v[152:155], v[56:59], v[64:67], v[152:155]
    v_mfma_f32_16x16x32_bf16 v[156:159], v[60:63], v[64:67], v[156:159]
    s_waitcnt lgkmcnt(1)
    v_mfma_f32_16x16x32_bf16 v[160:163], v[48:51], v[68:71], v[160:163]
    s_waitcnt vmcnt(1) lgkmcnt(0)
    s_cbranch_vccz VR33
    s_waitcnt vmcnt(0)
VR33:
    s_barrier
    ds_read_b64_tr_b16 v[32:33], v16 offset:0
    ds_read_b64_tr_b16 v[34:35], v16 offset:512
    ds_read_b128 v[64:67], v12 offset:0
    v_mfma_f32_16x16x32_bf16 v[164:167], v[52:55], v[68:71], v[164:167]
    ds_read_b64_tr_b16 v[36:37], v17 offset:0
    v_mfma_f32_16x16x32_bf16 v[168:171], v[56:59], v[68:71], v[168:171]
    ds_read_b64_tr_b16 v[38:39], v17 offset:512
    s_add_u32 m0, s36, 65536
    s_nop 0
    buffer_load_dwordx4 v24, s[60:63], s34 offen offset:0 lds
    v_mfma_f32_16x16x32_bf16 v[172:175], v[60:63], v[68:71], v[172:175]
    ds_read_b64_tr_b16 v[40:41], v16 offset:8192
    ds_read_b128 v[68:71], v12 offset:2048
    v_mfma_f32_16x16x32_bf16 v[176:179], v[48:51], v[72:75], v[176:179]
    ds_read_b64_tr_b16 v[42:43], v16 offset:8704
    v_mfma_f32_16x16x32_bf16 v[180:183], v[52:55], v[72:75], v[180:183]
    ds_read_b64_tr_b16 v[44:45], v17 offset:8192
    buffer_load_dwordx4 v25, s[60:63], s34 offen offset:1024 lds
    v_mfma_f32_16x16x32_bf16 v[184:187], v[56:59], v[72:75], v[184:187]
    ds_read_b64_tr_b16 v[46:47], v17 offset:8704
    v_mfma_f32_16x16x32_bf16 v[188:191], v[60:63], v[72:75], v[188:191]
    ds_read_b128 v[72:75], v12 offset:4096
    v_mfma_f32_16x16x32_bf16 v[192:195], v[48:51], v[76:79], v[192:195]
    buffer_load_dwordx4 v26, s[60:63], s34 offen offset:2048 lds
    v_mfma_f32_16x16x32_bf16 v[196:199], v[52:55], v[76:79], v[196:199]
    v_mfma_f32_16x16x32_bf16 v[200:203], v[56:59], v[76:79], v[200:203]
    v_mfma_f32_16x16x32_bf16 v[204:207], v[60:63], v[76:79], v[204:207]
    ds_read_b128 v[76:79], v12 offset:6144
    s_waitcnt lgkmcnt(8)
    v_mfma_f32_16x16x32_bf16 v[80:83], v[32:35], v[64:67], v[80:83]
    buffer_load_dwordx4 v27, s[60:63], s34 offen offset:3072 lds
    s_add_u32 s34, s34, 128
    s_waitcnt lgkmcnt(6)
    v_mfma_f32_16x16x32_bf16 v[84:87], v[36:39], v[64:67], v[84:87]
    s_waitcnt lgkmcnt(3)
    v_mfma_f32_16x16x32_bf16 v[88:91], v[40:43], v[64:67], v[88:91]
    s_waitcnt lgkmcnt(1)
    v_mfma_f32_16x16x32_bf16 v[92:95], v[44:47], v[64:67], v[92:95]
    ds_read_b128 v[64:67], v12 offset:8192
    v_mfma_f32_16x16x32_bf16 v[96:99], v[32:35], v[68:71], v[96:99]
    s_add_u32 m0, s37, 65536
    s_nop 0
    buffer_load_dwordx4 v8, s[72:75], s35 offen offset:0 lds
    v_mfma_f32_16x16x32_bf16 v[100:103], v[36:39], v[68:71], v[100:103]
    ds_read_b64_tr_b16 v[48:49], v16 offset:4096
    v_mfma_f32_16x16x32_bf16 v[104:107], v[40:43], v[68:71], v[104:107]
    s_and_b32 s80, s4, 3
    s_lshr_b32 s81, s4, 2
    s_lshl_b32 s81, s81, 3
    v_mfma_f32_16x16x32_bf16 v[108:111], v[44:47], v[68:71], v[108:111]
    ds_read_b128 v[68:71], v12 offset:10240
    s_add_u32 s81, s81, s7
    s_sub_u32 s82, 15, s81
    v_mfma_f32_16x16x32_bf16 v[112:115], v[32:35], v[72:75], v[112:115]
    buffer_load_dwordx4 v9, s[72:75], s35 offen offset:1024 lds
    ds_read_b64_tr_b16 v[50:51], v16 offset:4608
    s_min_u32 s82, s82, s81
    s_and_b32 s83, s5, 3
    v_mfma_f32_16x16x32_bf16 v[116:119], v[36:39], v[72:75], v[116:119]
    s_lshl_b32 s84, s7, 1
    s_sub_u32 s85, 30, s84
    v_mfma_f32_16x16x32_bf16 v[120:123], v[40:43], v[72:75], v[120:123]
    s_lshl_b32 s86, s81, 1
    s_mov_b32 s88, 0xcccc
    s_mov_b32 s89, 0
    v_mfma_f32_16x16x32_bf16 v[124:127], v[44:47], v[72:75], v[124:127]
    ds_read_b128 v[72:75], v12 offset:12288
    ds_read_b64_tr_b16 v[52:53], v17 offset:4096
    s_mov_b32 s90, 0xffff0000
    s_mov_b32 s91, -1
    s_waitcnt lgkmcnt(5)
    v_mfma_f32_16x16x32_bf16 v[128:131], v[32:35], v[76:79], v[128:131]
    buffer_load_dwordx4 v10, s[72:75], s35 offen offset:2048 lds
    v_mov_b32 v24, s85
    v_mov_b32 v25, s84
    v_mfma_f32_16x16x32_bf16 v[132:135], v[36:39], v[76:79], v[132:135]
    v_cndmask_b32 v24, v24, v25, s[88:89]
    v_mov_b32 v25, s86
    v_mfma_f32_16x16x32_bf16 v[136:139], v[40:43], v[76:79], v[136:139]
    ds_read_b64_tr_b16 v[54:55], v17 offset:4608
    v_cndmask_b32 v24, v24, v25, s[90:91]
    v_and_b32 v25, 1, v1
    v_add_u32 v24, v24, v25
    v_mfma_f32_16x16x32_bf16 v[140:143], v[44:47], v[76:79], v[140:143]
    ds_read_b128 v[76:79], v12 offset:14336
    v_mul_u32_u24 v25, 52, v24
    v_lshrrev_b32 v25, 8, v25
    v_mfma_f32_16x16x32_bf16 v[144:147], v[32:35], v[64:67], v[144:147]
    buffer_load_dwordx4 v11, s[72:75], s35 offen offset:3072 lds
    s_add_u32 s35, s35, 221184
    v_lshlrev_b32 v26, 1, v25
    v_sub_u32 v24, v24, v26
    v_mfma_f32_16x16x32_bf16 v[148:151], v[36:39], v[64:67], v[148:151]
    ds_read_b64_tr_b16 v[56:57], v16 offset:12288
    v_add_u32 v24, 3, v24
    v_and_b32 v24, 7, v24
    v_mfma_f32_16x16x32_bf16 v[152:155], v[40:43], v[64:67], v[152:155]
    v_lshl_add_u32 v24, v25, 5, v24
    v_add_u32 v24, 24, v24
    s_mul_i32 s84, s80, 7
    v_mfma_f32_16x16x32_bf16 v[156:159], v[44:47], v[64:67], v[156:159]
    ds_read_b128 v[64:67], v13 offset:0
    v_and_b32 v27, 7, v1
    v_min_u32 v25, 6, v27
    s_waitcnt lgkmcnt(6)
    v_mfma_f32_16x16x32_bf16 v[160:163], v[32:35], v[68:71], v[160:163]
    ds_read_b64_tr_b16 v[58:59], v16 offset:12800
    v_add_u32 v25, s84, v25
    v_min_u32 v25, 26, v25
    v_mfma_f32_16x16x32_bf16 v[164:167], v[36:39], v[68:71], v[164:167]
    v_and_b32 v26, 7, v25
    v_lshlrev_b32 v26, 2, v26
    v_mfma_f32_16x16x32_bf16 v[168:171], v[40:43], v[68:71], v[168:171]
    v_lshrrev_b32 v31, 3, v25
    v_add_u32 v26, v26, v31
    s_lshr_b32 s54, s4, 2
    v_mfma_f32_16x16x32_bf16 v[172:175], v[44:47], v[68:71], v[172:175]
    ds_read_b128 v[68:71], v13 offset:2048
    ds_read_b64_tr_b16 v[60:61], v17 offset:12288
    v_cmp_le_u32 s[88:89], 24, v25
    v_subrev_u32 v25, 24, v25
    v_lshlrev_b32 v25, 3, v25
    s_lshl_b32 s54, s54, 5
    s_waitcnt lgkmcnt(7)
    v_mfma_f32_16x16x32_bf16 v[176:179], v[32:35], v[72:75], v[176:179]
    v_add_u32 v25, s82, v25
    v_mul_u32_u24 v25, 86, v25
    s_add_u32 s54, s54, s5
    v_mfma_f32_16x16x32_bf16 v[180:183], v[36:39], v[72:75], v[180:183]
    v_lshrrev_b32 v25, 8, v25
    v_lshlrev_b32 v25, 2, v25
    s_lshl_b32 s54, s54, 2
    v_mfma_f32_16x16x32_bf16 v[184:187], v[40:43], v[72:75], v[184:187]
    ds_read_b64_tr_b16 v[62:63], v17 offset:12800
    v_add_u32 v25, 3, v25
    v_cndmask_b32 v26, v26, v25, s[88:89]
    v_mfma_f32_16x16x32_bf16 v[188:191], v[44:47], v[72:75], v[188:191]
    ds_read_b128 v[72:75], v13 offset:4096
    v_lshlrev_b32 v26, 3, v26
    v_add_u32 v26, s82, v26
    s_mov_b32 s88, 0x00ff0000
    s_and_b32 s55, s4, 3
    s_waitcnt lgkmcnt(6)
    v_mfma_f32_16x16x32_bf16 v[192:195], v[32:35], v[76:79], v[192:195]
    s_mov_b32 s89, 0
    v_cndmask_b32 v24, v24, v26, s[88:89]
    s_add_u32 s54, s54, s55
    v_mfma_f32_16x16x32_bf16 v[196:199], v[36:39], v[76:79], v[196:199]
    s_and_b32 s84, s4, 4
    s_lshl_b32 s84, s84, 2
    s_lshl_b32 s54, s54, 3
    v_mfma_f32_16x16x32_bf16 v[200:203], v[40:43], v[76:79], v[200:203]
    s_add_u32 s84, s84, s83
    s_lshl_b32 s84, s84, 3
    v_mfma_f32_16x16x32_bf16 v[204:207], v[44:47], v[76:79], v[204:207]
    ds_read_b128 v[76:79], v13 offset:6144
    s_add_u32 s84, s84, s7
    v_and_b32 v25, 3, v1
    v_lshlrev_b32 v25, 5, v25
    s_add_u32 s54, s54, s3
    s_waitcnt lgkmcnt(5)
    v_mfma_f32_16x16x32_bf16 v[80:83], v[48:51], v[64:67], v[80:83]
    v_add_u32 v25, s84, v25
    s_mov_b32 s90, 0xf0000000
    s_mul_i32 s54, s54, 3840
    v_mfma_f32_16x16x32_bf16 v[84:87], v[52:55], v[64:67], v[84:87]
    s_mov_b32 s91, 0
    v_cndmask_b32 v24, v24, v25, s[90:91]
    s_add_u32 s54, s54, 0x4000000
    v_mfma_f32_16x16x32_bf16 v[88:91], v[56:59], v[64:67], v[88:91]
    s_lshl_b32 s84, s6, 3
    v_add_u32 v25, s84, v27
    v_mov_b32 v252, -1
    s_waitcnt lgkmcnt(1)
    v_mfma_f32_16x16x32_bf16 v[92:95], v[60:63], v[64:67], v[92:95]
    ds_read_b128 v[64:67], v13 offset:8192
    s_mov_b32 s88, 0xff
    v_cndmask_b32 v24, v24, v25, s[88:89]
    s_lshl_b32 s84, s80, 6
    v_mfma_f32_16x16x32_bf16 v[96:99], v[48:51], v[68:71], v[96:99]
    s_add_u32 s84, s84, s82
    v_lshlrev_b32 v25, 3, v27
    v_mov_b32 v253, -1
    v_mfma_f32_16x16x32_bf16 v[100:103], v[52:55], v[68:71], v[100:103]
    v_add_u32 v25, s84, v25
    s_mov_b32 s90, 0
    v_mov_b32 v254, -1
    v_mfma_f32_16x16x32_bf16 v[104:107], v[56:59], v[68:71], v[104:107]
    s_mov_b32 s91, -1
    v_cndmask_b32 v24, v24, v25, s[90:91]
    v_mov_b32 v255, -1
    v_mfma_f32_16x16x32_bf16 v[108:111], v[60:63], v[68:71], v[108:111]
    ds_read_b128 v[68:71], v13 offset:10240
    v_lshlrev_b32 v24, 8, v24
    v_add_u32 v1, 0x3900000, v24
    v_mfma_f32_16x16x32_bf16 v[112:115], v[48:51], v[72:75], v[112:115]
    v_mfma_f32_16x16x32_bf16 v[116:119], v[52:55], v[72:75], v[116:119]
    s_mov_b32 exec_lo, 0x1
    s_mov_b32 exec_hi, 0x0
    buffer_load_dword v28, v1, s[8:11], 0 offen sc1
    s_mov_b64 exec, -1
    v_mfma_f32_16x16x32_bf16 v[120:123], v[56:59], v[72:75], v[120:123]
    v_mov_b32 v208, 0
    v_mov_b32 v209, 0
    v_mfma_f32_16x16x32_bf16 v[124:127], v[60:63], v[72:75], v[124:127]
    ds_read_b128 v[72:75], v13 offset:12288
    v_mov_b32 v210, 0
    v_mov_b32 v211, 0
    s_waitcnt lgkmcnt(2)
    v_mfma_f32_16x16x32_bf16 v[128:131], v[48:51], v[76:79], v[128:131]
    v_mov_b32 v212, 0
    v_mov_b32 v213, 0
    v_mfma_f32_16x16x32_bf16 v[132:135], v[52:55], v[76:79], v[132:135]
    v_mov_b32 v214, 0
    v_mov_b32 v215, 0
    v_mfma_f32_16x16x32_bf16 v[136:139], v[56:59], v[76:79], v[136:139]
    v_mov_b32 v216, 0
    v_mov_b32 v217, 0
    v_mfma_f32_16x16x32_bf16 v[140:143], v[60:63], v[76:79], v[140:143]
    ds_read_b128 v[76:79], v13 offset:14336
    v_mov_b32 v218, 0
    v_mov_b32 v219, 0
    v_mfma_f32_16x16x32_bf16 v[144:147], v[48:51], v[64:67], v[144:147]
    v_mov_b32 v220, 0
    v_mov_b32 v221, 0
    v_mfma_f32_16x16x32_bf16 v[148:151], v[52:55], v[64:67], v[148:151]
    v_mov_b32 v222, 0
    v_mov_b32 v223, 0
    v_mfma_f32_16x16x32_bf16 v[152:155], v[56:59], v[64:67], v[152:155]
    v_mov_b32 v224, 0
    v_mov_b32 v225, 0
    v_mfma_f32_16x16x32_bf16 v[156:159], v[60:63], v[64:67], v[156:159]
    v_mov_b32 v226, 0
    v_mov_b32 v227, 0
    s_waitcnt lgkmcnt(1)
    v_mfma_f32_16x16x32_bf16 v[160:163], v[48:51], v[68:71], v[160:163]
    s_waitcnt vmcnt(1) lgkmcnt(0)
    s_barrier
    s_waitcnt vmcnt(0)
    s_add_u32 s26, s38, 1
    v_subrev_u32 v28, s26, v28
    v_cmp_le_u32 vcc, 7, v28
    s_mov_b32 s26, 0x1
    s_mov_b32 s27, 0x0
    s_and_b64 vcc, s[26:27], vcc
    s_cbranch_vccnz PL1_0_S
PL1_0_C:
    ds_read_b64_tr_b16 v[32:33], v20 offset:0
    ds_read_b64_tr_b16 v[34:35], v20 offset:512
    ds_read_b128 v[64:67], v14 offset:0
    v_mfma_f32_16x16x32_bf16 v[164:167], v[52:55], v[68:71], v[164:167]
    ds_read_b64_tr_b16 v[36:37], v21 offset:0
    v_mfma_f32_16x16x32_bf16 v[168:171], v[56:59], v[68:71], v[168:171]
    ds_read_b64_tr_b16 v[38:39], v21 offset:512
    s_mov_b32 m0, s46
    s_nop 0
    buffer_load_dwordx4 v4, s[8:11], s44 offen offset:0 sc1 lds
    v_mfma_f32_16x16x32_bf16 v[172:175], v[60:63], v[68:71], v[172:175]
    ds_read_b64_tr_b16 v[40:41], v20 offset:8192
    ds_read_b128 v[68:71], v14 offset:2048
    v_mfma_f32_16x16x32_bf16 v[176:179], v[48:51], v[72:75], v[176:179]
    ds_read_b64_tr_b16 v[42:43], v20 offset:8704
    v_mfma_f32_16x16x32_bf16 v[180:183], v[52:55], v[72:75], v[180:183]
    ds_read_b64_tr_b16 v[44:45], v21 offset:8192
    buffer_load_dwordx4 v4, s[8:11], s44 offen offset:1024 sc1 lds
    v_mfma_f32_16x16x32_bf16 v[184:187], v[56:59], v[72:75], v[184:187]
    ds_read_b64_tr_b16 v[46:47], v21 offset:8704
    v_mfma_f32_16x16x32_bf16 v[188:191], v[60:63], v[72:75], v[188:191]
    ds_read_b128 v[72:75], v14 offset:4096
    v_mfma_f32_16x16x32_bf16 v[192:195], v[48:51], v[76:79], v[192:195]
    buffer_load_dwordx4 v4, s[8:11], s44 offen offset:2048 sc1 lds
    v_mfma_f32_16x16x32_bf16 v[196:199], v[52:55], v[76:79], v[196:199]
    v_mfma_f32_16x16x32_bf16 v[200:203], v[56:59], v[76:79], v[200:203]
    v_mfma_f32_16x16x32_bf16 v[204:207], v[60:63], v[76:79], v[204:207]
    ds_read_b128 v[76:79], v14 offset:6144
    s_waitcnt lgkmcnt(8)
    v_mfma_f32_16x16x32_bf16 v[80:83], v[32:35], v[64:67], v[80:83]
    buffer_load_dwordx4 v4, s[8:11], s44 offen offset:3072 sc1 lds
    s_add_u32 s44, s44, 32768
    s_xor_b32 s46, s46, 0x10000
    v_mov_b32 v228, 0
    v_mov_b32 v229, 0
    s_waitcnt lgkmcnt(6)
    v_mfma_f32_16x16x32_bf16 v[84:87], v[36:39], v[64:67], v[84:87]
    v_mov_b32 v230, 0
    s_waitcnt lgkmcnt(3)
    v_mfma_f32_16x16x32_bf16 v[88:91], v[40:43], v[64:67], v[88:91]
    v_mov_b32 v231, 0
    s_waitcnt lgkmcnt(1)
    v_mfma_f32_16x16x32_bf16 v[92:95], v[44:47], v[64:67], v[92:95]
    ds_read_b128 v[64:67], v14 offset:8192
    v_mov_b32 v232, 0
    v_mfma_f32_16x16x32_bf16 v[96:99], v[32:35], v[68:71], v[96:99]
    v_mov_b32 v233, 0
    v_mfma_f32_16x16x32_bf16 v[100:103], v[36:39], v[68:71], v[100:103]
    ds_read_b64_tr_b16 v[48:49], v20 offset:4096
    v_mov_b32 v234, 0
    v_mfma_f32_16x16x32_bf16 v[104:107], v[40:43], v[68:71], v[104:107]
    v_mov_b32 v235, 0
    v_mfma_f32_16x16x32_bf16 v[108:111], v[44:47], v[68:71], v[108:111]
    ds_read_b128 v[68:71], v14 offset:10240
    v_mov_b32 v236, 0
    v_mov_b32 v237, 0
    v_mfma_f32_16x16x32_bf16 v[112:115], v[32:35], v[72:75], v[112:115]
    ds_read_b64_tr_b16 v[50:51], v20 offset:4608
    v_mov_b32 v238, 0
    v_mfma_f32_16x16x32_bf16 v[116:119], v[36:39], v[72:75], v[116:119]
    v_mov_b32 v239, 0
    v_mfma_f32_16x16x32_bf16 v[120:123], v[40:43], v[72:75], v[120:123]
    v_mov_b32 v240, 0
    v_mfma_f32_16x16x32_bf16 v[124:127], v[44:47], v[72:75], v[124:127]
    ds_read_b128 v[72:75], v14 offset:12288
    ds_read_b64_tr_b16 v[52:53], v21 offset:4096
    v_mov_b32 v241, 0
    s_waitcnt lgkmcnt(5)
    v_mfma_f32_16x16x32_bf16 v[128:131], v[32:35], v[76:79], v[128:131]
    v_mov_b32 v242, 0
    v_mfma_f32_16x16x32_bf16 v[132:135], v[36:39], v[76:79], v[132:135]
    v_mov_b32 v243, 0
    v_mfma_f32_16x16x32_bf16 v[136:139], v[40:43], v[76:79], v[136:139]
    ds_read_b64_tr_b16 v[54:55], v21 offset:4608
    v_mov_b32 v244, 0
    v_mov_b32 v245, 0
    v_mfma_f32_16x16x32_bf16 v[140:143], v[44:47], v[76:79], v[140:143]
    ds_read_b128 v[76:79], v14 offset:14336
    v_mov_b32 v246, 0
    v_mfma_f32_16x16x32_bf16 v[144:147], v[32:35], v[64:67], v[144:147]
    v_mov_b32 v247, 0
    v_mfma_f32_16x16x32_bf16 v[148:151], v[36:39], v[64:67], v[148:151]
    ds_read_b64_tr_b16 v[56:57], v20 offset:12288
    v_mov_b32 v248, 0
    v_mfma_f32_16x16x32_bf16 v[152:155], v[40:43], v[64:67], v[152:155]
    v_mov_b32 v249, 0
    v_mfma_f32_16x16x32_bf16 v[156:159], v[44:47], v[64:67], v[156:159]
    ds_read_b128 v[64:67], v15 offset:0
    v_mov_b32 v250, 0
    s_waitcnt lgkmcnt(6)
    v_mfma_f32_16x16x32_bf16 v[160:163], v[32:35], v[68:71], v[160:163]
    ds_read_b64_tr_b16 v[58:59], v20 offset:12800
    v_mov_b32 v251, 0
    v_mfma_f32_16x16x32_bf16 v[164:167], v[36:39], v[68:71], v[164:167]
    v_mov_b32 v5, v4
    v_add_u32 v6, 98304, v4
    v_mfma_f32_16x16x32_bf16 v[168:171], v[40:43], v[68:71], v[168:171]
    s_and_b32 s24, s3, 3
    s_lshl_b32 s25, s24, 13
    buffer_store_dwordx4 v[252:255], v4, s[8:11], s54 offen offset:0 sc1
    v_mfma_f32_16x16x32_bf16 v[172:175], v[44:47], v[68:71], v[172:175]
    ds_read_b128 v[68:71], v15 offset:2048
    ds_read_b64_tr_b16 v[60:61], v21 offset:12288
    s_add_u32 s25, s25, 131072
    v_add_u32 v8, s25, v4
    s_waitcnt lgkmcnt(7)
    v_mfma_f32_16x16x32_bf16 v[176:179], v[32:35], v[72:75], v[176:179]
    s_add_u32 s48, s7, 1
    s_sub_u32 s49, 7, s7
    v_mfma_f32_16x16x32_bf16 v[180:183], v[36:39], v[72:75], v[180:183]
    s_mov_b32 s52, 0x10000
    s_mov_b32 s53, 0x43800000
    v_mfma_f32_16x16x32_bf16 v[184:187], v[40:43], v[72:75], v[184:187]
    ds_read_b64_tr_b16 v[62:63], v21 offset:12800
    s_lshl_b32 s25, s6, 15
    s_add_u32 s25, s25, 0x206c000
    v_mfma_f32_16x16x32_bf16 v[188:191], v[44:47], v[72:75], v[188:191]
    ds_read_b128 v[72:75], v15 offset:4096
    s_lshl_b32 s26, s24, 12
    s_waitcnt lgkmcnt(6)
    v_mfma_f32_16x16x32_bf16 v[192:195], v[32:35], v[76:79], v[192:195]
    s_add_u32 s25, s25, s26
    s_mul_i32 s26, s7, 1490944
    buffer_store_dwordx4 v[252:255], v4, s[8:11], s54 offen offset:1024 sc1
    v_mfma_f32_16x16x32_bf16 v[196:199], v[36:39], v[76:79], v[196:199]
    s_add_u32 s58, s25, s26
    s_sub_u32 s26, 15, s7
    v_mfma_f32_16x16x32_bf16 v[200:203], v[40:43], v[76:79], v[200:203]
    s_mul_i32 s26, s26, 1490944
    s_add_u32 s57, s25, s26
    v_mfma_f32_16x16x32_bf16 v[204:207], v[44:47], v[76:79], v[204:207]
    ds_read_b128 v[76:79], v15 offset:6144
    s_cmp_eq_u32 s7, 7
    s_cselect_b32 s50, 1, 0
    s_mov_b32 s59, s50
    s_waitcnt lgkmcnt(5)
    v_mfma_f32_16x16x32_bf16 v[80:83], v[48:51], v[64:67], v[80:83]
    s_mov_b32 s56, 0
    s_mov_b32 s31, 3
    v_mfma_f32_16x16x32_bf16 v[84:87], v[52:55], v[64:67], v[84:87]
    s_and_b32 s27, s3, 3
    v_mfma_f32_16x16x32_bf16 v[88:91], v[56:59], v[64:67], v[88:91]
    s_lshl_b32 s27, s27, 5
    v_lshlrev_b32 v29, 2, v3
    buffer_store_dwordx4 v[252:255], v4, s[8:11], s54 offen offset:2048 sc1
    s_waitcnt lgkmcnt(1)
    v_mfma_f32_16x16x32_bf16 v[92:95], v[60:63], v[64:67], v[92:95]
    ds_read_b128 v[64:67], v15 offset:8192
    v_sub_u32 v29, v2, v29
    v_add_u32 v29, s27, v29
    v_mfma_f32_16x16x32_bf16 v[96:99], v[48:51], v[68:71], v[96:99]
    v_cmp_gt_i32 s[60:61], -16, v29
    v_cmp_gt_i32 s[62:63], -15, v29
    v_mfma_f32_16x16x32_bf16 v[100:103], v[52:55], v[68:71], v[100:103]
    v_cmp_gt_i32 s[64:65], -14, v29
    v_cmp_gt_i32 s[66:67], -13, v29
    v_mfma_f32_16x16x32_bf16 v[104:107], v[56:59], v[68:71], v[104:107]
    v_cmp_gt_i32 s[68:69], 0, v29
    v_cmp_gt_i32 s[70:71], 1, v29
    v_mfma_f32_16x16x32_bf16 v[108:111], v[60:63], v[68:71], v[108:111]
    ds_read_b128 v[68:71], v15 offset:10240
    v_cmp_gt_i32 s[72:73], 2, v29
    v_cmp_gt_i32 s[74:75], 3, v29
    v_mfma_f32_16x16x32_bf16 v[112:115], v[48:51], v[72:75], v[112:115]
    v_cmp_gt_i32 s[76:77], 16, v29
    s_mov_b32 exec_hi, 0xffff
    buffer_store_dwordx4 v[252:255], v4, s[8:11], s54 offen offset:3072 sc1
    s_mov_b32 exec_hi, -1
    v_mfma_f32_16x16x32_bf16 v[116:119], v[52:55], v[72:75], v[116:119]
    v_cmp_gt_i32 s[78:79], 17, v29
    v_cmp_gt_i32 s[80:81], 18, v29
    v_mfma_f32_16x16x32_bf16 v[120:123], v[56:59], v[72:75], v[120:123]
    v_cmp_gt_i32 s[82:83], 19, v29
    v_cmp_gt_i32 s[84:85], 32, v29
    v_mfma_f32_16x16x32_bf16 v[124:127], v[60:63], v[72:75], v[124:127]
    ds_read_b128 v[72:75], v15 offset:12288
    v_cmp_gt_i32 s[86:87], 33, v29
    v_cmp_gt_i32 s[88:89], 34, v29
    s_waitcnt lgkmcnt(2)
    v_mfma_f32_16x16x32_bf16 v[128:131], v[48:51], v[76:79], v[128:131]
    v_cmp_gt_i32 s[90:91], 35, v29
    v_cmp_gt_i32 s[92:93], 48, v29
    v_mfma_f32_16x16x32_bf16 v[132:135], v[52:55], v[76:79], v[132:135]
    v_cmp_gt_i32 s[94:95], 49, v29
    v_cmp_gt_i32 s[96:97], 50, v29
    v_mfma_f32_16x16x32_bf16 v[136:139], v[56:59], v[76:79], v[136:139]
    v_cmp_gt_i32 s[98:99], 51, v29
    v_mfma_f32_16x16x32_bf16 v[140:143], v[60:63], v[76:79], v[140:143]
    ds_read_b128 v[76:79], v15 offset:14336
    v_mfma_f32_16x16x32_bf16 v[144:147], v[48:51], v[64:67], v[144:147]
    s_waitcnt vmcnt(4) lgkmcnt(0)
    s_barrier
    s_cmp_lg_u32 s3, 0
    s_cbranch_scc1 SIG2_0
    v_mov_b32 v28, 2
    v_add_u32 v28, s38, v28
    s_mov_b64 exec, 1
    buffer_store_dword v28, off, s[8:11], s29 sc1
    s_mov_b64 exec, -1
SIG2_0:
    s_setprio 1
    v_mfma_f32_16x16x32_bf16 v[148:151], v[52:55], v[64:67], v[148:151]
    s_mov_b32 m0, s47
    s_nop 0
    buffer_load_dwordx4 v4, s[8:11], s45 offen offset:0 sc1 lds
    v_mfma_f32_16x16x32_bf16 v[152:155], v[56:59], v[64:67], v[152:155]
    v_mfma_f32_16x16x32_bf16 v[156:159], v[60:63], v[64:67], v[156:159]
    v_mfma_f32_16x16x32_bf16 v[160:163], v[48:51], v[68:71], v[160:163]
    buffer_load_dwordx4 v4, s[8:11], s45 offen offset:1024 sc1 lds
    v_mfma_f32_16x16x32_bf16 v[164:167], v[52:55], v[68:71], v[164:167]
    v_mfma_f32_16x16x32_bf16 v[168:171], v[56:59], v[68:71], v[168:171]
    v_mfma_f32_16x16x32_bf16 v[172:175], v[60:63], v[68:71], v[172:175]
    v_mfma_f32_16x16x32_bf16 v[176:179], v[48:51], v[72:75], v[176:179]
    buffer_load_dwordx4 v4, s[8:11], s45 offen offset:2048 sc1 lds
    v_mfma_f32_16x16x32_bf16 v[180:183], v[52:55], v[72:75], v[180:183]
    v_mfma_f32_16x16x32_bf16 v[184:187], v[56:59], v[72:75], v[184:187]
    v_mfma_f32_16x16x32_bf16 v[188:191], v[60:63], v[72:75], v[188:191]
    buffer_load_dwordx4 v4, s[8:11], s45 offen offset:3072 sc1 lds
    s_add_u32 s45, s45, 32768
    s_xor_b32 s47, s47, 0x10000
    v_mfma_f32_16x16x32_bf16 v[192:195], v[48:51], v[76:79], v[192:195]
    v_mfma_f32_16x16x32_bf16 v[196:199], v[52:55], v[76:79], v[196:199]
    v_mfma_f32_16x16x32_bf16 v[200:203], v[56:59], v[76:79], v[200:203]
    v_mfma_f32_16x16x32_bf16 v[204:207], v[60:63], v[76:79], v[204:207]
    s_nop 1
    v_mov_b32 v11, 0
    v_mov_b32 v12, 0
    v_mov_b32 v15, 0xff61b1e6
    s_sub_u32 s24, 15, s7
    s_cmp_lt_u32 s3, 2
    s_cselect_b32 s40, s24, s7
    s_mul_i32 s40, s40, 1490944
    s_add_u32 s40, s40, 0x2000000
    s_lshl_b32 s25, s39, 14
    s_add_u32 s40, s40, s25
    s_and_b32 s24, s3, 1
    s_lshl_b32 s24, s24, 10
    s_add_u32 s40, s40, s24
    s_mov_b32 s24, 0xbdd2d3e8
    s_mov_b32 s25, s24
    s_mov_b32 s26, 1.0
    s_mov_b32 s27, 1.0
    v_mov_b32 v30, 0xc0135761
    v_mov_b32 v31, 0xc0135761
    ds_read_b128 v[64:67], v5 offset:0
    ds_read_b128 v[68:71], v5 offset:1024
    ds_read_b128 v[72:75], v5 offset:2048
    ds_read_b128 v[76:79], v5 offset:3072
    v_pk_mul_f32 v[32:33], v[160:161], v[160:161]
    v_pk_mul_f32 v[34:35], v[162:163], v[162:163]
    v_pk_mul_f32 v[36:37], v[164:165], v[164:165]
    v_pk_mul_f32 v[38:39], v[166:167], v[166:167]
    v_pk_fma_f32 v[32:33], v[32:33], s[24:25], v[30:31]
    v_pk_fma_f32 v[34:35], v[34:35], s[24:25], v[30:31]
    v_pk_fma_f32 v[36:37], v[36:37], s[24:25], v[30:31]
    v_pk_fma_f32 v[38:39], v[38:39], s[24:25], v[30:31]
    v_pk_mul_f32 v[32:33], v[32:33], v[160:161]
    v_pk_mul_f32 v[34:35], v[34:35], v[162:163]
    v_pk_mul_f32 v[36:37], v[36:37], v[164:165]
    v_pk_mul_f32 v[38:39], v[38:39], v[166:167]
    v_exp_f32 v32, v32
    v_exp_f32 v33, v33
    v_exp_f32 v34, v34
    v_exp_f32 v35, v35
    v_exp_f32 v36, v36
    v_exp_f32 v37, v37
    v_exp_f32 v38, v38
    v_exp_f32 v39, v39
    v_pk_add_f32 v[32:33], v[32:33], s[26:27]
    v_pk_add_f32 v[34:35], v[34:35], s[26:27]
    v_pk_add_f32 v[36:37], v[36:37], s[26:27]
    v_pk_add_f32 v[38:39], v[38:39], s[26:27]
    v_rcp_f32 v32, v32
    v_rcp_f32 v33, v33
    v_rcp_f32 v34, v34
    v_rcp_f32 v35, v35
    v_rcp_f32 v36, v36
    v_rcp_f32 v37, v37
    v_rcp_f32 v38, v38
    v_rcp_f32 v39, v39
    v_pk_mul_f32 v[160:161], v[160:161], v[168:169]
    v_pk_mul_f32 v[162:163], v[162:163], v[170:171]
    v_pk_mul_f32 v[164:165], v[164:165], v[172:173]
    v_pk_mul_f32 v[166:167], v[166:167], v[174:175]
    v_pk_mul_f32 v[32:33], v[32:33], v[160:161]
    v_pk_mul_f32 v[34:35], v[34:35], v[162:163]
    v_pk_mul_f32 v[36:37], v[36:37], v[164:165]
    v_pk_mul_f32 v[38:39], v[38:39], v[166:167]
    s_add_u32 s39, s40, 8192
    v_cvt_pk_bf16_f32 v40, v32, v33
    v_cvt_pk_bf16_f32 v41, v34, v35
    v_cvt_pk_bf16_f32 v42, v36, v37
    v_cvt_pk_bf16_f32 v43, v38, v39
    buffer_store_dwordx4 v[40:43], v4, s[8:11], s39 offen offset:2048 sc1
    v_pk_mul_f32 v[48:49], v[176:177], v[176:177]
    v_pk_mul_f32 v[50:51], v[178:179], v[178:179]
    v_pk_mul_f32 v[52:53], v[180:181], v[180:181]
    v_pk_mul_f32 v[54:55], v[182:183], v[182:183]
    v_pk_fma_f32 v[48:49], v[48:49], s[24:25], v[30:31]
    v_pk_fma_f32 v[50:51], v[50:51], s[24:25], v[30:31]
    v_pk_fma_f32 v[52:53], v[52:53], s[24:25], v[30:31]
    v_pk_fma_f32 v[54:55], v[54:55], s[24:25], v[30:31]
    v_pk_mul_f32 v[48:49], v[48:49], v[176:177]
    v_pk_mul_f32 v[50:51], v[50:51], v[178:179]
    v_pk_mul_f32 v[52:53], v[52:53], v[180:181]
    v_pk_mul_f32 v[54:55], v[54:55], v[182:183]
    v_exp_f32 v48, v48
    v_exp_f32 v49, v49
    v_exp_f32 v50, v50
    v_exp_f32 v51, v51
    v_exp_f32 v52, v52
    v_exp_f32 v53, v53
    v_exp_f32 v54, v54
    v_exp_f32 v55, v55
    v_pk_add_f32 v[48:49], v[48:49], s[26:27]
    v_pk_add_f32 v[50:51], v[50:51], s[26:27]
    v_pk_add_f32 v[52:53], v[52:53], s[26:27]
    v_pk_add_f32 v[54:55], v[54:55], s[26:27]
    v_rcp_f32 v48, v48
    v_rcp_f32 v49, v49
    v_rcp_f32 v50, v50
    v_rcp_f32 v51, v51
    v_rcp_f32 v52, v52
    v_rcp_f32 v53, v53
    v_rcp_f32 v54, v54
    v_rcp_f32 v55, v55
    v_pk_mul_f32 v[176:177], v[176:177], v[184:185]
    v_pk_mul_f32 v[178:179], v[178:179], v[186:187]
    v_pk_mul_f32 v[180:181], v[180:181], v[188:189]
    v_pk_mul_f32 v[182:183], v[182:183], v[190:191]
    v_pk_mul_f32 v[48:49], v[48:49], v[176:177]
    v_pk_mul_f32 v[50:51], v[50:51], v[178:179]
    v_pk_mul_f32 v[52:53], v[52:53], v[180:181]
    v_pk_mul_f32 v[54:55], v[54:55], v[182:183]
    s_add_u32 s39, s40, 12288
    v_cvt_pk_bf16_f32 v56, v48, v49
    v_cvt_pk_bf16_f32 v57, v50, v51
    v_cvt_pk_bf16_f32 v58, v52, v53
    v_cvt_pk_bf16_f32 v59, v54, v55
    buffer_store_dwordx4 v[56:59], v4, s[8:11], s39 offen offset:0 sc1
    v_pk_mul_f32 v[32:33], v[80:81], v[80:81]
    v_pk_mul_f32 v[34:35], v[82:83], v[82:83]
    v_pk_mul_f32 v[36:37], v[84:85], v[84:85]
    v_pk_mul_f32 v[38:39], v[86:87], v[86:87]
    v_pk_fma_f32 v[32:33], v[32:33], s[24:25], v[30:31]
    v_pk_fma_f32 v[34:35], v[34:35], s[24:25], v[30:31]
    v_pk_fma_f32 v[36:37], v[36:37], s[24:25], v[30:31]
    v_pk_fma_f32 v[38:39], v[38:39], s[24:25], v[30:31]
    v_pk_mul_f32 v[32:33], v[32:33], v[80:81]
    v_pk_mul_f32 v[34:35], v[34:35], v[82:83]
    v_pk_mul_f32 v[36:37], v[36:37], v[84:85]
    v_pk_mul_f32 v[38:39], v[38:39], v[86:87]
    v_exp_f32 v32, v32
    v_exp_f32 v33, v33
    v_exp_f32 v34, v34
    v_exp_f32 v35, v35
    v_exp_f32 v36, v36
    v_exp_f32 v37, v37
    v_exp_f32 v38, v38
    v_exp_f32 v39, v39
    v_pk_add_f32 v[32:33], v[32:33], s[26:27]
    v_pk_add_f32 v[34:35], v[34:35], s[26:27]
    v_pk_add_f32 v[36:37], v[36:37], s[26:27]
    v_pk_add_f32 v[38:39], v[38:39], s[26:27]
    v_rcp_f32 v32, v32
    v_rcp_f32 v33, v33
    v_rcp_f32 v34, v34
    v_rcp_f32 v35, v35
    v_rcp_f32 v36, v36
    v_rcp_f32 v37, v37
    v_rcp_f32 v38, v38
    v_rcp_f32 v39, v39
    v_pk_mul_f32 v[80:81], v[80:81], v[88:89]
    v_pk_mul_f32 v[82:83], v[82:83], v[90:91]
    v_pk_mul_f32 v[84:85], v[84:85], v[92:93]
    v_pk_mul_f32 v[86:87], v[86:87], v[94:95]
    v_pk_mul_f32 v[32:33], v[32:33], v[80:81]
    v_pk_mul_f32 v[34:35], v[34:35], v[82:83]
    v_pk_mul_f32 v[36:37], v[36:37], v[84:85]
    v_pk_mul_f32 v[38:39], v[38:39], v[86:87]
    s_add_u32 s39, s40, 0
    v_cvt_pk_bf16_f32 v40, v32, v33
    v_cvt_pk_bf16_f32 v41, v34, v35
    v_cvt_pk_bf16_f32 v42, v36, v37
    v_cvt_pk_bf16_f32 v43, v38, v39
    buffer_store_dwordx4 v[40:43], v4, s[8:11], s39 offen offset:0 sc1
    s_barrier
    s_setprio 2
    ds_read_b128 v[160:163], v8 offset:0
    ds_read_b128 v[164:167], v8 offset:1024
    ds_read_b128 v[168:171], v8 offset:2048
    ds_read_b128 v[172:175], v8 offset:3072
    ds_read_b128 v[176:179], v8 offset:4096
    ds_read_b128 v[180:183], v8 offset:5120
    ds_read_b128 v[184:187], v8 offset:6144
    ds_read_b128 v[188:191], v8 offset:7168
    ds_read_b128 v[80:83], v5 offset:4096
    ds_read_b128 v[84:87], v5 offset:5120
    v_pk_mul_f32 v[48:49], v[128:129], v[128:129]
    v_pk_mul_f32 v[50:51], v[130:131], v[130:131]
    v_pk_mul_f32 v[52:53], v[132:133], v[132:133]
    v_pk_mul_f32 v[54:55], v[134:135], v[134:135]
    v_pk_fma_f32 v[48:49], v[48:49], s[24:25], v[30:31]
    v_pk_fma_f32 v[50:51], v[50:51], s[24:25], v[30:31]
    v_pk_fma_f32 v[52:53], v[52:53], s[24:25], v[30:31]
    v_pk_fma_f32 v[54:55], v[54:55], s[24:25], v[30:31]
    v_pk_mul_f32 v[48:49], v[48:49], v[128:129]
    v_pk_mul_f32 v[50:51], v[50:51], v[130:131]
    v_pk_mul_f32 v[52:53], v[52:53], v[132:133]
    v_pk_mul_f32 v[54:55], v[54:55], v[134:135]
    v_exp_f32 v48, v48
    v_exp_f32 v49, v49
    v_exp_f32 v50, v50
    v_exp_f32 v51, v51
    v_exp_f32 v52, v52
    v_exp_f32 v53, v53
    v_exp_f32 v54, v54
    v_exp_f32 v55, v55
    v_pk_add_f32 v[48:49], v[48:49], s[26:27]
    v_pk_add_f32 v[50:51], v[50:51], s[26:27]
    v_pk_add_f32 v[52:53], v[52:53], s[26:27]
    v_pk_add_f32 v[54:55], v[54:55], s[26:27]
    v_rcp_f32 v48, v48
    v_rcp_f32 v49, v49
    v_rcp_f32 v50, v50
    v_rcp_f32 v51, v51
    v_rcp_f32 v52, v52
    v_rcp_f32 v53, v53
    v_rcp_f32 v54, v54
    v_rcp_f32 v55, v55
    v_pk_mul_f32 v[128:129], v[128:129], v[136:137]
    v_pk_mul_f32 v[130:131], v[130:131], v[138:139]
    v_pk_mul_f32 v[132:133], v[132:133], v[140:141]
    v_pk_mul_f32 v[134:135], v[134:135], v[142:143]
    v_pk_mul_f32 v[48:49], v[48:49], v[128:129]
    v_pk_mul_f32 v[50:51], v[50:51], v[130:131]
    v_pk_mul_f32 v[52:53], v[52:53], v[132:133]
    v_pk_mul_f32 v[54:55], v[54:55], v[134:135]
    s_add_u32 s39, s40, 4096
    v_cvt_pk_bf16_f32 v56, v48, v49
    v_cvt_pk_bf16_f32 v57, v50, v51
    v_cvt_pk_bf16_f32 v58, v52, v53
    v_cvt_pk_bf16_f32 v59, v54, v55
    buffer_store_dwordx4 v[56:59], v4, s[8:11], s39 offen offset:2048 sc1
    v_pk_mul_f32 v[32:33], v[144:145], v[144:145]
    v_pk_mul_f32 v[34:35], v[146:147], v[146:147]
    v_pk_mul_f32 v[36:37], v[148:149], v[148:149]
    v_pk_mul_f32 v[38:39], v[150:151], v[150:151]
    v_pk_fma_f32 v[32:33], v[32:33], s[24:25], v[30:31]
    v_pk_fma_f32 v[34:35], v[34:35], s[24:25], v[30:31]
    v_pk_fma_f32 v[36:37], v[36:37], s[24:25], v[30:31]
    v_pk_fma_f32 v[38:39], v[38:39], s[24:25], v[30:31]
    v_pk_mul_f32 v[32:33], v[32:33], v[144:145]
    v_pk_mul_f32 v[34:35], v[34:35], v[146:147]
    v_pk_mul_f32 v[36:37], v[36:37], v[148:149]
    v_pk_mul_f32 v[38:39], v[38:39], v[150:151]
    v_exp_f32 v32, v32
    v_exp_f32 v33, v33
    v_exp_f32 v34, v34
    v_exp_f32 v35, v35
    v_exp_f32 v36, v36
    v_exp_f32 v37, v37
    v_exp_f32 v38, v38
    v_exp_f32 v39, v39
    v_pk_add_f32 v[32:33], v[32:33], s[26:27]
    v_pk_add_f32 v[34:35], v[34:35], s[26:27]
    v_pk_add_f32 v[36:37], v[36:37], s[26:27]
    v_pk_add_f32 v[38:39], v[38:39], s[26:27]
    v_rcp_f32 v32, v32
    v_rcp_f32 v33, v33
    v_rcp_f32 v34, v34
    v_rcp_f32 v35, v35
    v_rcp_f32 v36, v36
    v_rcp_f32 v37, v37
    v_rcp_f32 v38, v38
    v_rcp_f32 v39, v39
    v_pk_mul_f32 v[144:145], v[144:145], v[152:153]
    v_pk_mul_f32 v[146:147], v[146:147], v[154:155]
    v_pk_mul_f32 v[148:149], v[148:149], v[156:157]
    v_pk_mul_f32 v[150:151], v[150:151], v[158:159]
    v_pk_mul_f32 v[32:33], v[32:33], v[144:145]
    v_pk_mul_f32 v[34:35], v[34:35], v[146:147]
    v_pk_mul_f32 v[36:37], v[36:37], v[148:149]
    v_pk_mul_f32 v[38:39], v[38:39], v[150:151]
    s_add_u32 s39, s40, 8192
    v_cvt_pk_bf16_f32 v40, v32, v33
    v_cvt_pk_bf16_f32 v41, v34, v35
    v_cvt_pk_bf16_f32 v42, v36, v37
    v_cvt_pk_bf16_f32 v43, v38, v39
    buffer_store_dwordx4 v[40:43], v4, s[8:11], s39 offen offset:0 sc1
    v_pk_mul_f32 v[48:49], v[96:97], v[96:97]
    v_pk_mul_f32 v[50:51], v[98:99], v[98:99]
    v_pk_mul_f32 v[52:53], v[100:101], v[100:101]
    v_pk_mul_f32 v[54:55], v[102:103], v[102:103]
    v_pk_fma_f32 v[48:49], v[48:49], s[24:25], v[30:31]
    v_pk_fma_f32 v[50:51], v[50:51], s[24:25], v[30:31]
    v_pk_fma_f32 v[52:53], v[52:53], s[24:25], v[30:31]
    v_pk_fma_f32 v[54:55], v[54:55], s[24:25], v[30:31]
    v_pk_mul_f32 v[48:49], v[48:49], v[96:97]
    v_pk_mul_f32 v[50:51], v[50:51], v[98:99]
    v_pk_mul_f32 v[52:53], v[52:53], v[100:101]
    v_pk_mul_f32 v[54:55], v[54:55], v[102:103]
    v_exp_f32 v48, v48
    s_waitcnt lgkmcnt(8)
    v_mfma_f32_16x16x32_bf16 v[128:131], v[64:67], v[160:163], 0
    ds_read_b128 v[88:91], v5 offset:6144
    v_exp_f32 v49, v49
    s_waitcnt lgkmcnt(5)
    v_mfma_f32_16x16x32_bf16 v[132:135], v[64:67], v[176:179], 0
    v_exp_f32 v50, v50
    v_mfma_f32_16x16x32_bf16 v[128:131], v[68:71], v[164:167], v[128:131]
    ds_read_b128 v[92:95], v5 offset:7168
    v_exp_f32 v51, v51
    v_mfma_f32_16x16x32_bf16 v[132:135], v[68:71], v[180:183], v[132:135]
    v_exp_f32 v52, v52
    v_mfma_f32_16x16x32_bf16 v[128:131], v[72:75], v[168:171], v[128:131]
    ds_read_b128 v[64:67], v5 offset:8192
    v_exp_f32 v53, v53
    s_waitcnt lgkmcnt(5)
    v_mfma_f32_16x16x32_bf16 v[132:135], v[72:75], v[184:187], v[132:135]
    v_exp_f32 v54, v54
    v_mfma_f32_16x16x32_bf16 v[128:131], v[76:79], v[172:175], v[128:131]
    ds_read_b128 v[68:71], v5 offset:9216
    v_exp_f32 v55, v55
    v_mfma_f32_16x16x32_bf16 v[132:135], v[76:79], v[188:191], v[132:135]
    v_pk_add_f32 v[48:49], v[48:49], s[26:27]
    v_pk_add_f32 v[50:51], v[50:51], s[26:27]
    v_pk_add_f32 v[52:53], v[52:53], s[26:27]
    v_pk_add_f32 v[54:55], v[54:55], s[26:27]
    v_rcp_f32 v48, v48
    s_waitcnt lgkmcnt(4)
    v_mfma_f32_16x16x32_bf16 v[136:139], v[80:83], v[160:163], 0
    ds_read_b128 v[72:75], v5 offset:10240
    v_rcp_f32 v49, v49
    v_mfma_f32_16x16x32_bf16 v[140:143], v[80:83], v[176:179], 0
    v_rcp_f32 v50, v50
    v_mfma_f32_16x16x32_bf16 v[136:139], v[84:87], v[164:167], v[136:139]
    ds_read_b128 v[76:79], v5 offset:11264
    v_rcp_f32 v51, v51
    v_mfma_f32_16x16x32_bf16 v[140:143], v[84:87], v[180:183], v[140:143]
    v_rcp_f32 v52, v52
    s_waitcnt lgkmcnt(4)
    v_mfma_f32_16x16x32_bf16 v[136:139], v[88:91], v[168:171], v[136:139]
    ds_read_b128 v[80:83], v5 offset:12288
    v_rcp_f32 v53, v53
    v_mfma_f32_16x16x32_bf16 v[140:143], v[88:91], v[184:187], v[140:143]
    v_rcp_f32 v54, v54
    v_mfma_f32_16x16x32_bf16 v[136:139], v[92:95], v[172:175], v[136:139]
    ds_read_b128 v[84:87], v5 offset:13312
    v_rcp_f32 v55, v55
    v_mfma_f32_16x16x32_bf16 v[140:143], v[92:95], v[188:191], v[140:143]
    v_pk_mul_f32 v[96:97], v[96:97], v[104:105]
    v_pk_mul_f32 v[98:99], v[98:99], v[106:107]
    v_pk_mul_f32 v[100:101], v[100:101], v[108:109]
    v_pk_mul_f32 v[102:103], v[102:103], v[110:111]
    v_pk_mul_f32 v[48:49], v[48:49], v[96:97]
    v_pk_mul_f32 v[50:51], v[50:51], v[98:99]
    v_pk_mul_f32 v[52:53], v[52:53], v[100:101]
    v_pk_mul_f32 v[54:55], v[54:55], v[102:103]
    s_add_u32 s39, s40, 0
    v_cvt_pk_bf16_f32 v56, v48, v49
    v_cvt_pk_bf16_f32 v57, v50, v51
    v_cvt_pk_bf16_f32 v58, v52, v53
    v_cvt_pk_bf16_f32 v59, v54, v55
    buffer_store_dwordx4 v[56:59], v4, s[8:11], s39 offen offset:2048 sc1
    v_pk_mul_f32 v[32:33], v[112:113], v[112:113]
    v_pk_mul_f32 v[34:35], v[114:115], v[114:115]
    v_pk_mul_f32 v[36:37], v[116:117], v[116:117]
    v_pk_mul_f32 v[38:39], v[118:119], v[118:119]
    v_pk_fma_f32 v[32:33], v[32:33], s[24:25], v[30:31]
    v_pk_fma_f32 v[34:35], v[34:35], s[24:25], v[30:31]
    v_pk_fma_f32 v[36:37], v[36:37], s[24:25], v[30:31]
    v_pk_fma_f32 v[38:39], v[38:39], s[24:25], v[30:31]
    v_pk_mul_f32 v[32:33], v[32:33], v[112:113]
    v_pk_mul_f32 v[34:35], v[34:35], v[114:115]
    v_pk_mul_f32 v[36:37], v[36:37], v[116:117]
    v_pk_mul_f32 v[38:39], v[38:39], v[118:119]
    v_exp_f32 v32, v32
    s_waitcnt lgkmcnt(4)
    v_mfma_f32_16x16x32_bf16 v[144:147], v[64:67], v[160:163], 0
    ds_read_b128 v[88:91], v5 offset:14336
    v_exp_f32 v33, v33
    v_mfma_f32_16x16x32_bf16 v[148:151], v[64:67], v[176:179], 0
    v_exp_f32 v34, v34
    v_mfma_f32_16x16x32_bf16 v[144:147], v[68:71], v[164:167], v[144:147]
    ds_read_b128 v[92:95], v5 offset:15360
    v_exp_f32 v35, v35
    v_mfma_f32_16x16x32_bf16 v[148:151], v[68:71], v[180:183], v[148:151]
    v_exp_f32 v36, v36
    s_waitcnt lgkmcnt(4)
    v_mfma_f32_16x16x32_bf16 v[144:147], v[72:75], v[168:171], v[144:147]
    v_xor_b32 v5, 0x4000, v5
    ds_read_b128 v[64:67], v5 offset:0
    v_exp_f32 v37, v37
    v_mfma_f32_16x16x32_bf16 v[148:151], v[72:75], v[184:187], v[148:151]
    v_exp_f32 v38, v38
    v_mfma_f32_16x16x32_bf16 v[144:147], v[76:79], v[172:175], v[144:147]
    ds_read_b128 v[68:71], v5 offset:1024
    v_exp_f32 v39, v39
    v_mfma_f32_16x16x32_bf16 v[148:151], v[76:79], v[188:191], v[148:151]
    v_pk_add_f32 v[32:33], v[32:33], s[26:27]
    v_pk_add_f32 v[34:35], v[34:35], s[26:27]
    v_pk_add_f32 v[36:37], v[36:37], s[26:27]
    v_pk_add_f32 v[38:39], v[38:39], s[26:27]
    v_rcp_f32 v32, v32
    s_waitcnt lgkmcnt(4)
    v_mfma_f32_16x16x32_bf16 v[152:155], v[80:83], v[160:163], 0
    ds_read_b128 v[72:75], v5 offset:2048
    v_rcp_f32 v33, v33
    v_mfma_f32_16x16x32_bf16 v[156:159], v[80:83], v[176:179], 0
    v_rcp_f32 v34, v34
    v_mfma_f32_16x16x32_bf16 v[152:155], v[84:87], v[164:167], v[152:155]
    ds_read_b128 v[76:79], v5 offset:3072
    v_rcp_f32 v35, v35
    v_mfma_f32_16x16x32_bf16 v[156:159], v[84:87], v[180:183], v[156:159]
    v_rcp_f32 v36, v36
    s_waitcnt lgkmcnt(4)
    v_mfma_f32_16x16x32_bf16 v[152:155], v[88:91], v[168:171], v[152:155]
    ds_read_b128 v[80:83], v5 offset:4096
    v_rcp_f32 v37, v37
    v_mfma_f32_16x16x32_bf16 v[156:159], v[88:91], v[184:187], v[156:159]
    v_rcp_f32 v38, v38
    v_mfma_f32_16x16x32_bf16 v[152:155], v[92:95], v[172:175], v[152:155]
    ds_read_b128 v[84:87], v5 offset:5120
    v_rcp_f32 v39, v39
    v_mfma_f32_16x16x32_bf16 v[156:159], v[92:95], v[188:191], v[156:159]
    v_pk_mul_f32 v[112:113], v[112:113], v[120:121]
    v_pk_mul_f32 v[114:115], v[114:115], v[122:123]
    v_pk_mul_f32 v[116:117], v[116:117], v[124:125]
    v_pk_mul_f32 v[118:119], v[118:119], v[126:127]
    v_pk_mul_f32 v[32:33], v[32:33], v[112:113]
    v_pk_mul_f32 v[34:35], v[34:35], v[114:115]
    v_pk_mul_f32 v[36:37], v[36:37], v[116:117]
    v_pk_mul_f32 v[38:39], v[38:39], v[118:119]
    s_add_u32 s39, s40, 4096
    v_cvt_pk_bf16_f32 v40, v32, v33
    v_cvt_pk_bf16_f32 v41, v34, v35
    v_cvt_pk_bf16_f32 v42, v36, v37
    v_cvt_pk_bf16_f32 v43, v38, v39
    buffer_store_dwordx4 v[40:43], v4, s[8:11], s39 offen offset:0 sc1
    v_pk_mul_f32 v[48:49], v[192:193], v[192:193]
    v_pk_mul_f32 v[50:51], v[194:195], v[194:195]
    v_pk_mul_f32 v[52:53], v[196:197], v[196:197]
    v_pk_mul_f32 v[54:55], v[198:199], v[198:199]
    v_pk_fma_f32 v[48:49], v[48:49], s[24:25], v[30:31]
    v_pk_fma_f32 v[50:51], v[50:51], s[24:25], v[30:31]
    v_pk_fma_f32 v[52:53], v[52:53], s[24:25], v[30:31]
    v_pk_fma_f32 v[54:55], v[54:55], s[24:25], v[30:31]
    v_pk_mul_f32 v[48:49], v[48:49], v[192:193]
    v_pk_mul_f32 v[50:51], v[50:51], v[194:195]
    v_pk_mul_f32 v[52:53], v[52:53], v[196:197]
    v_pk_mul_f32 v[54:55], v[54:55], v[198:199]
    v_exp_f32 v48, v48
    v_exp_f32 v49, v49
    v_exp_f32 v50, v50
    v_exp_f32 v51, v51
    v_exp_f32 v52, v52
    v_exp_f32 v53, v53
    v_exp_f32 v54, v54
    v_exp_f32 v55, v55
    v_pk_add_f32 v[48:49], v[48:49], s[26:27]
    v_pk_add_f32 v[50:51], v[50:51], s[26:27]
    v_pk_add_f32 v[52:53], v[52:53], s[26:27]
    v_pk_add_f32 v[54:55], v[54:55], s[26:27]
    v_rcp_f32 v48, v48
    v_rcp_f32 v49, v49
    v_rcp_f32 v50, v50
    v_rcp_f32 v51, v51
    v_rcp_f32 v52, v52
    v_rcp_f32 v53, v53
    v_rcp_f32 v54, v54
    v_rcp_f32 v55, v55
    v_pk_mul_f32 v[192:193], v[192:193], v[200:201]
    v_pk_mul_f32 v[194:195], v[194:195], v[202:203]
    v_pk_mul_f32 v[196:197], v[196:197], v[204:205]
    v_pk_mul_f32 v[198:199], v[198:199], v[206:207]
    v_pk_mul_f32 v[48:49], v[48:49], v[192:193]
    v_pk_mul_f32 v[50:51], v[50:51], v[194:195]
    v_pk_mul_f32 v[52:53], v[52:53], v[196:197]
    v_pk_mul_f32 v[54:55], v[54:55], v[198:199]
    s_add_u32 s39, s40, 12288
    v_cvt_pk_bf16_f32 v56, v48, v49
    v_cvt_pk_bf16_f32 v57, v50, v51
    v_cvt_pk_bf16_f32 v58, v52, v53
    v_cvt_pk_bf16_f32 v59, v54, v55
    buffer_store_dwordx4 v[56:59], v4, s[8:11], s39 offen offset:2048 sc1
    v_mov_b64 v[192:193], 0
    v_mov_b64 v[194:195], 0
    v_mov_b64 v[196:197], 0
    v_mov_b64 v[198:199], 0
    v_mov_b64 v[200:201], 0
    v_mov_b64 v[202:203], 0
    v_mov_b64 v[204:205], 0
    v_mov_b64 v[206:207], 0
    v_mov_b64 v[252:253], 0
    v_mov_b64 v[254:255], 0
    v_max3_f32 v16, v128, v129, v130
    v_max3_f32 v17, v132, v133, v134
    v_max3_f32 v16, v16, v131, v136
    v_max3_f32 v17, v17, v135, v140
    v_max3_f32 v16, v16, v137, v138
    v_max3_f32 v17, v17, v141, v142
    v_max3_f32 v16, v16, v139, v144
    v_max3_f32 v17, v17, v143, v148
    v_max3_f32 v16, v16, v145, v146
    v_max3_f32 v17, v17, v149, v150
    v_max3_f32 v16, v16, v147, v152
    v_max3_f32 v17, v17, v151, v156
    v_max3_f32 v16, v16, v153, v154
    v_max3_f32 v17, v17, v157, v158
    v_max_f32 v16, v16, v155
    v_max_f32 v17, v17, v159
    v_mov_b32 v18, v16
    s_nop 1
    v_permlane32_swap_b32 v18, v16
    s_nop 1
    v_max_f32 v16, v16, v18
    v_mov_b32 v18, v16
    s_nop 1
    v_permlane16_swap_b32 v18, v16
    s_nop 1
    v_max_f32 v16, v16, v18
    v_max_f32 v16, 0xf149f2ca, v16
    v_mov_b32 v19, v17
    s_nop 1
    v_permlane32_swap_b32 v19, v17
    s_nop 1
    v_max_f32 v17, v17, v19
    v_mov_b32 v19, v17
    s_nop 1
    v_permlane16_swap_b32 v19, v17
    s_nop 1
    v_max_f32 v17, v17, v19
    v_max_f32 v17, 0xf149f2ca, v17
    v_sub_f32 v32, 0, v16
    v_sub_f32 v33, 0, v16
    v_sub_f32 v34, 0, v16
    v_sub_f32 v35, 0, v16
    v_sub_f32 v36, 0, v17
    v_sub_f32 v37, 0, v17
    v_sub_f32 v38, 0, v17
    v_sub_f32 v39, 0, v17
    v_pk_add_f32 v[128:129], v[128:129], v[32:33]
    v_pk_add_f32 v[130:131], v[130:131], v[32:33]
    v_pk_add_f32 v[136:137], v[136:137], v[32:33]
    v_pk_add_f32 v[138:139], v[138:139], v[32:33]
    v_pk_add_f32 v[132:133], v[132:133], v[36:37]
    v_pk_add_f32 v[134:135], v[134:135], v[36:37]
    v_pk_add_f32 v[140:141], v[140:141], v[36:37]
    v_pk_add_f32 v[142:143], v[142:143], v[36:37]
    v_pk_add_f32 v[144:145], v[144:145], v[32:33]
    v_pk_add_f32 v[146:147], v[146:147], v[32:33]
    v_pk_add_f32 v[152:153], v[152:153], v[32:33]
    v_pk_add_f32 v[154:155], v[154:155], v[32:33]
    v_pk_add_f32 v[148:149], v[148:149], v[36:37]
    v_pk_add_f32 v[150:151], v[150:151], v[36:37]
    v_pk_add_f32 v[156:157], v[156:157], v[36:37]
    v_pk_add_f32 v[158:159], v[158:159], v[36:37]
    v_exp_f32 v24, v128
    s_mov_b32 m0, s46
    s_nop 0
    buffer_load_dwordx4 v4, s[8:11], s44 offen offset:0 sc1 lds
    v_exp_f32 v25, v129
    v_exp_f32 v26, v132
    v_exp_f32 v27, v133
    v_add_f32 v9, v24, v25
    v_cvt_pk_bf16_f32 v56, v24, v25
    v_exp_f32 v28, v130
    v_exp_f32 v29, v131
    v_add_f32 v10, v26, v27
    v_cvt_pk_bf16_f32 v60, v26, v27
    v_exp_f32 v30, v134
    buffer_load_dwordx4 v4, s[8:11], s44 offen offset:1024 sc1 lds
    v_exp_f32 v31, v135
    v_add_f32 v9, v9, v28
    v_add_f32 v9, v9, v29
    v_cvt_pk_bf16_f32 v57, v28, v29
    v_exp_f32 v24, v136
    v_exp_f32 v25, v137
    v_add_f32 v10, v10, v30
    v_add_f32 v10, v10, v31
    v_cvt_pk_bf16_f32 v61, v30, v31
    v_exp_f32 v26, v140
    buffer_load_dwordx4 v4, s[8:11], s44 offen offset:2048 sc1 lds
    v_exp_f32 v27, v141
    v_add_f32 v9, v9, v24
    v_add_f32 v9, v9, v25
    v_cvt_pk_bf16_f32 v58, v24, v25
    v_exp_f32 v28, v138
    v_exp_f32 v29, v139
    v_add_f32 v10, v10, v26
    v_add_f32 v10, v10, v27
    v_cvt_pk_bf16_f32 v62, v26, v27
    v_exp_f32 v30, v142
    buffer_load_dwordx4 v4, s[8:11], s44 offen offset:3072 sc1 lds
    s_add_u32 s44, s44, 32768
    s_xor_b32 s46, s46, 0x10000
    v_exp_f32 v31, v143
    v_add_f32 v9, v9, v28
    v_add_f32 v9, v9, v29
    v_cvt_pk_bf16_f32 v59, v28, v29
    s_nop 0
    v_add_f32 v10, v10, v30
    v_add_f32 v10, v10, v31
    v_cvt_pk_bf16_f32 v63, v30, v31
    s_mov_b32 exec_lo, 0xffff
    s_mov_b32 exec_hi, 0x0
    buffer_load_dword v22, v1, s[8:11], 0 offen sc1
    s_mov_b64 exec, -1
    s_setprio 0
    s_waitcnt vmcnt(13)
    s_barrier
    s_branch K_ATT
K_G:
    s_waitcnt lgkmcnt(12)
    v_mfma_f32_16x16x32_bf16 v[128:131], v[64:67], v[32:35], 0
    ds_read_b64_tr_b16 v[112:113], v16 offset:8192
    s_lshl_b32 s24, s2, 2
    s_waitcnt lgkmcnt(11)
    v_mfma_f32_16x16x32_bf16 v[132:135], v[68:71], v[32:35], 0
    ds_read_b64_tr_b16 v[114:115], v16 offset:9216
    s_and_b32 s25, s3, 3
    s_waitcnt lgkmcnt(10)
    v_mfma_f32_16x16x32_bf16 v[136:139], v[72:75], v[32:35], 0
    s_add_u32 s24, s24, s25
    s_waitcnt lgkmcnt(8)
    v_mfma_f32_16x16x32_bf16 v[140:143], v[76:79], v[32:35], 0
    ds_read_b128 v[80:83], v13 offset:0
    s_mul_i32 s24, s24, 1536
    v_mfma_f32_16x16x32_bf16 v[144:147], v[64:67], v[36:39], 0
    ds_read_b64_tr_b16 v[116:117], v17 offset:8192
    s_add_u32 s24, s24, 1048576
    v_mfma_f32_16x16x32_bf16 v[148:151], v[68:71], v[36:39], 0
    v_min_u32 v29, 11, v1
    v_mfma_f32_16x16x32_bf16 v[152:155], v[72:75], v[36:39], 0
    ds_read_b64_tr_b16 v[118:119], v17 offset:9216
    v_lshlrev_b32 v29, 7, v29
    v_mfma_f32_16x16x32_bf16 v[156:159], v[76:79], v[36:39], 0
    ds_read_b64_tr_b16 v[120:121], v18 offset:8192
    buffer_load_dword v28, v29, s[68:71], s24 offen
    s_waitcnt lgkmcnt(10)
    v_mfma_f32_16x16x32_bf16 v[160:163], v[64:67], v[40:43], 0
    s_lshl_b32 s24, s2, 3
    v_mfma_f32_16x16x32_bf16 v[164:167], v[68:71], v[40:43], 0
    ds_read_b64_tr_b16 v[122:123], v18 offset:9216
    s_add_u32 s24, s24, s3
    v_mfma_f32_16x16x32_bf16 v[168:171], v[72:75], v[40:43], 0
    ds_read_b64_tr_b16 v[124:125], v19 offset:8192
    s_lshl_b32 s24, s24, 10
    v_mfma_f32_16x16x32_bf16 v[172:175], v[76:79], v[40:43], 0
    v_min_u32 v29, 2, v1
    v_mfma_f32_16x16x32_bf16 v[176:179], v[64:67], v[44:47], 0
    ds_read_b64_tr_b16 v[126:127], v19 offset:9216
    v_lshlrev_b32 v29, 7, v29
    v_mfma_f32_16x16x32_bf16 v[180:183], v[68:71], v[44:47], 0
    ds_read_b128 v[84:87], v13 offset:2048
    buffer_load_dword v28, v29, s[64:67], s24 offen offset:256
    v_mfma_f32_16x16x32_bf16 v[184:187], v[72:75], v[44:47], 0
    v_mfma_f32_16x16x32_bf16 v[188:191], v[76:79], v[44:47], 0
    ds_read_b128 v[88:91], v13 offset:4096
    s_waitcnt lgkmcnt(13)
    v_mfma_f32_16x16x32_bf16 v[192:195], v[64:67], v[48:51], 0
    ds_read_b128 v[92:95], v13 offset:6144
    v_mfma_f32_16x16x32_bf16 v[196:199], v[68:71], v[48:51], 0
    v_mfma_f32_16x16x32_bf16 v[200:203], v[72:75], v[48:51], 0
    ds_read_b128 v[96:99], v13 offset:8192
    v_mfma_f32_16x16x32_bf16 v[204:207], v[76:79], v[48:51], 0
    ds_read_b128 v[100:103], v13 offset:10240
    v_mfma_f32_16x16x32_bf16 v[208:211], v[64:67], v[52:55], 0
    v_mfma_f32_16x16x32_bf16 v[212:215], v[68:71], v[52:55], 0
    ds_read_b128 v[104:107], v13 offset:12288
    v_mfma_f32_16x16x32_bf16 v[216:219], v[72:75], v[52:55], 0
    ds_read_b128 v[108:111], v13 offset:14336
    v_mfma_f32_16x16x32_bf16 v[220:223], v[76:79], v[52:55], 0
    s_waitcnt lgkmcnt(15)
    v_mfma_f32_16x16x32_bf16 v[224:227], v[64:67], v[56:59], 0
    v_mfma_f32_16x16x32_bf16 v[228:231], v[68:71], v[56:59], 0
    v_mfma_f32_16x16x32_bf16 v[232:235], v[72:75], v[56:59], 0
    v_mfma_f32_16x16x32_bf16 v[236:239], v[76:79], v[56:59], 0
    v_mfma_f32_16x16x32_bf16 v[240:243], v[64:67], v[60:63], 0
    v_mfma_f32_16x16x32_bf16 v[244:247], v[68:71], v[60:63], 0
    v_mfma_f32_16x16x32_bf16 v[248:251], v[72:75], v[60:63], 0
    v_mfma_f32_16x16x32_bf16 v[252:255], v[76:79], v[60:63], 0
    s_waitcnt vmcnt(2) lgkmcnt(0)
    s_barrier
    v_mfma_f32_16x16x32_bf16 v[128:131], v[112:115], v[80:83], v[128:131]
    ds_read_b64_tr_b16 v[64:65], v20 offset:0
    v_mfma_f32_16x16x32_bf16 v[132:135], v[116:119], v[80:83], v[132:135]
    ds_read_b64_tr_b16 v[66:67], v20 offset:1024
    s_add_u32 m0, s36, 0
    s_nop 0
    buffer_load_dwordx4 v5, s[64:67], s32 offen offset:0 lds
    v_mfma_f32_16x16x32_bf16 v[136:139], v[120:123], v[80:83], v[136:139]
    v_mfma_f32_16x16x32_bf16 v[140:143], v[124:127], v[80:83], v[140:143]
    ds_read_b128 v[32:35], v14 offset:0
    v_mfma_f32_16x16x32_bf16 v[144:147], v[112:115], v[84:87], v[144:147]
    ds_read_b64_tr_b16 v[68:69], v21 offset:0
    buffer_load_dwordx4 v6, s[64:67], s32 offen offset:1024 lds
    v_mfma_f32_16x16x32_bf16 v[148:151], v[116:119], v[84:87], v[148:151]
    v_mfma_f32_16x16x32_bf16 v[152:155], v[120:123], v[84:87], v[152:155]
    ds_read_b64_tr_b16 v[70:71], v21 offset:1024
    v_mfma_f32_16x16x32_bf16 v[156:159], v[124:127], v[84:87], v[156:159]
    ds_read_b64_tr_b16 v[72:73], v22 offset:0
    buffer_load_dwordx4 v7, s[64:67], s32 offen offset:2048 lds
    v_mfma_f32_16x16x32_bf16 v[160:163], v[112:115], v[88:91], v[160:163]
    v_mfma_f32_16x16x32_bf16 v[164:167], v[116:119], v[88:91], v[164:167]
    ds_read_b64_tr_b16 v[74:75], v22 offset:1024
    v_mfma_f32_16x16x32_bf16 v[168:171], v[120:123], v[88:91], v[168:171]
    ds_read_b64_tr_b16 v[76:77], v23 offset:0
    buffer_load_dwordx4 v30, s[64:67], s32 offen offset:3072 lds
    s_add_u32 s32, s32, 128
    v_mfma_f32_16x16x32_bf16 v[172:175], v[124:127], v[88:91], v[172:175]
    v_mfma_f32_16x16x32_bf16 v[176:179], v[112:115], v[92:95], v[176:179]
    ds_read_b64_tr_b16 v[78:79], v23 offset:1024
    v_mfma_f32_16x16x32_bf16 v[180:183], v[116:119], v[92:95], v[180:183]
    ds_read_b128 v[36:39], v14 offset:2048
    s_add_u32 m0, s37, 0
    s_nop 0
    buffer_load_dwordx4 v8, s[68:71], s33 offen offset:0 lds
    v_mfma_f32_16x16x32_bf16 v[184:187], v[120:123], v[92:95], v[184:187]
    v_mfma_f32_16x16x32_bf16 v[188:191], v[124:127], v[92:95], v[188:191]
    ds_read_b128 v[40:43], v14 offset:4096
    v_mfma_f32_16x16x32_bf16 v[192:195], v[112:115], v[96:99], v[192:195]
    ds_read_b128 v[44:47], v14 offset:6144
    buffer_load_dwordx4 v9, s[68:71], s33 offen offset:1024 lds
    v_mfma_f32_16x16x32_bf16 v[196:199], v[116:119], v[96:99], v[196:199]
    v_mfma_f32_16x16x32_bf16 v[200:203], v[120:123], v[96:99], v[200:203]
    ds_read_b128 v[48:51], v14 offset:8192
    v_mfma_f32_16x16x32_bf16 v[204:207], v[124:127], v[96:99], v[204:207]
    ds_read_b128 v[52:55], v14 offset:10240
    buffer_load_dwordx4 v10, s[68:71], s33 offen offset:2048 lds
    v_mfma_f32_16x16x32_bf16 v[208:211], v[112:115], v[100:103], v[208:211]
    v_mfma_f32_16x16x32_bf16 v[212:215], v[116:119], v[100:103], v[212:215]
    ds_read_b128 v[56:59], v14 offset:12288
    v_mfma_f32_16x16x32_bf16 v[216:219], v[120:123], v[100:103], v[216:219]
    ds_read_b128 v[60:63], v14 offset:14336
    buffer_load_dwordx4 v11, s[68:71], s33 offen offset:3072 lds
    s_add_u32 s33, s33, 524288
    v_mfma_f32_16x16x32_bf16 v[220:223], v[124:127], v[100:103], v[220:223]
    v_mfma_f32_16x16x32_bf16 v[224:227], v[112:115], v[104:107], v[224:227]
    v_mfma_f32_16x16x32_bf16 v[228:231], v[116:119], v[104:107], v[228:231]
    s_lshl_b32 s24, s2, 2
    s_and_b32 s25, s3, 3
    s_add_u32 s24, s24, s25
    v_mfma_f32_16x16x32_bf16 v[232:235], v[120:123], v[104:107], v[232:235]
    s_mul_i32 s24, s24, 1536
    s_add_u32 s24, s24, 2621440
    v_mfma_f32_16x16x32_bf16 v[236:239], v[124:127], v[104:107], v[236:239]
    v_min_u32 v29, 11, v1
    v_lshlrev_b32 v29, 7, v29
    v_mfma_f32_16x16x32_bf16 v[240:243], v[112:115], v[108:111], v[240:243]
    buffer_load_dword v28, v29, s[68:71], s24 offen
    s_lshl_b32 s24, s2, 3
    s_add_u32 s24, s24, s3
    v_mfma_f32_16x16x32_bf16 v[244:247], v[116:119], v[108:111], v[244:247]
    s_lshl_b32 s24, s24, 10
    v_min_u32 v29, 2, v1
    v_mfma_f32_16x16x32_bf16 v[248:251], v[120:123], v[108:111], v[248:251]
    v_lshlrev_b32 v29, 7, v29
    buffer_load_dword v28, v29, s[64:67], s24 offen offset:640
    v_mfma_f32_16x16x32_bf16 v[252:255], v[124:127], v[108:111], v[252:255]
    s_waitcnt lgkmcnt(12)
    v_mfma_f32_16x16x32_bf16 v[128:131], v[64:67], v[32:35], v[128:131]
    ds_read_b64_tr_b16 v[112:113], v20 offset:8192
    s_waitcnt lgkmcnt(11)
    v_mfma_f32_16x16x32_bf16 v[132:135], v[68:71], v[32:35], v[132:135]
    ds_read_b64_tr_b16 v[114:115], v20 offset:9216
    s_waitcnt lgkmcnt(10)
    v_mfma_f32_16x16x32_bf16 v[136:139], v[72:75], v[32:35], v[136:139]
    s_waitcnt lgkmcnt(8)
    v_mfma_f32_16x16x32_bf16 v[140:143], v[76:79], v[32:35], v[140:143]
    ds_read_b128 v[80:83], v15 offset:0
    v_mfma_f32_16x16x32_bf16 v[144:147], v[64:67], v[36:39], v[144:147]
    ds_read_b64_tr_b16 v[116:117], v21 offset:8192
    v_mfma_f32_16x16x32_bf16 v[148:151], v[68:71], v[36:39], v[148:151]
    v_mfma_f32_16x16x32_bf16 v[152:155], v[72:75], v[36:39], v[152:155]
    ds_read_b64_tr_b16 v[118:119], v21 offset:9216
    v_mfma_f32_16x16x32_bf16 v[156:159], v[76:79], v[36:39], v[156:159]
    ds_read_b64_tr_b16 v[120:121], v22 offset:8192
    s_waitcnt lgkmcnt(10)
    v_mfma_f32_16x16x32_bf16 v[160:163], v[64:67], v[40:43], v[160:163]
    v_mfma_f32_16x16x32_bf16 v[164:167], v[68:71], v[40:43], v[164:167]
    ds_read_b64_tr_b16 v[122:123], v22 offset:9216
    v_mfma_f32_16x16x32_bf16 v[168:171], v[72:75], v[40:43], v[168:171]
    ds_read_b64_tr_b16 v[124:125], v23 offset:8192
    v_mfma_f32_16x16x32_bf16 v[172:175], v[76:79], v[40:43], v[172:175]
    v_mfma_f32_16x16x32_bf16 v[176:179], v[64:67], v[44:47], v[176:179]
    ds_read_b64_tr_b16 v[126:127], v23 offset:9216
    v_mfma_f32_16x16x32_bf16 v[180:183], v[68:71], v[44:47], v[180:183]
    ds_read_b128 v[84:87], v15 offset:2048
    v_mfma_f32_16x16x32_bf16 v[184:187], v[72:75], v[44:47], v[184:187]
    v_mfma_f32_16x16x32_bf16 v[188:191], v[76:79], v[44:47], v[188:191]
    ds_read_b128 v[88:91], v15 offset:4096
    s_waitcnt lgkmcnt(13)
    v_mfma_f32_16x16x32_bf16 v[192:195], v[64:67], v[48:51], v[192:195]
    ds_read_b128 v[92:95], v15 offset:6144
    v_mfma_f32_16x16x32_bf16 v[196:199], v[68:71], v[48:51], v[196:199]
    v_mfma_f32_16x16x32_bf16 v[200:203], v[72:75], v[48:51], v[200:203]
    ds_read_b128 v[96:99], v15 offset:8192
    v_mfma_f32_16x16x32_bf16 v[204:207], v[76:79], v[48:51], v[204:207]
    ds_read_b128 v[100:103], v15 offset:10240
    v_mfma_f32_16x16x32_bf16 v[208:211], v[64:67], v[52:55], v[208:211]
    v_mfma_f32_16x16x32_bf16 v[212:215], v[68:71], v[52:55], v[212:215]
    ds_read_b128 v[104:107], v15 offset:12288
    v_mfma_f32_16x16x32_bf16 v[216:219], v[72:75], v[52:55], v[216:219]
    ds_read_b128 v[108:111], v15 offset:14336
    v_mfma_f32_16x16x32_bf16 v[220:223], v[76:79], v[52:55], v[220:223]
    s_waitcnt lgkmcnt(15)
    v_mfma_f32_16x16x32_bf16 v[224:227], v[64:67], v[56:59], v[224:227]
    v_mfma_f32_16x16x32_bf16 v[228:231], v[68:71], v[56:59], v[228:231]
    v_mfma_f32_16x16x32_bf16 v[232:235], v[72:75], v[56:59], v[232:235]
    v_mfma_f32_16x16x32_bf16 v[236:239], v[76:79], v[56:59], v[236:239]
    v_mfma_f32_16x16x32_bf16 v[240:243], v[64:67], v[60:63], v[240:243]
    v_mfma_f32_16x16x32_bf16 v[244:247], v[68:71], v[60:63], v[244:247]
    v_mfma_f32_16x16x32_bf16 v[248:251], v[72:75], v[60:63], v[248:251]
    v_mfma_f32_16x16x32_bf16 v[252:255], v[76:79], v[60:63], v[252:255]
    s_waitcnt vmcnt(2) lgkmcnt(0)
    s_barrier
    v_mfma_f32_16x16x32_bf16 v[128:131], v[112:115], v[80:83], v[128:131]
    ds_read_b64_tr_b16 v[64:65], v16 offset:0
    v_mfma_f32_16x16x32_bf16 v[132:135], v[116:119], v[80:83], v[132:135]
    ds_read_b64_tr_b16 v[66:67], v16 offset:1024
    s_add_u32 m0, s36, 65536
    s_nop 0
    buffer_load_dwordx4 v5, s[64:67], s32 offen offset:0 lds
    v_mfma_f32_16x16x32_bf16 v[136:139], v[120:123], v[80:83], v[136:139]
    v_mfma_f32_16x16x32_bf16 v[140:143], v[124:127], v[80:83], v[140:143]
    ds_read_b128 v[32:35], v12 offset:0
    v_mfma_f32_16x16x32_bf16 v[144:147], v[112:115], v[84:87], v[144:147]
    ds_read_b64_tr_b16 v[68:69], v17 offset:0
    buffer_load_dwordx4 v6, s[64:67], s32 offen offset:1024 lds
    v_mfma_f32_16x16x32_bf16 v[148:151], v[116:119], v[84:87], v[148:151]
    v_mfma_f32_16x16x32_bf16 v[152:155], v[120:123], v[84:87], v[152:155]
    ds_read_b64_tr_b16 v[70:71], v17 offset:1024
    v_mfma_f32_16x16x32_bf16 v[156:159], v[124:127], v[84:87], v[156:159]
    ds_read_b64_tr_b16 v[72:73], v18 offset:0
    buffer_load_dwordx4 v7, s[64:67], s32 offen offset:2048 lds
    v_mfma_f32_16x16x32_bf16 v[160:163], v[112:115], v[88:91], v[160:163]
    v_mfma_f32_16x16x32_bf16 v[164:167], v[116:119], v[88:91], v[164:167]
    ds_read_b64_tr_b16 v[74:75], v18 offset:1024
    v_mfma_f32_16x16x32_bf16 v[168:171], v[120:123], v[88:91], v[168:171]
    ds_read_b64_tr_b16 v[76:77], v19 offset:0
    buffer_load_dwordx4 v30, s[64:67], s32 offen offset:3072 lds
    s_add_u32 s32, s32, 128
    v_mfma_f32_16x16x32_bf16 v[172:175], v[124:127], v[88:91], v[172:175]
    v_mfma_f32_16x16x32_bf16 v[176:179], v[112:115], v[92:95], v[176:179]
    ds_read_b64_tr_b16 v[78:79], v19 offset:1024
    v_mfma_f32_16x16x32_bf16 v[180:183], v[116:119], v[92:95], v[180:183]
    ds_read_b128 v[36:39], v12 offset:2048
    s_add_u32 m0, s37, 65536
    s_nop 0
    buffer_load_dwordx4 v8, s[68:71], s33 offen offset:0 lds
    v_mfma_f32_16x16x32_bf16 v[184:187], v[120:123], v[92:95], v[184:187]
    v_mfma_f32_16x16x32_bf16 v[188:191], v[124:127], v[92:95], v[188:191]
    ds_read_b128 v[40:43], v12 offset:4096
    v_mfma_f32_16x16x32_bf16 v[192:195], v[112:115], v[96:99], v[192:195]
    ds_read_b128 v[44:47], v12 offset:6144
    buffer_load_dwordx4 v9, s[68:71], s33 offen offset:1024 lds
    v_mfma_f32_16x16x32_bf16 v[196:199], v[116:119], v[96:99], v[196:199]
    v_mfma_f32_16x16x32_bf16 v[200:203], v[120:123], v[96:99], v[200:203]
    ds_read_b128 v[48:51], v12 offset:8192
    v_mfma_f32_16x16x32_bf16 v[204:207], v[124:127], v[96:99], v[204:207]
    ds_read_b128 v[52:55], v12 offset:10240
    buffer_load_dwordx4 v10, s[68:71], s33 offen offset:2048 lds
    v_mfma_f32_16x16x32_bf16 v[208:211], v[112:115], v[100:103], v[208:211]
    v_mfma_f32_16x16x32_bf16 v[212:215], v[116:119], v[100:103], v[212:215]
    ds_read_b128 v[56:59], v12 offset:12288
    v_mfma_f32_16x16x32_bf16 v[216:219], v[120:123], v[100:103], v[216:219]
    ds_read_b128 v[60:63], v12 offset:14336
    buffer_load_dwordx4 v11, s[68:71], s33 offen offset:3072 lds
    s_add_u32 s33, s33, 524288
    v_mfma_f32_16x16x32_bf16 v[220:223], v[124:127], v[100:103], v[220:223]
    v_mfma_f32_16x16x32_bf16 v[224:227], v[112:115], v[104:107], v[224:227]
    v_mfma_f32_16x16x32_bf16 v[228:231], v[116:119], v[104:107], v[228:231]
    s_lshl_b32 s24, s2, 3
    v_mfma_f32_16x16x32_bf16 v[232:235], v[120:123], v[104:107], v[232:235]
    s_add_u32 s24, s24, s3
    v_mfma_f32_16x16x32_bf16 v[236:239], v[124:127], v[104:107], v[236:239]
    s_mul_i32 s24, s24, 1280
    v_mfma_f32_16x16x32_bf16 v[240:243], v[112:115], v[108:111], v[240:243]
    v_min_u32 v29, 9, v1
    v_mfma_f32_16x16x32_bf16 v[244:247], v[116:119], v[108:111], v[244:247]
    v_lshlrev_b32 v29, 7, v29
    v_mfma_f32_16x16x32_bf16 v[248:251], v[120:123], v[108:111], v[248:251]
    buffer_load_dword v28, v29, s[60:63], s24 offen
    v_mfma_f32_16x16x32_bf16 v[252:255], v[124:127], v[108:111], v[252:255]
    s_waitcnt lgkmcnt(12)
    v_mfma_f32_16x16x32_bf16 v[128:131], v[64:67], v[32:35], v[128:131]
    ds_read_b64_tr_b16 v[112:113], v16 offset:8192
    s_waitcnt lgkmcnt(11)
    v_mfma_f32_16x16x32_bf16 v[132:135], v[68:71], v[32:35], v[132:135]
    ds_read_b64_tr_b16 v[114:115], v16 offset:9216
    s_waitcnt lgkmcnt(10)
    v_mfma_f32_16x16x32_bf16 v[136:139], v[72:75], v[32:35], v[136:139]
    s_waitcnt lgkmcnt(8)
    v_mfma_f32_16x16x32_bf16 v[140:143], v[76:79], v[32:35], v[140:143]
    ds_read_b128 v[80:83], v13 offset:0
    v_mfma_f32_16x16x32_bf16 v[144:147], v[64:67], v[36:39], v[144:147]
    ds_read_b64_tr_b16 v[116:117], v17 offset:8192
    buffer_load_dword v31, off, s[12:15], 0 sc1
    v_mfma_f32_16x16x32_bf16 v[148:151], v[68:71], v[36:39], v[148:151]
    v_mfma_f32_16x16x32_bf16 v[152:155], v[72:75], v[36:39], v[152:155]
    ds_read_b64_tr_b16 v[118:119], v17 offset:9216
    v_mfma_f32_16x16x32_bf16 v[156:159], v[76:79], v[36:39], v[156:159]
    ds_read_b64_tr_b16 v[120:121], v18 offset:8192
    s_waitcnt lgkmcnt(10)
    v_mfma_f32_16x16x32_bf16 v[160:163], v[64:67], v[40:43], v[160:163]
    v_mfma_f32_16x16x32_bf16 v[164:167], v[68:71], v[40:43], v[164:167]
    ds_read_b64_tr_b16 v[122:123], v18 offset:9216
    v_mfma_f32_16x16x32_bf16 v[168:171], v[72:75], v[40:43], v[168:171]
    ds_read_b64_tr_b16 v[124:125], v19 offset:8192
    v_mfma_f32_16x16x32_bf16 v[172:175], v[76:79], v[40:43], v[172:175]
    v_mfma_f32_16x16x32_bf16 v[176:179], v[64:67], v[44:47], v[176:179]
    ds_read_b64_tr_b16 v[126:127], v19 offset:9216
    v_mfma_f32_16x16x32_bf16 v[180:183], v[68:71], v[44:47], v[180:183]
    ds_read_b128 v[84:87], v13 offset:2048
    v_mfma_f32_16x16x32_bf16 v[184:187], v[72:75], v[44:47], v[184:187]
    v_mfma_f32_16x16x32_bf16 v[188:191], v[76:79], v[44:47], v[188:191]
    ds_read_b128 v[88:91], v13 offset:4096
    s_waitcnt lgkmcnt(13)
    v_mfma_f32_16x16x32_bf16 v[192:195], v[64:67], v[48:51], v[192:195]
    ds_read_b128 v[92:95], v13 offset:6144
    v_mfma_f32_16x16x32_bf16 v[196:199], v[68:71], v[48:51], v[196:199]
    v_mfma_f32_16x16x32_bf16 v[200:203], v[72:75], v[48:51], v[200:203]
    ds_read_b128 v[96:99], v13 offset:8192
    v_mfma_f32_16x16x32_bf16 v[204:207], v[76:79], v[48:51], v[204:207]
    ds_read_b128 v[100:103], v13 offset:10240
    v_mfma_f32_16x16x32_bf16 v[208:211], v[64:67], v[52:55], v[208:211]
    v_mfma_f32_16x16x32_bf16 v[212:215], v[68:71], v[52:55], v[212:215]
    ds_read_b128 v[104:107], v13 offset:12288
    v_mfma_f32_16x16x32_bf16 v[216:219], v[72:75], v[52:55], v[216:219]
    ds_read_b128 v[108:111], v13 offset:14336
    v_mfma_f32_16x16x32_bf16 v[220:223], v[76:79], v[52:55], v[220:223]
    s_waitcnt lgkmcnt(15)
    v_mfma_f32_16x16x32_bf16 v[224:227], v[64:67], v[56:59], v[224:227]
    v_mfma_f32_16x16x32_bf16 v[228:231], v[68:71], v[56:59], v[228:231]
    v_mfma_f32_16x16x32_bf16 v[232:235], v[72:75], v[56:59], v[232:235]
    v_mfma_f32_16x16x32_bf16 v[236:239], v[76:79], v[56:59], v[236:239]
    v_mfma_f32_16x16x32_bf16 v[240:243], v[64:67], v[60:63], v[240:243]
    v_mfma_f32_16x16x32_bf16 v[244:247], v[68:71], v[60:63], v[244:247]
    v_mfma_f32_16x16x32_bf16 v[248:251], v[72:75], v[60:63], v[248:251]
    v_mfma_f32_16x16x32_bf16 v[252:255], v[76:79], v[60:63], v[252:255]
    s_waitcnt vmcnt(2) lgkmcnt(0)
    s_barrier
    v_mfma_f32_16x16x32_bf16 v[128:131], v[112:115], v[80:83], v[128:131]
    ds_read_b64_tr_b16 v[64:65], v20 offset:0
    v_mfma_f32_16x16x32_bf16 v[132:135], v[116:119], v[80:83], v[132:135]
    ds_read_b64_tr_b16 v[66:67], v20 offset:1024
    s_add_u32 m0, s36, 0
    s_nop 0
    buffer_load_dwordx4 v5, s[64:67], s32 offen offset:0 lds
    v_mfma_f32_16x16x32_bf16 v[136:139], v[120:123], v[80:83], v[136:139]
    v_mfma_f32_16x16x32_bf16 v[140:143], v[124:127], v[80:83], v[140:143]
    ds_read_b128 v[32:35], v14 offset:0
    v_mfma_f32_16x16x32_bf16 v[144:147], v[112:115], v[84:87], v[144:147]
    ds_read_b64_tr_b16 v[68:69], v21 offset:0
    buffer_load_dwordx4 v6, s[64:67], s32 offen offset:1024 lds
    v_mfma_f32_16x16x32_bf16 v[148:151], v[116:119], v[84:87], v[148:151]
    v_mfma_f32_16x16x32_bf16 v[152:155], v[120:123], v[84:87], v[152:155]
    ds_read_b64_tr_b16 v[70:71], v21 offset:1024
    v_mfma_f32_16x16x32_bf16 v[156:159], v[124:127], v[84:87], v[156:159]
    ds_read_b64_tr_b16 v[72:73], v22 offset:0
    buffer_load_dwordx4 v7, s[64:67], s32 offen offset:2048 lds
    v_mfma_f32_16x16x32_bf16 v[160:163], v[112:115], v[88:91], v[160:163]
    v_mfma_f32_16x16x32_bf16 v[164:167], v[116:119], v[88:91], v[164:167]
    ds_read_b64_tr_b16 v[74:75], v22 offset:1024
    v_mfma_f32_16x16x32_bf16 v[168:171], v[120:123], v[88:91], v[168:171]
    ds_read_b64_tr_b16 v[76:77], v23 offset:0
    buffer_load_dwordx4 v30, s[64:67], s32 offen offset:3072 lds
    s_add_u32 s32, s32, 128
    v_mfma_f32_16x16x32_bf16 v[172:175], v[124:127], v[88:91], v[172:175]
    v_mfma_f32_16x16x32_bf16 v[176:179], v[112:115], v[92:95], v[176:179]
    ds_read_b64_tr_b16 v[78:79], v23 offset:1024
    v_mfma_f32_16x16x32_bf16 v[180:183], v[116:119], v[92:95], v[180:183]
    ds_read_b128 v[36:39], v14 offset:2048
    s_add_u32 m0, s37, 0
    s_nop 0
    buffer_load_dwordx4 v8, s[68:71], s33 offen offset:0 lds
    v_mfma_f32_16x16x32_bf16 v[184:187], v[120:123], v[92:95], v[184:187]
    v_mfma_f32_16x16x32_bf16 v[188:191], v[124:127], v[92:95], v[188:191]
    ds_read_b128 v[40:43], v14 offset:4096
    v_mfma_f32_16x16x32_bf16 v[192:195], v[112:115], v[96:99], v[192:195]
    ds_read_b128 v[44:47], v14 offset:6144
    buffer_load_dwordx4 v9, s[68:71], s33 offen offset:1024 lds
    v_mfma_f32_16x16x32_bf16 v[196:199], v[116:119], v[96:99], v[196:199]
    v_mfma_f32_16x16x32_bf16 v[200:203], v[120:123], v[96:99], v[200:203]
    ds_read_b128 v[48:51], v14 offset:8192
    v_mfma_f32_16x16x32_bf16 v[204:207], v[124:127], v[96:99], v[204:207]
    ds_read_b128 v[52:55], v14 offset:10240
    buffer_load_dwordx4 v10, s[68:71], s33 offen offset:2048 lds
    v_mfma_f32_16x16x32_bf16 v[208:211], v[112:115], v[100:103], v[208:211]
    v_mfma_f32_16x16x32_bf16 v[212:215], v[116:119], v[100:103], v[212:215]
    ds_read_b128 v[56:59], v14 offset:12288
    v_mfma_f32_16x16x32_bf16 v[216:219], v[120:123], v[100:103], v[216:219]
    ds_read_b128 v[60:63], v14 offset:14336
    buffer_load_dwordx4 v11, s[68:71], s33 offen offset:3072 lds
    s_add_u32 s33, s33, 524288
    v_mfma_f32_16x16x32_bf16 v[220:223], v[124:127], v[100:103], v[220:223]
    v_mfma_f32_16x16x32_bf16 v[224:227], v[112:115], v[104:107], v[224:227]
    v_mfma_f32_16x16x32_bf16 v[228:231], v[116:119], v[104:107], v[228:231]
    s_lshl_b32 s24, s2, 1
    s_and_b32 s25, s3, 1
    v_mfma_f32_16x16x32_bf16 v[232:235], v[120:123], v[104:107], v[232:235]
    s_add_u32 s24, s24, s25
    v_mfma_f32_16x16x32_bf16 v[236:239], v[124:127], v[104:107], v[236:239]
    s_add_u32 s24, s24, 0
    v_mfma_f32_16x16x32_bf16 v[240:243], v[112:115], v[108:111], v[240:243]
    s_mul_i32 s24, s24, 2176
    v_min_u32 v29, 16, v1
    v_mfma_f32_16x16x32_bf16 v[244:247], v[116:119], v[108:111], v[244:247]
    v_lshlrev_b32 v29, 7, v29
    v_mfma_f32_16x16x32_bf16 v[248:251], v[120:123], v[108:111], v[248:251]
    buffer_load_dword v28, v29, s[72:75], s24 offen
    v_mfma_f32_16x16x32_bf16 v[252:255], v[124:127], v[108:111], v[252:255]
    s_waitcnt lgkmcnt(12)
    v_mfma_f32_16x16x32_bf16 v[128:131], v[64:67], v[32:35], v[128:131]
    ds_read_b64_tr_b16 v[112:113], v20 offset:8192
    s_waitcnt lgkmcnt(11)
    v_mfma_f32_16x16x32_bf16 v[132:135], v[68:71], v[32:35], v[132:135]
    ds_read_b64_tr_b16 v[114:115], v20 offset:9216
    s_waitcnt lgkmcnt(10)
    v_mfma_f32_16x16x32_bf16 v[136:139], v[72:75], v[32:35], v[136:139]
    s_waitcnt lgkmcnt(8)
    v_mfma_f32_16x16x32_bf16 v[140:143], v[76:79], v[32:35], v[140:143]
    ds_read_b128 v[80:83], v15 offset:0
    v_mfma_f32_16x16x32_bf16 v[144:147], v[64:67], v[36:39], v[144:147]
    ds_read_b64_tr_b16 v[116:117], v21 offset:8192
    v_mfma_f32_16x16x32_bf16 v[148:151], v[68:71], v[36:39], v[148:151]
    v_mfma_f32_16x16x32_bf16 v[152:155], v[72:75], v[36:39], v[152:155]
    ds_read_b64_tr_b16 v[118:119], v21 offset:9216
    v_mfma_f32_16x16x32_bf16 v[156:159], v[76:79], v[36:39], v[156:159]
    ds_read_b64_tr_b16 v[120:121], v22 offset:8192
    s_waitcnt lgkmcnt(10)
    v_mfma_f32_16x16x32_bf16 v[160:163], v[64:67], v[40:43], v[160:163]
    v_mfma_f32_16x16x32_bf16 v[164:167], v[68:71], v[40:43], v[164:167]
    ds_read_b64_tr_b16 v[122:123], v22 offset:9216
    v_mfma_f32_16x16x32_bf16 v[168:171], v[72:75], v[40:43], v[168:171]
    ds_read_b64_tr_b16 v[124:125], v23 offset:8192
    v_mfma_f32_16x16x32_bf16 v[172:175], v[76:79], v[40:43], v[172:175]
    v_mfma_f32_16x16x32_bf16 v[176:179], v[64:67], v[44:47], v[176:179]
    ds_read_b64_tr_b16 v[126:127], v23 offset:9216
    v_mfma_f32_16x16x32_bf16 v[180:183], v[68:71], v[44:47], v[180:183]
    ds_read_b128 v[84:87], v15 offset:2048
    v_mfma_f32_16x16x32_bf16 v[184:187], v[72:75], v[44:47], v[184:187]
    v_mfma_f32_16x16x32_bf16 v[188:191], v[76:79], v[44:47], v[188:191]
    ds_read_b128 v[88:91], v15 offset:4096
    s_waitcnt lgkmcnt(13)
    v_mfma_f32_16x16x32_bf16 v[192:195], v[64:67], v[48:51], v[192:195]
    ds_read_b128 v[92:95], v15 offset:6144
    v_mfma_f32_16x16x32_bf16 v[196:199], v[68:71], v[48:51], v[196:199]
    v_mfma_f32_16x16x32_bf16 v[200:203], v[72:75], v[48:51], v[200:203]
    ds_read_b128 v[96:99], v15 offset:8192
    v_mfma_f32_16x16x32_bf16 v[204:207], v[76:79], v[48:51], v[204:207]
    ds_read_b128 v[100:103], v15 offset:10240
    v_mfma_f32_16x16x32_bf16 v[208:211], v[64:67], v[52:55], v[208:211]
    v_mfma_f32_16x16x32_bf16 v[212:215], v[68:71], v[52:55], v[212:215]
    ds_read_b128 v[104:107], v15 offset:12288
    v_mfma_f32_16x16x32_bf16 v[216:219], v[72:75], v[52:55], v[216:219]
    ds_read_b128 v[108:111], v15 offset:14336
    v_mfma_f32_16x16x32_bf16 v[220:223], v[76:79], v[52:55], v[220:223]
    s_waitcnt lgkmcnt(15)
    v_mfma_f32_16x16x32_bf16 v[224:227], v[64:67], v[56:59], v[224:227]
    v_mfma_f32_16x16x32_bf16 v[228:231], v[68:71], v[56:59], v[228:231]
    v_mfma_f32_16x16x32_bf16 v[232:235], v[72:75], v[56:59], v[232:235]
    v_mfma_f32_16x16x32_bf16 v[236:239], v[76:79], v[56:59], v[236:239]
    v_mfma_f32_16x16x32_bf16 v[240:243], v[64:67], v[60:63], v[240:243]
    v_mfma_f32_16x16x32_bf16 v[244:247], v[68:71], v[60:63], v[244:247]
    v_mfma_f32_16x16x32_bf16 v[248:251], v[72:75], v[60:63], v[248:251]
    v_mfma_f32_16x16x32_bf16 v[252:255], v[76:79], v[60:63], v[252:255]
    s_waitcnt vmcnt(1) lgkmcnt(0)
    s_barrier
    s_waitcnt vmcnt(9)
    v_readfirstlane_b32 s38, v31
    s_cmp_eq_u32 s38, 0
    s_cbranch_scc1 TAG2_S
TAG2_C:
    v_mfma_f32_16x16x32_bf16 v[128:131], v[112:115], v[80:83], v[128:131]
    ds_read_b64_tr_b16 v[64:65], v16 offset:0
    v_mfma_f32_16x16x32_bf16 v[132:135], v[116:119], v[80:83], v[132:135]
    ds_read_b64_tr_b16 v[66:67], v16 offset:1024
    s_add_u32 m0, s36, 65536
    s_nop 0
    buffer_load_dwordx4 v5, s[64:67], s32 offen offset:0 lds
    v_mfma_f32_16x16x32_bf16 v[136:139], v[120:123], v[80:83], v[136:139]
    v_mfma_f32_16x16x32_bf16 v[140:143], v[124:127], v[80:83], v[140:143]
    ds_read_b128 v[32:35], v12 offset:0
    v_mfma_f32_16x16x32_bf16 v[144:147], v[112:115], v[84:87], v[144:147]
    ds_read_b64_tr_b16 v[68:69], v17 offset:0
    buffer_load_dwordx4 v6, s[64:67], s32 offen offset:1024 lds
    v_mfma_f32_16x16x32_bf16 v[148:151], v[116:119], v[84:87], v[148:151]
    v_mfma_f32_16x16x32_bf16 v[152:155], v[120:123], v[84:87], v[152:155]
    ds_read_b64_tr_b16 v[70:71], v17 offset:1024
    v_mfma_f32_16x16x32_bf16 v[156:159], v[124:127], v[84:87], v[156:159]
    ds_read_b64_tr_b16 v[72:73], v18 offset:0
    buffer_load_dwordx4 v7, s[64:67], s32 offen offset:2048 lds
    v_mfma_f32_16x16x32_bf16 v[160:163], v[112:115], v[88:91], v[160:163]
    v_mfma_f32_16x16x32_bf16 v[164:167], v[116:119], v[88:91], v[164:167]
    ds_read_b64_tr_b16 v[74:75], v18 offset:1024
    v_mfma_f32_16x16x32_bf16 v[168:171], v[120:123], v[88:91], v[168:171]
    ds_read_b64_tr_b16 v[76:77], v19 offset:0
    buffer_load_dwordx4 v30, s[64:67], s32 offen offset:3072 lds
    s_add_u32 s32, s32, 128
    v_mfma_f32_16x16x32_bf16 v[172:175], v[124:127], v[88:91], v[172:175]
    v_mfma_f32_16x16x32_bf16 v[176:179], v[112:115], v[92:95], v[176:179]
    ds_read_b64_tr_b16 v[78:79], v19 offset:1024
    v_mfma_f32_16x16x32_bf16 v[180:183], v[116:119], v[92:95], v[180:183]
    ds_read_b128 v[36:39], v12 offset:2048
    s_add_u32 m0, s37, 65536
    s_nop 0
    buffer_load_dwordx4 v8, s[68:71], s33 offen offset:0 lds
    v_mfma_f32_16x16x32_bf16 v[184:187], v[120:123], v[92:95], v[184:187]
    v_mfma_f32_16x16x32_bf16 v[188:191], v[124:127], v[92:95], v[188:191]
    ds_read_b128 v[40:43], v12 offset:4096
    v_mfma_f32_16x16x32_bf16 v[192:195], v[112:115], v[96:99], v[192:195]
    ds_read_b128 v[44:47], v12 offset:6144
    buffer_load_dwordx4 v9, s[68:71], s33 offen offset:1024 lds
    v_mfma_f32_16x16x32_bf16 v[196:199], v[116:119], v[96:99], v[196:199]
    v_mfma_f32_16x16x32_bf16 v[200:203], v[120:123], v[96:99], v[200:203]
    ds_read_b128 v[48:51], v12 offset:8192
    v_mfma_f32_16x16x32_bf16 v[204:207], v[124:127], v[96:99], v[204:207]
    ds_read_b128 v[52:55], v12 offset:10240
    buffer_load_dwordx4 v10, s[68:71], s33 offen offset:2048 lds
    v_mfma_f32_16x16x32_bf16 v[208:211], v[112:115], v[100:103], v[208:211]
    v_mfma_f32_16x16x32_bf16 v[212:215], v[116:119], v[100:103], v[212:215]
    ds_read_b128 v[56:59], v12 offset:12288
    v_mfma_f32_16x16x32_bf16 v[216:219], v[120:123], v[100:103], v[216:219]
    ds_read_b128 v[60:63], v12 offset:14336
    buffer_load_dwordx4 v11, s[68:71], s33 offen offset:3072 lds
    s_add_u32 s33, s33, 524288
    v_mfma_f32_16x16x32_bf16 v[220:223], v[124:127], v[100:103], v[220:223]
    v_mfma_f32_16x16x32_bf16 v[224:227], v[112:115], v[104:107], v[224:227]
    v_mfma_f32_16x16x32_bf16 v[228:231], v[116:119], v[104:107], v[228:231]
    s_lshl_b32 s24, s2, 1
    s_and_b32 s25, s3, 1
    v_mfma_f32_16x16x32_bf16 v[232:235], v[120:123], v[104:107], v[232:235]
    s_add_u32 s24, s24, s25
    v_mfma_f32_16x16x32_bf16 v[236:239], v[124:127], v[104:107], v[236:239]
    s_add_u32 s24, s24, 512
    v_mfma_f32_16x16x32_bf16 v[240:243], v[112:115], v[108:111], v[240:243]
    s_mul_i32 s24, s24, 2176
    v_min_u32 v29, 16, v1
    v_mfma_f32_16x16x32_bf16 v[244:247], v[116:119], v[108:111], v[244:247]
    v_lshlrev_b32 v29, 7, v29
    v_mfma_f32_16x16x32_bf16 v[248:251], v[120:123], v[108:111], v[248:251]
    buffer_load_dword v28, v29, s[72:75], s24 offen
    v_mfma_f32_16x16x32_bf16 v[252:255], v[124:127], v[108:111], v[252:255]
    s_waitcnt lgkmcnt(12)
    v_mfma_f32_16x16x32_bf16 v[128:131], v[64:67], v[32:35], v[128:131]
    ds_read_b64_tr_b16 v[112:113], v16 offset:8192
    s_waitcnt lgkmcnt(11)
    v_mfma_f32_16x16x32_bf16 v[132:135], v[68:71], v[32:35], v[132:135]
    ds_read_b64_tr_b16 v[114:115], v16 offset:9216
    s_waitcnt lgkmcnt(10)
    v_mfma_f32_16x16x32_bf16 v[136:139], v[72:75], v[32:35], v[136:139]
    s_waitcnt lgkmcnt(8)
    v_mfma_f32_16x16x32_bf16 v[140:143], v[76:79], v[32:35], v[140:143]
    ds_read_b128 v[80:83], v13 offset:0
    v_mfma_f32_16x16x32_bf16 v[144:147], v[64:67], v[36:39], v[144:147]
    ds_read_b64_tr_b16 v[116:117], v17 offset:8192
    v_mfma_f32_16x16x32_bf16 v[148:151], v[68:71], v[36:39], v[148:151]
    v_mfma_f32_16x16x32_bf16 v[152:155], v[72:75], v[36:39], v[152:155]
    ds_read_b64_tr_b16 v[118:119], v17 offset:9216
    v_mfma_f32_16x16x32_bf16 v[156:159], v[76:79], v[36:39], v[156:159]
    ds_read_b64_tr_b16 v[120:121], v18 offset:8192
    s_waitcnt lgkmcnt(10)
    v_mfma_f32_16x16x32_bf16 v[160:163], v[64:67], v[40:43], v[160:163]
    v_mfma_f32_16x16x32_bf16 v[164:167], v[68:71], v[40:43], v[164:167]
    ds_read_b64_tr_b16 v[122:123], v18 offset:9216
    v_mfma_f32_16x16x32_bf16 v[168:171], v[72:75], v[40:43], v[168:171]
    ds_read_b64_tr_b16 v[124:125], v19 offset:8192
    v_mfma_f32_16x16x32_bf16 v[172:175], v[76:79], v[40:43], v[172:175]
    v_mfma_f32_16x16x32_bf16 v[176:179], v[64:67], v[44:47], v[176:179]
    ds_read_b64_tr_b16 v[126:127], v19 offset:9216
    v_mfma_f32_16x16x32_bf16 v[180:183], v[68:71], v[44:47], v[180:183]
    ds_read_b128 v[84:87], v13 offset:2048
    v_mfma_f32_16x16x32_bf16 v[184:187], v[72:75], v[44:47], v[184:187]
    v_mfma_f32_16x16x32_bf16 v[188:191], v[76:79], v[44:47], v[188:191]
    ds_read_b128 v[88:91], v13 offset:4096
    s_waitcnt lgkmcnt(13)
    v_mfma_f32_16x16x32_bf16 v[192:195], v[64:67], v[48:51], v[192:195]
    ds_read_b128 v[92:95], v13 offset:6144
    v_mfma_f32_16x16x32_bf16 v[196:199], v[68:71], v[48:51], v[196:199]
    v_mfma_f32_16x16x32_bf16 v[200:203], v[72:75], v[48:51], v[200:203]
    ds_read_b128 v[96:99], v13 offset:8192
    v_mfma_f32_16x16x32_bf16 v[204:207], v[76:79], v[48:51], v[204:207]
    ds_read_b128 v[100:103], v13 offset:10240
    v_mfma_f32_16x16x32_bf16 v[208:211], v[64:67], v[52:55], v[208:211]
    v_mfma_f32_16x16x32_bf16 v[212:215], v[68:71], v[52:55], v[212:215]
    ds_read_b128 v[104:107], v13 offset:12288
    v_mfma_f32_16x16x32_bf16 v[216:219], v[72:75], v[52:55], v[216:219]
    ds_read_b128 v[108:111], v13 offset:14336
    v_mfma_f32_16x16x32_bf16 v[220:223], v[76:79], v[52:55], v[220:223]
    s_waitcnt lgkmcnt(15)
    v_mfma_f32_16x16x32_bf16 v[224:227], v[64:67], v[56:59], v[224:227]
    v_mfma_f32_16x16x32_bf16 v[228:231], v[68:71], v[56:59], v[228:231]
    v_mfma_f32_16x16x32_bf16 v[232:235], v[72:75], v[56:59], v[232:235]
    v_mfma_f32_16x16x32_bf16 v[236:239], v[76:79], v[56:59], v[236:239]
    v_mfma_f32_16x16x32_bf16 v[240:243], v[64:67], v[60:63], v[240:243]
    v_mfma_f32_16x16x32_bf16 v[244:247], v[68:71], v[60:63], v[244:247]
    v_mfma_f32_16x16x32_bf16 v[248:251], v[72:75], v[60:63], v[248:251]
    v_mfma_f32_16x16x32_bf16 v[252:255], v[76:79], v[60:63], v[252:255]
    s_waitcnt vmcnt(1) lgkmcnt(0)
    s_barrier
    v_mfma_f32_16x16x32_bf16 v[128:131], v[112:115], v[80:83], v[128:131]
    ds_read_b64_tr_b16 v[64:65], v20 offset:0
    v_mfma_f32_16x16x32_bf16 v[132:135], v[116:119], v[80:83], v[132:135]
    ds_read_b64_tr_b16 v[66:67], v20 offset:1024
    s_add_u32 m0, s36, 0
    s_nop 0
    buffer_load_dwordx4 v5, s[64:67], s32 offen offset:0 lds
    v_mfma_f32_16x16x32_bf16 v[136:139], v[120:123], v[80:83], v[136:139]
    v_mfma_f32_16x16x32_bf16 v[140:143], v[124:127], v[80:83], v[140:143]
    ds_read_b128 v[32:35], v14 offset:0
    v_mfma_f32_16x16x32_bf16 v[144:147], v[112:115], v[84:87], v[144:147]
    ds_read_b64_tr_b16 v[68:69], v21 offset:0
    buffer_load_dwordx4 v6, s[64:67], s32 offen offset:1024 lds
    v_mfma_f32_16x16x32_bf16 v[148:151], v[116:119], v[84:87], v[148:151]
    v_mfma_f32_16x16x32_bf16 v[152:155], v[120:123], v[84:87], v[152:155]
    ds_read_b64_tr_b16 v[70:71], v21 offset:1024
    v_mfma_f32_16x16x32_bf16 v[156:159], v[124:127], v[84:87], v[156:159]
    ds_read_b64_tr_b16 v[72:73], v22 offset:0
    buffer_load_dwordx4 v7, s[64:67], s32 offen offset:2048 lds
    v_mfma_f32_16x16x32_bf16 v[160:163], v[112:115], v[88:91], v[160:163]
    v_mfma_f32_16x16x32_bf16 v[164:167], v[116:119], v[88:91], v[164:167]
    ds_read_b64_tr_b16 v[74:75], v22 offset:1024
    v_mfma_f32_16x16x32_bf16 v[168:171], v[120:123], v[88:91], v[168:171]
    ds_read_b64_tr_b16 v[76:77], v23 offset:0
    buffer_load_dwordx4 v30, s[64:67], s32 offen offset:3072 lds
    s_add_u32 s32, s32, 128
    v_mfma_f32_16x16x32_bf16 v[172:175], v[124:127], v[88:91], v[172:175]
    v_mfma_f32_16x16x32_bf16 v[176:179], v[112:115], v[92:95], v[176:179]
    ds_read_b64_tr_b16 v[78:79], v23 offset:1024
    v_mfma_f32_16x16x32_bf16 v[180:183], v[116:119], v[92:95], v[180:183]
    ds_read_b128 v[36:39], v14 offset:2048
    s_add_u32 m0, s37, 0
    s_nop 0
    buffer_load_dwordx4 v8, s[68:71], s33 offen offset:0 lds
    v_mfma_f32_16x16x32_bf16 v[184:187], v[120:123], v[92:95], v[184:187]
    v_mfma_f32_16x16x32_bf16 v[188:191], v[124:127], v[92:95], v[188:191]
    ds_read_b128 v[40:43], v14 offset:4096
    v_mfma_f32_16x16x32_bf16 v[192:195], v[112:115], v[96:99], v[192:195]
    ds_read_b128 v[44:47], v14 offset:6144
    buffer_load_dwordx4 v9, s[68:71], s33 offen offset:1024 lds
    v_mfma_f32_16x16x32_bf16 v[196:199], v[116:119], v[96:99], v[196:199]
    v_mfma_f32_16x16x32_bf16 v[200:203], v[120:123], v[96:99], v[200:203]
    ds_read_b128 v[48:51], v14 offset:8192
    v_mfma_f32_16x16x32_bf16 v[204:207], v[124:127], v[96:99], v[204:207]
    ds_read_b128 v[52:55], v14 offset:10240
    buffer_load_dwordx4 v10, s[68:71], s33 offen offset:2048 lds
    v_mfma_f32_16x16x32_bf16 v[208:211], v[112:115], v[100:103], v[208:211]
    v_mfma_f32_16x16x32_bf16 v[212:215], v[116:119], v[100:103], v[212:215]
    ds_read_b128 v[56:59], v14 offset:12288
    v_mfma_f32_16x16x32_bf16 v[216:219], v[120:123], v[100:103], v[216:219]
    ds_read_b128 v[60:63], v14 offset:14336
    buffer_load_dwordx4 v11, s[68:71], s33 offen offset:3072 lds
    s_add_u32 s33, s33, 524288
    v_mfma_f32_16x16x32_bf16 v[220:223], v[124:127], v[100:103], v[220:223]
    v_mfma_f32_16x16x32_bf16 v[224:227], v[112:115], v[104:107], v[224:227]
    v_mfma_f32_16x16x32_bf16 v[228:231], v[116:119], v[104:107], v[228:231]
    v_mfma_f32_16x16x32_bf16 v[232:235], v[120:123], v[104:107], v[232:235]
    v_mfma_f32_16x16x32_bf16 v[236:239], v[124:127], v[104:107], v[236:239]
    v_mfma_f32_16x16x32_bf16 v[240:243], v[112:115], v[108:111], v[240:243]
    v_mfma_f32_16x16x32_bf16 v[244:247], v[116:119], v[108:111], v[244:247]
    v_mfma_f32_16x16x32_bf16 v[248:251], v[120:123], v[108:111], v[248:251]
    v_mfma_f32_16x16x32_bf16 v[252:255], v[124:127], v[108:111], v[252:255]
    s_waitcnt lgkmcnt(12)
    v_mfma_f32_16x16x32_bf16 v[128:131], v[64:67], v[32:35], v[128:131]
    ds_read_b64_tr_b16 v[112:113], v20 offset:8192
    s_waitcnt lgkmcnt(11)
    v_mfma_f32_16x16x32_bf16 v[132:135], v[68:71], v[32:35], v[132:135]
    ds_read_b64_tr_b16 v[114:115], v20 offset:9216
    s_waitcnt lgkmcnt(10)
    v_mfma_f32_16x16x32_bf16 v[136:139], v[72:75], v[32:35], v[136:139]
    s_waitcnt lgkmcnt(8)
    v_mfma_f32_16x16x32_bf16 v[140:143], v[76:79], v[32:35], v[140:143]
    ds_read_b128 v[80:83], v15 offset:0
    v_mfma_f32_16x16x32_bf16 v[144:147], v[64:67], v[36:39], v[144:147]
    ds_read_b64_tr_b16 v[116:117], v21 offset:8192
    v_mfma_f32_16x16x32_bf16 v[148:151], v[68:71], v[36:39], v[148:151]
    v_mfma_f32_16x16x32_bf16 v[152:155], v[72:75], v[36:39], v[152:155]
    ds_read_b64_tr_b16 v[118:119], v21 offset:9216
    v_mfma_f32_16x16x32_bf16 v[156:159], v[76:79], v[36:39], v[156:159]
    ds_read_b64_tr_b16 v[120:121], v22 offset:8192
    s_waitcnt lgkmcnt(10)
    v_mfma_f32_16x16x32_bf16 v[160:163], v[64:67], v[40:43], v[160:163]
    v_mfma_f32_16x16x32_bf16 v[164:167], v[68:71], v[40:43], v[164:167]
    ds_read_b64_tr_b16 v[122:123], v22 offset:9216
    v_mfma_f32_16x16x32_bf16 v[168:171], v[72:75], v[40:43], v[168:171]
    ds_read_b64_tr_b16 v[124:125], v23 offset:8192
    v_mfma_f32_16x16x32_bf16 v[172:175], v[76:79], v[40:43], v[172:175]
    v_mfma_f32_16x16x32_bf16 v[176:179], v[64:67], v[44:47], v[176:179]
    ds_read_b64_tr_b16 v[126:127], v23 offset:9216
    v_mfma_f32_16x16x32_bf16 v[180:183], v[68:71], v[44:47], v[180:183]
    ds_read_b128 v[84:87], v15 offset:2048
    v_mfma_f32_16x16x32_bf16 v[184:187], v[72:75], v[44:47], v[184:187]
    v_mfma_f32_16x16x32_bf16 v[188:191], v[76:79], v[44:47], v[188:191]
    ds_read_b128 v[88:91], v15 offset:4096
    s_waitcnt lgkmcnt(13)
    v_mfma_f32_16x16x32_bf16 v[192:195], v[64:67], v[48:51], v[192:195]
    ds_read_b128 v[92:95], v15 offset:6144
    v_mfma_f32_16x16x32_bf16 v[196:199], v[68:71], v[48:51], v[196:199]
    v_mfma_f32_16x16x32_bf16 v[200:203], v[72:75], v[48:51], v[200:203]
    ds_read_b128 v[96:99], v15 offset:8192
    v_mfma_f32_16x16x32_bf16 v[204:207], v[76:79], v[48:51], v[204:207]
    ds_read_b128 v[100:103], v15 offset:10240
    v_mfma_f32_16x16x32_bf16 v[208:211], v[64:67], v[52:55], v[208:211]
    v_mfma_f32_16x16x32_bf16 v[212:215], v[68:71], v[52:55], v[212:215]
    ds_read_b128 v[104:107], v15 offset:12288
    v_mfma_f32_16x16x32_bf16 v[216:219], v[72:75], v[52:55], v[216:219]
    ds_read_b128 v[108:111], v15 offset:14336
    v_mfma_f32_16x16x32_bf16 v[220:223], v[76:79], v[52:55], v[220:223]
    s_waitcnt lgkmcnt(15)
    v_mfma_f32_16x16x32_bf16 v[224:227], v[64:67], v[56:59], v[224:227]
    v_mfma_f32_16x16x32_bf16 v[228:231], v[68:71], v[56:59], v[228:231]
    v_mfma_f32_16x16x32_bf16 v[232:235], v[72:75], v[56:59], v[232:235]
    v_mfma_f32_16x16x32_bf16 v[236:239], v[76:79], v[56:59], v[236:239]
    v_mfma_f32_16x16x32_bf16 v[240:243], v[64:67], v[60:63], v[240:243]
    v_mfma_f32_16x16x32_bf16 v[244:247], v[68:71], v[60:63], v[244:247]
    v_mfma_f32_16x16x32_bf16 v[248:251], v[72:75], v[60:63], v[248:251]
    v_mfma_f32_16x16x32_bf16 v[252:255], v[76:79], v[60:63], v[252:255]
    s_waitcnt vmcnt(0) lgkmcnt(0)
    s_barrier
    v_mfma_f32_16x16x32_bf16 v[128:131], v[112:115], v[80:83], v[128:131]
    ds_read_b64_tr_b16 v[64:65], v16 offset:0
    v_mfma_f32_16x16x32_bf16 v[132:135], v[116:119], v[80:83], v[132:135]
    ds_read_b64_tr_b16 v[66:67], v16 offset:1024
    s_add_u32 m0, s36, 65536
    s_nop 0
    buffer_load_dwordx4 v5, s[64:67], s32 offen offset:0 lds
    v_mfma_f32_16x16x32_bf16 v[136:139], v[120:123], v[80:83], v[136:139]
    v_mfma_f32_16x16x32_bf16 v[140:143], v[124:127], v[80:83], v[140:143]
    ds_read_b128 v[32:35], v12 offset:0
    v_mfma_f32_16x16x32_bf16 v[144:147], v[112:115], v[84:87], v[144:147]
    ds_read_b64_tr_b16 v[68:69], v17 offset:0
    buffer_load_dwordx4 v6, s[64:67], s32 offen offset:1024 lds
    v_mfma_f32_16x16x32_bf16 v[148:151], v[116:119], v[84:87], v[148:151]
    v_mfma_f32_16x16x32_bf16 v[152:155], v[120:123], v[84:87], v[152:155]
    ds_read_b64_tr_b16 v[70:71], v17 offset:1024
    v_mfma_f32_16x16x32_bf16 v[156:159], v[124:127], v[84:87], v[156:159]
    ds_read_b64_tr_b16 v[72:73], v18 offset:0
    buffer_load_dwordx4 v7, s[64:67], s32 offen offset:2048 lds
    v_mfma_f32_16x16x32_bf16 v[160:163], v[112:115], v[88:91], v[160:163]
    v_mfma_f32_16x16x32_bf16 v[164:167], v[116:119], v[88:91], v[164:167]
    ds_read_b64_tr_b16 v[74:75], v18 offset:1024
    v_mfma_f32_16x16x32_bf16 v[168:171], v[120:123], v[88:91], v[168:171]
    ds_read_b64_tr_b16 v[76:77], v19 offset:0
    buffer_load_dwordx4 v30, s[64:67], s32 offen offset:3072 lds
    s_add_u32 s32, s32, 128
    v_mfma_f32_16x16x32_bf16 v[172:175], v[124:127], v[88:91], v[172:175]
    v_mfma_f32_16x16x32_bf16 v[176:179], v[112:115], v[92:95], v[176:179]
    ds_read_b64_tr_b16 v[78:79], v19 offset:1024
    v_mfma_f32_16x16x32_bf16 v[180:183], v[116:119], v[92:95], v[180:183]
    ds_read_b128 v[36:39], v12 offset:2048
    s_add_u32 m0, s37, 65536
    s_nop 0
    buffer_load_dwordx4 v8, s[68:71], s33 offen offset:0 lds
    v_mfma_f32_16x16x32_bf16 v[184:187], v[120:123], v[92:95], v[184:187]
    v_mfma_f32_16x16x32_bf16 v[188:191], v[124:127], v[92:95], v[188:191]
    ds_read_b128 v[40:43], v12 offset:4096
    v_mfma_f32_16x16x32_bf16 v[192:195], v[112:115], v[96:99], v[192:195]
    ds_read_b128 v[44:47], v12 offset:6144
    buffer_load_dwordx4 v9, s[68:71], s33 offen offset:1024 lds
    v_mfma_f32_16x16x32_bf16 v[196:199], v[116:119], v[96:99], v[196:199]
    v_mfma_f32_16x16x32_bf16 v[200:203], v[120:123], v[96:99], v[200:203]
    ds_read_b128 v[48:51], v12 offset:8192
    v_mfma_f32_16x16x32_bf16 v[204:207], v[124:127], v[96:99], v[204:207]
    ds_read_b128 v[52:55], v12 offset:10240
    buffer_load_dwordx4 v10, s[68:71], s33 offen offset:2048 lds
    v_mfma_f32_16x16x32_bf16 v[208:211], v[112:115], v[100:103], v[208:211]
    v_mfma_f32_16x16x32_bf16 v[212:215], v[116:119], v[100:103], v[212:215]
    ds_read_b128 v[56:59], v12 offset:12288
    v_mfma_f32_16x16x32_bf16 v[216:219], v[120:123], v[100:103], v[216:219]
    ds_read_b128 v[60:63], v12 offset:14336
    buffer_load_dwordx4 v11, s[68:71], s33 offen offset:3072 lds
    s_add_u32 s33, s33, 524288
    v_mfma_f32_16x16x32_bf16 v[220:223], v[124:127], v[100:103], v[220:223]
    v_mfma_f32_16x16x32_bf16 v[224:227], v[112:115], v[104:107], v[224:227]
    v_mfma_f32_16x16x32_bf16 v[228:231], v[116:119], v[104:107], v[228:231]
    v_mfma_f32_16x16x32_bf16 v[232:235], v[120:123], v[104:107], v[232:235]
    v_mfma_f32_16x16x32_bf16 v[236:239], v[124:127], v[104:107], v[236:239]
    v_mfma_f32_16x16x32_bf16 v[240:243], v[112:115], v[108:111], v[240:243]
    v_mfma_f32_16x16x32_bf16 v[244:247], v[116:119], v[108:111], v[244:247]
    v_mfma_f32_16x16x32_bf16 v[248:251], v[120:123], v[108:111], v[248:251]
    v_mfma_f32_16x16x32_bf16 v[252:255], v[124:127], v[108:111], v[252:255]
    s_waitcnt lgkmcnt(12)
    v_mfma_f32_16x16x32_bf16 v[128:131], v[64:67], v[32:35], v[128:131]
    ds_read_b64_tr_b16 v[112:113], v16 offset:8192
    s_waitcnt lgkmcnt(11)
    v_mfma_f32_16x16x32_bf16 v[132:135], v[68:71], v[32:35], v[132:135]
    ds_read_b64_tr_b16 v[114:115], v16 offset:9216
    s_waitcnt lgkmcnt(10)
    v_mfma_f32_16x16x32_bf16 v[136:139], v[72:75], v[32:35], v[136:139]
    s_waitcnt lgkmcnt(8)
    v_mfma_f32_16x16x32_bf16 v[140:143], v[76:79], v[32:35], v[140:143]
    ds_read_b128 v[80:83], v13 offset:0
    v_mfma_f32_16x16x32_bf16 v[144:147], v[64:67], v[36:39], v[144:147]
    ds_read_b64_tr_b16 v[116:117], v17 offset:8192
    v_mfma_f32_16x16x32_bf16 v[148:151], v[68:71], v[36:39], v[148:151]
    v_mfma_f32_16x16x32_bf16 v[152:155], v[72:75], v[36:39], v[152:155]
    ds_read_b64_tr_b16 v[118:119], v17 offset:9216
    v_mfma_f32_16x16x32_bf16 v[156:159], v[76:79], v[36:39], v[156:159]
    ds_read_b64_tr_b16 v[120:121], v18 offset:8192
    s_waitcnt lgkmcnt(10)
    v_mfma_f32_16x16x32_bf16 v[160:163], v[64:67], v[40:43], v[160:163]
    v_mfma_f32_16x16x32_bf16 v[164:167], v[68:71], v[40:43], v[164:167]
    ds_read_b64_tr_b16 v[122:123], v18 offset:9216
    v_mfma_f32_16x16x32_bf16 v[168:171], v[72:75], v[40:43], v[168:171]
    ds_read_b64_tr_b16 v[124:125], v19 offset:8192
    v_mfma_f32_16x16x32_bf16 v[172:175], v[76:79], v[40:43], v[172:175]
    v_mfma_f32_16x16x32_bf16 v[176:179], v[64:67], v[44:47], v[176:179]
    ds_read_b64_tr_b16 v[126:127], v19 offset:9216
    v_mfma_f32_16x16x32_bf16 v[180:183], v[68:71], v[44:47], v[180:183]
    ds_read_b128 v[84:87], v13 offset:2048
    v_mfma_f32_16x16x32_bf16 v[184:187], v[72:75], v[44:47], v[184:187]
    v_mfma_f32_16x16x32_bf16 v[188:191], v[76:79], v[44:47], v[188:191]
    ds_read_b128 v[88:91], v13 offset:4096
    s_waitcnt lgkmcnt(13)
    v_mfma_f32_16x16x32_bf16 v[192:195], v[64:67], v[48:51], v[192:195]
    ds_read_b128 v[92:95], v13 offset:6144
    v_mfma_f32_16x16x32_bf16 v[196:199], v[68:71], v[48:51], v[196:199]
    v_mfma_f32_16x16x32_bf16 v[200:203], v[72:75], v[48:51], v[200:203]
    ds_read_b128 v[96:99], v13 offset:8192
    v_mfma_f32_16x16x32_bf16 v[204:207], v[76:79], v[48:51], v[204:207]
    ds_read_b128 v[100:103], v13 offset:10240
    v_mfma_f32_16x16x32_bf16 v[208:211], v[64:67], v[52:55], v[208:211]
    v_mfma_f32_16x16x32_bf16 v[212:215], v[68:71], v[52:55], v[212:215]
    ds_read_b128 v[104:107], v13 offset:12288
    v_mfma_f32_16x16x32_bf16 v[216:219], v[72:75], v[52:55], v[216:219]
    ds_read_b128 v[108:111], v13 offset:14336
    v_mfma_f32_16x16x32_bf16 v[220:223], v[76:79], v[52:55], v[220:223]
    s_waitcnt lgkmcnt(15)
    v_mfma_f32_16x16x32_bf16 v[224:227], v[64:67], v[56:59], v[224:227]
    v_mfma_f32_16x16x32_bf16 v[228:231], v[68:71], v[56:59], v[228:231]
    v_mfma_f32_16x16x32_bf16 v[232:235], v[72:75], v[56:59], v[232:235]
    v_mfma_f32_16x16x32_bf16 v[236:239], v[76:79], v[56:59], v[236:239]
    v_mfma_f32_16x16x32_bf16 v[240:243], v[64:67], v[60:63], v[240:243]
    v_mfma_f32_16x16x32_bf16 v[244:247], v[68:71], v[60:63], v[244:247]
    v_mfma_f32_16x16x32_bf16 v[248:251], v[72:75], v[60:63], v[248:251]
    v_mfma_f32_16x16x32_bf16 v[252:255], v[76:79], v[60:63], v[252:255]
    s_waitcnt vmcnt(0) lgkmcnt(0)
    s_barrier
    v_mfma_f32_16x16x32_bf16 v[128:131], v[112:115], v[80:83], v[128:131]
    ds_read_b64_tr_b16 v[64:65], v20 offset:0
    v_mfma_f32_16x16x32_bf16 v[132:135], v[116:119], v[80:83], v[132:135]
    ds_read_b64_tr_b16 v[66:67], v20 offset:1024
    s_add_u32 m0, s36, 0
    s_nop 0
    buffer_load_dwordx4 v24, s[60:63], s34 offen offset:0 lds
    v_mfma_f32_16x16x32_bf16 v[136:139], v[120:123], v[80:83], v[136:139]
    v_mfma_f32_16x16x32_bf16 v[140:143], v[124:127], v[80:83], v[140:143]
    ds_read_b128 v[32:35], v14 offset:0
    v_mfma_f32_16x16x32_bf16 v[144:147], v[112:115], v[84:87], v[144:147]
    ds_read_b64_tr_b16 v[68:69], v21 offset:0
    v_mfma_f32_16x16x32_bf16 v[148:151], v[116:119], v[84:87], v[148:151]
    v_mfma_f32_16x16x32_bf16 v[152:155], v[120:123], v[84:87], v[152:155]
    ds_read_b64_tr_b16 v[70:71], v21 offset:1024
    v_mfma_f32_16x16x32_bf16 v[156:159], v[124:127], v[84:87], v[156:159]
    ds_read_b64_tr_b16 v[72:73], v22 offset:0
    buffer_load_dwordx4 v25, s[60:63], s34 offen offset:1024 lds
    v_mfma_f32_16x16x32_bf16 v[160:163], v[112:115], v[88:91], v[160:163]
    v_mfma_f32_16x16x32_bf16 v[164:167], v[116:119], v[88:91], v[164:167]
    ds_read_b64_tr_b16 v[74:75], v22 offset:1024
    v_mfma_f32_16x16x32_bf16 v[168:171], v[120:123], v[88:91], v[168:171]
    ds_read_b64_tr_b16 v[76:77], v23 offset:0
    v_mfma_f32_16x16x32_bf16 v[172:175], v[124:127], v[88:91], v[172:175]
    v_mfma_f32_16x16x32_bf16 v[176:179], v[112:115], v[92:95], v[176:179]
    ds_read_b64_tr_b16 v[78:79], v23 offset:1024
    v_mfma_f32_16x16x32_bf16 v[180:183], v[116:119], v[92:95], v[180:183]
    ds_read_b128 v[36:39], v14 offset:2048
    buffer_load_dwordx4 v26, s[60:63], s34 offen offset:2048 lds
    v_mfma_f32_16x16x32_bf16 v[184:187], v[120:123], v[92:95], v[184:187]
    v_mfma_f32_16x16x32_bf16 v[188:191], v[124:127], v[92:95], v[188:191]
    ds_read_b128 v[40:43], v14 offset:4096
    v_mfma_f32_16x16x32_bf16 v[192:195], v[112:115], v[96:99], v[192:195]
    ds_read_b128 v[44:47], v14 offset:6144
    v_mfma_f32_16x16x32_bf16 v[196:199], v[116:119], v[96:99], v[196:199]
    v_mfma_f32_16x16x32_bf16 v[200:203], v[120:123], v[96:99], v[200:203]
    ds_read_b128 v[48:51], v14 offset:8192
    v_mfma_f32_16x16x32_bf16 v[204:207], v[124:127], v[96:99], v[204:207]
    ds_read_b128 v[52:55], v14 offset:10240
    buffer_load_dwordx4 v27, s[60:63], s34 offen offset:3072 lds
    s_add_u32 s34, s34, 128
    v_mfma_f32_16x16x32_bf16 v[208:211], v[112:115], v[100:103], v[208:211]
    v_mfma_f32_16x16x32_bf16 v[212:215], v[116:119], v[100:103], v[212:215]
    ds_read_b128 v[56:59], v14 offset:12288
    v_mfma_f32_16x16x32_bf16 v[216:219], v[120:123], v[100:103], v[216:219]
    ds_read_b128 v[60:63], v14 offset:14336
    v_mfma_f32_16x16x32_bf16 v[220:223], v[124:127], v[100:103], v[220:223]
    v_mfma_f32_16x16x32_bf16 v[224:227], v[112:115], v[104:107], v[224:227]
    v_mfma_f32_16x16x32_bf16 v[228:231], v[116:119], v[104:107], v[228:231]
    v_mfma_f32_16x16x32_bf16 v[232:235], v[120:123], v[104:107], v[232:235]
    v_mfma_f32_16x16x32_bf16 v[236:239], v[124:127], v[104:107], v[236:239]
    v_mfma_f32_16x16x32_bf16 v[240:243], v[112:115], v[108:111], v[240:243]
    v_mfma_f32_16x16x32_bf16 v[244:247], v[116:119], v[108:111], v[244:247]
    v_mfma_f32_16x16x32_bf16 v[248:251], v[120:123], v[108:111], v[248:251]
    v_mfma_f32_16x16x32_bf16 v[252:255], v[124:127], v[108:111], v[252:255]
    s_waitcnt lgkmcnt(12)
    v_mfma_f32_16x16x32_bf16 v[128:131], v[64:67], v[32:35], v[128:131]
    ds_read_b64_tr_b16 v[112:113], v20 offset:8192
    s_waitcnt lgkmcnt(11)
    v_mfma_f32_16x16x32_bf16 v[132:135], v[68:71], v[32:35], v[132:135]
    ds_read_b64_tr_b16 v[114:115], v20 offset:9216
    s_waitcnt lgkmcnt(10)
    v_mfma_f32_16x16x32_bf16 v[136:139], v[72:75], v[32:35], v[136:139]
    s_waitcnt lgkmcnt(8)
    v_mfma_f32_16x16x32_bf16 v[140:143], v[76:79], v[32:35], v[140:143]
    ds_read_b128 v[80:83], v15 offset:0
    v_mfma_f32_16x16x32_bf16 v[144:147], v[64:67], v[36:39], v[144:147]
    ds_read_b64_tr_b16 v[116:117], v21 offset:8192
    v_mfma_f32_16x16x32_bf16 v[148:151], v[68:71], v[36:39], v[148:151]
    v_mfma_f32_16x16x32_bf16 v[152:155], v[72:75], v[36:39], v[152:155]
    ds_read_b64_tr_b16 v[118:119], v21 offset:9216
    v_mfma_f32_16x16x32_bf16 v[156:159], v[76:79], v[36:39], v[156:159]
    ds_read_b64_tr_b16 v[120:121], v22 offset:8192
    s_waitcnt lgkmcnt(10)
    v_mfma_f32_16x16x32_bf16 v[160:163], v[64:67], v[40:43], v[160:163]
    v_mfma_f32_16x16x32_bf16 v[164:167], v[68:71], v[40:43], v[164:167]
    ds_read_b64_tr_b16 v[122:123], v22 offset:9216
    v_mfma_f32_16x16x32_bf16 v[168:171], v[72:75], v[40:43], v[168:171]
    ds_read_b64_tr_b16 v[124:125], v23 offset:8192
    v_mfma_f32_16x16x32_bf16 v[172:175], v[76:79], v[40:43], v[172:175]
    v_mfma_f32_16x16x32_bf16 v[176:179], v[64:67], v[44:47], v[176:179]
    ds_read_b64_tr_b16 v[126:127], v23 offset:9216
    v_mfma_f32_16x16x32_bf16 v[180:183], v[68:71], v[44:47], v[180:183]
    ds_read_b128 v[84:87], v15 offset:2048
    v_mfma_f32_16x16x32_bf16 v[184:187], v[72:75], v[44:47], v[184:187]
    v_mfma_f32_16x16x32_bf16 v[188:191], v[76:79], v[44:47], v[188:191]
    ds_read_b128 v[88:91], v15 offset:4096
    s_waitcnt lgkmcnt(13)
    v_mfma_f32_16x16x32_bf16 v[192:195], v[64:67], v[48:51], v[192:195]
    ds_read_b128 v[92:95], v15 offset:6144
    v_mfma_f32_16x16x32_bf16 v[196:199], v[68:71], v[48:51], v[196:199]
    v_mfma_f32_16x16x32_bf16 v[200:203], v[72:75], v[48:51], v[200:203]
    ds_read_b128 v[96:99], v15 offset:8192
    v_mfma_f32_16x16x32_bf16 v[204:207], v[76:79], v[48:51], v[204:207]
    ds_read_b128 v[100:103], v15 offset:10240
    v_mfma_f32_16x16x32_bf16 v[208:211], v[64:67], v[52:55], v[208:211]
    v_mfma_f32_16x16x32_bf16 v[212:215], v[68:71], v[52:55], v[212:215]
    ds_read_b128 v[104:107], v15 offset:12288
    v_mfma_f32_16x16x32_bf16 v[216:219], v[72:75], v[52:55], v[216:219]
    ds_read_b128 v[108:111], v15 offset:14336
    v_mfma_f32_16x16x32_bf16 v[220:223], v[76:79], v[52:55], v[220:223]
    s_waitcnt lgkmcnt(15)
    v_mfma_f32_16x16x32_bf16 v[224:227], v[64:67], v[56:59], v[224:227]
    s_lshl_b32 s40, s6, 19
    s_add_u32 s40, s40, 0x0
    v_mfma_f32_16x16x32_bf16 v[228:231], v[68:71], v[56:59], v[228:231]
    s_lshl_b32 s24, s7, 16
    v_mfma_f32_16x16x32_bf16 v[232:235], v[72:75], v[56:59], v[232:235]
    s_add_u32 s40, s40, s24
    s_lshr_b32 s24, s3, 1
    v_mfma_f32_16x16x32_bf16 v[236:239], v[76:79], v[56:59], v[236:239]
    s_lshl_b32 s24, s24, 15
    v_mfma_f32_16x16x32_bf16 v[240:243], v[64:67], v[60:63], v[240:243]
    s_add_u32 s40, s40, s24
    s_and_b32 s24, s3, 1
    v_mfma_f32_16x16x32_bf16 v[244:247], v[68:71], v[60:63], v[244:247]
    s_lshl_b32 s24, s24, 11
    v_mfma_f32_16x16x32_bf16 v[248:251], v[72:75], v[60:63], v[248:251]
    s_add_u32 s40, s40, s24
    v_mfma_f32_16x16x32_bf16 v[252:255], v[76:79], v[60:63], v[252:255]
    s_waitcnt vmcnt(0) lgkmcnt(0)
    s_barrier
    v_mfma_f32_16x16x32_bf16 v[240:243], v[112:115], v[108:111], v[240:243]
    v_mfma_f32_16x16x32_bf16 v[244:247], v[116:119], v[108:111], v[244:247]
    s_add_u32 m0, s36, 65536
    s_nop 0
    buffer_load_dwordx4 v24, s[60:63], s34 offen offset:0 lds
    v_mfma_f32_16x16x32_bf16 v[248:251], v[120:123], v[108:111], v[248:251]
    v_mfma_f32_16x16x32_bf16 v[252:255], v[124:127], v[108:111], v[252:255]
    v_mfma_f32_16x16x32_bf16 v[224:227], v[112:115], v[104:107], v[224:227]
    v_mfma_f32_16x16x32_bf16 v[228:231], v[116:119], v[104:107], v[228:231]
    v_mfma_f32_16x16x32_bf16 v[232:235], v[120:123], v[104:107], v[232:235]
    v_mfma_f32_16x16x32_bf16 v[236:239], v[124:127], v[104:107], v[236:239]
    buffer_load_dwordx4 v25, s[60:63], s34 offen offset:1024 lds
    v_mfma_f32_16x16x32_bf16 v[208:211], v[112:115], v[100:103], v[208:211]
    v_mfma_f32_16x16x32_bf16 v[212:215], v[116:119], v[100:103], v[212:215]
    v_mfma_f32_16x16x32_bf16 v[216:219], v[120:123], v[100:103], v[216:219]
    v_mfma_f32_16x16x32_bf16 v[220:223], v[124:127], v[100:103], v[220:223]
    v_mfma_f32_16x16x32_bf16 v[192:195], v[112:115], v[96:99], v[192:195]
    v_mfma_f32_16x16x32_bf16 v[196:199], v[116:119], v[96:99], v[196:199]
    buffer_load_dwordx4 v26, s[60:63], s34 offen offset:2048 lds
    v_mfma_f32_16x16x32_bf16 v[200:203], v[120:123], v[96:99], v[200:203]
    v_mfma_f32_16x16x32_bf16 v[204:207], v[124:127], v[96:99], v[204:207]
    v_mfma_f32_16x16x32_bf16 v[176:179], v[112:115], v[92:95], v[176:179]
    v_mfma_f32_16x16x32_bf16 v[180:183], v[116:119], v[92:95], v[180:183]
    v_mfma_f32_16x16x32_bf16 v[184:187], v[120:123], v[92:95], v[184:187]
    v_mfma_f32_16x16x32_bf16 v[188:191], v[124:127], v[92:95], v[188:191]
    buffer_load_dwordx4 v27, s[60:63], s34 offen offset:3072 lds
    s_add_u32 s34, s34, 128
    v_mfma_f32_16x16x32_bf16 v[160:163], v[112:115], v[88:91], v[160:163]
    v_mfma_f32_16x16x32_bf16 v[164:167], v[116:119], v[88:91], v[164:167]
    v_mfma_f32_16x16x32_bf16 v[168:171], v[120:123], v[88:91], v[168:171]
    v_mfma_f32_16x16x32_bf16 v[172:175], v[124:127], v[88:91], v[172:175]
    v_mfma_f32_16x16x32_bf16 v[144:147], v[112:115], v[84:87], v[144:147]
    v_mfma_f32_16x16x32_bf16 v[148:151], v[116:119], v[84:87], v[148:151]
    v_mfma_f32_16x16x32_bf16 v[152:155], v[120:123], v[84:87], v[152:155]
    v_mfma_f32_16x16x32_bf16 v[156:159], v[124:127], v[84:87], v[156:159]
    v_mfma_f32_16x16x32_bf16 v[128:131], v[112:115], v[80:83], v[128:131]
    v_mfma_f32_16x16x32_bf16 v[132:135], v[116:119], v[80:83], v[132:135]
    v_mfma_f32_16x16x32_bf16 v[136:139], v[120:123], v[80:83], v[136:139]
    v_mfma_f32_16x16x32_bf16 v[140:143], v[124:127], v[80:83], v[140:143]
    s_nop 7
    v_cvt_pk_bf16_f32 v255, v254, v255
    v_cvt_pk_bf16_f32 v254, v252, v253
    v_cvt_pk_bf16_f32 v253, v250, v251
    v_cvt_pk_bf16_f32 v252, v248, v249
    v_cvt_pk_bf16_f32 v251, v246, v247
    v_cvt_pk_bf16_f32 v250, v244, v245
    v_cvt_pk_bf16_f32 v249, v242, v243
    v_cvt_pk_bf16_f32 v248, v240, v241
    v_cvt_pk_bf16_f32 v247, v238, v239
    v_cvt_pk_bf16_f32 v246, v236, v237
    v_cvt_pk_bf16_f32 v245, v234, v235
    v_cvt_pk_bf16_f32 v244, v232, v233
    v_cvt_pk_bf16_f32 v243, v230, v231
    v_cvt_pk_bf16_f32 v242, v228, v229
    v_cvt_pk_bf16_f32 v241, v226, v227
    v_cvt_pk_bf16_f32 v240, v224, v225
    v_cvt_pk_bf16_f32 v239, v222, v223
    v_cvt_pk_bf16_f32 v238, v220, v221
    v_cvt_pk_bf16_f32 v237, v218, v219
    v_cvt_pk_bf16_f32 v236, v216, v217
    v_cvt_pk_bf16_f32 v235, v214, v215
    v_cvt_pk_bf16_f32 v234, v212, v213
    v_cvt_pk_bf16_f32 v233, v210, v211
    v_cvt_pk_bf16_f32 v232, v208, v209
    v_cvt_pk_bf16_f32 v231, v206, v207
    v_cvt_pk_bf16_f32 v230, v204, v205
    v_cvt_pk_bf16_f32 v229, v202, v203
    v_cvt_pk_bf16_f32 v228, v200, v201
    v_cvt_pk_bf16_f32 v227, v198, v199
    v_cvt_pk_bf16_f32 v226, v196, v197
    v_cvt_pk_bf16_f32 v225, v194, v195
    v_cvt_pk_bf16_f32 v224, v192, v193
    v_cvt_pk_bf16_f32 v223, v190, v191
    v_cvt_pk_bf16_f32 v222, v188, v189
    v_cvt_pk_bf16_f32 v221, v186, v187
    v_cvt_pk_bf16_f32 v220, v184, v185
    v_cvt_pk_bf16_f32 v219, v182, v183
    v_cvt_pk_bf16_f32 v218, v180, v181
    v_cvt_pk_bf16_f32 v217, v178, v179
    v_cvt_pk_bf16_f32 v216, v176, v177
    v_cvt_pk_bf16_f32 v215, v174, v175
    v_cvt_pk_bf16_f32 v214, v172, v173
    v_cvt_pk_bf16_f32 v213, v170, v171
    v_cvt_pk_bf16_f32 v212, v168, v169
    v_cvt_pk_bf16_f32 v211, v166, v167
    v_cvt_pk_bf16_f32 v210, v164, v165
    v_cvt_pk_bf16_f32 v209, v162, v163
    v_cvt_pk_bf16_f32 v208, v160, v161
    v_cvt_pk_bf16_f32 v207, v158, v159
    v_cvt_pk_bf16_f32 v206, v156, v157
    v_cvt_pk_bf16_f32 v205, v154, v155
    v_cvt_pk_bf16_f32 v204, v152, v153
    v_cvt_pk_bf16_f32 v203, v150, v151
    v_cvt_pk_bf16_f32 v202, v148, v149
    v_cvt_pk_bf16_f32 v201, v146, v147
    v_cvt_pk_bf16_f32 v200, v144, v145
    v_cvt_pk_bf16_f32 v199, v142, v143
    v_cvt_pk_bf16_f32 v198, v140, v141
    v_cvt_pk_bf16_f32 v197, v138, v139
    v_cvt_pk_bf16_f32 v196, v136, v137
    v_cvt_pk_bf16_f32 v195, v134, v135
    v_cvt_pk_bf16_f32 v194, v132, v133
    v_cvt_pk_bf16_f32 v193, v130, v131
    v_cvt_pk_bf16_f32 v192, v128, v129
    buffer_store_dwordx4 v[192:195], v4, s[8:11], s40 offen offset:0 sc1
    buffer_store_dwordx4 v[196:199], v4, s[8:11], s40 offen offset:1024 sc1
    s_add_u32 s40, s40, 4096
    buffer_store_dwordx4 v[200:203], v4, s[8:11], s40 offen offset:0 sc1
    buffer_store_dwordx4 v[204:207], v4, s[8:11], s40 offen offset:1024 sc1
    s_add_u32 s40, s40, 4096
    s_cbranch_vccz VR67
    buffer_store_dwordx4 v[208:211], v4, s[8:11], s40 offen offset:0 sc1
VR67:
    s_cbranch_vccz VR68
    buffer_store_dwordx4 v[212:215], v4, s[8:11], s40 offen offset:1024 sc1
    s_add_u32 s40, s40, 4096
VR68:
    s_cbranch_vccz VR69
    buffer_store_dwordx4 v[216:219], v4, s[8:11], s40 offen offset:0 sc1
VR69:
    s_lshl_b32 s24, s41, 6
    s_lshl_b32 s25, s3, 4
    s_add_u32 s24, s24, s25
    s_add_u32 s24, s24, 0
    v_lshrrev_b32 v116, 3, v1
    v_add_u32 v116, s24, v116
    v_and_b32 v117, 7, v1
    v_lshlrev_b32 v117, 4, v117
    v_mul_u32_u24 v118, 1280, v116
    v_add_u32 v118, v118, v117
    buffer_load_dwordx4 v[32:35], v118, s[60:63], 0 offen offset:0
    buffer_load_dwordx4 v[72:75], v117, s[76:79], 0 offen offset:0
    buffer_load_dwordx4 v[36:39], v118, s[60:63], 0 offen offset:128
    buffer_load_dwordx4 v[76:79], v117, s[76:79], 0 offen offset:128
    buffer_load_dwordx4 v[40:43], v118, s[60:63], 0 offen offset:256
    buffer_load_dwordx4 v[80:83], v117, s[76:79], 0 offen offset:256
    buffer_load_dwordx4 v[44:47], v118, s[60:63], 0 offen offset:384
    buffer_load_dwordx4 v[84:87], v117, s[76:79], 0 offen offset:384
    buffer_load_dwordx4 v[48:51], v118, s[60:63], 0 offen offset:512
    buffer_load_dwordx4 v[88:91], v117, s[76:79], 0 offen offset:512
    buffer_load_dwordx4 v[52:55], v118, s[60:63], 0 offen offset:640
    buffer_load_dwordx4 v[92:95], v117, s[76:79], 0 offen offset:640
    buffer_load_dwordx4 v[56:59], v118, s[60:63], 0 offen offset:768
    buffer_load_dwordx4 v[96:99], v117, s[76:79], 0 offen offset:768
    buffer_load_dwordx4 v[60:63], v118, s[60:63], 0 offen offset:896
    buffer_load_dwordx4 v[100:103], v117, s[76:79], 0 offen offset:896
    buffer_load_dwordx4 v[64:67], v118, s[60:63], 0 offen offset:1024
    buffer_load_dwordx4 v[104:107], v117, s[76:79], 0 offen offset:1024
    buffer_load_dwordx4 v[68:71], v118, s[60:63], 0 offen offset:1152
    buffer_load_dwordx4 v[108:111], v117, s[76:79], 0 offen offset:1152
    s_waitcnt vmcnt(27) lgkmcnt(0)
    s_cbranch_vccnz VR92
    s_waitcnt vmcnt(24)
VR92:
    s_barrier
    s_add_u32 m0, s36, 0
    s_nop 0
    buffer_load_dwordx4 v24, s[60:63], s34 offen offset:0 lds
    buffer_load_dwordx4 v25, s[60:63], s34 offen offset:1024 lds
    buffer_load_dwordx4 v26, s[60:63], s34 offen offset:2048 lds
    buffer_load_dwordx4 v27, s[60:63], s34 offen offset:3072 lds
    s_add_u32 s34, s34, 128
    s_cbranch_vccnz VR73
    buffer_store_dwordx4 v[208:211], v4, s[8:11], s40 offen offset:0 sc1
VR73:
    s_cbranch_vccz VR70
    buffer_store_dwordx4 v[220:223], v4, s[8:11], s40 offen offset:1024 sc1
    s_add_u32 s40, s40, 4096
VR70:
    s_cbranch_vccz VR71
    buffer_store_dwordx4 v[224:227], v4, s[8:11], s40 offen offset:0 sc1
VR71:
    s_cbranch_vccnz VR74
    buffer_store_dwordx4 v[212:215], v4, s[8:11], s40 offen offset:1024 sc1
    s_add_u32 s40, s40, 4096
VR74:
    s_cbranch_vccz VR72
    buffer_store_dwordx4 v[228:231], v4, s[8:11], s40 offen offset:1024 sc1
    s_add_u32 s40, s40, 4096
VR72:
    v_mov_b32 v112, 0
    v_mov_b32 v113, 0
    s_mov_b32 s25, 0xffff0000
    s_waitcnt vmcnt(7)
    s_cbranch_vccnz VR93
    s_waitcnt vmcnt(6)
VR93:
    v_lshlrev_b32 v120, 16, v32
    v_and_b32 v121, s25, v32
    v_lshlrev_b32 v122, 16, v72
    v_and_b32 v123, s25, v72
    v_mul_f32 v120, v120, v122
    v_mul_f32 v121, v121, v123
    v_cvt_pk_bf16_f32 v120, v120, v121
    v_and_b32 v121, s25, v120
    v_lshlrev_b32 v120, 16, v120
    v_add_f32 v112, v112, v120
    v_add_f32 v113, v113, v121
    v_lshlrev_b32 v120, 16, v33
    v_and_b32 v121, s25, v33
    v_lshlrev_b32 v122, 16, v73
    v_and_b32 v123, s25, v73
    v_mul_f32 v120, v120, v122
    v_mul_f32 v121, v121, v123
    v_cvt_pk_bf16_f32 v120, v120, v121
    v_and_b32 v121, s25, v120
    v_lshlrev_b32 v120, 16, v120
    v_add_f32 v112, v112, v120
    v_add_f32 v113, v113, v121
    v_lshlrev_b32 v120, 16, v34
    v_and_b32 v121, s25, v34
    v_lshlrev_b32 v122, 16, v74
    v_and_b32 v123, s25, v74
    v_mul_f32 v120, v120, v122
    v_mul_f32 v121, v121, v123
    v_cvt_pk_bf16_f32 v120, v120, v121
    v_and_b32 v121, s25, v120
    v_lshlrev_b32 v120, 16, v120
    v_add_f32 v112, v112, v120
    v_add_f32 v113, v113, v121
    v_lshlrev_b32 v120, 16, v35
    v_and_b32 v121, s25, v35
    v_lshlrev_b32 v122, 16, v75
    v_and_b32 v123, s25, v75
    v_mul_f32 v120, v120, v122
    v_mul_f32 v121, v121, v123
    v_cvt_pk_bf16_f32 v120, v120, v121
    v_and_b32 v121, s25, v120
    v_lshlrev_b32 v120, 16, v120
    v_add_f32 v112, v112, v120
    v_add_f32 v113, v113, v121
    v_lshlrev_b32 v120, 16, v36
    v_and_b32 v121, s25, v36
    v_lshlrev_b32 v122, 16, v76
    v_and_b32 v123, s25, v76
    v_mul_f32 v120, v120, v122
    v_mul_f32 v121, v121, v123
    v_cvt_pk_bf16_f32 v120, v120, v121
    v_and_b32 v121, s25, v120
    v_lshlrev_b32 v120, 16, v120
    v_add_f32 v112, v112, v120
    v_add_f32 v113, v113, v121
    v_lshlrev_b32 v120, 16, v37
    v_and_b32 v121, s25, v37
    v_lshlrev_b32 v122, 16, v77
    v_and_b32 v123, s25, v77
    v_mul_f32 v120, v120, v122
    v_mul_f32 v121, v121, v123
    v_cvt_pk_bf16_f32 v120, v120, v121
    v_and_b32 v121, s25, v120
    v_lshlrev_b32 v120, 16, v120
    v_add_f32 v112, v112, v120
    v_add_f32 v113, v113, v121
    v_lshlrev_b32 v120, 16, v38
    v_and_b32 v121, s25, v38
    v_lshlrev_b32 v122, 16, v78
    v_and_b32 v123, s25, v78
    v_mul_f32 v120, v120, v122
    v_mul_f32 v121, v121, v123
    v_cvt_pk_bf16_f32 v120, v120, v121
    v_and_b32 v121, s25, v120
    v_lshlrev_b32 v120, 16, v120
    v_add_f32 v112, v112, v120
    v_add_f32 v113, v113, v121
    v_lshlrev_b32 v120, 16, v39
    v_and_b32 v121, s25, v39
    v_lshlrev_b32 v122, 16, v79
    v_and_b32 v123, s25, v79
    v_mul_f32 v120, v120, v122
    v_mul_f32 v121, v121, v123
    v_cvt_pk_bf16_f32 v120, v120, v121
    v_and_b32 v121, s25, v120
    v_lshlrev_b32 v120, 16, v120
    v_add_f32 v112, v112, v120
    v_add_f32 v113, v113, v121
    v_lshlrev_b32 v120, 16, v40
    v_and_b32 v121, s25, v40
    v_lshlrev_b32 v122, 16, v80
    v_and_b32 v123, s25, v80
    v_mul_f32 v120, v120, v122
    v_mul_f32 v121, v121, v123
    v_cvt_pk_bf16_f32 v120, v120, v121
    v_and_b32 v121, s25, v120
    v_lshlrev_b32 v120, 16, v120
    v_add_f32 v112, v112, v120
    v_add_f32 v113, v113, v121
    v_lshlrev_b32 v120, 16, v41
    v_and_b32 v121, s25, v41
    v_lshlrev_b32 v122, 16, v81
    v_and_b32 v123, s25, v81
    v_mul_f32 v120, v120, v122
    v_mul_f32 v121, v121, v123
    v_cvt_pk_bf16_f32 v120, v120, v121
    v_and_b32 v121, s25, v120
    v_lshlrev_b32 v120, 16, v120
    v_add_f32 v112, v112, v120
    v_add_f32 v113, v113, v121
    v_lshlrev_b32 v120, 16, v42
    v_and_b32 v121, s25, v42
    v_lshlrev_b32 v122, 16, v82
    v_and_b32 v123, s25, v82
    v_mul_f32 v120, v120, v122
    v_mul_f32 v121, v121, v123
    v_cvt_pk_bf16_f32 v120, v120, v121
    v_and_b32 v121, s25, v120
    v_lshlrev_b32 v120, 16, v120
    v_add_f32 v112, v112, v120
    v_add_f32 v113, v113, v121
    v_lshlrev_b32 v120, 16, v43
    v_and_b32 v121, s25, v43
    v_lshlrev_b32 v122, 16, v83
    v_and_b32 v123, s25, v83
    v_mul_f32 v120, v120, v122
    v_mul_f32 v121, v121, v123
    v_cvt_pk_bf16_f32 v120, v120, v121
    v_and_b32 v121, s25, v120
    v_lshlrev_b32 v120, 16, v120
    v_add_f32 v112, v112, v120
    v_add_f32 v113, v113, v121
    v_lshlrev_b32 v120, 16, v44
    v_and_b32 v121, s25, v44
    v_lshlrev_b32 v122, 16, v84
    v_and_b32 v123, s25, v84
    v_mul_f32 v120, v120, v122
    v_mul_f32 v121, v121, v123
    v_cvt_pk_bf16_f32 v120, v120, v121
    v_and_b32 v121, s25, v120
    v_lshlrev_b32 v120, 16, v120
    v_add_f32 v112, v112, v120
    v_add_f32 v113, v113, v121
    v_lshlrev_b32 v120, 16, v45
    v_and_b32 v121, s25, v45
    v_lshlrev_b32 v122, 16, v85
    v_and_b32 v123, s25, v85
    v_mul_f32 v120, v120, v122
    v_mul_f32 v121, v121, v123
    v_cvt_pk_bf16_f32 v120, v120, v121
    v_and_b32 v121, s25, v120
    v_lshlrev_b32 v120, 16, v120
    v_add_f32 v112, v112, v120
    v_add_f32 v113, v113, v121
    v_lshlrev_b32 v120, 16, v46
    v_and_b32 v121, s25, v46
    v_lshlrev_b32 v122, 16, v86
    v_and_b32 v123, s25, v86
    v_mul_f32 v120, v120, v122
    v_mul_f32 v121, v121, v123
    v_cvt_pk_bf16_f32 v120, v120, v121
    v_and_b32 v121, s25, v120
    v_lshlrev_b32 v120, 16, v120
    v_add_f32 v112, v112, v120
    v_add_f32 v113, v113, v121
    v_lshlrev_b32 v120, 16, v47
    v_and_b32 v121, s25, v47
    v_lshlrev_b32 v122, 16, v87
    v_and_b32 v123, s25, v87
    v_mul_f32 v120, v120, v122
    v_mul_f32 v121, v121, v123
    v_cvt_pk_bf16_f32 v120, v120, v121
    v_and_b32 v121, s25, v120
    v_lshlrev_b32 v120, 16, v120
    v_add_f32 v112, v112, v120
    v_add_f32 v113, v113, v121
    v_lshlrev_b32 v120, 16, v48
    v_and_b32 v121, s25, v48
    v_lshlrev_b32 v122, 16, v88
    v_and_b32 v123, s25, v88
    v_mul_f32 v120, v120, v122
    v_mul_f32 v121, v121, v123
    v_cvt_pk_bf16_f32 v120, v120, v121
    v_and_b32 v121, s25, v120
    v_lshlrev_b32 v120, 16, v120
    v_add_f32 v112, v112, v120
    v_add_f32 v113, v113, v121
    v_lshlrev_b32 v120, 16, v49
    v_and_b32 v121, s25, v49
    v_lshlrev_b32 v122, 16, v89
    v_and_b32 v123, s25, v89
    v_mul_f32 v120, v120, v122
    v_mul_f32 v121, v121, v123
    v_cvt_pk_bf16_f32 v120, v120, v121
    v_and_b32 v121, s25, v120
    v_lshlrev_b32 v120, 16, v120
    v_add_f32 v112, v112, v120
    v_add_f32 v113, v113, v121
    v_lshlrev_b32 v120, 16, v50
    v_and_b32 v121, s25, v50
    v_lshlrev_b32 v122, 16, v90
    v_and_b32 v123, s25, v90
    v_mul_f32 v120, v120, v122
    v_mul_f32 v121, v121, v123
    v_cvt_pk_bf16_f32 v120, v120, v121
    v_and_b32 v121, s25, v120
    v_lshlrev_b32 v120, 16, v120
    v_add_f32 v112, v112, v120
    v_add_f32 v113, v113, v121
    v_lshlrev_b32 v120, 16, v51
    v_and_b32 v121, s25, v51
    v_lshlrev_b32 v122, 16, v91
    v_and_b32 v123, s25, v91
    v_mul_f32 v120, v120, v122
    v_mul_f32 v121, v121, v123
    v_cvt_pk_bf16_f32 v120, v120, v121
    v_and_b32 v121, s25, v120
    v_lshlrev_b32 v120, 16, v120
    v_add_f32 v112, v112, v120
    v_add_f32 v113, v113, v121
    v_lshlrev_b32 v120, 16, v52
    v_and_b32 v121, s25, v52
    v_lshlrev_b32 v122, 16, v92
    v_and_b32 v123, s25, v92
    v_mul_f32 v120, v120, v122
    v_mul_f32 v121, v121, v123
    v_cvt_pk_bf16_f32 v120, v120, v121
    v_and_b32 v121, s25, v120
    v_lshlrev_b32 v120, 16, v120
    v_add_f32 v112, v112, v120
    v_add_f32 v113, v113, v121
    v_lshlrev_b32 v120, 16, v53
    v_and_b32 v121, s25, v53
    v_lshlrev_b32 v122, 16, v93
    v_and_b32 v123, s25, v93
    v_mul_f32 v120, v120, v122
    v_mul_f32 v121, v121, v123
    v_cvt_pk_bf16_f32 v120, v120, v121
    v_and_b32 v121, s25, v120
    v_lshlrev_b32 v120, 16, v120
    v_add_f32 v112, v112, v120
    v_add_f32 v113, v113, v121
    v_lshlrev_b32 v120, 16, v54
    v_and_b32 v121, s25, v54
    v_lshlrev_b32 v122, 16, v94
    v_and_b32 v123, s25, v94
    v_mul_f32 v120, v120, v122
    v_mul_f32 v121, v121, v123
    v_cvt_pk_bf16_f32 v120, v120, v121
    v_and_b32 v121, s25, v120
    v_lshlrev_b32 v120, 16, v120
    v_add_f32 v112, v112, v120
    v_add_f32 v113, v113, v121
    v_lshlrev_b32 v120, 16, v55
    v_and_b32 v121, s25, v55
    v_lshlrev_b32 v122, 16, v95
    v_and_b32 v123, s25, v95
    v_mul_f32 v120, v120, v122
    v_mul_f32 v121, v121, v123
    v_cvt_pk_bf16_f32 v120, v120, v121
    v_and_b32 v121, s25, v120
    v_lshlrev_b32 v120, 16, v120
    v_add_f32 v112, v112, v120
    v_add_f32 v113, v113, v121
    v_lshlrev_b32 v120, 16, v56
    v_and_b32 v121, s25, v56
    v_lshlrev_b32 v122, 16, v96
    v_and_b32 v123, s25, v96
    v_mul_f32 v120, v120, v122
    v_mul_f32 v121, v121, v123
    v_cvt_pk_bf16_f32 v120, v120, v121
    v_and_b32 v121, s25, v120
    v_lshlrev_b32 v120, 16, v120
    v_add_f32 v112, v112, v120
    v_add_f32 v113, v113, v121
    v_lshlrev_b32 v120, 16, v57
    v_and_b32 v121, s25, v57
    v_lshlrev_b32 v122, 16, v97
    v_and_b32 v123, s25, v97
    v_mul_f32 v120, v120, v122
    v_mul_f32 v121, v121, v123
    v_cvt_pk_bf16_f32 v120, v120, v121
    v_and_b32 v121, s25, v120
    v_lshlrev_b32 v120, 16, v120
    v_add_f32 v112, v112, v120
    v_add_f32 v113, v113, v121
    v_lshlrev_b32 v120, 16, v58
    v_and_b32 v121, s25, v58
    v_lshlrev_b32 v122, 16, v98
    v_and_b32 v123, s25, v98
    v_mul_f32 v120, v120, v122
    v_mul_f32 v121, v121, v123
    v_cvt_pk_bf16_f32 v120, v120, v121
    v_and_b32 v121, s25, v120
    v_lshlrev_b32 v120, 16, v120
    v_add_f32 v112, v112, v120
    v_add_f32 v113, v113, v121
    v_lshlrev_b32 v120, 16, v59
    v_and_b32 v121, s25, v59
    v_lshlrev_b32 v122, 16, v99
    v_and_b32 v123, s25, v99
    v_mul_f32 v120, v120, v122
    v_mul_f32 v121, v121, v123
    v_cvt_pk_bf16_f32 v120, v120, v121
    v_and_b32 v121, s25, v120
    v_lshlrev_b32 v120, 16, v120
    v_add_f32 v112, v112, v120
    v_add_f32 v113, v113, v121
    v_lshlrev_b32 v120, 16, v60
    v_and_b32 v121, s25, v60
    v_lshlrev_b32 v122, 16, v100
    v_and_b32 v123, s25, v100
    v_mul_f32 v120, v120, v122
    v_mul_f32 v121, v121, v123
    v_cvt_pk_bf16_f32 v120, v120, v121
    v_and_b32 v121, s25, v120
    v_lshlrev_b32 v120, 16, v120
    v_add_f32 v112, v112, v120
    v_add_f32 v113, v113, v121
    v_lshlrev_b32 v120, 16, v61
    v_and_b32 v121, s25, v61
    v_lshlrev_b32 v122, 16, v101
    v_and_b32 v123, s25, v101
    v_mul_f32 v120, v120, v122
    v_mul_f32 v121, v121, v123
    v_cvt_pk_bf16_f32 v120, v120, v121
    v_and_b32 v121, s25, v120
    v_lshlrev_b32 v120, 16, v120
    v_add_f32 v112, v112, v120
    v_add_f32 v113, v113, v121
    v_lshlrev_b32 v120, 16, v62
    v_and_b32 v121, s25, v62
    v_lshlrev_b32 v122, 16, v102
    v_and_b32 v123, s25, v102
    v_mul_f32 v120, v120, v122
    v_mul_f32 v121, v121, v123
    v_cvt_pk_bf16_f32 v120, v120, v121
    v_and_b32 v121, s25, v120
    v_lshlrev_b32 v120, 16, v120
    v_add_f32 v112, v112, v120
    v_add_f32 v113, v113, v121
    v_lshlrev_b32 v120, 16, v63
    v_and_b32 v121, s25, v63
    v_lshlrev_b32 v122, 16, v103
    v_and_b32 v123, s25, v103
    v_mul_f32 v120, v120, v122
    v_mul_f32 v121, v121, v123
    v_cvt_pk_bf16_f32 v120, v120, v121
    v_and_b32 v121, s25, v120
    v_lshlrev_b32 v120, 16, v120
    v_add_f32 v112, v112, v120
    v_add_f32 v113, v113, v121
    v_lshlrev_b32 v120, 16, v64
    v_and_b32 v121, s25, v64
    v_lshlrev_b32 v122, 16, v104
    v_and_b32 v123, s25, v104
    v_mul_f32 v120, v120, v122
    v_mul_f32 v121, v121, v123
    v_cvt_pk_bf16_f32 v120, v120, v121
    v_and_b32 v121, s25, v120
    v_lshlrev_b32 v120, 16, v120
    v_add_f32 v112, v112, v120
    v_add_f32 v113, v113, v121
    v_lshlrev_b32 v120, 16, v65
    v_and_b32 v121, s25, v65
    v_lshlrev_b32 v122, 16, v105
    v_and_b32 v123, s25, v105
    v_mul_f32 v120, v120, v122
    v_mul_f32 v121, v121, v123
    v_cvt_pk_bf16_f32 v120, v120, v121
    v_and_b32 v121, s25, v120
    v_lshlrev_b32 v120, 16, v120
    v_add_f32 v112, v112, v120
    v_add_f32 v113, v113, v121
    v_lshlrev_b32 v120, 16, v66
    v_and_b32 v121, s25, v66
    v_lshlrev_b32 v122, 16, v106
    v_and_b32 v123, s25, v106
    v_mul_f32 v120, v120, v122
    v_mul_f32 v121, v121, v123
    v_cvt_pk_bf16_f32 v120, v120, v121
    v_and_b32 v121, s25, v120
    v_lshlrev_b32 v120, 16, v120
    v_add_f32 v112, v112, v120
    v_add_f32 v113, v113, v121
    v_lshlrev_b32 v120, 16, v67
    v_and_b32 v121, s25, v67
    v_lshlrev_b32 v122, 16, v107
    v_and_b32 v123, s25, v107
    v_mul_f32 v120, v120, v122
    v_mul_f32 v121, v121, v123
    v_cvt_pk_bf16_f32 v120, v120, v121
    v_and_b32 v121, s25, v120
    v_lshlrev_b32 v120, 16, v120
    v_add_f32 v112, v112, v120
    v_add_f32 v113, v113, v121
    v_lshlrev_b32 v120, 16, v68
    v_and_b32 v121, s25, v68
    v_lshlrev_b32 v122, 16, v108
    v_and_b32 v123, s25, v108
    v_mul_f32 v120, v120, v122
    v_mul_f32 v121, v121, v123
    v_cvt_pk_bf16_f32 v120, v120, v121
    v_and_b32 v121, s25, v120
    v_lshlrev_b32 v120, 16, v120
    v_add_f32 v112, v112, v120
    v_add_f32 v113, v113, v121
    v_lshlrev_b32 v120, 16, v69
    v_and_b32 v121, s25, v69
    v_lshlrev_b32 v122, 16, v109
    v_and_b32 v123, s25, v109
    v_mul_f32 v120, v120, v122
    v_mul_f32 v121, v121, v123
    v_cvt_pk_bf16_f32 v120, v120, v121
    v_and_b32 v121, s25, v120
    v_lshlrev_b32 v120, 16, v120
    v_add_f32 v112, v112, v120
    v_add_f32 v113, v113, v121
    v_lshlrev_b32 v120, 16, v70
    v_and_b32 v121, s25, v70
    v_lshlrev_b32 v122, 16, v110
    v_and_b32 v123, s25, v110
    v_mul_f32 v120, v120, v122
    v_mul_f32 v121, v121, v123
    v_cvt_pk_bf16_f32 v120, v120, v121
    v_and_b32 v121, s25, v120
    v_lshlrev_b32 v120, 16, v120
    v_add_f32 v112, v112, v120
    v_add_f32 v113, v113, v121
    v_lshlrev_b32 v120, 16, v71
    v_and_b32 v121, s25, v71
    v_lshlrev_b32 v122, 16, v111
    v_and_b32 v123, s25, v111
    v_mul_f32 v120, v120, v122
    v_mul_f32 v121, v121, v123
    v_cvt_pk_bf16_f32 v120, v120, v121
    v_and_b32 v121, s25, v120
    v_lshlrev_b32 v120, 16, v120
    v_add_f32 v112, v112, v120
    v_add_f32 v113, v113, v121
    v_add_f32 v112, v112, v113
    s_nop 1
    v_add_f32_dpp v112, v112, v112 quad_perm:[1,0,3,2] row_mask:0xf bank_mask:0xf
    s_nop 1
    v_add_f32_dpp v112, v112, v112 quad_perm:[2,3,0,1] row_mask:0xf bank_mask:0xf
    s_nop 1
    v_add_f32_dpp v112, v112, v112 row_half_mirror row_mask:0xf bank_mask:0xf
    v_cvt_pk_bf16_f32 v112, v112, v112
    v_lshlrev_b32 v112, 16, v112
    v_mul_f32 v112, 0xbfb8aa3b, v112
    v_exp_f32 v112, v112
    s_nop 0
    v_add_f32 v112, 1.0, v112
    v_rcp_f32 v112, v112
    s_nop 0
    v_cvt_pk_bf16_f32 v112, v112, v112
    v_lshlrev_b32 v112, 16, v112
    v_sub_f32 v113, 1.0, v112
    v_cvt_pk_bf16_f32 v113, v113, v113
    v_lshlrev_b32 v113, 16, v113
    v_lshlrev_b32 v116, 2, v116
    s_mov_b32 s25, 0x3800000
    s_cmp_ge_u32 s41, 32
    s_cselect_b32 s25, 0x70000000, s25
    buffer_store_dword v112, v116, s[8:11], s25 offen sc1
    s_add_u32 s25, s25, 8192
    buffer_store_dword v113, v116, s[8:11], s25 offen sc1
    s_lshl_b32 s24, s41, 6
    s_lshl_b32 s25, s3, 4
    s_add_u32 s24, s24, s25
    s_add_u32 s24, s24, 8
    v_lshrrev_b32 v116, 3, v1
    v_add_u32 v116, s24, v116
    v_and_b32 v117, 7, v1
    v_lshlrev_b32 v117, 4, v117
    v_mul_u32_u24 v118, 1280, v116
    v_add_u32 v118, v118, v117
    buffer_load_dwordx4 v[32:35], v118, s[60:63], 0 offen offset:0
    buffer_load_dwordx4 v[36:39], v118, s[60:63], 0 offen offset:128
    buffer_load_dwordx4 v[40:43], v118, s[60:63], 0 offen offset:256
    buffer_load_dwordx4 v[44:47], v118, s[60:63], 0 offen offset:384
    buffer_load_dwordx4 v[48:51], v118, s[60:63], 0 offen offset:512
    buffer_load_dwordx4 v[52:55], v118, s[60:63], 0 offen offset:640
    buffer_load_dwordx4 v[56:59], v118, s[60:63], 0 offen offset:768
    buffer_load_dwordx4 v[60:63], v118, s[60:63], 0 offen offset:896
    buffer_load_dwordx4 v[64:67], v118, s[60:63], 0 offen offset:1024
    buffer_load_dwordx4 v[68:71], v118, s[60:63], 0 offen offset:1152
    s_waitcnt vmcnt(15) lgkmcnt(0)
    s_cbranch_vccnz VR94
    s_waitcnt vmcnt(14)
VR94:
    s_barrier
    s_add_u32 m0, s36, 65536
    s_nop 0
    buffer_load_dwordx4 v24, s[60:63], s34 offen offset:0 lds
    buffer_load_dwordx4 v25, s[60:63], s34 offen offset:1024 lds
    buffer_load_dwordx4 v26, s[60:63], s34 offen offset:2048 lds
    buffer_load_dwordx4 v27, s[60:63], s34 offen offset:3072 lds
    s_add_u32 s34, s34, 128
    s_cbranch_vccnz VR78
    buffer_store_dwordx4 v[216:219], v4, s[8:11], s40 offen offset:0 sc1
VR78:
    s_cbranch_vccz VR75
    buffer_store_dwordx4 v[232:235], v4, s[8:11], s40 offen offset:0 sc1
VR75:
    s_cbranch_vccz VR76
    buffer_store_dwordx4 v[236:239], v4, s[8:11], s40 offen offset:1024 sc1
    s_add_u32 s40, s40, 4096
VR76:
    s_cbranch_vccnz VR79
    buffer_store_dwordx4 v[220:223], v4, s[8:11], s40 offen offset:1024 sc1
    s_add_u32 s40, s40, 4096
VR79:
    s_cbranch_vccz VR77
    buffer_store_dwordx4 v[240:243], v4, s[8:11], s40 offen offset:0 sc1
VR77:
    v_mov_b32 v112, 0
    v_mov_b32 v113, 0
    s_mov_b32 s25, 0xffff0000
    s_waitcnt vmcnt(7)
    s_cbranch_vccnz VR95
    s_waitcnt vmcnt(6)
VR95:
    v_lshlrev_b32 v120, 16, v32
    v_and_b32 v121, s25, v32
    v_lshlrev_b32 v122, 16, v72
    v_and_b32 v123, s25, v72
    v_mul_f32 v120, v120, v122
    v_mul_f32 v121, v121, v123
    v_cvt_pk_bf16_f32 v120, v120, v121
    v_and_b32 v121, s25, v120
    v_lshlrev_b32 v120, 16, v120
    v_add_f32 v112, v112, v120
    v_add_f32 v113, v113, v121
    v_lshlrev_b32 v120, 16, v33
    v_and_b32 v121, s25, v33
    v_lshlrev_b32 v122, 16, v73
    v_and_b32 v123, s25, v73
    v_mul_f32 v120, v120, v122
    v_mul_f32 v121, v121, v123
    v_cvt_pk_bf16_f32 v120, v120, v121
    v_and_b32 v121, s25, v120
    v_lshlrev_b32 v120, 16, v120
    v_add_f32 v112, v112, v120
    v_add_f32 v113, v113, v121
    v_lshlrev_b32 v120, 16, v34
    v_and_b32 v121, s25, v34
    v_lshlrev_b32 v122, 16, v74
    v_and_b32 v123, s25, v74
    v_mul_f32 v120, v120, v122
    v_mul_f32 v121, v121, v123
    v_cvt_pk_bf16_f32 v120, v120, v121
    v_and_b32 v121, s25, v120
    v_lshlrev_b32 v120, 16, v120
    v_add_f32 v112, v112, v120
    v_add_f32 v113, v113, v121
    v_lshlrev_b32 v120, 16, v35
    v_and_b32 v121, s25, v35
    v_lshlrev_b32 v122, 16, v75
    v_and_b32 v123, s25, v75
    v_mul_f32 v120, v120, v122
    v_mul_f32 v121, v121, v123
    v_cvt_pk_bf16_f32 v120, v120, v121
    v_and_b32 v121, s25, v120
    v_lshlrev_b32 v120, 16, v120
    v_add_f32 v112, v112, v120
    v_add_f32 v113, v113, v121
    v_lshlrev_b32 v120, 16, v36
    v_and_b32 v121, s25, v36
    v_lshlrev_b32 v122, 16, v76
    v_and_b32 v123, s25, v76
    v_mul_f32 v120, v120, v122
    v_mul_f32 v121, v121, v123
    v_cvt_pk_bf16_f32 v120, v120, v121
    v_and_b32 v121, s25, v120
    v_lshlrev_b32 v120, 16, v120
    v_add_f32 v112, v112, v120
    v_add_f32 v113, v113, v121
    v_lshlrev_b32 v120, 16, v37
    v_and_b32 v121, s25, v37
    v_lshlrev_b32 v122, 16, v77
    v_and_b32 v123, s25, v77
    v_mul_f32 v120, v120, v122
    v_mul_f32 v121, v121, v123
    v_cvt_pk_bf16_f32 v120, v120, v121
    v_and_b32 v121, s25, v120
    v_lshlrev_b32 v120, 16, v120
    v_add_f32 v112, v112, v120
    v_add_f32 v113, v113, v121
    v_lshlrev_b32 v120, 16, v38
    v_and_b32 v121, s25, v38
    v_lshlrev_b32 v122, 16, v78
    v_and_b32 v123, s25, v78
    v_mul_f32 v120, v120, v122
    v_mul_f32 v121, v121, v123
    v_cvt_pk_bf16_f32 v120, v120, v121
    v_and_b32 v121, s25, v120
    v_lshlrev_b32 v120, 16, v120
    v_add_f32 v112, v112, v120
    v_add_f32 v113, v113, v121
    v_lshlrev_b32 v120, 16, v39
    v_and_b32 v121, s25, v39
    v_lshlrev_b32 v122, 16, v79
    v_and_b32 v123, s25, v79
    v_mul_f32 v120, v120, v122
    v_mul_f32 v121, v121, v123
    v_cvt_pk_bf16_f32 v120, v120, v121
    v_and_b32 v121, s25, v120
    v_lshlrev_b32 v120, 16, v120
    v_add_f32 v112, v112, v120
    v_add_f32 v113, v113, v121
    v_lshlrev_b32 v120, 16, v40
    v_and_b32 v121, s25, v40
    v_lshlrev_b32 v122, 16, v80
    v_and_b32 v123, s25, v80
    v_mul_f32 v120, v120, v122
    v_mul_f32 v121, v121, v123
    v_cvt_pk_bf16_f32 v120, v120, v121
    v_and_b32 v121, s25, v120
    v_lshlrev_b32 v120, 16, v120
    v_add_f32 v112, v112, v120
    v_add_f32 v113, v113, v121
    v_lshlrev_b32 v120, 16, v41
    v_and_b32 v121, s25, v41
    v_lshlrev_b32 v122, 16, v81
    v_and_b32 v123, s25, v81
    v_mul_f32 v120, v120, v122
    v_mul_f32 v121, v121, v123
    v_cvt_pk_bf16_f32 v120, v120, v121
    v_and_b32 v121, s25, v120
    v_lshlrev_b32 v120, 16, v120
    v_add_f32 v112, v112, v120
    v_add_f32 v113, v113, v121
    v_lshlrev_b32 v120, 16, v42
    v_and_b32 v121, s25, v42
    v_lshlrev_b32 v122, 16, v82
    v_and_b32 v123, s25, v82
    v_mul_f32 v120, v120, v122
    v_mul_f32 v121, v121, v123
    v_cvt_pk_bf16_f32 v120, v120, v121
    v_and_b32 v121, s25, v120
    v_lshlrev_b32 v120, 16, v120
    v_add_f32 v112, v112, v120
    v_add_f32 v113, v113, v121
    v_lshlrev_b32 v120, 16, v43
    v_and_b32 v121, s25, v43
    v_lshlrev_b32 v122, 16, v83
    v_and_b32 v123, s25, v83
    v_mul_f32 v120, v120, v122
    v_mul_f32 v121, v121, v123
    v_cvt_pk_bf16_f32 v120, v120, v121
    v_and_b32 v121, s25, v120
    v_lshlrev_b32 v120, 16, v120
    v_add_f32 v112, v112, v120
    v_add_f32 v113, v113, v121
    v_lshlrev_b32 v120, 16, v44
    v_and_b32 v121, s25, v44
    v_lshlrev_b32 v122, 16, v84
    v_and_b32 v123, s25, v84
    v_mul_f32 v120, v120, v122
    v_mul_f32 v121, v121, v123
    v_cvt_pk_bf16_f32 v120, v120, v121
    v_and_b32 v121, s25, v120
    v_lshlrev_b32 v120, 16, v120
    v_add_f32 v112, v112, v120
    v_add_f32 v113, v113, v121
    v_lshlrev_b32 v120, 16, v45
    v_and_b32 v121, s25, v45
    v_lshlrev_b32 v122, 16, v85
    v_and_b32 v123, s25, v85
    v_mul_f32 v120, v120, v122
    v_mul_f32 v121, v121, v123
    v_cvt_pk_bf16_f32 v120, v120, v121
    v_and_b32 v121, s25, v120
    v_lshlrev_b32 v120, 16, v120
    v_add_f32 v112, v112, v120
    v_add_f32 v113, v113, v121
    v_lshlrev_b32 v120, 16, v46
    v_and_b32 v121, s25, v46
    v_lshlrev_b32 v122, 16, v86
    v_and_b32 v123, s25, v86
    v_mul_f32 v120, v120, v122
    v_mul_f32 v121, v121, v123
    v_cvt_pk_bf16_f32 v120, v120, v121
    v_and_b32 v121, s25, v120
    v_lshlrev_b32 v120, 16, v120
    v_add_f32 v112, v112, v120
    v_add_f32 v113, v113, v121
    v_lshlrev_b32 v120, 16, v47
    v_and_b32 v121, s25, v47
    v_lshlrev_b32 v122, 16, v87
    v_and_b32 v123, s25, v87
    v_mul_f32 v120, v120, v122
    v_mul_f32 v121, v121, v123
    v_cvt_pk_bf16_f32 v120, v120, v121
    v_and_b32 v121, s25, v120
    v_lshlrev_b32 v120, 16, v120
    v_add_f32 v112, v112, v120
    v_add_f32 v113, v113, v121
    v_lshlrev_b32 v120, 16, v48
    v_and_b32 v121, s25, v48
    v_lshlrev_b32 v122, 16, v88
    v_and_b32 v123, s25, v88
    v_mul_f32 v120, v120, v122
    v_mul_f32 v121, v121, v123
    v_cvt_pk_bf16_f32 v120, v120, v121
    v_and_b32 v121, s25, v120
    v_lshlrev_b32 v120, 16, v120
    v_add_f32 v112, v112, v120
    v_add_f32 v113, v113, v121
    v_lshlrev_b32 v120, 16, v49
    v_and_b32 v121, s25, v49
    v_lshlrev_b32 v122, 16, v89
    v_and_b32 v123, s25, v89
    v_mul_f32 v120, v120, v122
    v_mul_f32 v121, v121, v123
    v_cvt_pk_bf16_f32 v120, v120, v121
    v_and_b32 v121, s25, v120
    v_lshlrev_b32 v120, 16, v120
    v_add_f32 v112, v112, v120
    v_add_f32 v113, v113, v121
    v_lshlrev_b32 v120, 16, v50
    v_and_b32 v121, s25, v50
    v_lshlrev_b32 v122, 16, v90
    v_and_b32 v123, s25, v90
    v_mul_f32 v120, v120, v122
    v_mul_f32 v121, v121, v123
    v_cvt_pk_bf16_f32 v120, v120, v121
    v_and_b32 v121, s25, v120
    v_lshlrev_b32 v120, 16, v120
    v_add_f32 v112, v112, v120
    v_add_f32 v113, v113, v121
    v_lshlrev_b32 v120, 16, v51
    v_and_b32 v121, s25, v51
    v_lshlrev_b32 v122, 16, v91
    v_and_b32 v123, s25, v91
    v_mul_f32 v120, v120, v122
    v_mul_f32 v121, v121, v123
    v_cvt_pk_bf16_f32 v120, v120, v121
    v_and_b32 v121, s25, v120
    v_lshlrev_b32 v120, 16, v120
    v_add_f32 v112, v112, v120
    v_add_f32 v113, v113, v121
    v_lshlrev_b32 v120, 16, v52
    v_and_b32 v121, s25, v52
    v_lshlrev_b32 v122, 16, v92
    v_and_b32 v123, s25, v92
    v_mul_f32 v120, v120, v122
    v_mul_f32 v121, v121, v123
    v_cvt_pk_bf16_f32 v120, v120, v121
    v_and_b32 v121, s25, v120
    v_lshlrev_b32 v120, 16, v120
    v_add_f32 v112, v112, v120
    v_add_f32 v113, v113, v121
    v_lshlrev_b32 v120, 16, v53
    v_and_b32 v121, s25, v53
    v_lshlrev_b32 v122, 16, v93
    v_and_b32 v123, s25, v93
    v_mul_f32 v120, v120, v122
    v_mul_f32 v121, v121, v123
    v_cvt_pk_bf16_f32 v120, v120, v121
    v_and_b32 v121, s25, v120
    v_lshlrev_b32 v120, 16, v120
    v_add_f32 v112, v112, v120
    v_add_f32 v113, v113, v121
    v_lshlrev_b32 v120, 16, v54
    v_and_b32 v121, s25, v54
    v_lshlrev_b32 v122, 16, v94
    v_and_b32 v123, s25, v94
    v_mul_f32 v120, v120, v122
    v_mul_f32 v121, v121, v123
    v_cvt_pk_bf16_f32 v120, v120, v121
    v_and_b32 v121, s25, v120
    v_lshlrev_b32 v120, 16, v120
    v_add_f32 v112, v112, v120
    v_add_f32 v113, v113, v121
    v_lshlrev_b32 v120, 16, v55
    v_and_b32 v121, s25, v55
    v_lshlrev_b32 v122, 16, v95
    v_and_b32 v123, s25, v95
    v_mul_f32 v120, v120, v122
    v_mul_f32 v121, v121, v123
    v_cvt_pk_bf16_f32 v120, v120, v121
    v_and_b32 v121, s25, v120
    v_lshlrev_b32 v120, 16, v120
    v_add_f32 v112, v112, v120
    v_add_f32 v113, v113, v121
    v_lshlrev_b32 v120, 16, v56
    v_and_b32 v121, s25, v56
    v_lshlrev_b32 v122, 16, v96
    v_and_b32 v123, s25, v96
    v_mul_f32 v120, v120, v122
    v_mul_f32 v121, v121, v123
    v_cvt_pk_bf16_f32 v120, v120, v121
    v_and_b32 v121, s25, v120
    v_lshlrev_b32 v120, 16, v120
    v_add_f32 v112, v112, v120
    v_add_f32 v113, v113, v121
    v_lshlrev_b32 v120, 16, v57
    v_and_b32 v121, s25, v57
    v_lshlrev_b32 v122, 16, v97
    v_and_b32 v123, s25, v97
    v_mul_f32 v120, v120, v122
    v_mul_f32 v121, v121, v123
    v_cvt_pk_bf16_f32 v120, v120, v121
    v_and_b32 v121, s25, v120
    v_lshlrev_b32 v120, 16, v120
    v_add_f32 v112, v112, v120
    v_add_f32 v113, v113, v121
    v_lshlrev_b32 v120, 16, v58
    v_and_b32 v121, s25, v58
    v_lshlrev_b32 v122, 16, v98
    v_and_b32 v123, s25, v98
    v_mul_f32 v120, v120, v122
    v_mul_f32 v121, v121, v123
    v_cvt_pk_bf16_f32 v120, v120, v121
    v_and_b32 v121, s25, v120
    v_lshlrev_b32 v120, 16, v120
    v_add_f32 v112, v112, v120
    v_add_f32 v113, v113, v121
    v_lshlrev_b32 v120, 16, v59
    v_and_b32 v121, s25, v59
    v_lshlrev_b32 v122, 16, v99
    v_and_b32 v123, s25, v99
    v_mul_f32 v120, v120, v122
    v_mul_f32 v121, v121, v123
    v_cvt_pk_bf16_f32 v120, v120, v121
    v_and_b32 v121, s25, v120
    v_lshlrev_b32 v120, 16, v120
    v_add_f32 v112, v112, v120
    v_add_f32 v113, v113, v121
    v_lshlrev_b32 v120, 16, v60
    v_and_b32 v121, s25, v60
    v_lshlrev_b32 v122, 16, v100
    v_and_b32 v123, s25, v100
    v_mul_f32 v120, v120, v122
    v_mul_f32 v121, v121, v123
    v_cvt_pk_bf16_f32 v120, v120, v121
    v_and_b32 v121, s25, v120
    v_lshlrev_b32 v120, 16, v120
    v_add_f32 v112, v112, v120
    v_add_f32 v113, v113, v121
    v_lshlrev_b32 v120, 16, v61
    v_and_b32 v121, s25, v61
    v_lshlrev_b32 v122, 16, v101
    v_and_b32 v123, s25, v101
    v_mul_f32 v120, v120, v122
    v_mul_f32 v121, v121, v123
    v_cvt_pk_bf16_f32 v120, v120, v121
    v_and_b32 v121, s25, v120
    v_lshlrev_b32 v120, 16, v120
    v_add_f32 v112, v112, v120
    v_add_f32 v113, v113, v121
    v_lshlrev_b32 v120, 16, v62
    v_and_b32 v121, s25, v62
    v_lshlrev_b32 v122, 16, v102
    v_and_b32 v123, s25, v102
    v_mul_f32 v120, v120, v122
    v_mul_f32 v121, v121, v123
    v_cvt_pk_bf16_f32 v120, v120, v121
    v_and_b32 v121, s25, v120
    v_lshlrev_b32 v120, 16, v120
    v_add_f32 v112, v112, v120
    v_add_f32 v113, v113, v121
    v_lshlrev_b32 v120, 16, v63
    v_and_b32 v121, s25, v63
    v_lshlrev_b32 v122, 16, v103
    v_and_b32 v123, s25, v103
    v_mul_f32 v120, v120, v122
    v_mul_f32 v121, v121, v123
    v_cvt_pk_bf16_f32 v120, v120, v121
    v_and_b32 v121, s25, v120
    v_lshlrev_b32 v120, 16, v120
    v_add_f32 v112, v112, v120
    v_add_f32 v113, v113, v121
    v_lshlrev_b32 v120, 16, v64
    v_and_b32 v121, s25, v64
    v_lshlrev_b32 v122, 16, v104
    v_and_b32 v123, s25, v104
    v_mul_f32 v120, v120, v122
    v_mul_f32 v121, v121, v123
    v_cvt_pk_bf16_f32 v120, v120, v121
    v_and_b32 v121, s25, v120
    v_lshlrev_b32 v120, 16, v120
    v_add_f32 v112, v112, v120
    v_add_f32 v113, v113, v121
    v_lshlrev_b32 v120, 16, v65
    v_and_b32 v121, s25, v65
    v_lshlrev_b32 v122, 16, v105
    v_and_b32 v123, s25, v105
    v_mul_f32 v120, v120, v122
    v_mul_f32 v121, v121, v123
    v_cvt_pk_bf16_f32 v120, v120, v121
    v_and_b32 v121, s25, v120
    v_lshlrev_b32 v120, 16, v120
    v_add_f32 v112, v112, v120
    v_add_f32 v113, v113, v121
    v_lshlrev_b32 v120, 16, v66
    v_and_b32 v121, s25, v66
    v_lshlrev_b32 v122, 16, v106
    v_and_b32 v123, s25, v106
    v_mul_f32 v120, v120, v122
    v_mul_f32 v121, v121, v123
    v_cvt_pk_bf16_f32 v120, v120, v121
    v_and_b32 v121, s25, v120
    v_lshlrev_b32 v120, 16, v120
    v_add_f32 v112, v112, v120
    v_add_f32 v113, v113, v121
    v_lshlrev_b32 v120, 16, v67
    v_and_b32 v121, s25, v67
    v_lshlrev_b32 v122, 16, v107
    v_and_b32 v123, s25, v107
    v_mul_f32 v120, v120, v122
    v_mul_f32 v121, v121, v123
    v_cvt_pk_bf16_f32 v120, v120, v121
    v_and_b32 v121, s25, v120
    v_lshlrev_b32 v120, 16, v120
    v_add_f32 v112, v112, v120
    v_add_f32 v113, v113, v121
    v_lshlrev_b32 v120, 16, v68
    v_and_b32 v121, s25, v68
    v_lshlrev_b32 v122, 16, v108
    v_and_b32 v123, s25, v108
    v_mul_f32 v120, v120, v122
    v_mul_f32 v121, v121, v123
    v_cvt_pk_bf16_f32 v120, v120, v121
    v_and_b32 v121, s25, v120
    v_lshlrev_b32 v120, 16, v120
    v_add_f32 v112, v112, v120
    v_add_f32 v113, v113, v121
    v_lshlrev_b32 v120, 16, v69
    v_and_b32 v121, s25, v69
    v_lshlrev_b32 v122, 16, v109
    v_and_b32 v123, s25, v109
    v_mul_f32 v120, v120, v122
    v_mul_f32 v121, v121, v123
    v_cvt_pk_bf16_f32 v120, v120, v121
    v_and_b32 v121, s25, v120
    v_lshlrev_b32 v120, 16, v120
    v_add_f32 v112, v112, v120
    v_add_f32 v113, v113, v121
    v_lshlrev_b32 v120, 16, v70
    v_and_b32 v121, s25, v70
    v_lshlrev_b32 v122, 16, v110
    v_and_b32 v123, s25, v110
    v_mul_f32 v120, v120, v122
    v_mul_f32 v121, v121, v123
    v_cvt_pk_bf16_f32 v120, v120, v121
    v_and_b32 v121, s25, v120
    v_lshlrev_b32 v120, 16, v120
    v_add_f32 v112, v112, v120
    v_add_f32 v113, v113, v121
    v_lshlrev_b32 v120, 16, v71
    v_and_b32 v121, s25, v71
    v_lshlrev_b32 v122, 16, v111
    v_and_b32 v123, s25, v111
    v_mul_f32 v120, v120, v122
    v_mul_f32 v121, v121, v123
    v_cvt_pk_bf16_f32 v120, v120, v121
    v_and_b32 v121, s25, v120
    v_lshlrev_b32 v120, 16, v120
    v_add_f32 v112, v112, v120
    v_add_f32 v113, v113, v121
    v_add_f32 v112, v112, v113
    s_nop 1
    v_add_f32_dpp v112, v112, v112 quad_perm:[1,0,3,2] row_mask:0xf bank_mask:0xf
    s_nop 1
    v_add_f32_dpp v112, v112, v112 quad_perm:[2,3,0,1] row_mask:0xf bank_mask:0xf
    s_nop 1
    v_add_f32_dpp v112, v112, v112 row_half_mirror row_mask:0xf bank_mask:0xf
    v_cvt_pk_bf16_f32 v112, v112, v112
    v_lshlrev_b32 v112, 16, v112
    v_mul_f32 v112, 0xbfb8aa3b, v112
    v_exp_f32 v112, v112
    s_nop 0
    v_add_f32 v112, 1.0, v112
    v_rcp_f32 v112, v112
    s_nop 0
    v_cvt_pk_bf16_f32 v112, v112, v112
    v_lshlrev_b32 v112, 16, v112
    v_sub_f32 v113, 1.0, v112
    v_cvt_pk_bf16_f32 v113, v113, v113
    v_lshlrev_b32 v113, 16, v113
    v_lshlrev_b32 v116, 2, v116
    s_mov_b32 s25, 0x3800000
    s_cmp_ge_u32 s41, 32
    s_cselect_b32 s25, 0x70000000, s25
    buffer_store_dword v112, v116, s[8:11], s25 offen sc1
    s_add_u32 s25, s25, 8192
    buffer_store_dword v113, v116, s[8:11], s25 offen sc1
    s_waitcnt vmcnt(5) lgkmcnt(0)
    s_cbranch_vccnz VR96
    s_waitcnt vmcnt(4)
VR96:
    s_barrier
    s_add_u32 m0, s36, 0
    s_nop 0
    buffer_load_dwordx4 v24, s[60:63], s34 offen offset:0 lds
    buffer_load_dwordx4 v25, s[60:63], s34 offen offset:1024 lds
    buffer_load_dwordx4 v26, s[60:63], s34 offen offset:2048 lds
    buffer_load_dwordx4 v27, s[60:63], s34 offen offset:3072 lds
    s_add_u32 s34, s34, 128
    s_cbranch_vccnz VR83
    buffer_store_dwordx4 v[224:227], v4, s[8:11], s40 offen offset:0 sc1
VR83:
    s_cbranch_vccz VR80
    buffer_store_dwordx4 v[244:247], v4, s[8:11], s40 offen offset:1024 sc1
    s_add_u32 s40, s40, 4096
VR80:
    s_cbranch_vccz VR81
    buffer_store_dwordx4 v[248:251], v4, s[8:11], s40 offen offset:0 sc1
VR81:
    s_cbranch_vccnz VR84
    buffer_store_dwordx4 v[228:231], v4, s[8:11], s40 offen offset:1024 sc1
    s_add_u32 s40, s40, 4096
VR84:
    s_cbranch_vccz VR82
    buffer_store_dwordx4 v[252:255], v4, s[8:11], s40 offen offset:1024 sc1
    s_add_u32 s40, s40, 4096
VR82:
    s_waitcnt vmcnt(3) lgkmcnt(0)
    s_cbranch_vccnz VR97
    s_waitcnt vmcnt(2)
VR97:
    s_barrier
    s_add_u32 m0, s36, 65536
    s_nop 0
    buffer_load_dwordx4 v24, s[60:63], s34 offen offset:0 lds
    buffer_load_dwordx4 v25, s[60:63], s34 offen offset:1024 lds
    buffer_load_dwordx4 v26, s[60:63], s34 offen offset:2048 lds
    buffer_load_dwordx4 v27, s[60:63], s34 offen offset:3072 lds
    s_add_u32 s34, s34, 128
    s_cbranch_vccnz VR85
    buffer_store_dwordx4 v[232:235], v4, s[8:11], s40 offen offset:0 sc1
VR85:
    s_cbranch_vccnz VR86
    buffer_store_dwordx4 v[236:239], v4, s[8:11], s40 offen offset:1024 sc1
    s_add_u32 s40, s40, 4096
VR86:
    s_waitcnt vmcnt(2) lgkmcnt(0)
    s_cbranch_vccz VR98
    s_waitcnt vmcnt(0)
VR98:
    s_barrier
    s_cbranch_vccz VR87
    s_cmp_lg_u32 s3, 0
    s_cbranch_scc1 SIG1_2
    v_mov_b32 v28, 1
    v_add_u32 v28, s38, v28
    s_mov_b64 exec, 1
    buffer_store_dword v28, off, s[8:11], s29 sc1
    s_mov_b64 exec, -1
SIG1_2:
VR87:
    s_add_u32 m0, s36, 0
    s_nop 0
    buffer_load_dwordx4 v24, s[60:63], s34 offen offset:0 lds
    buffer_load_dwordx4 v25, s[60:63], s34 offen offset:1024 lds
    buffer_load_dwordx4 v26, s[60:63], s34 offen offset:2048 lds
    buffer_load_dwordx4 v27, s[60:63], s34 offen offset:3072 lds
    s_add_u32 s34, s34, 128
    s_cbranch_vccnz VR88
    buffer_store_dwordx4 v[240:243], v4, s[8:11], s40 offen offset:0 sc1
VR88:
    s_cbranch_vccnz VR89
    buffer_store_dwordx4 v[244:247], v4, s[8:11], s40 offen offset:1024 sc1
    s_add_u32 s40, s40, 4096
VR89:
    s_waitcnt vmcnt(2) lgkmcnt(0)
    s_cbranch_vccz VR99
    s_waitcnt vmcnt(0)
VR99:
    s_barrier
    s_add_u32 m0, s36, 65536
    s_nop 0
    buffer_load_dwordx4 v24, s[60:63], s34 offen offset:0 lds
    buffer_load_dwordx4 v25, s[60:63], s34 offen offset:1024 lds
    buffer_load_dwordx4 v26, s[60:63], s34 offen offset:2048 lds
    buffer_load_dwordx4 v27, s[60:63], s34 offen offset:3072 lds
    s_add_u32 s34, s34, 128
    s_cbranch_vccnz VR90
    buffer_store_dwordx4 v[248:251], v4, s[8:11], s40 offen offset:0 sc1
VR90:
    s_waitcnt vmcnt(1) lgkmcnt(0)
    s_cbranch_vccz VR100
    s_waitcnt vmcnt(0)
VR100:
    s_barrier
    s_add_u32 m0, s36, 0
    s_nop 0
    buffer_load_dwordx4 v24, s[60:63], s34 offen offset:0 lds
    buffer_load_dwordx4 v25, s[60:63], s34 offen offset:1024 lds
    buffer_load_dwordx4 v26, s[60:63], s34 offen offset:2048 lds
    buffer_load_dwordx4 v27, s[60:63], s34 offen offset:3072 lds
    s_add_u32 s34, s34, 128
    s_cbranch_vccnz VR91
    buffer_store_dwordx4 v[252:255], v4, s[8:11], s40 offen offset:1024 sc1
    s_add_u32 s40, s40, 4096
VR91:
    s_lshl_b32 s44, s6, 19
    s_add_u32 s44, s44, s36
    s_add_u32 s44, s44, 0x0
    s_add_u32 s45, s44, 0x1000000
    s_mov_b32 s46, s36
    s_add_u32 s47, s36, 98304
    s_waitcnt vmcnt(1) lgkmcnt(0)
    s_cbranch_vccz VR101
    s_waitcnt vmcnt(0)
VR101:
    s_barrier
    s_add_u32 m0, s36, 65536
    s_nop 0
    buffer_load_dwordx4 v24, s[60:63], s34 offen offset:0 lds
    buffer_load_dwordx4 v25, s[60:63], s34 offen offset:1024 lds
    buffer_load_dwordx4 v26, s[60:63], s34 offen offset:2048 lds
    buffer_load_dwordx4 v27, s[60:63], s34 offen offset:3072 lds
    s_add_u32 s34, s34, 128
    s_and_b32 s80, s4, 3
    s_lshr_b32 s81, s4, 2
    s_lshl_b32 s81, s81, 3
    s_add_u32 s81, s81, s7
    s_sub_u32 s82, 15, s81
    s_min_u32 s82, s82, s81
    s_and_b32 s83, s5, 3
    s_lshl_b32 s84, s7, 1
    s_sub_u32 s85, 30, s84
    s_lshl_b32 s86, s81, 1
    s_mov_b32 s88, 0xcccc
    s_mov_b32 s89, 0
    s_mov_b32 s90, 0xffff0000
    s_mov_b32 s91, -1
    v_mov_b32 v24, s85
    v_mov_b32 v25, s84
    v_cndmask_b32 v24, v24, v25, s[88:89]
    v_mov_b32 v25, s86
    v_cndmask_b32 v24, v24, v25, s[90:91]
    v_and_b32 v25, 1, v1
    v_add_u32 v24, v24, v25
    v_mul_u32_u24 v25, 52, v24
    v_lshrrev_b32 v25, 8, v25
    v_lshlrev_b32 v26, 1, v25
    v_sub_u32 v24, v24, v26
    v_add_u32 v24, 3, v24
    v_and_b32 v24, 7, v24
    v_lshl_add_u32 v24, v25, 5, v24
    v_add_u32 v24, 24, v24
    s_mul_i32 s84, s80, 7
    v_and_b32 v27, 7, v1
    v_min_u32 v25, 6, v27
    v_add_u32 v25, s84, v25
    v_min_u32 v25, 26, v25
    v_and_b32 v26, 7, v25
    v_lshlrev_b32 v26, 2, v26
    v_lshrrev_b32 v31, 3, v25
    v_add_u32 v26, v26, v31
    s_lshr_b32 s54, s4, 2
    v_cmp_le_u32 s[88:89], 24, v25
    v_subrev_u32 v25, 24, v25
    v_lshlrev_b32 v25, 3, v25
    s_lshl_b32 s54, s54, 5
    v_add_u32 v25, s82, v25
    v_mul_u32_u24 v25, 86, v25
    s_add_u32 s54, s54, s5
    v_lshrrev_b32 v25, 8, v25
    v_lshlrev_b32 v25, 2, v25
    s_lshl_b32 s54, s54, 2
    v_add_u32 v25, 3, v25
    v_cndmask_b32 v26, v26, v25, s[88:89]
    v_lshlrev_b32 v26, 3, v26
    v_add_u32 v26, s82, v26
    s_mov_b32 s88, 0x00ff0000
    s_and_b32 s55, s4, 3
    s_mov_b32 s89, 0
    v_cndmask_b32 v24, v24, v26, s[88:89]
    s_add_u32 s54, s54, s55
    s_and_b32 s84, s4, 4
    s_lshl_b32 s84, s84, 2
    s_lshl_b32 s54, s54, 3
    s_add_u32 s84, s84, s83
    s_lshl_b32 s84, s84, 3
    s_add_u32 s84, s84, s7
    v_and_b32 v25, 3, v1
    v_lshlrev_b32 v25, 5, v25
    s_add_u32 s54, s54, s3
    v_add_u32 v25, s84, v25
    s_mov_b32 s90, 0xf0000000
    s_mul_i32 s54, s54, 3840
    s_mov_b32 s91, 0
    v_cndmask_b32 v24, v24, v25, s[90:91]
    s_add_u32 s54, s54, 0x4000000
    s_lshl_b32 s84, s6, 3
    v_add_u32 v25, s84, v27
    v_mov_b32 v252, -1
    s_mov_b32 s88, 0xff
    v_cndmask_b32 v24, v24, v25, s[88:89]
    s_lshl_b32 s84, s80, 6
    s_add_u32 s84, s84, s82
    v_lshlrev_b32 v25, 3, v27
    v_mov_b32 v253, -1
    v_add_u32 v25, s84, v25
    s_mov_b32 s90, 0
    v_mov_b32 v254, -1
    s_mov_b32 s91, -1
    v_cndmask_b32 v24, v24, v25, s[90:91]
    v_mov_b32 v255, -1
    v_lshlrev_b32 v24, 8, v24
    v_add_u32 v1, 0x3900000, v24
    s_mov_b32 exec_lo, 0x1
    s_mov_b32 exec_hi, 0x0
    buffer_load_dword v28, v1, s[8:11], 0 offen sc1
    s_mov_b64 exec, -1
    v_mov_b32 v208, 0
    v_mov_b32 v209, 0
    v_mov_b32 v210, 0
    v_mov_b32 v211, 0
    v_mov_b32 v212, 0
    v_mov_b32 v213, 0
    v_mov_b32 v214, 0
    v_mov_b32 v215, 0
    v_mov_b32 v216, 0
    v_mov_b32 v217, 0
    v_mov_b32 v218, 0
    v_mov_b32 v219, 0
    v_mov_b32 v220, 0
    v_mov_b32 v221, 0
    v_mov_b32 v222, 0
    v_mov_b32 v223, 0
    v_mov_b32 v224, 0
    v_mov_b32 v225, 0
    v_mov_b32 v226, 0
    v_mov_b32 v227, 0
    s_waitcnt vmcnt(1) lgkmcnt(0)
    s_barrier
    s_waitcnt vmcnt(0)
    s_add_u32 s26, s38, 1
    v_subrev_u32 v28, s26, v28
    v_cmp_le_u32 vcc, 7, v28
    s_mov_b32 s26, 0x1
    s_mov_b32 s27, 0x0
    s_and_b64 vcc, s[26:27], vcc
    s_cbranch_vccnz PL1_2_S
PL1_2_C:
    s_mov_b32 m0, s46
    s_nop 0
    buffer_load_dwordx4 v4, s[8:11], s44 offen offset:0 sc1 lds
    buffer_load_dwordx4 v4, s[8:11], s44 offen offset:1024 sc1 lds
    buffer_load_dwordx4 v4, s[8:11], s44 offen offset:2048 sc1 lds
    buffer_load_dwordx4 v4, s[8:11], s44 offen offset:3072 sc1 lds
    s_add_u32 s44, s44, 32768
    s_xor_b32 s46, s46, 0x10000
    v_mov_b32 v228, 0
    v_mov_b32 v229, 0
    v_mov_b32 v230, 0
    v_mov_b32 v231, 0
    v_mov_b32 v232, 0
    v_mov_b32 v233, 0
    v_mov_b32 v234, 0
    v_mov_b32 v235, 0
    v_mov_b32 v236, 0
    v_mov_b32 v237, 0
    v_mov_b32 v238, 0
    v_mov_b32 v239, 0
    v_mov_b32 v240, 0
    v_mov_b32 v241, 0
    v_mov_b32 v242, 0
    v_mov_b32 v243, 0
    v_mov_b32 v244, 0
    v_mov_b32 v245, 0
    v_mov_b32 v246, 0
    v_mov_b32 v247, 0
    v_mov_b32 v248, 0
    v_mov_b32 v249, 0
    v_mov_b32 v250, 0
    v_mov_b32 v251, 0
    v_mov_b32 v5, v4
    v_add_u32 v6, 98304, v4
    s_and_b32 s24, s3, 3
    s_lshl_b32 s25, s24, 13
    buffer_store_dwordx4 v[252:255], v4, s[8:11], s54 offen offset:0 sc1
    s_add_u32 s25, s25, 131072
    v_add_u32 v8, s25, v4
    s_add_u32 s48, s7, 1
    s_sub_u32 s49, 7, s7
    s_mov_b32 s52, 0x10000
    s_mov_b32 s53, 0x43800000
    s_lshl_b32 s25, s6, 15
    s_add_u32 s25, s25, 0x206c000
    s_lshl_b32 s26, s24, 12
    s_add_u32 s25, s25, s26
    s_mul_i32 s26, s7, 1490944
    buffer_store_dwordx4 v[252:255], v4, s[8:11], s54 offen offset:1024 sc1
    s_add_u32 s58, s25, s26
    s_sub_u32 s26, 15, s7
    s_mul_i32 s26, s26, 1490944
    s_add_u32 s57, s25, s26
    s_cmp_eq_u32 s7, 7
    s_cselect_b32 s50, 1, 0
    s_mov_b32 s59, s50
    s_mov_b32 s56, 0
    s_mov_b32 s31, 3
    s_and_b32 s27, s3, 3
    s_lshl_b32 s27, s27, 5
    v_lshlrev_b32 v29, 2, v3
    buffer_store_dwordx4 v[252:255], v4, s[8:11], s54 offen offset:2048 sc1
    v_sub_u32 v29, v2, v29
    v_add_u32 v29, s27, v29
    v_cmp_gt_i32 s[60:61], -16, v29
    v_cmp_gt_i32 s[62:63], -15, v29
    v_cmp_gt_i32 s[64:65], -14, v29
    v_cmp_gt_i32 s[66:67], -13, v29
    v_cmp_gt_i32 s[68:69], 0, v29
    v_cmp_gt_i32 s[70:71], 1, v29
    v_cmp_gt_i32 s[72:73], 2, v29
    v_cmp_gt_i32 s[74:75], 3, v29
    v_cmp_gt_i32 s[76:77], 16, v29
    s_mov_b32 exec_hi, 0xffff
    buffer_store_dwordx4 v[252:255], v4, s[8:11], s54 offen offset:3072 sc1
    s_mov_b32 exec_hi, -1
    v_cmp_gt_i32 s[78:79], 17, v29
    v_cmp_gt_i32 s[80:81], 18, v29
    v_cmp_gt_i32 s[82:83], 19, v29
    v_cmp_gt_i32 s[84:85], 32, v29
    v_cmp_gt_i32 s[86:87], 33, v29
    v_cmp_gt_i32 s[88:89], 34, v29
    v_cmp_gt_i32 s[90:91], 35, v29
    v_cmp_gt_i32 s[92:93], 48, v29
    v_cmp_gt_i32 s[94:95], 49, v29
    v_cmp_gt_i32 s[96:97], 50, v29
    v_cmp_gt_i32 s[98:99], 51, v29
    s_waitcnt vmcnt(4) lgkmcnt(0)
    s_barrier
    s_cmp_lg_u32 s3, 0
    s_cbranch_scc1 SIG2_2
    v_mov_b32 v28, 2
    v_add_u32 v28, s38, v28
    s_mov_b64 exec, 1
    buffer_store_dword v28, off, s[8:11], s29 sc1
    s_mov_b64 exec, -1
SIG2_2:
    s_mov_b32 m0, s47
    s_nop 0
    buffer_load_dwordx4 v4, s[8:11], s45 offen offset:0 sc1 lds
    buffer_load_dwordx4 v4, s[8:11], s45 offen offset:1024 sc1 lds
    buffer_load_dwordx4 v4, s[8:11], s45 offen offset:2048 sc1 lds
    buffer_load_dwordx4 v4, s[8:11], s45 offen offset:3072 sc1 lds
    s_add_u32 s45, s45, 32768
    s_xor_b32 s47, s47, 0x10000
    s_nop 1
    v_mov_b32 v11, 0
    v_mov_b32 v12, 0
    v_mov_b32 v15, 0xff61b1e6
    ds_read_b128 v[64:67], v5 offset:0
    ds_read_b128 v[68:71], v5 offset:1024
    ds_read_b128 v[72:75], v5 offset:2048
    ds_read_b128 v[76:79], v5 offset:3072
    ds_read_b128 v[80:83], v5 offset:4096
    ds_read_b128 v[84:87], v5 offset:5120
    v_mov_b64 v[192:193], 0
    v_mov_b64 v[194:195], 0
    v_mov_b64 v[196:197], 0
    v_mov_b64 v[198:199], 0
    v_mov_b64 v[200:201], 0
    v_mov_b64 v[202:203], 0
    v_mov_b64 v[204:205], 0
    v_mov_b64 v[206:207], 0
    v_mov_b64 v[252:253], 0
    v_mov_b64 v[254:255], 0
    s_barrier
    ds_read_b128 v[160:163], v8 offset:0
    ds_read_b128 v[164:167], v8 offset:1024
    ds_read_b128 v[168:171], v8 offset:2048
    ds_read_b128 v[172:175], v8 offset:3072
    ds_read_b128 v[176:179], v8 offset:4096
    ds_read_b128 v[180:183], v8 offset:5120
    ds_read_b128 v[184:187], v8 offset:6144
    ds_read_b128 v[188:191], v8 offset:7168
    s_waitcnt lgkmcnt(6)
    v_mfma_f32_16x16x32_bf16 v[128:131], v[64:67], v[160:163], 0
    ds_read_b128 v[88:91], v5 offset:6144
    s_waitcnt lgkmcnt(3)
    v_mfma_f32_16x16x32_bf16 v[132:135], v[64:67], v[176:179], 0
    v_mfma_f32_16x16x32_bf16 v[128:131], v[68:71], v[164:167], v[128:131]
    ds_read_b128 v[92:95], v5 offset:7168
    v_mfma_f32_16x16x32_bf16 v[132:135], v[68:71], v[180:183], v[132:135]
    v_mfma_f32_16x16x32_bf16 v[128:131], v[72:75], v[168:171], v[128:131]
    ds_read_b128 v[64:67], v5 offset:8192
    s_waitcnt lgkmcnt(3)
    v_mfma_f32_16x16x32_bf16 v[132:135], v[72:75], v[184:187], v[132:135]
    v_mfma_f32_16x16x32_bf16 v[128:131], v[76:79], v[172:175], v[128:131]
    ds_read_b128 v[68:71], v5 offset:9216
    v_mfma_f32_16x16x32_bf16 v[132:135], v[76:79], v[188:191], v[132:135]
    v_mfma_f32_16x16x32_bf16 v[136:139], v[80:83], v[160:163], 0
    ds_read_b128 v[72:75], v5 offset:10240
    v_mfma_f32_16x16x32_bf16 v[140:143], v[80:83], v[176:179], 0
    v_mfma_f32_16x16x32_bf16 v[136:139], v[84:87], v[164:167], v[136:139]
    ds_read_b128 v[76:79], v5 offset:11264
    v_mfma_f32_16x16x32_bf16 v[140:143], v[84:87], v[180:183], v[140:143]
    s_waitcnt lgkmcnt(4)
    v_mfma_f32_16x16x32_bf16 v[136:139], v[88:91], v[168:171], v[136:139]
    ds_read_b128 v[80:83], v5 offset:12288
    v_mfma_f32_16x16x32_bf16 v[140:143], v[88:91], v[184:187], v[140:143]
    v_mfma_f32_16x16x32_bf16 v[136:139], v[92:95], v[172:175], v[136:139]
    ds_read_b128 v[84:87], v5 offset:13312
    v_mfma_f32_16x16x32_bf16 v[140:143], v[92:95], v[188:191], v[140:143]
    s_waitcnt lgkmcnt(4)
    v_mfma_f32_16x16x32_bf16 v[144:147], v[64:67], v[160:163], 0
    ds_read_b128 v[88:91], v5 offset:14336
    v_mfma_f32_16x16x32_bf16 v[148:151], v[64:67], v[176:179], 0
    v_mfma_f32_16x16x32_bf16 v[144:147], v[68:71], v[164:167], v[144:147]
    ds_read_b128 v[92:95], v5 offset:15360
    v_mfma_f32_16x16x32_bf16 v[148:151], v[68:71], v[180:183], v[148:151]
    s_waitcnt lgkmcnt(4)
    v_mfma_f32_16x16x32_bf16 v[144:147], v[72:75], v[168:171], v[144:147]
    v_xor_b32 v5, 0x4000, v5
    ds_read_b128 v[64:67], v5 offset:0
    v_mfma_f32_16x16x32_bf16 v[148:151], v[72:75], v[184:187], v[148:151]
    v_mfma_f32_16x16x32_bf16 v[144:147], v[76:79], v[172:175], v[144:147]
    ds_read_b128 v[68:71], v5 offset:1024
    v_mfma_f32_16x16x32_bf16 v[148:151], v[76:79], v[188:191], v[148:151]
    s_waitcnt lgkmcnt(4)
    v_mfma_f32_16x16x32_bf16 v[152:155], v[80:83], v[160:163], 0
    ds_read_b128 v[72:75], v5 offset:2048
    v_mfma_f32_16x16x32_bf16 v[156:159], v[80:83], v[176:179], 0
    v_mfma_f32_16x16x32_bf16 v[152:155], v[84:87], v[164:167], v[152:155]
    ds_read_b128 v[76:79], v5 offset:3072
    v_mfma_f32_16x16x32_bf16 v[156:159], v[84:87], v[180:183], v[156:159]
    s_waitcnt lgkmcnt(4)
    v_mfma_f32_16x16x32_bf16 v[152:155], v[88:91], v[168:171], v[152:155]
    ds_read_b128 v[80:83], v5 offset:4096
    v_mfma_f32_16x16x32_bf16 v[156:159], v[88:91], v[184:187], v[156:159]
    v_mfma_f32_16x16x32_bf16 v[152:155], v[92:95], v[172:175], v[152:155]
    ds_read_b128 v[84:87], v5 offset:5120
    v_mfma_f32_16x16x32_bf16 v[156:159], v[92:95], v[188:191], v[156:159]
    s_nop 2
    v_max3_f32 v16, v128, v129, v130
    v_max3_f32 v17, v132, v133, v134
    v_max3_f32 v16, v16, v131, v136
    v_max3_f32 v17, v17, v135, v140
    v_max3_f32 v16, v16, v137, v138
    v_max3_f32 v17, v17, v141, v142
    v_max3_f32 v16, v16, v139, v144
    v_max3_f32 v17, v17, v143, v148
    v_max3_f32 v16, v16, v145, v146
    v_max3_f32 v17, v17, v149, v150
    v_max3_f32 v16, v16, v147, v152
    v_max3_f32 v17, v17, v151, v156
    v_max3_f32 v16, v16, v153, v154
    v_max3_f32 v17, v17, v157, v158
    v_max_f32 v16, v16, v155
    v_max_f32 v17, v17, v159
    v_mov_b32 v18, v16
    s_nop 1
    v_permlane32_swap_b32 v18, v16
    s_nop 1
    v_max_f32 v16, v16, v18
    v_mov_b32 v18, v16
    s_nop 1
    v_permlane16_swap_b32 v18, v16
    s_nop 1
    v_max_f32 v16, v16, v18
    v_max_f32 v16, 0xf149f2ca, v16
    v_mov_b32 v19, v17
    s_nop 1
    v_permlane32_swap_b32 v19, v17
    s_nop 1
    v_max_f32 v17, v17, v19
    v_mov_b32 v19, v17
    s_nop 1
    v_permlane16_swap_b32 v19, v17
    s_nop 1
    v_max_f32 v17, v17, v19
    v_max_f32 v17, 0xf149f2ca, v17
    v_sub_f32 v32, 0, v16
    v_sub_f32 v33, 0, v16
    v_sub_f32 v34, 0, v16
    v_sub_f32 v35, 0, v16
    v_sub_f32 v36, 0, v17
    v_sub_f32 v37, 0, v17
    v_sub_f32 v38, 0, v17
    v_sub_f32 v39, 0, v17
    v_pk_add_f32 v[128:129], v[128:129], v[32:33]
    v_pk_add_f32 v[130:131], v[130:131], v[32:33]
    v_pk_add_f32 v[136:137], v[136:137], v[32:33]
    v_pk_add_f32 v[138:139], v[138:139], v[32:33]
    v_pk_add_f32 v[132:133], v[132:133], v[36:37]
    v_pk_add_f32 v[134:135], v[134:135], v[36:37]
    v_pk_add_f32 v[140:141], v[140:141], v[36:37]
    v_pk_add_f32 v[142:143], v[142:143], v[36:37]
    v_pk_add_f32 v[144:145], v[144:145], v[32:33]
    v_pk_add_f32 v[146:147], v[146:147], v[32:33]
    v_pk_add_f32 v[152:153], v[152:153], v[32:33]
    v_pk_add_f32 v[154:155], v[154:155], v[32:33]
    v_pk_add_f32 v[148:149], v[148:149], v[36:37]
    v_pk_add_f32 v[150:151], v[150:151], v[36:37]
    v_pk_add_f32 v[156:157], v[156:157], v[36:37]
    v_pk_add_f32 v[158:159], v[158:159], v[36:37]
    v_exp_f32 v24, v128
    s_mov_b32 m0, s46
    s_nop 0
    buffer_load_dwordx4 v4, s[8:11], s44 offen offset:0 sc1 lds
    v_exp_f32 v25, v129
    v_exp_f32 v26, v132
    v_exp_f32 v27, v133
    v_add_f32 v9, v24, v25
    v_cvt_pk_bf16_f32 v56, v24, v25
    v_exp_f32 v28, v130
    v_exp_f32 v29, v131
    v_add_f32 v10, v26, v27
    v_cvt_pk_bf16_f32 v60, v26, v27
    v_exp_f32 v30, v134
    buffer_load_dwordx4 v4, s[8:11], s44 offen offset:1024 sc1 lds
    v_exp_f32 v31, v135
    v_add_f32 v9, v9, v28
    v_add_f32 v9, v9, v29
    v_cvt_pk_bf16_f32 v57, v28, v29
    v_exp_f32 v24, v136
    v_exp_f32 v25, v137
    v_add_f32 v10, v10, v30
    v_add_f32 v10, v10, v31
    v_cvt_pk_bf16_f32 v61, v30, v31
    v_exp_f32 v26, v140
    buffer_load_dwordx4 v4, s[8:11], s44 offen offset:2048 sc1 lds
    v_exp_f32 v27, v141
    v_add_f32 v9, v9, v24
    v_add_f32 v9, v9, v25
    v_cvt_pk_bf16_f32 v58, v24, v25
    v_exp_f32 v28, v138
    v_exp_f32 v29, v139
    v_add_f32 v10, v10, v26
    v_add_f32 v10, v10, v27
    v_cvt_pk_bf16_f32 v62, v26, v27
    v_exp_f32 v30, v142
    buffer_load_dwordx4 v4, s[8:11], s44 offen offset:3072 sc1 lds
    s_add_u32 s44, s44, 32768
    s_xor_b32 s46, s46, 0x10000
    v_exp_f32 v31, v143
    v_add_f32 v9, v9, v28
    v_add_f32 v9, v9, v29
    v_cvt_pk_bf16_f32 v59, v28, v29
    s_nop 0
    v_add_f32 v10, v10, v30
    v_add_f32 v10, v10, v31
    v_cvt_pk_bf16_f32 v63, v30, v31
    s_mov_b32 exec_lo, 0xffff
    s_mov_b32 exec_hi, 0x0
    buffer_load_dword v22, v1, s[8:11], 0 offen sc1
    s_mov_b64 exec, -1
    s_setprio 0
    s_waitcnt vmcnt(5)
    s_barrier
    s_branch K_ATT
K_V:
    s_waitcnt lgkmcnt(12)
    v_mfma_f32_16x16x32_bf16 v[128:131], v[32:35], v[64:67], 0
    ds_read_b64_tr_b16 v[112:113], v16 offset:8192
    s_lshl_b32 s24, s2, 2
    s_waitcnt lgkmcnt(11)
    v_mfma_f32_16x16x32_bf16 v[132:135], v[32:35], v[68:71], 0
    ds_read_b64_tr_b16 v[114:115], v16 offset:9216
    s_and_b32 s25, s3, 3
    s_waitcnt lgkmcnt(10)
    v_mfma_f32_16x16x32_bf16 v[136:139], v[32:35], v[72:75], 0
    s_add_u32 s24, s24, s25
    s_waitcnt lgkmcnt(8)
    v_mfma_f32_16x16x32_bf16 v[140:143], v[32:35], v[76:79], 0
    ds_read_b128 v[80:83], v13 offset:0
    s_mul_i32 s24, s24, 1536
    v_mfma_f32_16x16x32_bf16 v[144:147], v[36:39], v[64:67], 0
    ds_read_b64_tr_b16 v[116:117], v17 offset:8192
    s_add_u32 s24, s24, 1048576
    v_mfma_f32_16x16x32_bf16 v[148:151], v[36:39], v[68:71], 0
    v_min_u32 v29, 11, v1
    v_mfma_f32_16x16x32_bf16 v[152:155], v[36:39], v[72:75], 0
    ds_read_b64_tr_b16 v[118:119], v17 offset:9216
    v_lshlrev_b32 v29, 7, v29
    v_mfma_f32_16x16x32_bf16 v[156:159], v[36:39], v[76:79], 0
    ds_read_b64_tr_b16 v[120:121], v18 offset:8192
    buffer_load_dword v28, v29, s[68:71], s24 offen
    s_waitcnt lgkmcnt(10)
    v_mfma_f32_16x16x32_bf16 v[160:163], v[40:43], v[64:67], 0
    s_lshl_b32 s24, s2, 3
    v_mfma_f32_16x16x32_bf16 v[164:167], v[40:43], v[68:71], 0
    ds_read_b64_tr_b16 v[122:123], v18 offset:9216
    s_add_u32 s24, s24, s3
    v_mfma_f32_16x16x32_bf16 v[168:171], v[40:43], v[72:75], 0
    ds_read_b64_tr_b16 v[124:125], v19 offset:8192
    s_lshl_b32 s24, s24, 10
    v_mfma_f32_16x16x32_bf16 v[172:175], v[40:43], v[76:79], 0
    v_min_u32 v29, 2, v1
    v_mfma_f32_16x16x32_bf16 v[176:179], v[44:47], v[64:67], 0
    ds_read_b64_tr_b16 v[126:127], v19 offset:9216
    v_lshlrev_b32 v29, 7, v29
    v_mfma_f32_16x16x32_bf16 v[180:183], v[44:47], v[68:71], 0
    ds_read_b128 v[84:87], v13 offset:2048
    buffer_load_dword v28, v29, s[64:67], s24 offen offset:256
    v_mfma_f32_16x16x32_bf16 v[184:187], v[44:47], v[72:75], 0
    v_mfma_f32_16x16x32_bf16 v[188:191], v[44:47], v[76:79], 0
    ds_read_b128 v[88:91], v13 offset:4096
    s_waitcnt lgkmcnt(13)
    v_mfma_f32_16x16x32_bf16 v[192:195], v[48:51], v[64:67], 0
    ds_read_b128 v[92:95], v13 offset:6144
    v_mfma_f32_16x16x32_bf16 v[196:199], v[48:51], v[68:71], 0
    v_mfma_f32_16x16x32_bf16 v[200:203], v[48:51], v[72:75], 0
    ds_read_b128 v[96:99], v13 offset:8192
    v_mfma_f32_16x16x32_bf16 v[204:207], v[48:51], v[76:79], 0
    ds_read_b128 v[100:103], v13 offset:10240
    v_mfma_f32_16x16x32_bf16 v[208:211], v[52:55], v[64:67], 0
    v_mfma_f32_16x16x32_bf16 v[212:215], v[52:55], v[68:71], 0
    ds_read_b128 v[104:107], v13 offset:12288
    v_mfma_f32_16x16x32_bf16 v[216:219], v[52:55], v[72:75], 0
    ds_read_b128 v[108:111], v13 offset:14336
    v_mfma_f32_16x16x32_bf16 v[220:223], v[52:55], v[76:79], 0
    s_waitcnt lgkmcnt(15)
    v_mfma_f32_16x16x32_bf16 v[224:227], v[56:59], v[64:67], 0
    v_mfma_f32_16x16x32_bf16 v[228:231], v[56:59], v[68:71], 0
    v_mfma_f32_16x16x32_bf16 v[232:235], v[56:59], v[72:75], 0
    v_mfma_f32_16x16x32_bf16 v[236:239], v[56:59], v[76:79], 0
    v_mfma_f32_16x16x32_bf16 v[240:243], v[60:63], v[64:67], 0
    v_mfma_f32_16x16x32_bf16 v[244:247], v[60:63], v[68:71], 0
    v_mfma_f32_16x16x32_bf16 v[248:251], v[60:63], v[72:75], 0
    v_mfma_f32_16x16x32_bf16 v[252:255], v[60:63], v[76:79], 0
    s_waitcnt vmcnt(2) lgkmcnt(0)
    s_barrier
    v_mfma_f32_16x16x32_bf16 v[128:131], v[80:83], v[112:115], v[128:131]
    ds_read_b64_tr_b16 v[64:65], v20 offset:0
    v_mfma_f32_16x16x32_bf16 v[132:135], v[80:83], v[116:119], v[132:135]
    ds_read_b64_tr_b16 v[66:67], v20 offset:1024
    s_add_u32 m0, s36, 0
    s_nop 0
    buffer_load_dwordx4 v5, s[64:67], s32 offen offset:0 lds
    v_mfma_f32_16x16x32_bf16 v[136:139], v[80:83], v[120:123], v[136:139]
    v_mfma_f32_16x16x32_bf16 v[140:143], v[80:83], v[124:127], v[140:143]
    ds_read_b128 v[32:35], v14 offset:0
    v_mfma_f32_16x16x32_bf16 v[144:147], v[84:87], v[112:115], v[144:147]
    ds_read_b64_tr_b16 v[68:69], v21 offset:0
    buffer_load_dwordx4 v6, s[64:67], s32 offen offset:1024 lds
    v_mfma_f32_16x16x32_bf16 v[148:151], v[84:87], v[116:119], v[148:151]
    v_mfma_f32_16x16x32_bf16 v[152:155], v[84:87], v[120:123], v[152:155]
    ds_read_b64_tr_b16 v[70:71], v21 offset:1024
    v_mfma_f32_16x16x32_bf16 v[156:159], v[84:87], v[124:127], v[156:159]
    ds_read_b64_tr_b16 v[72:73], v22 offset:0
    buffer_load_dwordx4 v7, s[64:67], s32 offen offset:2048 lds
    v_mfma_f32_16x16x32_bf16 v[160:163], v[88:91], v[112:115], v[160:163]
    v_mfma_f32_16x16x32_bf16 v[164:167], v[88:91], v[116:119], v[164:167]
    ds_read_b64_tr_b16 v[74:75], v22 offset:1024
    v_mfma_f32_16x16x32_bf16 v[168:171], v[88:91], v[120:123], v[168:171]
    ds_read_b64_tr_b16 v[76:77], v23 offset:0
    buffer_load_dwordx4 v30, s[64:67], s32 offen offset:3072 lds
    s_add_u32 s32, s32, 128
    v_mfma_f32_16x16x32_bf16 v[172:175], v[88:91], v[124:127], v[172:175]
    v_mfma_f32_16x16x32_bf16 v[176:179], v[92:95], v[112:115], v[176:179]
    ds_read_b64_tr_b16 v[78:79], v23 offset:1024
    v_mfma_f32_16x16x32_bf16 v[180:183], v[92:95], v[116:119], v[180:183]
    ds_read_b128 v[36:39], v14 offset:2048
    s_add_u32 m0, s37, 0
    s_nop 0
    buffer_load_dwordx4 v8, s[68:71], s33 offen offset:0 lds
    v_mfma_f32_16x16x32_bf16 v[184:187], v[92:95], v[120:123], v[184:187]
    v_mfma_f32_16x16x32_bf16 v[188:191], v[92:95], v[124:127], v[188:191]
    ds_read_b128 v[40:43], v14 offset:4096
    v_mfma_f32_16x16x32_bf16 v[192:195], v[96:99], v[112:115], v[192:195]
    ds_read_b128 v[44:47], v14 offset:6144
    buffer_load_dwordx4 v9, s[68:71], s33 offen offset:1024 lds
    v_mfma_f32_16x16x32_bf16 v[196:199], v[96:99], v[116:119], v[196:199]
    v_mfma_f32_16x16x32_bf16 v[200:203], v[96:99], v[120:123], v[200:203]
    ds_read_b128 v[48:51], v14 offset:8192
    v_mfma_f32_16x16x32_bf16 v[204:207], v[96:99], v[124:127], v[204:207]
    ds_read_b128 v[52:55], v14 offset:10240
    buffer_load_dwordx4 v10, s[68:71], s33 offen offset:2048 lds
    v_mfma_f32_16x16x32_bf16 v[208:211], v[100:103], v[112:115], v[208:211]
    v_mfma_f32_16x16x32_bf16 v[212:215], v[100:103], v[116:119], v[212:215]
    ds_read_b128 v[56:59], v14 offset:12288
    v_mfma_f32_16x16x32_bf16 v[216:219], v[100:103], v[120:123], v[216:219]
    ds_read_b128 v[60:63], v14 offset:14336
    buffer_load_dwordx4 v11, s[68:71], s33 offen offset:3072 lds
    s_add_u32 s33, s33, 524288
    v_mfma_f32_16x16x32_bf16 v[220:223], v[100:103], v[124:127], v[220:223]
    v_mfma_f32_16x16x32_bf16 v[224:227], v[104:107], v[112:115], v[224:227]
    v_mfma_f32_16x16x32_bf16 v[228:231], v[104:107], v[116:119], v[228:231]
    s_lshl_b32 s24, s2, 2
    s_and_b32 s25, s3, 3
    s_add_u32 s24, s24, s25
    v_mfma_f32_16x16x32_bf16 v[232:235], v[104:107], v[120:123], v[232:235]
    s_mul_i32 s24, s24, 1536
    s_add_u32 s24, s24, 2621440
    v_mfma_f32_16x16x32_bf16 v[236:239], v[104:107], v[124:127], v[236:239]
    v_min_u32 v29, 11, v1
    v_lshlrev_b32 v29, 7, v29
    v_mfma_f32_16x16x32_bf16 v[240:243], v[108:111], v[112:115], v[240:243]
    buffer_load_dword v28, v29, s[68:71], s24 offen
    s_lshl_b32 s24, s2, 3
    s_add_u32 s24, s24, s3
    v_mfma_f32_16x16x32_bf16 v[244:247], v[108:111], v[116:119], v[244:247]
    s_lshl_b32 s24, s24, 10
    v_min_u32 v29, 2, v1
    v_mfma_f32_16x16x32_bf16 v[248:251], v[108:111], v[120:123], v[248:251]
    v_lshlrev_b32 v29, 7, v29
    buffer_load_dword v28, v29, s[64:67], s24 offen offset:640
    v_mfma_f32_16x16x32_bf16 v[252:255], v[108:111], v[124:127], v[252:255]
    s_waitcnt lgkmcnt(12)
    v_mfma_f32_16x16x32_bf16 v[128:131], v[32:35], v[64:67], v[128:131]
    ds_read_b64_tr_b16 v[112:113], v20 offset:8192
    s_waitcnt lgkmcnt(11)
    v_mfma_f32_16x16x32_bf16 v[132:135], v[32:35], v[68:71], v[132:135]
    ds_read_b64_tr_b16 v[114:115], v20 offset:9216
    s_waitcnt lgkmcnt(10)
    v_mfma_f32_16x16x32_bf16 v[136:139], v[32:35], v[72:75], v[136:139]
    s_waitcnt lgkmcnt(8)
    v_mfma_f32_16x16x32_bf16 v[140:143], v[32:35], v[76:79], v[140:143]
    ds_read_b128 v[80:83], v15 offset:0
    v_mfma_f32_16x16x32_bf16 v[144:147], v[36:39], v[64:67], v[144:147]
    ds_read_b64_tr_b16 v[116:117], v21 offset:8192
    v_mfma_f32_16x16x32_bf16 v[148:151], v[36:39], v[68:71], v[148:151]
    v_mfma_f32_16x16x32_bf16 v[152:155], v[36:39], v[72:75], v[152:155]
    ds_read_b64_tr_b16 v[118:119], v21 offset:9216
    v_mfma_f32_16x16x32_bf16 v[156:159], v[36:39], v[76:79], v[156:159]
    ds_read_b64_tr_b16 v[120:121], v22 offset:8192
    s_waitcnt lgkmcnt(10)
    v_mfma_f32_16x16x32_bf16 v[160:163], v[40:43], v[64:67], v[160:163]
    v_mfma_f32_16x16x32_bf16 v[164:167], v[40:43], v[68:71], v[164:167]
    ds_read_b64_tr_b16 v[122:123], v22 offset:9216
    v_mfma_f32_16x16x32_bf16 v[168:171], v[40:43], v[72:75], v[168:171]
    ds_read_b64_tr_b16 v[124:125], v23 offset:8192
    v_mfma_f32_16x16x32_bf16 v[172:175], v[40:43], v[76:79], v[172:175]
    v_mfma_f32_16x16x32_bf16 v[176:179], v[44:47], v[64:67], v[176:179]
    ds_read_b64_tr_b16 v[126:127], v23 offset:9216
    v_mfma_f32_16x16x32_bf16 v[180:183], v[44:47], v[68:71], v[180:183]
    ds_read_b128 v[84:87], v15 offset:2048
    v_mfma_f32_16x16x32_bf16 v[184:187], v[44:47], v[72:75], v[184:187]
    v_mfma_f32_16x16x32_bf16 v[188:191], v[44:47], v[76:79], v[188:191]
    ds_read_b128 v[88:91], v15 offset:4096
    s_waitcnt lgkmcnt(13)
    v_mfma_f32_16x16x32_bf16 v[192:195], v[48:51], v[64:67], v[192:195]
    ds_read_b128 v[92:95], v15 offset:6144
    v_mfma_f32_16x16x32_bf16 v[196:199], v[48:51], v[68:71], v[196:199]
    v_mfma_f32_16x16x32_bf16 v[200:203], v[48:51], v[72:75], v[200:203]
    ds_read_b128 v[96:99], v15 offset:8192
    v_mfma_f32_16x16x32_bf16 v[204:207], v[48:51], v[76:79], v[204:207]
    ds_read_b128 v[100:103], v15 offset:10240
    v_mfma_f32_16x16x32_bf16 v[208:211], v[52:55], v[64:67], v[208:211]
    v_mfma_f32_16x16x32_bf16 v[212:215], v[52:55], v[68:71], v[212:215]
    ds_read_b128 v[104:107], v15 offset:12288
    v_mfma_f32_16x16x32_bf16 v[216:219], v[52:55], v[72:75], v[216:219]
    ds_read_b128 v[108:111], v15 offset:14336
    v_mfma_f32_16x16x32_bf16 v[220:223], v[52:55], v[76:79], v[220:223]
    s_waitcnt lgkmcnt(15)
    v_mfma_f32_16x16x32_bf16 v[224:227], v[56:59], v[64:67], v[224:227]
    v_mfma_f32_16x16x32_bf16 v[228:231], v[56:59], v[68:71], v[228:231]
    v_mfma_f32_16x16x32_bf16 v[232:235], v[56:59], v[72:75], v[232:235]
    v_mfma_f32_16x16x32_bf16 v[236:239], v[56:59], v[76:79], v[236:239]
    v_mfma_f32_16x16x32_bf16 v[240:243], v[60:63], v[64:67], v[240:243]
    v_mfma_f32_16x16x32_bf16 v[244:247], v[60:63], v[68:71], v[244:247]
    v_mfma_f32_16x16x32_bf16 v[248:251], v[60:63], v[72:75], v[248:251]
    v_mfma_f32_16x16x32_bf16 v[252:255], v[60:63], v[76:79], v[252:255]
    s_waitcnt vmcnt(2) lgkmcnt(0)
    s_barrier
    v_mfma_f32_16x16x32_bf16 v[128:131], v[80:83], v[112:115], v[128:131]
    ds_read_b64_tr_b16 v[64:65], v16 offset:0
    v_mfma_f32_16x16x32_bf16 v[132:135], v[80:83], v[116:119], v[132:135]
    ds_read_b64_tr_b16 v[66:67], v16 offset:1024
    s_add_u32 m0, s36, 65536
    s_nop 0
    buffer_load_dwordx4 v5, s[64:67], s32 offen offset:0 lds
    v_mfma_f32_16x16x32_bf16 v[136:139], v[80:83], v[120:123], v[136:139]
    v_mfma_f32_16x16x32_bf16 v[140:143], v[80:83], v[124:127], v[140:143]
    ds_read_b128 v[32:35], v12 offset:0
    v_mfma_f32_16x16x32_bf16 v[144:147], v[84:87], v[112:115], v[144:147]
    ds_read_b64_tr_b16 v[68:69], v17 offset:0
    buffer_load_dwordx4 v6, s[64:67], s32 offen offset:1024 lds
    v_mfma_f32_16x16x32_bf16 v[148:151], v[84:87], v[116:119], v[148:151]
    v_mfma_f32_16x16x32_bf16 v[152:155], v[84:87], v[120:123], v[152:155]
    ds_read_b64_tr_b16 v[70:71], v17 offset:1024
    v_mfma_f32_16x16x32_bf16 v[156:159], v[84:87], v[124:127], v[156:159]
    ds_read_b64_tr_b16 v[72:73], v18 offset:0
    buffer_load_dwordx4 v7, s[64:67], s32 offen offset:2048 lds
    v_mfma_f32_16x16x32_bf16 v[160:163], v[88:91], v[112:115], v[160:163]
    v_mfma_f32_16x16x32_bf16 v[164:167], v[88:91], v[116:119], v[164:167]
    ds_read_b64_tr_b16 v[74:75], v18 offset:1024
    v_mfma_f32_16x16x32_bf16 v[168:171], v[88:91], v[120:123], v[168:171]
    ds_read_b64_tr_b16 v[76:77], v19 offset:0
    buffer_load_dwordx4 v30, s[64:67], s32 offen offset:3072 lds
    s_add_u32 s32, s32, 128
    v_mfma_f32_16x16x32_bf16 v[172:175], v[88:91], v[124:127], v[172:175]
    v_mfma_f32_16x16x32_bf16 v[176:179], v[92:95], v[112:115], v[176:179]
    ds_read_b64_tr_b16 v[78:79], v19 offset:1024
    v_mfma_f32_16x16x32_bf16 v[180:183], v[92:95], v[116:119], v[180:183]
    ds_read_b128 v[36:39], v12 offset:2048
    s_add_u32 m0, s37, 65536
    s_nop 0
    buffer_load_dwordx4 v8, s[68:71], s33 offen offset:0 lds
    v_mfma_f32_16x16x32_bf16 v[184:187], v[92:95], v[120:123], v[184:187]
    v_mfma_f32_16x16x32_bf16 v[188:191], v[92:95], v[124:127], v[188:191]
    ds_read_b128 v[40:43], v12 offset:4096
    v_mfma_f32_16x16x32_bf16 v[192:195], v[96:99], v[112:115], v[192:195]
    ds_read_b128 v[44:47], v12 offset:6144
    buffer_load_dwordx4 v9, s[68:71], s33 offen offset:1024 lds
    v_mfma_f32_16x16x32_bf16 v[196:199], v[96:99], v[116:119], v[196:199]
    v_mfma_f32_16x16x32_bf16 v[200:203], v[96:99], v[120:123], v[200:203]
    ds_read_b128 v[48:51], v12 offset:8192
    v_mfma_f32_16x16x32_bf16 v[204:207], v[96:99], v[124:127], v[204:207]
    ds_read_b128 v[52:55], v12 offset:10240
    buffer_load_dwordx4 v10, s[68:71], s33 offen offset:2048 lds
    v_mfma_f32_16x16x32_bf16 v[208:211], v[100:103], v[112:115], v[208:211]
    v_mfma_f32_16x16x32_bf16 v[212:215], v[100:103], v[116:119], v[212:215]
    ds_read_b128 v[56:59], v12 offset:12288
    v_mfma_f32_16x16x32_bf16 v[216:219], v[100:103], v[120:123], v[216:219]
    ds_read_b128 v[60:63], v12 offset:14336
    buffer_load_dwordx4 v11, s[68:71], s33 offen offset:3072 lds
    s_add_u32 s33, s33, 524288
    v_mfma_f32_16x16x32_bf16 v[220:223], v[100:103], v[124:127], v[220:223]
    v_mfma_f32_16x16x32_bf16 v[224:227], v[104:107], v[112:115], v[224:227]
    v_mfma_f32_16x16x32_bf16 v[228:231], v[104:107], v[116:119], v[228:231]
    s_lshl_b32 s24, s2, 3
    v_mfma_f32_16x16x32_bf16 v[232:235], v[104:107], v[120:123], v[232:235]
    s_add_u32 s24, s24, s3
    v_mfma_f32_16x16x32_bf16 v[236:239], v[104:107], v[124:127], v[236:239]
    s_mul_i32 s24, s24, 1280
    v_mfma_f32_16x16x32_bf16 v[240:243], v[108:111], v[112:115], v[240:243]
    v_min_u32 v29, 9, v1
    v_mfma_f32_16x16x32_bf16 v[244:247], v[108:111], v[116:119], v[244:247]
    v_lshlrev_b32 v29, 7, v29
    v_mfma_f32_16x16x32_bf16 v[248:251], v[108:111], v[120:123], v[248:251]
    buffer_load_dword v28, v29, s[60:63], s24 offen
    v_mfma_f32_16x16x32_bf16 v[252:255], v[108:111], v[124:127], v[252:255]
    s_waitcnt lgkmcnt(12)
    v_mfma_f32_16x16x32_bf16 v[128:131], v[32:35], v[64:67], v[128:131]
    ds_read_b64_tr_b16 v[112:113], v16 offset:8192
    s_waitcnt lgkmcnt(11)
    v_mfma_f32_16x16x32_bf16 v[132:135], v[32:35], v[68:71], v[132:135]
    ds_read_b64_tr_b16 v[114:115], v16 offset:9216
    s_waitcnt lgkmcnt(10)
    v_mfma_f32_16x16x32_bf16 v[136:139], v[32:35], v[72:75], v[136:139]
    s_waitcnt lgkmcnt(8)
    v_mfma_f32_16x16x32_bf16 v[140:143], v[32:35], v[76:79], v[140:143]
    ds_read_b128 v[80:83], v13 offset:0
    v_mfma_f32_16x16x32_bf16 v[144:147], v[36:39], v[64:67], v[144:147]
    ds_read_b64_tr_b16 v[116:117], v17 offset:8192
    buffer_load_dword v31, off, s[12:15], 0 sc1
    v_mfma_f32_16x16x32_bf16 v[148:151], v[36:39], v[68:71], v[148:151]
    v_mfma_f32_16x16x32_bf16 v[152:155], v[36:39], v[72:75], v[152:155]
    ds_read_b64_tr_b16 v[118:119], v17 offset:9216
    v_mfma_f32_16x16x32_bf16 v[156:159], v[36:39], v[76:79], v[156:159]
    ds_read_b64_tr_b16 v[120:121], v18 offset:8192
    s_waitcnt lgkmcnt(10)
    v_mfma_f32_16x16x32_bf16 v[160:163], v[40:43], v[64:67], v[160:163]
    v_mfma_f32_16x16x32_bf16 v[164:167], v[40:43], v[68:71], v[164:167]
    ds_read_b64_tr_b16 v[122:123], v18 offset:9216
    v_mfma_f32_16x16x32_bf16 v[168:171], v[40:43], v[72:75], v[168:171]
    ds_read_b64_tr_b16 v[124:125], v19 offset:8192
    v_mfma_f32_16x16x32_bf16 v[172:175], v[40:43], v[76:79], v[172:175]
    v_mfma_f32_16x16x32_bf16 v[176:179], v[44:47], v[64:67], v[176:179]
    ds_read_b64_tr_b16 v[126:127], v19 offset:9216
    v_mfma_f32_16x16x32_bf16 v[180:183], v[44:47], v[68:71], v[180:183]
    ds_read_b128 v[84:87], v13 offset:2048
    v_mfma_f32_16x16x32_bf16 v[184:187], v[44:47], v[72:75], v[184:187]
    v_mfma_f32_16x16x32_bf16 v[188:191], v[44:47], v[76:79], v[188:191]
    ds_read_b128 v[88:91], v13 offset:4096
    s_waitcnt lgkmcnt(13)
    v_mfma_f32_16x16x32_bf16 v[192:195], v[48:51], v[64:67], v[192:195]
    ds_read_b128 v[92:95], v13 offset:6144
    v_mfma_f32_16x16x32_bf16 v[196:199], v[48:51], v[68:71], v[196:199]
    v_mfma_f32_16x16x32_bf16 v[200:203], v[48:51], v[72:75], v[200:203]
    ds_read_b128 v[96:99], v13 offset:8192
    v_mfma_f32_16x16x32_bf16 v[204:207], v[48:51], v[76:79], v[204:207]
    ds_read_b128 v[100:103], v13 offset:10240
    v_mfma_f32_16x16x32_bf16 v[208:211], v[52:55], v[64:67], v[208:211]
    v_mfma_f32_16x16x32_bf16 v[212:215], v[52:55], v[68:71], v[212:215]
    ds_read_b128 v[104:107], v13 offset:12288
    v_mfma_f32_16x16x32_bf16 v[216:219], v[52:55], v[72:75], v[216:219]
    ds_read_b128 v[108:111], v13 offset:14336
    v_mfma_f32_16x16x32_bf16 v[220:223], v[52:55], v[76:79], v[220:223]
    s_waitcnt lgkmcnt(15)
    v_mfma_f32_16x16x32_bf16 v[224:227], v[56:59], v[64:67], v[224:227]
    v_mfma_f32_16x16x32_bf16 v[228:231], v[56:59], v[68:71], v[228:231]
    v_mfma_f32_16x16x32_bf16 v[232:235], v[56:59], v[72:75], v[232:235]
    v_mfma_f32_16x16x32_bf16 v[236:239], v[56:59], v[76:79], v[236:239]
    v_mfma_f32_16x16x32_bf16 v[240:243], v[60:63], v[64:67], v[240:243]
    v_mfma_f32_16x16x32_bf16 v[244:247], v[60:63], v[68:71], v[244:247]
    v_mfma_f32_16x16x32_bf16 v[248:251], v[60:63], v[72:75], v[248:251]
    v_mfma_f32_16x16x32_bf16 v[252:255], v[60:63], v[76:79], v[252:255]
    s_waitcnt vmcnt(2) lgkmcnt(0)
    s_barrier
    v_mfma_f32_16x16x32_bf16 v[128:131], v[80:83], v[112:115], v[128:131]
    ds_read_b64_tr_b16 v[64:65], v20 offset:0
    v_mfma_f32_16x16x32_bf16 v[132:135], v[80:83], v[116:119], v[132:135]
    ds_read_b64_tr_b16 v[66:67], v20 offset:1024
    s_add_u32 m0, s36, 0
    s_nop 0
    buffer_load_dwordx4 v5, s[64:67], s32 offen offset:0 lds
    v_mfma_f32_16x16x32_bf16 v[136:139], v[80:83], v[120:123], v[136:139]
    v_mfma_f32_16x16x32_bf16 v[140:143], v[80:83], v[124:127], v[140:143]
    ds_read_b128 v[32:35], v14 offset:0
    v_mfma_f32_16x16x32_bf16 v[144:147], v[84:87], v[112:115], v[144:147]
    ds_read_b64_tr_b16 v[68:69], v21 offset:0
    buffer_load_dwordx4 v6, s[64:67], s32 offen offset:1024 lds
    v_mfma_f32_16x16x32_bf16 v[148:151], v[84:87], v[116:119], v[148:151]
    v_mfma_f32_16x16x32_bf16 v[152:155], v[84:87], v[120:123], v[152:155]
    ds_read_b64_tr_b16 v[70:71], v21 offset:1024
    v_mfma_f32_16x16x32_bf16 v[156:159], v[84:87], v[124:127], v[156:159]
    ds_read_b64_tr_b16 v[72:73], v22 offset:0
    buffer_load_dwordx4 v7, s[64:67], s32 offen offset:2048 lds
    v_mfma_f32_16x16x32_bf16 v[160:163], v[88:91], v[112:115], v[160:163]
    v_mfma_f32_16x16x32_bf16 v[164:167], v[88:91], v[116:119], v[164:167]
    ds_read_b64_tr_b16 v[74:75], v22 offset:1024
    v_mfma_f32_16x16x32_bf16 v[168:171], v[88:91], v[120:123], v[168:171]
    ds_read_b64_tr_b16 v[76:77], v23 offset:0
    buffer_load_dwordx4 v30, s[64:67], s32 offen offset:3072 lds
    s_add_u32 s32, s32, 128
    v_mfma_f32_16x16x32_bf16 v[172:175], v[88:91], v[124:127], v[172:175]
    v_mfma_f32_16x16x32_bf16 v[176:179], v[92:95], v[112:115], v[176:179]
    ds_read_b64_tr_b16 v[78:79], v23 offset:1024
    v_mfma_f32_16x16x32_bf16 v[180:183], v[92:95], v[116:119], v[180:183]
    ds_read_b128 v[36:39], v14 offset:2048
    s_add_u32 m0, s37, 0
    s_nop 0
    buffer_load_dwordx4 v8, s[68:71], s33 offen offset:0 lds
    v_mfma_f32_16x16x32_bf16 v[184:187], v[92:95], v[120:123], v[184:187]
    v_mfma_f32_16x16x32_bf16 v[188:191], v[92:95], v[124:127], v[188:191]
    ds_read_b128 v[40:43], v14 offset:4096
    v_mfma_f32_16x16x32_bf16 v[192:195], v[96:99], v[112:115], v[192:195]
    ds_read_b128 v[44:47], v14 offset:6144
    buffer_load_dwordx4 v9, s[68:71], s33 offen offset:1024 lds
    v_mfma_f32_16x16x32_bf16 v[196:199], v[96:99], v[116:119], v[196:199]
    v_mfma_f32_16x16x32_bf16 v[200:203], v[96:99], v[120:123], v[200:203]
    ds_read_b128 v[48:51], v14 offset:8192
    v_mfma_f32_16x16x32_bf16 v[204:207], v[96:99], v[124:127], v[204:207]
    ds_read_b128 v[52:55], v14 offset:10240
    buffer_load_dwordx4 v10, s[68:71], s33 offen offset:2048 lds
    v_mfma_f32_16x16x32_bf16 v[208:211], v[100:103], v[112:115], v[208:211]
    v_mfma_f32_16x16x32_bf16 v[212:215], v[100:103], v[116:119], v[212:215]
    ds_read_b128 v[56:59], v14 offset:12288
    v_mfma_f32_16x16x32_bf16 v[216:219], v[100:103], v[120:123], v[216:219]
    ds_read_b128 v[60:63], v14 offset:14336
    buffer_load_dwordx4 v11, s[68:71], s33 offen offset:3072 lds
    s_add_u32 s33, s33, 524288
    v_mfma_f32_16x16x32_bf16 v[220:223], v[100:103], v[124:127], v[220:223]
    v_mfma_f32_16x16x32_bf16 v[224:227], v[104:107], v[112:115], v[224:227]
    v_mfma_f32_16x16x32_bf16 v[228:231], v[104:107], v[116:119], v[228:231]
    s_lshl_b32 s24, s2, 2
    s_add_u32 s24, s24, s3
    v_mfma_f32_16x16x32_bf16 v[232:235], v[104:107], v[120:123], v[232:235]
    s_add_u32 s24, s24, -4
    v_mfma_f32_16x16x32_bf16 v[236:239], v[104:107], v[124:127], v[236:239]
    s_mul_i32 s24, s24, 2560
    v_mfma_f32_16x16x32_bf16 v[240:243], v[108:111], v[112:115], v[240:243]
    v_min_u32 v29, 19, v1
    v_mfma_f32_16x16x32_bf16 v[244:247], v[108:111], v[116:119], v[244:247]
    v_lshlrev_b32 v29, 7, v29
    v_mfma_f32_16x16x32_bf16 v[248:251], v[108:111], v[120:123], v[248:251]
    buffer_load_dword v28, v29, s[72:75], s24 offen
    v_mfma_f32_16x16x32_bf16 v[252:255], v[108:111], v[124:127], v[252:255]
    s_waitcnt lgkmcnt(12)
    v_mfma_f32_16x16x32_bf16 v[128:131], v[32:35], v[64:67], v[128:131]
    ds_read_b64_tr_b16 v[112:113], v20 offset:8192
    s_waitcnt lgkmcnt(11)
    v_mfma_f32_16x16x32_bf16 v[132:135], v[32:35], v[68:71], v[132:135]
    ds_read_b64_tr_b16 v[114:115], v20 offset:9216
    s_waitcnt lgkmcnt(10)
    v_mfma_f32_16x16x32_bf16 v[136:139], v[32:35], v[72:75], v[136:139]
    s_waitcnt lgkmcnt(8)
    v_mfma_f32_16x16x32_bf16 v[140:143], v[32:35], v[76:79], v[140:143]
    ds_read_b128 v[80:83], v15 offset:0
    v_mfma_f32_16x16x32_bf16 v[144:147], v[36:39], v[64:67], v[144:147]
    ds_read_b64_tr_b16 v[116:117], v21 offset:8192
    v_mfma_f32_16x16x32_bf16 v[148:151], v[36:39], v[68:71], v[148:151]
    v_mfma_f32_16x16x32_bf16 v[152:155], v[36:39], v[72:75], v[152:155]
    ds_read_b64_tr_b16 v[118:119], v21 offset:9216
    v_mfma_f32_16x16x32_bf16 v[156:159], v[36:39], v[76:79], v[156:159]
    ds_read_b64_tr_b16 v[120:121], v22 offset:8192
    s_waitcnt lgkmcnt(10)
    v_mfma_f32_16x16x32_bf16 v[160:163], v[40:43], v[64:67], v[160:163]
    v_mfma_f32_16x16x32_bf16 v[164:167], v[40:43], v[68:71], v[164:167]
    ds_read_b64_tr_b16 v[122:123], v22 offset:9216
    v_mfma_f32_16x16x32_bf16 v[168:171], v[40:43], v[72:75], v[168:171]
    ds_read_b64_tr_b16 v[124:125], v23 offset:8192
    v_mfma_f32_16x16x32_bf16 v[172:175], v[40:43], v[76:79], v[172:175]
    v_mfma_f32_16x16x32_bf16 v[176:179], v[44:47], v[64:67], v[176:179]
    ds_read_b64_tr_b16 v[126:127], v23 offset:9216
    v_mfma_f32_16x16x32_bf16 v[180:183], v[44:47], v[68:71], v[180:183]
    ds_read_b128 v[84:87], v15 offset:2048
    v_mfma_f32_16x16x32_bf16 v[184:187], v[44:47], v[72:75], v[184:187]
    v_mfma_f32_16x16x32_bf16 v[188:191], v[44:47], v[76:79], v[188:191]
    ds_read_b128 v[88:91], v15 offset:4096
    s_waitcnt lgkmcnt(13)
    v_mfma_f32_16x16x32_bf16 v[192:195], v[48:51], v[64:67], v[192:195]
    ds_read_b128 v[92:95], v15 offset:6144
    v_mfma_f32_16x16x32_bf16 v[196:199], v[48:51], v[68:71], v[196:199]
    v_mfma_f32_16x16x32_bf16 v[200:203], v[48:51], v[72:75], v[200:203]
    ds_read_b128 v[96:99], v15 offset:8192
    v_mfma_f32_16x16x32_bf16 v[204:207], v[48:51], v[76:79], v[204:207]
    ds_read_b128 v[100:103], v15 offset:10240
    v_mfma_f32_16x16x32_bf16 v[208:211], v[52:55], v[64:67], v[208:211]
    v_mfma_f32_16x16x32_bf16 v[212:215], v[52:55], v[68:71], v[212:215]
    ds_read_b128 v[104:107], v15 offset:12288
    v_mfma_f32_16x16x32_bf16 v[216:219], v[52:55], v[72:75], v[216:219]
    ds_read_b128 v[108:111], v15 offset:14336
    v_mfma_f32_16x16x32_bf16 v[220:223], v[52:55], v[76:79], v[220:223]
    s_waitcnt lgkmcnt(15)
    v_mfma_f32_16x16x32_bf16 v[224:227], v[56:59], v[64:67], v[224:227]
    v_mfma_f32_16x16x32_bf16 v[228:231], v[56:59], v[68:71], v[228:231]
    v_mfma_f32_16x16x32_bf16 v[232:235], v[56:59], v[72:75], v[232:235]
    v_mfma_f32_16x16x32_bf16 v[236:239], v[56:59], v[76:79], v[236:239]
    v_mfma_f32_16x16x32_bf16 v[240:243], v[60:63], v[64:67], v[240:243]
    v_mfma_f32_16x16x32_bf16 v[244:247], v[60:63], v[68:71], v[244:247]
    v_mfma_f32_16x16x32_bf16 v[248:251], v[60:63], v[72:75], v[248:251]
    v_mfma_f32_16x16x32_bf16 v[252:255], v[60:63], v[76:79], v[252:255]
    s_waitcnt vmcnt(1) lgkmcnt(0)
    s_barrier
    s_waitcnt vmcnt(9)
    v_readfirstlane_b32 s38, v31
    s_cmp_eq_u32 s38, 0
    s_cbranch_scc1 TAG1_S
TAG1_C:
    v_mfma_f32_16x16x32_bf16 v[128:131], v[80:83], v[112:115], v[128:131]
    ds_read_b64_tr_b16 v[64:65], v16 offset:0
    v_mfma_f32_16x16x32_bf16 v[132:135], v[80:83], v[116:119], v[132:135]
    ds_read_b64_tr_b16 v[66:67], v16 offset:1024
    s_add_u32 m0, s36, 65536
    s_nop 0
    buffer_load_dwordx4 v5, s[64:67], s32 offen offset:0 lds
    v_mfma_f32_16x16x32_bf16 v[136:139], v[80:83], v[120:123], v[136:139]
    v_mfma_f32_16x16x32_bf16 v[140:143], v[80:83], v[124:127], v[140:143]
    ds_read_b128 v[32:35], v12 offset:0
    v_mfma_f32_16x16x32_bf16 v[144:147], v[84:87], v[112:115], v[144:147]
    ds_read_b64_tr_b16 v[68:69], v17 offset:0
    buffer_load_dwordx4 v6, s[64:67], s32 offen offset:1024 lds
    v_mfma_f32_16x16x32_bf16 v[148:151], v[84:87], v[116:119], v[148:151]
    v_mfma_f32_16x16x32_bf16 v[152:155], v[84:87], v[120:123], v[152:155]
    ds_read_b64_tr_b16 v[70:71], v17 offset:1024
    v_mfma_f32_16x16x32_bf16 v[156:159], v[84:87], v[124:127], v[156:159]
    ds_read_b64_tr_b16 v[72:73], v18 offset:0
    buffer_load_dwordx4 v7, s[64:67], s32 offen offset:2048 lds
    v_mfma_f32_16x16x32_bf16 v[160:163], v[88:91], v[112:115], v[160:163]
    v_mfma_f32_16x16x32_bf16 v[164:167], v[88:91], v[116:119], v[164:167]
    ds_read_b64_tr_b16 v[74:75], v18 offset:1024
    v_mfma_f32_16x16x32_bf16 v[168:171], v[88:91], v[120:123], v[168:171]
    ds_read_b64_tr_b16 v[76:77], v19 offset:0
    buffer_load_dwordx4 v30, s[64:67], s32 offen offset:3072 lds
    s_add_u32 s32, s32, 128
    v_mfma_f32_16x16x32_bf16 v[172:175], v[88:91], v[124:127], v[172:175]
    v_mfma_f32_16x16x32_bf16 v[176:179], v[92:95], v[112:115], v[176:179]
    ds_read_b64_tr_b16 v[78:79], v19 offset:1024
    v_mfma_f32_16x16x32_bf16 v[180:183], v[92:95], v[116:119], v[180:183]
    ds_read_b128 v[36:39], v12 offset:2048
    s_add_u32 m0, s37, 65536
    s_nop 0
    buffer_load_dwordx4 v8, s[68:71], s33 offen offset:0 lds
    v_mfma_f32_16x16x32_bf16 v[184:187], v[92:95], v[120:123], v[184:187]
    v_mfma_f32_16x16x32_bf16 v[188:191], v[92:95], v[124:127], v[188:191]
    ds_read_b128 v[40:43], v12 offset:4096
    v_mfma_f32_16x16x32_bf16 v[192:195], v[96:99], v[112:115], v[192:195]
    ds_read_b128 v[44:47], v12 offset:6144
    buffer_load_dwordx4 v9, s[68:71], s33 offen offset:1024 lds
    v_mfma_f32_16x16x32_bf16 v[196:199], v[96:99], v[116:119], v[196:199]
    v_mfma_f32_16x16x32_bf16 v[200:203], v[96:99], v[120:123], v[200:203]
    ds_read_b128 v[48:51], v12 offset:8192
    v_mfma_f32_16x16x32_bf16 v[204:207], v[96:99], v[124:127], v[204:207]
    ds_read_b128 v[52:55], v12 offset:10240
    buffer_load_dwordx4 v10, s[68:71], s33 offen offset:2048 lds
    v_mfma_f32_16x16x32_bf16 v[208:211], v[100:103], v[112:115], v[208:211]
    v_mfma_f32_16x16x32_bf16 v[212:215], v[100:103], v[116:119], v[212:215]
    ds_read_b128 v[56:59], v12 offset:12288
    v_mfma_f32_16x16x32_bf16 v[216:219], v[100:103], v[120:123], v[216:219]
    ds_read_b128 v[60:63], v12 offset:14336
    buffer_load_dwordx4 v11, s[68:71], s33 offen offset:3072 lds
    s_add_u32 s33, s33, 524288
    v_mfma_f32_16x16x32_bf16 v[220:223], v[100:103], v[124:127], v[220:223]
    v_mfma_f32_16x16x32_bf16 v[224:227], v[104:107], v[112:115], v[224:227]
    v_mfma_f32_16x16x32_bf16 v[228:231], v[104:107], v[116:119], v[228:231]
    s_lshl_b32 s24, s2, 2
    s_add_u32 s24, s24, s3
    v_mfma_f32_16x16x32_bf16 v[232:235], v[104:107], v[120:123], v[232:235]
    s_add_u32 s24, s24, 1020
    v_mfma_f32_16x16x32_bf16 v[236:239], v[104:107], v[124:127], v[236:239]
    s_mul_i32 s24, s24, 2560
    v_mfma_f32_16x16x32_bf16 v[240:243], v[108:111], v[112:115], v[240:243]
    v_min_u32 v29, 19, v1
    v_mfma_f32_16x16x32_bf16 v[244:247], v[108:111], v[116:119], v[244:247]
    v_lshlrev_b32 v29, 7, v29
    v_mfma_f32_16x16x32_bf16 v[248:251], v[108:111], v[120:123], v[248:251]
    buffer_load_dword v28, v29, s[72:75], s24 offen
    v_mfma_f32_16x16x32_bf16 v[252:255], v[108:111], v[124:127], v[252:255]
    s_waitcnt lgkmcnt(12)
    v_mfma_f32_16x16x32_bf16 v[128:131], v[32:35], v[64:67], v[128:131]
    ds_read_b64_tr_b16 v[112:113], v16 offset:8192
    s_waitcnt lgkmcnt(11)
    v_mfma_f32_16x16x32_bf16 v[132:135], v[32:35], v[68:71], v[132:135]
    ds_read_b64_tr_b16 v[114:115], v16 offset:9216
    s_waitcnt lgkmcnt(10)
    v_mfma_f32_16x16x32_bf16 v[136:139], v[32:35], v[72:75], v[136:139]
    s_waitcnt lgkmcnt(8)
    v_mfma_f32_16x16x32_bf16 v[140:143], v[32:35], v[76:79], v[140:143]
    ds_read_b128 v[80:83], v13 offset:0
    v_mfma_f32_16x16x32_bf16 v[144:147], v[36:39], v[64:67], v[144:147]
    ds_read_b64_tr_b16 v[116:117], v17 offset:8192
    v_mfma_f32_16x16x32_bf16 v[148:151], v[36:39], v[68:71], v[148:151]
    v_mfma_f32_16x16x32_bf16 v[152:155], v[36:39], v[72:75], v[152:155]
    ds_read_b64_tr_b16 v[118:119], v17 offset:9216
    v_mfma_f32_16x16x32_bf16 v[156:159], v[36:39], v[76:79], v[156:159]
    ds_read_b64_tr_b16 v[120:121], v18 offset:8192
    s_waitcnt lgkmcnt(10)
    v_mfma_f32_16x16x32_bf16 v[160:163], v[40:43], v[64:67], v[160:163]
    v_mfma_f32_16x16x32_bf16 v[164:167], v[40:43], v[68:71], v[164:167]
    ds_read_b64_tr_b16 v[122:123], v18 offset:9216
    v_mfma_f32_16x16x32_bf16 v[168:171], v[40:43], v[72:75], v[168:171]
    ds_read_b64_tr_b16 v[124:125], v19 offset:8192
    v_mfma_f32_16x16x32_bf16 v[172:175], v[40:43], v[76:79], v[172:175]
    v_mfma_f32_16x16x32_bf16 v[176:179], v[44:47], v[64:67], v[176:179]
    ds_read_b64_tr_b16 v[126:127], v19 offset:9216
    v_mfma_f32_16x16x32_bf16 v[180:183], v[44:47], v[68:71], v[180:183]
    ds_read_b128 v[84:87], v13 offset:2048
    v_mfma_f32_16x16x32_bf16 v[184:187], v[44:47], v[72:75], v[184:187]
    v_mfma_f32_16x16x32_bf16 v[188:191], v[44:47], v[76:79], v[188:191]
    ds_read_b128 v[88:91], v13 offset:4096
    s_waitcnt lgkmcnt(13)
    v_mfma_f32_16x16x32_bf16 v[192:195], v[48:51], v[64:67], v[192:195]
    ds_read_b128 v[92:95], v13 offset:6144
    v_mfma_f32_16x16x32_bf16 v[196:199], v[48:51], v[68:71], v[196:199]
    v_mfma_f32_16x16x32_bf16 v[200:203], v[48:51], v[72:75], v[200:203]
    ds_read_b128 v[96:99], v13 offset:8192
    v_mfma_f32_16x16x32_bf16 v[204:207], v[48:51], v[76:79], v[204:207]
    ds_read_b128 v[100:103], v13 offset:10240
    v_mfma_f32_16x16x32_bf16 v[208:211], v[52:55], v[64:67], v[208:211]
    v_mfma_f32_16x16x32_bf16 v[212:215], v[52:55], v[68:71], v[212:215]
    ds_read_b128 v[104:107], v13 offset:12288
    v_mfma_f32_16x16x32_bf16 v[216:219], v[52:55], v[72:75], v[216:219]
    ds_read_b128 v[108:111], v13 offset:14336
    v_mfma_f32_16x16x32_bf16 v[220:223], v[52:55], v[76:79], v[220:223]
    s_waitcnt lgkmcnt(15)
    v_mfma_f32_16x16x32_bf16 v[224:227], v[56:59], v[64:67], v[224:227]
    v_mfma_f32_16x16x32_bf16 v[228:231], v[56:59], v[68:71], v[228:231]
    v_mfma_f32_16x16x32_bf16 v[232:235], v[56:59], v[72:75], v[232:235]
    v_mfma_f32_16x16x32_bf16 v[236:239], v[56:59], v[76:79], v[236:239]
    v_mfma_f32_16x16x32_bf16 v[240:243], v[60:63], v[64:67], v[240:243]
    v_mfma_f32_16x16x32_bf16 v[244:247], v[60:63], v[68:71], v[244:247]
    v_mfma_f32_16x16x32_bf16 v[248:251], v[60:63], v[72:75], v[248:251]
    v_mfma_f32_16x16x32_bf16 v[252:255], v[60:63], v[76:79], v[252:255]
    s_waitcnt vmcnt(1) lgkmcnt(0)
    s_barrier
    v_mfma_f32_16x16x32_bf16 v[128:131], v[80:83], v[112:115], v[128:131]
    ds_read_b64_tr_b16 v[64:65], v20 offset:0
    v_mfma_f32_16x16x32_bf16 v[132:135], v[80:83], v[116:119], v[132:135]
    ds_read_b64_tr_b16 v[66:67], v20 offset:1024
    s_add_u32 m0, s36, 0
    s_nop 0
    buffer_load_dwordx4 v5, s[64:67], s32 offen offset:0 lds
    v_mfma_f32_16x16x32_bf16 v[136:139], v[80:83], v[120:123], v[136:139]
    v_mfma_f32_16x16x32_bf16 v[140:143], v[80:83], v[124:127], v[140:143]
    ds_read_b128 v[32:35], v14 offset:0
    v_mfma_f32_16x16x32_bf16 v[144:147], v[84:87], v[112:115], v[144:147]
    ds_read_b64_tr_b16 v[68:69], v21 offset:0
    buffer_load_dwordx4 v6, s[64:67], s32 offen offset:1024 lds
    v_mfma_f32_16x16x32_bf16 v[148:151], v[84:87], v[116:119], v[148:151]
    v_mfma_f32_16x16x32_bf16 v[152:155], v[84:87], v[120:123], v[152:155]
    ds_read_b64_tr_b16 v[70:71], v21 offset:1024
    v_mfma_f32_16x16x32_bf16 v[156:159], v[84:87], v[124:127], v[156:159]
    ds_read_b64_tr_b16 v[72:73], v22 offset:0
    buffer_load_dwordx4 v7, s[64:67], s32 offen offset:2048 lds
    v_mfma_f32_16x16x32_bf16 v[160:163], v[88:91], v[112:115], v[160:163]
    v_mfma_f32_16x16x32_bf16 v[164:167], v[88:91], v[116:119], v[164:167]
    ds_read_b64_tr_b16 v[74:75], v22 offset:1024
    v_mfma_f32_16x16x32_bf16 v[168:171], v[88:91], v[120:123], v[168:171]
    ds_read_b64_tr_b16 v[76:77], v23 offset:0
    buffer_load_dwordx4 v30, s[64:67], s32 offen offset:3072 lds
    s_add_u32 s32, s32, 128
    v_mfma_f32_16x16x32_bf16 v[172:175], v[88:91], v[124:127], v[172:175]
    v_mfma_f32_16x16x32_bf16 v[176:179], v[92:95], v[112:115], v[176:179]
    ds_read_b64_tr_b16 v[78:79], v23 offset:1024
    v_mfma_f32_16x16x32_bf16 v[180:183], v[92:95], v[116:119], v[180:183]
    ds_read_b128 v[36:39], v14 offset:2048
    s_add_u32 m0, s37, 0
    s_nop 0
    buffer_load_dwordx4 v8, s[68:71], s33 offen offset:0 lds
    v_mfma_f32_16x16x32_bf16 v[184:187], v[92:95], v[120:123], v[184:187]
    v_mfma_f32_16x16x32_bf16 v[188:191], v[92:95], v[124:127], v[188:191]
    ds_read_b128 v[40:43], v14 offset:4096
    v_mfma_f32_16x16x32_bf16 v[192:195], v[96:99], v[112:115], v[192:195]
    ds_read_b128 v[44:47], v14 offset:6144
    buffer_load_dwordx4 v9, s[68:71], s33 offen offset:1024 lds
    v_mfma_f32_16x16x32_bf16 v[196:199], v[96:99], v[116:119], v[196:199]
    v_mfma_f32_16x16x32_bf16 v[200:203], v[96:99], v[120:123], v[200:203]
    ds_read_b128 v[48:51], v14 offset:8192
    v_mfma_f32_16x16x32_bf16 v[204:207], v[96:99], v[124:127], v[204:207]
    ds_read_b128 v[52:55], v14 offset:10240
    buffer_load_dwordx4 v10, s[68:71], s33 offen offset:2048 lds
    v_mfma_f32_16x16x32_bf16 v[208:211], v[100:103], v[112:115], v[208:211]
    v_mfma_f32_16x16x32_bf16 v[212:215], v[100:103], v[116:119], v[212:215]
    ds_read_b128 v[56:59], v14 offset:12288
    v_mfma_f32_16x16x32_bf16 v[216:219], v[100:103], v[120:123], v[216:219]
    ds_read_b128 v[60:63], v14 offset:14336
    buffer_load_dwordx4 v11, s[68:71], s33 offen offset:3072 lds
    s_add_u32 s33, s33, 524288
    v_mfma_f32_16x16x32_bf16 v[220:223], v[100:103], v[124:127], v[220:223]
    v_mfma_f32_16x16x32_bf16 v[224:227], v[104:107], v[112:115], v[224:227]
    v_mfma_f32_16x16x32_bf16 v[228:231], v[104:107], v[116:119], v[228:231]
    v_mfma_f32_16x16x32_bf16 v[232:235], v[104:107], v[120:123], v[232:235]
    v_mfma_f32_16x16x32_bf16 v[236:239], v[104:107], v[124:127], v[236:239]
    v_mfma_f32_16x16x32_bf16 v[240:243], v[108:111], v[112:115], v[240:243]
    v_mfma_f32_16x16x32_bf16 v[244:247], v[108:111], v[116:119], v[244:247]
    v_mfma_f32_16x16x32_bf16 v[248:251], v[108:111], v[120:123], v[248:251]
    v_mfma_f32_16x16x32_bf16 v[252:255], v[108:111], v[124:127], v[252:255]
    s_waitcnt lgkmcnt(12)
    v_mfma_f32_16x16x32_bf16 v[128:131], v[32:35], v[64:67], v[128:131]
    ds_read_b64_tr_b16 v[112:113], v20 offset:8192
    s_waitcnt lgkmcnt(11)
    v_mfma_f32_16x16x32_bf16 v[132:135], v[32:35], v[68:71], v[132:135]
    ds_read_b64_tr_b16 v[114:115], v20 offset:9216
    s_waitcnt lgkmcnt(10)
    v_mfma_f32_16x16x32_bf16 v[136:139], v[32:35], v[72:75], v[136:139]
    s_waitcnt lgkmcnt(8)
    v_mfma_f32_16x16x32_bf16 v[140:143], v[32:35], v[76:79], v[140:143]
    ds_read_b128 v[80:83], v15 offset:0
    v_mfma_f32_16x16x32_bf16 v[144:147], v[36:39], v[64:67], v[144:147]
    ds_read_b64_tr_b16 v[116:117], v21 offset:8192
    v_mfma_f32_16x16x32_bf16 v[148:151], v[36:39], v[68:71], v[148:151]
    v_mfma_f32_16x16x32_bf16 v[152:155], v[36:39], v[72:75], v[152:155]
    ds_read_b64_tr_b16 v[118:119], v21 offset:9216
    v_mfma_f32_16x16x32_bf16 v[156:159], v[36:39], v[76:79], v[156:159]
    ds_read_b64_tr_b16 v[120:121], v22 offset:8192
    s_waitcnt lgkmcnt(10)
    v_mfma_f32_16x16x32_bf16 v[160:163], v[40:43], v[64:67], v[160:163]
    v_mfma_f32_16x16x32_bf16 v[164:167], v[40:43], v[68:71], v[164:167]
    ds_read_b64_tr_b16 v[122:123], v22 offset:9216
    v_mfma_f32_16x16x32_bf16 v[168:171], v[40:43], v[72:75], v[168:171]
    ds_read_b64_tr_b16 v[124:125], v23 offset:8192
    v_mfma_f32_16x16x32_bf16 v[172:175], v[40:43], v[76:79], v[172:175]
    v_mfma_f32_16x16x32_bf16 v[176:179], v[44:47], v[64:67], v[176:179]
    ds_read_b64_tr_b16 v[126:127], v23 offset:9216
    v_mfma_f32_16x16x32_bf16 v[180:183], v[44:47], v[68:71], v[180:183]
    ds_read_b128 v[84:87], v15 offset:2048
    v_mfma_f32_16x16x32_bf16 v[184:187], v[44:47], v[72:75], v[184:187]
    v_mfma_f32_16x16x32_bf16 v[188:191], v[44:47], v[76:79], v[188:191]
    ds_read_b128 v[88:91], v15 offset:4096
    s_waitcnt lgkmcnt(13)
    v_mfma_f32_16x16x32_bf16 v[192:195], v[48:51], v[64:67], v[192:195]
    ds_read_b128 v[92:95], v15 offset:6144
    v_mfma_f32_16x16x32_bf16 v[196:199], v[48:51], v[68:71], v[196:199]
    v_mfma_f32_16x16x32_bf16 v[200:203], v[48:51], v[72:75], v[200:203]
    ds_read_b128 v[96:99], v15 offset:8192
    v_mfma_f32_16x16x32_bf16 v[204:207], v[48:51], v[76:79], v[204:207]
    ds_read_b128 v[100:103], v15 offset:10240
    v_mfma_f32_16x16x32_bf16 v[208:211], v[52:55], v[64:67], v[208:211]
    v_mfma_f32_16x16x32_bf16 v[212:215], v[52:55], v[68:71], v[212:215]
    ds_read_b128 v[104:107], v15 offset:12288
    v_mfma_f32_16x16x32_bf16 v[216:219], v[52:55], v[72:75], v[216:219]
    ds_read_b128 v[108:111], v15 offset:14336
    v_mfma_f32_16x16x32_bf16 v[220:223], v[52:55], v[76:79], v[220:223]
    s_waitcnt lgkmcnt(15)
    v_mfma_f32_16x16x32_bf16 v[224:227], v[56:59], v[64:67], v[224:227]
    v_mfma_f32_16x16x32_bf16 v[228:231], v[56:59], v[68:71], v[228:231]
    v_mfma_f32_16x16x32_bf16 v[232:235], v[56:59], v[72:75], v[232:235]
    v_mfma_f32_16x16x32_bf16 v[236:239], v[56:59], v[76:79], v[236:239]
    v_mfma_f32_16x16x32_bf16 v[240:243], v[60:63], v[64:67], v[240:243]
    v_mfma_f32_16x16x32_bf16 v[244:247], v[60:63], v[68:71], v[244:247]
    v_mfma_f32_16x16x32_bf16 v[248:251], v[60:63], v[72:75], v[248:251]
    v_mfma_f32_16x16x32_bf16 v[252:255], v[60:63], v[76:79], v[252:255]
    s_waitcnt vmcnt(0) lgkmcnt(0)
    s_barrier
    v_mfma_f32_16x16x32_bf16 v[128:131], v[80:83], v[112:115], v[128:131]
    ds_read_b64_tr_b16 v[64:65], v16 offset:0
    v_mfma_f32_16x16x32_bf16 v[132:135], v[80:83], v[116:119], v[132:135]
    ds_read_b64_tr_b16 v[66:67], v16 offset:1024
    s_add_u32 m0, s36, 65536
    s_nop 0
    buffer_load_dwordx4 v5, s[64:67], s32 offen offset:0 lds
    v_mfma_f32_16x16x32_bf16 v[136:139], v[80:83], v[120:123], v[136:139]
    v_mfma_f32_16x16x32_bf16 v[140:143], v[80:83], v[124:127], v[140:143]
    ds_read_b128 v[32:35], v12 offset:0
    v_mfma_f32_16x16x32_bf16 v[144:147], v[84:87], v[112:115], v[144:147]
    ds_read_b64_tr_b16 v[68:69], v17 offset:0
    buffer_load_dwordx4 v6, s[64:67], s32 offen offset:1024 lds
    v_mfma_f32_16x16x32_bf16 v[148:151], v[84:87], v[116:119], v[148:151]
    v_mfma_f32_16x16x32_bf16 v[152:155], v[84:87], v[120:123], v[152:155]
    ds_read_b64_tr_b16 v[70:71], v17 offset:1024
    v_mfma_f32_16x16x32_bf16 v[156:159], v[84:87], v[124:127], v[156:159]
    ds_read_b64_tr_b16 v[72:73], v18 offset:0
    buffer_load_dwordx4 v7, s[64:67], s32 offen offset:2048 lds
    v_mfma_f32_16x16x32_bf16 v[160:163], v[88:91], v[112:115], v[160:163]
    v_mfma_f32_16x16x32_bf16 v[164:167], v[88:91], v[116:119], v[164:167]
    ds_read_b64_tr_b16 v[74:75], v18 offset:1024
    v_mfma_f32_16x16x32_bf16 v[168:171], v[88:91], v[120:123], v[168:171]
    ds_read_b64_tr_b16 v[76:77], v19 offset:0
    buffer_load_dwordx4 v30, s[64:67], s32 offen offset:3072 lds
    s_add_u32 s32, s32, 128
    v_mfma_f32_16x16x32_bf16 v[172:175], v[88:91], v[124:127], v[172:175]
    v_mfma_f32_16x16x32_bf16 v[176:179], v[92:95], v[112:115], v[176:179]
    ds_read_b64_tr_b16 v[78:79], v19 offset:1024
    v_mfma_f32_16x16x32_bf16 v[180:183], v[92:95], v[116:119], v[180:183]
    ds_read_b128 v[36:39], v12 offset:2048
    s_add_u32 m0, s37, 65536
    s_nop 0
    buffer_load_dwordx4 v8, s[68:71], s33 offen offset:0 lds
    v_mfma_f32_16x16x32_bf16 v[184:187], v[92:95], v[120:123], v[184:187]
    v_mfma_f32_16x16x32_bf16 v[188:191], v[92:95], v[124:127], v[188:191]
    ds_read_b128 v[40:43], v12 offset:4096
    v_mfma_f32_16x16x32_bf16 v[192:195], v[96:99], v[112:115], v[192:195]
    ds_read_b128 v[44:47], v12 offset:6144
    buffer_load_dwordx4 v9, s[68:71], s33 offen offset:1024 lds
    v_mfma_f32_16x16x32_bf16 v[196:199], v[96:99], v[116:119], v[196:199]
    v_mfma_f32_16x16x32_bf16 v[200:203], v[96:99], v[120:123], v[200:203]
    ds_read_b128 v[48:51], v12 offset:8192
    v_mfma_f32_16x16x32_bf16 v[204:207], v[96:99], v[124:127], v[204:207]
    ds_read_b128 v[52:55], v12 offset:10240
    buffer_load_dwordx4 v10, s[68:71], s33 offen offset:2048 lds
    v_mfma_f32_16x16x32_bf16 v[208:211], v[100:103], v[112:115], v[208:211]
    v_mfma_f32_16x16x32_bf16 v[212:215], v[100:103], v[116:119], v[212:215]
    ds_read_b128 v[56:59], v12 offset:12288
    v_mfma_f32_16x16x32_bf16 v[216:219], v[100:103], v[120:123], v[216:219]
    ds_read_b128 v[60:63], v12 offset:14336
    buffer_load_dwordx4 v11, s[68:71], s33 offen offset:3072 lds
    s_add_u32 s33, s33, 524288
    v_mfma_f32_16x16x32_bf16 v[220:223], v[100:103], v[124:127], v[220:223]
    v_mfma_f32_16x16x32_bf16 v[224:227], v[104:107], v[112:115], v[224:227]
    v_mfma_f32_16x16x32_bf16 v[228:231], v[104:107], v[116:119], v[228:231]
    v_mfma_f32_16x16x32_bf16 v[232:235], v[104:107], v[120:123], v[232:235]
    v_mfma_f32_16x16x32_bf16 v[236:239], v[104:107], v[124:127], v[236:239]
    v_mfma_f32_16x16x32_bf16 v[240:243], v[108:111], v[112:115], v[240:243]
    v_mfma_f32_16x16x32_bf16 v[244:247], v[108:111], v[116:119], v[244:247]
    v_mfma_f32_16x16x32_bf16 v[248:251], v[108:111], v[120:123], v[248:251]
    v_mfma_f32_16x16x32_bf16 v[252:255], v[108:111], v[124:127], v[252:255]
    s_waitcnt lgkmcnt(12)
    v_mfma_f32_16x16x32_bf16 v[128:131], v[32:35], v[64:67], v[128:131]
    ds_read_b64_tr_b16 v[112:113], v16 offset:8192
    s_waitcnt lgkmcnt(11)
    v_mfma_f32_16x16x32_bf16 v[132:135], v[32:35], v[68:71], v[132:135]
    ds_read_b64_tr_b16 v[114:115], v16 offset:9216
    s_waitcnt lgkmcnt(10)
    v_mfma_f32_16x16x32_bf16 v[136:139], v[32:35], v[72:75], v[136:139]
    s_waitcnt lgkmcnt(8)
    v_mfma_f32_16x16x32_bf16 v[140:143], v[32:35], v[76:79], v[140:143]
    ds_read_b128 v[80:83], v13 offset:0
    v_mfma_f32_16x16x32_bf16 v[144:147], v[36:39], v[64:67], v[144:147]
    ds_read_b64_tr_b16 v[116:117], v17 offset:8192
    v_mfma_f32_16x16x32_bf16 v[148:151], v[36:39], v[68:71], v[148:151]
    v_mfma_f32_16x16x32_bf16 v[152:155], v[36:39], v[72:75], v[152:155]
    ds_read_b64_tr_b16 v[118:119], v17 offset:9216
    v_mfma_f32_16x16x32_bf16 v[156:159], v[36:39], v[76:79], v[156:159]
    ds_read_b64_tr_b16 v[120:121], v18 offset:8192
    s_waitcnt lgkmcnt(10)
    v_mfma_f32_16x16x32_bf16 v[160:163], v[40:43], v[64:67], v[160:163]
    v_mfma_f32_16x16x32_bf16 v[164:167], v[40:43], v[68:71], v[164:167]
    ds_read_b64_tr_b16 v[122:123], v18 offset:9216
    v_mfma_f32_16x16x32_bf16 v[168:171], v[40:43], v[72:75], v[168:171]
    ds_read_b64_tr_b16 v[124:125], v19 offset:8192
    v_mfma_f32_16x16x32_bf16 v[172:175], v[40:43], v[76:79], v[172:175]
    v_mfma_f32_16x16x32_bf16 v[176:179], v[44:47], v[64:67], v[176:179]
    ds_read_b64_tr_b16 v[126:127], v19 offset:9216
    v_mfma_f32_16x16x32_bf16 v[180:183], v[44:47], v[68:71], v[180:183]
    ds_read_b128 v[84:87], v13 offset:2048
    v_mfma_f32_16x16x32_bf16 v[184:187], v[44:47], v[72:75], v[184:187]
    v_mfma_f32_16x16x32_bf16 v[188:191], v[44:47], v[76:79], v[188:191]
    ds_read_b128 v[88:91], v13 offset:4096
    s_waitcnt lgkmcnt(13)
    v_mfma_f32_16x16x32_bf16 v[192:195], v[48:51], v[64:67], v[192:195]
    ds_read_b128 v[92:95], v13 offset:6144
    v_mfma_f32_16x16x32_bf16 v[196:199], v[48:51], v[68:71], v[196:199]
    v_mfma_f32_16x16x32_bf16 v[200:203], v[48:51], v[72:75], v[200:203]
    ds_read_b128 v[96:99], v13 offset:8192
    v_mfma_f32_16x16x32_bf16 v[204:207], v[48:51], v[76:79], v[204:207]
    ds_read_b128 v[100:103], v13 offset:10240
    v_mfma_f32_16x16x32_bf16 v[208:211], v[52:55], v[64:67], v[208:211]
    v_mfma_f32_16x16x32_bf16 v[212:215], v[52:55], v[68:71], v[212:215]
    ds_read_b128 v[104:107], v13 offset:12288
    v_mfma_f32_16x16x32_bf16 v[216:219], v[52:55], v[72:75], v[216:219]
    ds_read_b128 v[108:111], v13 offset:14336
    v_mfma_f32_16x16x32_bf16 v[220:223], v[52:55], v[76:79], v[220:223]
    s_waitcnt lgkmcnt(15)
    v_mfma_f32_16x16x32_bf16 v[224:227], v[56:59], v[64:67], v[224:227]
    v_mfma_f32_16x16x32_bf16 v[228:231], v[56:59], v[68:71], v[228:231]
    v_mfma_f32_16x16x32_bf16 v[232:235], v[56:59], v[72:75], v[232:235]
    v_mfma_f32_16x16x32_bf16 v[236:239], v[56:59], v[76:79], v[236:239]
    v_mfma_f32_16x16x32_bf16 v[240:243], v[60:63], v[64:67], v[240:243]
    v_mfma_f32_16x16x32_bf16 v[244:247], v[60:63], v[68:71], v[244:247]
    v_mfma_f32_16x16x32_bf16 v[248:251], v[60:63], v[72:75], v[248:251]
    v_mfma_f32_16x16x32_bf16 v[252:255], v[60:63], v[76:79], v[252:255]
    s_waitcnt vmcnt(0) lgkmcnt(0)
    s_barrier
    v_mfma_f32_16x16x32_bf16 v[128:131], v[80:83], v[112:115], v[128:131]
    ds_read_b64_tr_b16 v[64:65], v20 offset:0
    v_mfma_f32_16x16x32_bf16 v[132:135], v[80:83], v[116:119], v[132:135]
    ds_read_b64_tr_b16 v[66:67], v20 offset:1024
    s_add_u32 m0, s36, 0
    s_nop 0
    buffer_load_dwordx4 v24, s[60:63], s34 offen offset:0 lds
    v_mfma_f32_16x16x32_bf16 v[136:139], v[80:83], v[120:123], v[136:139]
    v_mfma_f32_16x16x32_bf16 v[140:143], v[80:83], v[124:127], v[140:143]
    ds_read_b128 v[32:35], v14 offset:0
    v_mfma_f32_16x16x32_bf16 v[144:147], v[84:87], v[112:115], v[144:147]
    ds_read_b64_tr_b16 v[68:69], v21 offset:0
    buffer_load_dwordx4 v25, s[60:63], s34 offen offset:1024 lds
    v_mfma_f32_16x16x32_bf16 v[148:151], v[84:87], v[116:119], v[148:151]
    v_mfma_f32_16x16x32_bf16 v[152:155], v[84:87], v[120:123], v[152:155]
    ds_read_b64_tr_b16 v[70:71], v21 offset:1024
    v_mfma_f32_16x16x32_bf16 v[156:159], v[84:87], v[124:127], v[156:159]
    ds_read_b64_tr_b16 v[72:73], v22 offset:0
    buffer_load_dwordx4 v26, s[60:63], s34 offen offset:2048 lds
    v_mfma_f32_16x16x32_bf16 v[160:163], v[88:91], v[112:115], v[160:163]
    v_mfma_f32_16x16x32_bf16 v[164:167], v[88:91], v[116:119], v[164:167]
    ds_read_b64_tr_b16 v[74:75], v22 offset:1024
    v_mfma_f32_16x16x32_bf16 v[168:171], v[88:91], v[120:123], v[168:171]
    ds_read_b64_tr_b16 v[76:77], v23 offset:0
    buffer_load_dwordx4 v27, s[60:63], s34 offen offset:3072 lds
    s_add_u32 s34, s34, 128
    v_mfma_f32_16x16x32_bf16 v[172:175], v[88:91], v[124:127], v[172:175]
    v_mfma_f32_16x16x32_bf16 v[176:179], v[92:95], v[112:115], v[176:179]
    ds_read_b64_tr_b16 v[78:79], v23 offset:1024
    v_mfma_f32_16x16x32_bf16 v[180:183], v[92:95], v[116:119], v[180:183]
    ds_read_b128 v[36:39], v14 offset:2048
    s_add_u32 m0, s37, 0
    s_nop 0
    buffer_load_dwordx4 v8, s[72:75], s35 offen offset:0 lds
    v_mfma_f32_16x16x32_bf16 v[184:187], v[92:95], v[120:123], v[184:187]
    v_mfma_f32_16x16x32_bf16 v[188:191], v[92:95], v[124:127], v[188:191]
    ds_read_b128 v[40:43], v14 offset:4096
    v_mfma_f32_16x16x32_bf16 v[192:195], v[96:99], v[112:115], v[192:195]
    ds_read_b128 v[44:47], v14 offset:6144
    buffer_load_dwordx4 v9, s[72:75], s35 offen offset:1024 lds
    v_mfma_f32_16x16x32_bf16 v[196:199], v[96:99], v[116:119], v[196:199]
    v_mfma_f32_16x16x32_bf16 v[200:203], v[96:99], v[120:123], v[200:203]
    ds_read_b128 v[48:51], v14 offset:8192
    v_mfma_f32_16x16x32_bf16 v[204:207], v[96:99], v[124:127], v[204:207]
    ds_read_b128 v[52:55], v14 offset:10240
    buffer_load_dwordx4 v10, s[72:75], s35 offen offset:2048 lds
    v_mfma_f32_16x16x32_bf16 v[208:211], v[100:103], v[112:115], v[208:211]
    v_mfma_f32_16x16x32_bf16 v[212:215], v[100:103], v[116:119], v[212:215]
    ds_read_b128 v[56:59], v14 offset:12288
    v_mfma_f32_16x16x32_bf16 v[216:219], v[100:103], v[120:123], v[216:219]
    ds_read_b128 v[60:63], v14 offset:14336
    buffer_load_dwordx4 v11, s[72:75], s35 offen offset:3072 lds
    s_add_u32 s35, s35, 524288
    v_mfma_f32_16x16x32_bf16 v[220:223], v[100:103], v[124:127], v[220:223]
    v_mfma_f32_16x16x32_bf16 v[224:227], v[104:107], v[112:115], v[224:227]
    v_mfma_f32_16x16x32_bf16 v[228:231], v[104:107], v[116:119], v[228:231]
    v_mfma_f32_16x16x32_bf16 v[232:235], v[104:107], v[120:123], v[232:235]
    v_mfma_f32_16x16x32_bf16 v[236:239], v[104:107], v[124:127], v[236:239]
    v_mfma_f32_16x16x32_bf16 v[240:243], v[108:111], v[112:115], v[240:243]
    v_mfma_f32_16x16x32_bf16 v[244:247], v[108:111], v[116:119], v[244:247]
    v_mfma_f32_16x16x32_bf16 v[248:251], v[108:111], v[120:123], v[248:251]
    v_mfma_f32_16x16x32_bf16 v[252:255], v[108:111], v[124:127], v[252:255]
    s_waitcnt lgkmcnt(12)
    v_mfma_f32_16x16x32_bf16 v[128:131], v[32:35], v[64:67], v[128:131]
    ds_read_b64_tr_b16 v[112:113], v20 offset:8192
    s_waitcnt lgkmcnt(11)
    v_mfma_f32_16x16x32_bf16 v[132:135], v[32:35], v[68:71], v[132:135]
    ds_read_b64_tr_b16 v[114:115], v20 offset:9216
    s_waitcnt lgkmcnt(10)
    v_mfma_f32_16x16x32_bf16 v[136:139], v[32:35], v[72:75], v[136:139]
    s_waitcnt lgkmcnt(8)
    v_mfma_f32_16x16x32_bf16 v[140:143], v[32:35], v[76:79], v[140:143]
    ds_read_b128 v[80:83], v15 offset:0
    v_mfma_f32_16x16x32_bf16 v[144:147], v[36:39], v[64:67], v[144:147]
    ds_read_b64_tr_b16 v[116:117], v21 offset:8192
    v_mfma_f32_16x16x32_bf16 v[148:151], v[36:39], v[68:71], v[148:151]
    v_mfma_f32_16x16x32_bf16 v[152:155], v[36:39], v[72:75], v[152:155]
    ds_read_b64_tr_b16 v[118:119], v21 offset:9216
    v_mfma_f32_16x16x32_bf16 v[156:159], v[36:39], v[76:79], v[156:159]
    ds_read_b64_tr_b16 v[120:121], v22 offset:8192
    s_waitcnt lgkmcnt(10)
    v_mfma_f32_16x16x32_bf16 v[160:163], v[40:43], v[64:67], v[160:163]
    v_mfma_f32_16x16x32_bf16 v[164:167], v[40:43], v[68:71], v[164:167]
    ds_read_b64_tr_b16 v[122:123], v22 offset:9216
    v_mfma_f32_16x16x32_bf16 v[168:171], v[40:43], v[72:75], v[168:171]
    ds_read_b64_tr_b16 v[124:125], v23 offset:8192
    v_mfma_f32_16x16x32_bf16 v[172:175], v[40:43], v[76:79], v[172:175]
    v_mfma_f32_16x16x32_bf16 v[176:179], v[44:47], v[64:67], v[176:179]
    ds_read_b64_tr_b16 v[126:127], v23 offset:9216
    v_mfma_f32_16x16x32_bf16 v[180:183], v[44:47], v[68:71], v[180:183]
    ds_read_b128 v[84:87], v15 offset:2048
    v_mfma_f32_16x16x32_bf16 v[184:187], v[44:47], v[72:75], v[184:187]
    v_mfma_f32_16x16x32_bf16 v[188:191], v[44:47], v[76:79], v[188:191]
    ds_read_b128 v[88:91], v15 offset:4096
    s_waitcnt lgkmcnt(13)
    v_mfma_f32_16x16x32_bf16 v[192:195], v[48:51], v[64:67], v[192:195]
    ds_read_b128 v[92:95], v15 offset:6144
    v_mfma_f32_16x16x32_bf16 v[196:199], v[48:51], v[68:71], v[196:199]
    v_mfma_f32_16x16x32_bf16 v[200:203], v[48:51], v[72:75], v[200:203]
    ds_read_b128 v[96:99], v15 offset:8192
    v_mfma_f32_16x16x32_bf16 v[204:207], v[48:51], v[76:79], v[204:207]
    ds_read_b128 v[100:103], v15 offset:10240
    v_mfma_f32_16x16x32_bf16 v[208:211], v[52:55], v[64:67], v[208:211]
    v_mfma_f32_16x16x32_bf16 v[212:215], v[52:55], v[68:71], v[212:215]
    ds_read_b128 v[104:107], v15 offset:12288
    v_mfma_f32_16x16x32_bf16 v[216:219], v[52:55], v[72:75], v[216:219]
    ds_read_b128 v[108:111], v15 offset:14336
    v_mfma_f32_16x16x32_bf16 v[220:223], v[52:55], v[76:79], v[220:223]
    s_waitcnt lgkmcnt(15)
    v_mfma_f32_16x16x32_bf16 v[224:227], v[56:59], v[64:67], v[224:227]
    s_lshl_b32 s40, s6, 19
    s_add_u32 s40, s40, 0x1000000
    v_mfma_f32_16x16x32_bf16 v[228:231], v[56:59], v[68:71], v[228:231]
    s_lshl_b32 s24, s7, 16
    s_add_u32 s40, s40, s24
    v_mfma_f32_16x16x32_bf16 v[232:235], v[56:59], v[72:75], v[232:235]
    s_lshr_b32 s24, s3, 1
    v_mfma_f32_16x16x32_bf16 v[236:239], v[56:59], v[76:79], v[236:239]
    s_and_b32 s24, s24, 1
    s_lshl_b32 s24, s24, 15
    v_mfma_f32_16x16x32_bf16 v[240:243], v[60:63], v[64:67], v[240:243]
    s_add_u32 s40, s40, s24
    v_mfma_f32_16x16x32_bf16 v[244:247], v[60:63], v[68:71], v[244:247]
    s_and_b32 s24, s3, 1
    s_lshl_b32 s24, s24, 12
    v_mfma_f32_16x16x32_bf16 v[248:251], v[60:63], v[72:75], v[248:251]
    s_add_u32 s40, s40, s24
    v_mfma_f32_16x16x32_bf16 v[252:255], v[60:63], v[76:79], v[252:255]
    s_waitcnt vmcnt(0) lgkmcnt(0)
    s_barrier
    v_mfma_f32_16x16x32_bf16 v[240:243], v[108:111], v[112:115], v[240:243]
    v_mfma_f32_16x16x32_bf16 v[244:247], v[108:111], v[116:119], v[244:247]
    s_add_u32 m0, s36, 65536
    s_nop 0
    buffer_load_dwordx4 v24, s[60:63], s34 offen offset:0 lds
    v_mfma_f32_16x16x32_bf16 v[248:251], v[108:111], v[120:123], v[248:251]
    ds_read_b64_tr_b16 v[32:33], v16 offset:0
    v_mfma_f32_16x16x32_bf16 v[252:255], v[108:111], v[124:127], v[252:255]
    ds_read_b64_tr_b16 v[34:35], v16 offset:1024
    v_mfma_f32_16x16x32_bf16 v[224:227], v[104:107], v[112:115], v[224:227]
    buffer_load_dwordx4 v25, s[60:63], s34 offen offset:1024 lds
    v_mfma_f32_16x16x32_bf16 v[228:231], v[104:107], v[116:119], v[228:231]
    ds_read_b128 v[64:67], v12 offset:0
    v_mfma_f32_16x16x32_bf16 v[232:235], v[104:107], v[120:123], v[232:235]
    v_mfma_f32_16x16x32_bf16 v[236:239], v[104:107], v[124:127], v[236:239]
    buffer_load_dwordx4 v26, s[60:63], s34 offen offset:2048 lds
    ds_read_b64_tr_b16 v[36:37], v17 offset:0
    v_mfma_f32_16x16x32_bf16 v[208:211], v[100:103], v[112:115], v[208:211]
    v_mfma_f32_16x16x32_bf16 v[212:215], v[100:103], v[116:119], v[212:215]
    ds_read_b64_tr_b16 v[38:39], v17 offset:1024
    v_mfma_f32_16x16x32_bf16 v[216:219], v[100:103], v[120:123], v[216:219]
    buffer_load_dwordx4 v27, s[60:63], s34 offen offset:3072 lds
    s_add_u32 s34, s34, 128
    v_mfma_f32_16x16x32_bf16 v[220:223], v[100:103], v[124:127], v[220:223]
    ds_read_b64_tr_b16 v[40:41], v18 offset:0
    v_mfma_f32_16x16x32_bf16 v[192:195], v[96:99], v[112:115], v[192:195]
    v_mfma_f32_16x16x32_bf16 v[196:199], v[96:99], v[116:119], v[196:199]
    s_add_u32 m0, s37, 65536
    s_nop 0
    buffer_load_dwordx4 v8, s[72:75], s35 offen offset:0 lds
    ds_read_b64_tr_b16 v[42:43], v18 offset:1024
    v_mfma_f32_16x16x32_bf16 v[200:203], v[96:99], v[120:123], v[200:203]
    ds_read_b64_tr_b16 v[44:45], v19 offset:0
    v_mfma_f32_16x16x32_bf16 v[204:207], v[96:99], v[124:127], v[204:207]
    v_mfma_f32_16x16x32_bf16 v[176:179], v[92:95], v[112:115], v[176:179]
    buffer_load_dwordx4 v9, s[72:75], s35 offen offset:1024 lds
    ds_read_b64_tr_b16 v[46:47], v19 offset:1024
    v_mfma_f32_16x16x32_bf16 v[180:183], v[92:95], v[116:119], v[180:183]
    v_mfma_f32_16x16x32_bf16 v[184:187], v[92:95], v[120:123], v[184:187]
    ds_read_b128 v[68:71], v12 offset:2048
    v_mfma_f32_16x16x32_bf16 v[188:191], v[92:95], v[124:127], v[188:191]
    buffer_load_dwordx4 v10, s[72:75], s35 offen offset:2048 lds
    v_mfma_f32_16x16x32_bf16 v[160:163], v[88:91], v[112:115], v[160:163]
    ds_read_b128 v[72:75], v12 offset:4096
    v_mfma_f32_16x16x32_bf16 v[164:167], v[88:91], v[116:119], v[164:167]
    v_mfma_f32_16x16x32_bf16 v[168:171], v[88:91], v[120:123], v[168:171]
    buffer_load_dwordx4 v11, s[72:75], s35 offen offset:3072 lds
    s_add_u32 s35, s35, 524288
    ds_read_b128 v[76:79], v12 offset:6144
    v_mfma_f32_16x16x32_bf16 v[172:175], v[88:91], v[124:127], v[172:175]
    v_mfma_f32_16x16x32_bf16 v[144:147], v[84:87], v[112:115], v[144:147]
    v_mfma_f32_16x16x32_bf16 v[148:151], v[84:87], v[116:119], v[148:151]
    v_mfma_f32_16x16x32_bf16 v[152:155], v[84:87], v[120:123], v[152:155]
    v_mfma_f32_16x16x32_bf16 v[156:159], v[84:87], v[124:127], v[156:159]
    v_mfma_f32_16x16x32_bf16 v[128:131], v[80:83], v[112:115], v[128:131]
    v_mfma_f32_16x16x32_bf16 v[132:135], v[80:83], v[116:119], v[132:135]
    v_mfma_f32_16x16x32_bf16 v[136:139], v[80:83], v[120:123], v[136:139]
    v_mfma_f32_16x16x32_bf16 v[140:143], v[80:83], v[124:127], v[140:143]
    s_waitcnt lgkmcnt(8)
    v_mfma_f32_16x16x32_bf16 v[80:83], v[32:35], v[64:67], 0
    v_cvt_pk_bf16_f32 v255, v254, v255
    v_cvt_pk_bf16_f32 v254, v252, v253
    v_cvt_pk_bf16_f32 v253, v238, v239
    v_cvt_pk_bf16_f32 v252, v236, v237
    v_cvt_pk_bf16_f32 v251, v250, v251
    v_cvt_pk_bf16_f32 v250, v248, v249
    s_waitcnt lgkmcnt(6)
    v_mfma_f32_16x16x32_bf16 v[84:87], v[36:39], v[64:67], 0
    v_cvt_pk_bf16_f32 v249, v234, v235
    v_cvt_pk_bf16_f32 v248, v232, v233
    v_cvt_pk_bf16_f32 v247, v246, v247
    v_cvt_pk_bf16_f32 v246, v244, v245
    v_cvt_pk_bf16_f32 v245, v230, v231
    v_cvt_pk_bf16_f32 v244, v228, v229
    s_waitcnt lgkmcnt(4)
    v_mfma_f32_16x16x32_bf16 v[88:91], v[40:43], v[64:67], 0
    v_cvt_pk_bf16_f32 v243, v242, v243
    v_cvt_pk_bf16_f32 v242, v240, v241
    v_cvt_pk_bf16_f32 v241, v226, v227
    v_cvt_pk_bf16_f32 v240, v224, v225
    v_cvt_pk_bf16_f32 v239, v222, v223
    v_cvt_pk_bf16_f32 v238, v220, v221
    s_waitcnt lgkmcnt(2)
    v_mfma_f32_16x16x32_bf16 v[92:95], v[44:47], v[64:67], 0
    ds_read_b128 v[64:67], v12 offset:8192
    v_cvt_pk_bf16_f32 v237, v206, v207
    v_cvt_pk_bf16_f32 v236, v204, v205
    v_cvt_pk_bf16_f32 v235, v218, v219
    v_cvt_pk_bf16_f32 v234, v216, v217
    v_cvt_pk_bf16_f32 v233, v202, v203
    v_cvt_pk_bf16_f32 v232, v200, v201
    v_mfma_f32_16x16x32_bf16 v[96:99], v[32:35], v[68:71], 0
    v_cvt_pk_bf16_f32 v231, v214, v215
    v_cvt_pk_bf16_f32 v230, v212, v213
    v_cvt_pk_bf16_f32 v229, v198, v199
    v_cvt_pk_bf16_f32 v228, v196, v197
    v_cvt_pk_bf16_f32 v227, v210, v211
    v_cvt_pk_bf16_f32 v226, v208, v209
    v_mfma_f32_16x16x32_bf16 v[100:103], v[36:39], v[68:71], 0
    ds_read_b64_tr_b16 v[48:49], v16 offset:8192
    v_cvt_pk_bf16_f32 v225, v194, v195
    v_cvt_pk_bf16_f32 v224, v192, v193
    v_cvt_pk_bf16_f32 v223, v190, v191
    v_cvt_pk_bf16_f32 v222, v188, v189
    v_cvt_pk_bf16_f32 v221, v174, v175
    v_mfma_f32_16x16x32_bf16 v[104:107], v[40:43], v[68:71], 0
    v_cvt_pk_bf16_f32 v220, v172, v173
    v_cvt_pk_bf16_f32 v219, v186, v187
    v_cvt_pk_bf16_f32 v218, v184, v185
    v_cvt_pk_bf16_f32 v217, v170, v171
    v_cvt_pk_bf16_f32 v216, v168, v169
    v_cvt_pk_bf16_f32 v215, v182, v183
    v_mfma_f32_16x16x32_bf16 v[108:111], v[44:47], v[68:71], 0
    ds_read_b128 v[68:71], v12 offset:10240
    v_cvt_pk_bf16_f32 v214, v180, v181
    v_cvt_pk_bf16_f32 v213, v166, v167
    v_cvt_pk_bf16_f32 v212, v164, v165
    v_cvt_pk_bf16_f32 v211, v178, v179
    v_cvt_pk_bf16_f32 v210, v176, v177
    v_cvt_pk_bf16_f32 v209, v162, v163
    s_waitcnt lgkmcnt(3)
    v_mfma_f32_16x16x32_bf16 v[112:115], v[32:35], v[72:75], 0
    ds_read_b64_tr_b16 v[50:51], v16 offset:9216
    v_cvt_pk_bf16_f32 v208, v160, v161
    v_cvt_pk_bf16_f32 v207, v158, v159
    v_cvt_pk_bf16_f32 v206, v156, v157
    v_cvt_pk_bf16_f32 v205, v142, v143
    v_cvt_pk_bf16_f32 v204, v140, v141
    v_cvt_pk_bf16_f32 v203, v154, v155
    v_mfma_f32_16x16x32_bf16 v[116:119], v[36:39], v[72:75], 0
    v_cvt_pk_bf16_f32 v202, v152, v153
    v_cvt_pk_bf16_f32 v201, v138, v139
    v_cvt_pk_bf16_f32 v200, v136, v137
    v_cvt_pk_bf16_f32 v199, v150, v151
    v_cvt_pk_bf16_f32 v198, v148, v149
    v_cvt_pk_bf16_f32 v197, v134, v135
    v_mfma_f32_16x16x32_bf16 v[120:123], v[40:43], v[72:75], 0
    v_cvt_pk_bf16_f32 v196, v132, v133
    v_cvt_pk_bf16_f32 v195, v146, v147
    v_cvt_pk_bf16_f32 v194, v144, v145
    v_cvt_pk_bf16_f32 v193, v130, v131
    v_cvt_pk_bf16_f32 v192, v128, v129
    v_mfma_f32_16x16x32_bf16 v[124:127], v[44:47], v[72:75], 0
    ds_read_b128 v[72:75], v12 offset:12288
    ds_read_b64_tr_b16 v[52:53], v17 offset:8192
    v_mfma_f32_16x16x32_bf16 v[128:131], v[32:35], v[76:79], 0
    buffer_store_dwordx4 v[192:195], v4, s[8:11], s40 offen offset:0 sc1
    v_mfma_f32_16x16x32_bf16 v[132:135], v[36:39], v[76:79], 0
    v_mfma_f32_16x16x32_bf16 v[136:139], v[40:43], v[76:79], 0
    ds_read_b64_tr_b16 v[54:55], v17 offset:9216
    v_mfma_f32_16x16x32_bf16 v[140:143], v[44:47], v[76:79], 0
    ds_read_b128 v[76:79], v12 offset:14336
    s_waitcnt lgkmcnt(6)
    v_mfma_f32_16x16x32_bf16 v[144:147], v[32:35], v[64:67], 0
    buffer_store_dwordx4 v[196:199], v4, s[8:11], s40 offen offset:1024 sc1
    v_mfma_f32_16x16x32_bf16 v[148:151], v[36:39], v[64:67], 0
    ds_read_b64_tr_b16 v[56:57], v18 offset:8192
    v_mfma_f32_16x16x32_bf16 v[152:155], v[40:43], v[64:67], 0
    v_mfma_f32_16x16x32_bf16 v[156:159], v[44:47], v[64:67], 0
    ds_read_b128 v[64:67], v13 offset:0
    s_waitcnt lgkmcnt(6)
    v_mfma_f32_16x16x32_bf16 v[160:163], v[32:35], v[68:71], 0
    ds_read_b64_tr_b16 v[58:59], v18 offset:9216
    buffer_store_dwordx4 v[200:203], v4, s[8:11], s40 offen offset:2048 sc1
    v_mfma_f32_16x16x32_bf16 v[164:167], v[36:39], v[68:71], 0
    v_mfma_f32_16x16x32_bf16 v[168:171], v[40:43], v[68:71], 0
    v_mfma_f32_16x16x32_bf16 v[172:175], v[44:47], v[68:71], 0
    ds_read_b128 v[68:71], v13 offset:2048
    ds_read_b64_tr_b16 v[60:61], v19 offset:8192
    s_waitcnt lgkmcnt(7)
    v_mfma_f32_16x16x32_bf16 v[176:179], v[32:35], v[72:75], 0
    buffer_store_dwordx4 v[204:207], v4, s[8:11], s40 offen offset:3072 sc1
    s_add_u32 s40, s40, 8192
    v_mfma_f32_16x16x32_bf16 v[180:183], v[36:39], v[72:75], 0
    v_mfma_f32_16x16x32_bf16 v[184:187], v[40:43], v[72:75], 0
    ds_read_b64_tr_b16 v[62:63], v19 offset:9216
    v_mfma_f32_16x16x32_bf16 v[188:191], v[44:47], v[72:75], 0
    ds_read_b128 v[72:75], v13 offset:4096
    s_waitcnt lgkmcnt(6)
    v_mfma_f32_16x16x32_bf16 v[192:195], v[32:35], v[76:79], 0
    v_mfma_f32_16x16x32_bf16 v[196:199], v[36:39], v[76:79], 0
    v_mfma_f32_16x16x32_bf16 v[200:203], v[40:43], v[76:79], 0
    s_cbranch_vccz VR34
    buffer_store_dwordx4 v[208:211], v4, s[8:11], s40 offen offset:0 sc1
VR34:
    v_mfma_f32_16x16x32_bf16 v[204:207], v[44:47], v[76:79], 0
    ds_read_b128 v[76:79], v13 offset:6144
    s_waitcnt lgkmcnt(5)
    v_mfma_f32_16x16x32_bf16 v[80:83], v[48:51], v[64:67], v[80:83]
    v_mfma_f32_16x16x32_bf16 v[84:87], v[52:55], v[64:67], v[84:87]
    v_mfma_f32_16x16x32_bf16 v[88:91], v[56:59], v[64:67], v[88:91]
    s_waitcnt lgkmcnt(1)
    v_mfma_f32_16x16x32_bf16 v[92:95], v[60:63], v[64:67], v[92:95]
    ds_read_b128 v[64:67], v13 offset:8192
    v_mfma_f32_16x16x32_bf16 v[96:99], v[48:51], v[68:71], v[96:99]
    v_mfma_f32_16x16x32_bf16 v[100:103], v[52:55], v[68:71], v[100:103]
    v_mfma_f32_16x16x32_bf16 v[104:107], v[56:59], v[68:71], v[104:107]
    s_cbranch_vccz VR35
    buffer_store_dwordx4 v[212:215], v4, s[8:11], s40 offen offset:1024 sc1
VR35:
    v_mfma_f32_16x16x32_bf16 v[108:111], v[60:63], v[68:71], v[108:111]
    ds_read_b128 v[68:71], v13 offset:10240
    v_mfma_f32_16x16x32_bf16 v[112:115], v[48:51], v[72:75], v[112:115]
    v_mfma_f32_16x16x32_bf16 v[116:119], v[52:55], v[72:75], v[116:119]
    v_mfma_f32_16x16x32_bf16 v[120:123], v[56:59], v[72:75], v[120:123]
    v_mfma_f32_16x16x32_bf16 v[124:127], v[60:63], v[72:75], v[124:127]
    ds_read_b128 v[72:75], v13 offset:12288
    s_waitcnt lgkmcnt(2)
    v_mfma_f32_16x16x32_bf16 v[128:131], v[48:51], v[76:79], v[128:131]
    v_mfma_f32_16x16x32_bf16 v[132:135], v[52:55], v[76:79], v[132:135]
    v_mfma_f32_16x16x32_bf16 v[136:139], v[56:59], v[76:79], v[136:139]
    s_cbranch_vccz VR36
    buffer_store_dwordx4 v[216:219], v4, s[8:11], s40 offen offset:2048 sc1
VR36:
    v_mfma_f32_16x16x32_bf16 v[140:143], v[60:63], v[76:79], v[140:143]
    ds_read_b128 v[76:79], v13 offset:14336
    v_mfma_f32_16x16x32_bf16 v[144:147], v[48:51], v[64:67], v[144:147]
    v_mfma_f32_16x16x32_bf16 v[148:151], v[52:55], v[64:67], v[148:151]
    v_mfma_f32_16x16x32_bf16 v[152:155], v[56:59], v[64:67], v[152:155]
    v_mfma_f32_16x16x32_bf16 v[156:159], v[60:63], v[64:67], v[156:159]
    s_waitcnt lgkmcnt(1)
    v_mfma_f32_16x16x32_bf16 v[160:163], v[48:51], v[68:71], v[160:163]
    s_waitcnt vmcnt(7) lgkmcnt(0)
    s_cbranch_vccnz VR59
    s_waitcnt vmcnt(4)
VR59:
    s_barrier
    ds_read_b64_tr_b16 v[32:33], v20 offset:0
    ds_read_b64_tr_b16 v[34:35], v20 offset:1024
    ds_read_b128 v[64:67], v14 offset:0
    v_mfma_f32_16x16x32_bf16 v[164:167], v[52:55], v[68:71], v[164:167]
    ds_read_b64_tr_b16 v[36:37], v21 offset:0
    v_mfma_f32_16x16x32_bf16 v[168:171], v[56:59], v[68:71], v[168:171]
    ds_read_b64_tr_b16 v[38:39], v21 offset:1024
    s_add_u32 m0, s36, 0
    s_nop 0
    buffer_load_dwordx4 v24, s[60:63], s34 offen offset:0 lds
    v_mfma_f32_16x16x32_bf16 v[172:175], v[60:63], v[68:71], v[172:175]
    ds_read_b64_tr_b16 v[40:41], v22 offset:0
    ds_read_b128 v[68:71], v14 offset:2048
    v_mfma_f32_16x16x32_bf16 v[176:179], v[48:51], v[72:75], v[176:179]
    ds_read_b64_tr_b16 v[42:43], v22 offset:1024
    v_mfma_f32_16x16x32_bf16 v[180:183], v[52:55], v[72:75], v[180:183]
    ds_read_b64_tr_b16 v[44:45], v23 offset:0
    buffer_load_dwordx4 v25, s[60:63], s34 offen offset:1024 lds
    v_mfma_f32_16x16x32_bf16 v[184:187], v[56:59], v[72:75], v[184:187]
    ds_read_b64_tr_b16 v[46:47], v23 offset:1024
    v_mfma_f32_16x16x32_bf16 v[188:191], v[60:63], v[72:75], v[188:191]
    ds_read_b128 v[72:75], v14 offset:4096
    v_mfma_f32_16x16x32_bf16 v[192:195], v[48:51], v[76:79], v[192:195]
    buffer_load_dwordx4 v26, s[60:63], s34 offen offset:2048 lds
    v_mfma_f32_16x16x32_bf16 v[196:199], v[52:55], v[76:79], v[196:199]
    v_mfma_f32_16x16x32_bf16 v[200:203], v[56:59], v[76:79], v[200:203]
    v_mfma_f32_16x16x32_bf16 v[204:207], v[60:63], v[76:79], v[204:207]
    ds_read_b128 v[76:79], v14 offset:6144
    s_waitcnt lgkmcnt(8)
    v_mfma_f32_16x16x32_bf16 v[80:83], v[32:35], v[64:67], v[80:83]
    buffer_load_dwordx4 v27, s[60:63], s34 offen offset:3072 lds
    s_add_u32 s34, s34, 128
    s_waitcnt lgkmcnt(6)
    v_mfma_f32_16x16x32_bf16 v[84:87], v[36:39], v[64:67], v[84:87]
    s_waitcnt lgkmcnt(3)
    v_mfma_f32_16x16x32_bf16 v[88:91], v[40:43], v[64:67], v[88:91]
    s_waitcnt lgkmcnt(1)
    v_mfma_f32_16x16x32_bf16 v[92:95], v[44:47], v[64:67], v[92:95]
    ds_read_b128 v[64:67], v14 offset:8192
    v_mfma_f32_16x16x32_bf16 v[96:99], v[32:35], v[68:71], v[96:99]
    s_add_u32 m0, s37, 0
    s_nop 0
    buffer_load_dwordx4 v8, s[72:75], s35 offen offset:0 lds
    v_mfma_f32_16x16x32_bf16 v[100:103], v[36:39], v[68:71], v[100:103]
    ds_read_b64_tr_b16 v[48:49], v20 offset:8192
    v_mfma_f32_16x16x32_bf16 v[104:107], v[40:43], v[68:71], v[104:107]
    v_mfma_f32_16x16x32_bf16 v[108:111], v[44:47], v[68:71], v[108:111]
    ds_read_b128 v[68:71], v14 offset:10240
    v_mfma_f32_16x16x32_bf16 v[112:115], v[32:35], v[72:75], v[112:115]
    buffer_load_dwordx4 v9, s[72:75], s35 offen offset:1024 lds
    ds_read_b64_tr_b16 v[50:51], v20 offset:9216
    v_mfma_f32_16x16x32_bf16 v[116:119], v[36:39], v[72:75], v[116:119]
    v_mfma_f32_16x16x32_bf16 v[120:123], v[40:43], v[72:75], v[120:123]
    v_mfma_f32_16x16x32_bf16 v[124:127], v[44:47], v[72:75], v[124:127]
    ds_read_b128 v[72:75], v14 offset:12288
    ds_read_b64_tr_b16 v[52:53], v21 offset:8192
    s_waitcnt lgkmcnt(5)
    v_mfma_f32_16x16x32_bf16 v[128:131], v[32:35], v[76:79], v[128:131]
    buffer_load_dwordx4 v10, s[72:75], s35 offen offset:2048 lds
    v_mfma_f32_16x16x32_bf16 v[132:135], v[36:39], v[76:79], v[132:135]
    v_mfma_f32_16x16x32_bf16 v[136:139], v[40:43], v[76:79], v[136:139]
    ds_read_b64_tr_b16 v[54:55], v21 offset:9216
    v_mfma_f32_16x16x32_bf16 v[140:143], v[44:47], v[76:79], v[140:143]
    ds_read_b128 v[76:79], v14 offset:14336
    v_mfma_f32_16x16x32_bf16 v[144:147], v[32:35], v[64:67], v[144:147]
    buffer_load_dwordx4 v11, s[72:75], s35 offen offset:3072 lds
    s_add_u32 s35, s35, 524288
    v_mfma_f32_16x16x32_bf16 v[148:151], v[36:39], v[64:67], v[148:151]
    ds_read_b64_tr_b16 v[56:57], v22 offset:8192
    v_mfma_f32_16x16x32_bf16 v[152:155], v[40:43], v[64:67], v[152:155]
    v_mfma_f32_16x16x32_bf16 v[156:159], v[44:47], v[64:67], v[156:159]
    ds_read_b128 v[64:67], v15 offset:0
    s_waitcnt lgkmcnt(6)
    v_mfma_f32_16x16x32_bf16 v[160:163], v[32:35], v[68:71], v[160:163]
    ds_read_b64_tr_b16 v[58:59], v22 offset:9216
    v_mfma_f32_16x16x32_bf16 v[164:167], v[36:39], v[68:71], v[164:167]
    s_cbranch_vccnz VR40
    buffer_store_dwordx4 v[208:211], v4, s[8:11], s40 offen offset:0 sc1
VR40:
    v_mfma_f32_16x16x32_bf16 v[168:171], v[40:43], v[68:71], v[168:171]
    s_cbranch_vccz VR37
    buffer_store_dwordx4 v[220:223], v4, s[8:11], s40 offen offset:3072 sc1
    s_add_u32 s40, s40, 8192
VR37:
    v_mfma_f32_16x16x32_bf16 v[172:175], v[44:47], v[68:71], v[172:175]
    ds_read_b128 v[68:71], v15 offset:2048
    ds_read_b64_tr_b16 v[60:61], v23 offset:8192
    s_waitcnt lgkmcnt(7)
    v_mfma_f32_16x16x32_bf16 v[176:179], v[32:35], v[72:75], v[176:179]
    v_mfma_f32_16x16x32_bf16 v[180:183], v[36:39], v[72:75], v[180:183]
    v_mfma_f32_16x16x32_bf16 v[184:187], v[40:43], v[72:75], v[184:187]
    ds_read_b64_tr_b16 v[62:63], v23 offset:9216
    v_mfma_f32_16x16x32_bf16 v[188:191], v[44:47], v[72:75], v[188:191]
    ds_read_b128 v[72:75], v15 offset:4096
    s_waitcnt lgkmcnt(6)
    v_mfma_f32_16x16x32_bf16 v[192:195], v[32:35], v[76:79], v[192:195]
    v_mfma_f32_16x16x32_bf16 v[196:199], v[36:39], v[76:79], v[196:199]
    v_mfma_f32_16x16x32_bf16 v[200:203], v[40:43], v[76:79], v[200:203]
    v_mfma_f32_16x16x32_bf16 v[204:207], v[44:47], v[76:79], v[204:207]
    ds_read_b128 v[76:79], v15 offset:6144
    s_waitcnt lgkmcnt(5)
    v_mfma_f32_16x16x32_bf16 v[80:83], v[48:51], v[64:67], v[80:83]
    s_cbranch_vccz VR38
    buffer_store_dwordx4 v[224:227], v4, s[8:11], s40 offen offset:0 sc1
VR38:
    v_mfma_f32_16x16x32_bf16 v[84:87], v[52:55], v[64:67], v[84:87]
    v_mfma_f32_16x16x32_bf16 v[88:91], v[56:59], v[64:67], v[88:91]
    s_waitcnt lgkmcnt(1)
    v_mfma_f32_16x16x32_bf16 v[92:95], v[60:63], v[64:67], v[92:95]
    ds_read_b128 v[64:67], v15 offset:8192
    v_mfma_f32_16x16x32_bf16 v[96:99], v[48:51], v[68:71], v[96:99]
    v_mfma_f32_16x16x32_bf16 v[100:103], v[52:55], v[68:71], v[100:103]
    s_cbranch_vccnz VR41
    buffer_store_dwordx4 v[212:215], v4, s[8:11], s40 offen offset:1024 sc1
VR41:
    v_mfma_f32_16x16x32_bf16 v[104:107], v[56:59], v[68:71], v[104:107]
    v_mfma_f32_16x16x32_bf16 v[108:111], v[60:63], v[68:71], v[108:111]
    ds_read_b128 v[68:71], v15 offset:10240
    v_mfma_f32_16x16x32_bf16 v[112:115], v[48:51], v[72:75], v[112:115]
    v_mfma_f32_16x16x32_bf16 v[116:119], v[52:55], v[72:75], v[116:119]
    v_mfma_f32_16x16x32_bf16 v[120:123], v[56:59], v[72:75], v[120:123]
    s_cbranch_vccz VR39
    buffer_store_dwordx4 v[228:231], v4, s[8:11], s40 offen offset:1024 sc1
VR39:
    v_mfma_f32_16x16x32_bf16 v[124:127], v[60:63], v[72:75], v[124:127]
    ds_read_b128 v[72:75], v15 offset:12288
    s_waitcnt lgkmcnt(2)
    v_mfma_f32_16x16x32_bf16 v[128:131], v[48:51], v[76:79], v[128:131]
    v_mfma_f32_16x16x32_bf16 v[132:135], v[52:55], v[76:79], v[132:135]
    v_mfma_f32_16x16x32_bf16 v[136:139], v[56:59], v[76:79], v[136:139]
    v_mfma_f32_16x16x32_bf16 v[140:143], v[60:63], v[76:79], v[140:143]
    ds_read_b128 v[76:79], v15 offset:14336
    v_mfma_f32_16x16x32_bf16 v[144:147], v[48:51], v[64:67], v[144:147]
    v_mfma_f32_16x16x32_bf16 v[148:151], v[52:55], v[64:67], v[148:151]
    v_mfma_f32_16x16x32_bf16 v[152:155], v[56:59], v[64:67], v[152:155]
    v_mfma_f32_16x16x32_bf16 v[156:159], v[60:63], v[64:67], v[156:159]
    s_waitcnt lgkmcnt(1)
    v_mfma_f32_16x16x32_bf16 v[160:163], v[48:51], v[68:71], v[160:163]
    s_waitcnt vmcnt(3) lgkmcnt(0)
    s_cbranch_vccnz VR60
    s_waitcnt vmcnt(2)
VR60:
    s_barrier
    ds_read_b64_tr_b16 v[32:33], v16 offset:0
    ds_read_b64_tr_b16 v[34:35], v16 offset:1024
    ds_read_b128 v[64:67], v12 offset:0
    v_mfma_f32_16x16x32_bf16 v[164:167], v[52:55], v[68:71], v[164:167]
    ds_read_b64_tr_b16 v[36:37], v17 offset:0
    v_mfma_f32_16x16x32_bf16 v[168:171], v[56:59], v[68:71], v[168:171]
    ds_read_b64_tr_b16 v[38:39], v17 offset:1024
    s_add_u32 m0, s36, 65536
    s_nop 0
    buffer_load_dwordx4 v24, s[60:63], s34 offen offset:0 lds
    v_mfma_f32_16x16x32_bf16 v[172:175], v[60:63], v[68:71], v[172:175]
    ds_read_b64_tr_b16 v[40:41], v18 offset:0
    ds_read_b128 v[68:71], v12 offset:2048
    v_mfma_f32_16x16x32_bf16 v[176:179], v[48:51], v[72:75], v[176:179]
    ds_read_b64_tr_b16 v[42:43], v18 offset:1024
    v_mfma_f32_16x16x32_bf16 v[180:183], v[52:55], v[72:75], v[180:183]
    ds_read_b64_tr_b16 v[44:45], v19 offset:0
    buffer_load_dwordx4 v25, s[60:63], s34 offen offset:1024 lds
    v_mfma_f32_16x16x32_bf16 v[184:187], v[56:59], v[72:75], v[184:187]
    ds_read_b64_tr_b16 v[46:47], v19 offset:1024
    v_mfma_f32_16x16x32_bf16 v[188:191], v[60:63], v[72:75], v[188:191]
    ds_read_b128 v[72:75], v12 offset:4096
    v_mfma_f32_16x16x32_bf16 v[192:195], v[48:51], v[76:79], v[192:195]
    buffer_load_dwordx4 v26, s[60:63], s34 offen offset:2048 lds
    v_mfma_f32_16x16x32_bf16 v[196:199], v[52:55], v[76:79], v[196:199]
    v_mfma_f32_16x16x32_bf16 v[200:203], v[56:59], v[76:79], v[200:203]
    v_mfma_f32_16x16x32_bf16 v[204:207], v[60:63], v[76:79], v[204:207]
    ds_read_b128 v[76:79], v12 offset:6144
    s_waitcnt lgkmcnt(8)
    v_mfma_f32_16x16x32_bf16 v[80:83], v[32:35], v[64:67], v[80:83]
    buffer_load_dwordx4 v27, s[60:63], s34 offen offset:3072 lds
    s_add_u32 s34, s34, 128
    s_waitcnt lgkmcnt(6)
    v_mfma_f32_16x16x32_bf16 v[84:87], v[36:39], v[64:67], v[84:87]
    s_waitcnt lgkmcnt(3)
    v_mfma_f32_16x16x32_bf16 v[88:91], v[40:43], v[64:67], v[88:91]
    s_waitcnt lgkmcnt(1)
    v_mfma_f32_16x16x32_bf16 v[92:95], v[44:47], v[64:67], v[92:95]
    ds_read_b128 v[64:67], v12 offset:8192
    v_mfma_f32_16x16x32_bf16 v[96:99], v[32:35], v[68:71], v[96:99]
    s_add_u32 m0, s37, 65536
    s_nop 0
    buffer_load_dwordx4 v8, s[72:75], s35 offen offset:0 lds
    v_mfma_f32_16x16x32_bf16 v[100:103], v[36:39], v[68:71], v[100:103]
    ds_read_b64_tr_b16 v[48:49], v16 offset:8192
    v_mfma_f32_16x16x32_bf16 v[104:107], v[40:43], v[68:71], v[104:107]
    v_mfma_f32_16x16x32_bf16 v[108:111], v[44:47], v[68:71], v[108:111]
    ds_read_b128 v[68:71], v12 offset:10240
    v_mfma_f32_16x16x32_bf16 v[112:115], v[32:35], v[72:75], v[112:115]
    buffer_load_dwordx4 v9, s[72:75], s35 offen offset:1024 lds
    ds_read_b64_tr_b16 v[50:51], v16 offset:9216
    v_mfma_f32_16x16x32_bf16 v[116:119], v[36:39], v[72:75], v[116:119]
    v_mfma_f32_16x16x32_bf16 v[120:123], v[40:43], v[72:75], v[120:123]
    v_mfma_f32_16x16x32_bf16 v[124:127], v[44:47], v[72:75], v[124:127]
    ds_read_b128 v[72:75], v12 offset:12288
    ds_read_b64_tr_b16 v[52:53], v17 offset:8192
    s_waitcnt lgkmcnt(5)
    v_mfma_f32_16x16x32_bf16 v[128:131], v[32:35], v[76:79], v[128:131]
    buffer_load_dwordx4 v10, s[72:75], s35 offen offset:2048 lds
    v_mfma_f32_16x16x32_bf16 v[132:135], v[36:39], v[76:79], v[132:135]
    v_mfma_f32_16x16x32_bf16 v[136:139], v[40:43], v[76:79], v[136:139]
    ds_read_b64_tr_b16 v[54:55], v17 offset:9216
    v_mfma_f32_16x16x32_bf16 v[140:143], v[44:47], v[76:79], v[140:143]
    ds_read_b128 v[76:79], v12 offset:14336
    v_mfma_f32_16x16x32_bf16 v[144:147], v[32:35], v[64:67], v[144:147]
    buffer_load_dwordx4 v11, s[72:75], s35 offen offset:3072 lds
    s_add_u32 s35, s35, 524288
    v_mfma_f32_16x16x32_bf16 v[148:151], v[36:39], v[64:67], v[148:151]
    ds_read_b64_tr_b16 v[56:57], v18 offset:8192
    v_mfma_f32_16x16x32_bf16 v[152:155], v[40:43], v[64:67], v[152:155]
    v_mfma_f32_16x16x32_bf16 v[156:159], v[44:47], v[64:67], v[156:159]
    ds_read_b128 v[64:67], v13 offset:0
    s_waitcnt lgkmcnt(6)
    v_mfma_f32_16x16x32_bf16 v[160:163], v[32:35], v[68:71], v[160:163]
    ds_read_b64_tr_b16 v[58:59], v18 offset:9216
    v_mfma_f32_16x16x32_bf16 v[164:167], v[36:39], v[68:71], v[164:167]
    s_cbranch_vccnz VR45
    buffer_store_dwordx4 v[216:219], v4, s[8:11], s40 offen offset:2048 sc1
VR45:
    v_mfma_f32_16x16x32_bf16 v[168:171], v[40:43], v[68:71], v[168:171]
    s_cbranch_vccz VR42
    buffer_store_dwordx4 v[232:235], v4, s[8:11], s40 offen offset:2048 sc1
VR42:
    v_mfma_f32_16x16x32_bf16 v[172:175], v[44:47], v[68:71], v[172:175]
    ds_read_b128 v[68:71], v13 offset:2048
    ds_read_b64_tr_b16 v[60:61], v19 offset:8192
    s_waitcnt lgkmcnt(7)
    v_mfma_f32_16x16x32_bf16 v[176:179], v[32:35], v[72:75], v[176:179]
    v_mfma_f32_16x16x32_bf16 v[180:183], v[36:39], v[72:75], v[180:183]
    v_mfma_f32_16x16x32_bf16 v[184:187], v[40:43], v[72:75], v[184:187]
    ds_read_b64_tr_b16 v[62:63], v19 offset:9216
    v_mfma_f32_16x16x32_bf16 v[188:191], v[44:47], v[72:75], v[188:191]
    ds_read_b128 v[72:75], v13 offset:4096
    s_waitcnt lgkmcnt(6)
    v_mfma_f32_16x16x32_bf16 v[192:195], v[32:35], v[76:79], v[192:195]
    v_mfma_f32_16x16x32_bf16 v[196:199], v[36:39], v[76:79], v[196:199]
    v_mfma_f32_16x16x32_bf16 v[200:203], v[40:43], v[76:79], v[200:203]
    v_mfma_f32_16x16x32_bf16 v[204:207], v[44:47], v[76:79], v[204:207]
    ds_read_b128 v[76:79], v13 offset:6144
    s_waitcnt lgkmcnt(5)
    v_mfma_f32_16x16x32_bf16 v[80:83], v[48:51], v[64:67], v[80:83]
    s_cbranch_vccz VR43
    buffer_store_dwordx4 v[236:239], v4, s[8:11], s40 offen offset:3072 sc1
    s_add_u32 s40, s40, 8192
VR43:
    v_mfma_f32_16x16x32_bf16 v[84:87], v[52:55], v[64:67], v[84:87]
    v_mfma_f32_16x16x32_bf16 v[88:91], v[56:59], v[64:67], v[88:91]
    s_waitcnt lgkmcnt(1)
    v_mfma_f32_16x16x32_bf16 v[92:95], v[60:63], v[64:67], v[92:95]
    ds_read_b128 v[64:67], v13 offset:8192
    v_mfma_f32_16x16x32_bf16 v[96:99], v[48:51], v[68:71], v[96:99]
    v_mfma_f32_16x16x32_bf16 v[100:103], v[52:55], v[68:71], v[100:103]
    s_cbranch_vccnz VR46
    buffer_store_dwordx4 v[220:223], v4, s[8:11], s40 offen offset:3072 sc1
    s_add_u32 s40, s40, 8192
VR46:
    v_mfma_f32_16x16x32_bf16 v[104:107], v[56:59], v[68:71], v[104:107]
    v_mfma_f32_16x16x32_bf16 v[108:111], v[60:63], v[68:71], v[108:111]
    ds_read_b128 v[68:71], v13 offset:10240
    v_mfma_f32_16x16x32_bf16 v[112:115], v[48:51], v[72:75], v[112:115]
    v_mfma_f32_16x16x32_bf16 v[116:119], v[52:55], v[72:75], v[116:119]
    v_mfma_f32_16x16x32_bf16 v[120:123], v[56:59], v[72:75], v[120:123]
    s_cbranch_vccz VR44
    buffer_store_dwordx4 v[240:243], v4, s[8:11], s40 offen offset:0 sc1
VR44:
    v_mfma_f32_16x16x32_bf16 v[124:127], v[60:63], v[72:75], v[124:127]
    ds_read_b128 v[72:75], v13 offset:12288
    s_waitcnt lgkmcnt(2)
    v_mfma_f32_16x16x32_bf16 v[128:131], v[48:51], v[76:79], v[128:131]
    v_mfma_f32_16x16x32_bf16 v[132:135], v[52:55], v[76:79], v[132:135]
    v_mfma_f32_16x16x32_bf16 v[136:139], v[56:59], v[76:79], v[136:139]
    v_mfma_f32_16x16x32_bf16 v[140:143], v[60:63], v[76:79], v[140:143]
    ds_read_b128 v[76:79], v13 offset:14336
    v_mfma_f32_16x16x32_bf16 v[144:147], v[48:51], v[64:67], v[144:147]
    v_mfma_f32_16x16x32_bf16 v[148:151], v[52:55], v[64:67], v[148:151]
    v_mfma_f32_16x16x32_bf16 v[152:155], v[56:59], v[64:67], v[152:155]
    v_mfma_f32_16x16x32_bf16 v[156:159], v[60:63], v[64:67], v[156:159]
    s_waitcnt lgkmcnt(1)
    v_mfma_f32_16x16x32_bf16 v[160:163], v[48:51], v[68:71], v[160:163]
    s_waitcnt vmcnt(3) lgkmcnt(0)
    s_cbranch_vccnz VR61
    s_waitcnt vmcnt(2)
VR61:
    s_barrier
    ds_read_b64_tr_b16 v[32:33], v20 offset:0
    ds_read_b64_tr_b16 v[34:35], v20 offset:1024
    ds_read_b128 v[64:67], v14 offset:0
    v_mfma_f32_16x16x32_bf16 v[164:167], v[52:55], v[68:71], v[164:167]
    ds_read_b64_tr_b16 v[36:37], v21 offset:0
    v_mfma_f32_16x16x32_bf16 v[168:171], v[56:59], v[68:71], v[168:171]
    ds_read_b64_tr_b16 v[38:39], v21 offset:1024
    s_add_u32 m0, s36, 0
    s_nop 0
    buffer_load_dwordx4 v24, s[60:63], s34 offen offset:0 lds
    v_mfma_f32_16x16x32_bf16 v[172:175], v[60:63], v[68:71], v[172:175]
    ds_read_b64_tr_b16 v[40:41], v22 offset:0
    ds_read_b128 v[68:71], v14 offset:2048
    v_mfma_f32_16x16x32_bf16 v[176:179], v[48:51], v[72:75], v[176:179]
    ds_read_b64_tr_b16 v[42:43], v22 offset:1024
    v_mfma_f32_16x16x32_bf16 v[180:183], v[52:55], v[72:75], v[180:183]
    ds_read_b64_tr_b16 v[44:45], v23 offset:0
    buffer_load_dwordx4 v25, s[60:63], s34 offen offset:1024 lds
    v_mfma_f32_16x16x32_bf16 v[184:187], v[56:59], v[72:75], v[184:187]
    ds_read_b64_tr_b16 v[46:47], v23 offset:1024
    v_mfma_f32_16x16x32_bf16 v[188:191], v[60:63], v[72:75], v[188:191]
    ds_read_b128 v[72:75], v14 offset:4096
    v_mfma_f32_16x16x32_bf16 v[192:195], v[48:51], v[76:79], v[192:195]
    buffer_load_dwordx4 v26, s[60:63], s34 offen offset:2048 lds
    v_mfma_f32_16x16x32_bf16 v[196:199], v[52:55], v[76:79], v[196:199]
    v_mfma_f32_16x16x32_bf16 v[200:203], v[56:59], v[76:79], v[200:203]
    v_mfma_f32_16x16x32_bf16 v[204:207], v[60:63], v[76:79], v[204:207]
    ds_read_b128 v[76:79], v14 offset:6144
    s_waitcnt lgkmcnt(8)
    v_mfma_f32_16x16x32_bf16 v[80:83], v[32:35], v[64:67], v[80:83]
    buffer_load_dwordx4 v27, s[60:63], s34 offen offset:3072 lds
    s_add_u32 s34, s34, 128
    s_waitcnt lgkmcnt(6)
    v_mfma_f32_16x16x32_bf16 v[84:87], v[36:39], v[64:67], v[84:87]
    s_waitcnt lgkmcnt(3)
    v_mfma_f32_16x16x32_bf16 v[88:91], v[40:43], v[64:67], v[88:91]
    s_waitcnt lgkmcnt(1)
    v_mfma_f32_16x16x32_bf16 v[92:95], v[44:47], v[64:67], v[92:95]
    ds_read_b128 v[64:67], v14 offset:8192
    v_mfma_f32_16x16x32_bf16 v[96:99], v[32:35], v[68:71], v[96:99]
    s_add_u32 m0, s37, 0
    s_nop 0
    buffer_load_dwordx4 v8, s[72:75], s35 offen offset:0 lds
    v_mfma_f32_16x16x32_bf16 v[100:103], v[36:39], v[68:71], v[100:103]
    ds_read_b64_tr_b16 v[48:49], v20 offset:8192
    v_mfma_f32_16x16x32_bf16 v[104:107], v[40:43], v[68:71], v[104:107]
    v_mfma_f32_16x16x32_bf16 v[108:111], v[44:47], v[68:71], v[108:111]
    ds_read_b128 v[68:71], v14 offset:10240
    v_mfma_f32_16x16x32_bf16 v[112:115], v[32:35], v[72:75], v[112:115]
    buffer_load_dwordx4 v9, s[72:75], s35 offen offset:1024 lds
    ds_read_b64_tr_b16 v[50:51], v20 offset:9216
    v_mfma_f32_16x16x32_bf16 v[116:119], v[36:39], v[72:75], v[116:119]
    v_mfma_f32_16x16x32_bf16 v[120:123], v[40:43], v[72:75], v[120:123]
    v_mfma_f32_16x16x32_bf16 v[124:127], v[44:47], v[72:75], v[124:127]
    ds_read_b128 v[72:75], v14 offset:12288
    ds_read_b64_tr_b16 v[52:53], v21 offset:8192
    s_waitcnt lgkmcnt(5)
    v_mfma_f32_16x16x32_bf16 v[128:131], v[32:35], v[76:79], v[128:131]
    buffer_load_dwordx4 v10, s[72:75], s35 offen offset:2048 lds
    v_mfma_f32_16x16x32_bf16 v[132:135], v[36:39], v[76:79], v[132:135]
    v_mfma_f32_16x16x32_bf16 v[136:139], v[40:43], v[76:79], v[136:139]
    ds_read_b64_tr_b16 v[54:55], v21 offset:9216
    v_mfma_f32_16x16x32_bf16 v[140:143], v[44:47], v[76:79], v[140:143]
    ds_read_b128 v[76:79], v14 offset:14336
    v_mfma_f32_16x16x32_bf16 v[144:147], v[32:35], v[64:67], v[144:147]
    buffer_load_dwordx4 v11, s[72:75], s35 offen offset:3072 lds
    s_add_u32 s35, s35, 524288
    v_mfma_f32_16x16x32_bf16 v[148:151], v[36:39], v[64:67], v[148:151]
    ds_read_b64_tr_b16 v[56:57], v22 offset:8192
    v_mfma_f32_16x16x32_bf16 v[152:155], v[40:43], v[64:67], v[152:155]
    v_mfma_f32_16x16x32_bf16 v[156:159], v[44:47], v[64:67], v[156:159]
    ds_read_b128 v[64:67], v15 offset:0
    s_waitcnt lgkmcnt(6)
    v_mfma_f32_16x16x32_bf16 v[160:163], v[32:35], v[68:71], v[160:163]
    ds_read_b64_tr_b16 v[58:59], v22 offset:9216
    v_mfma_f32_16x16x32_bf16 v[164:167], v[36:39], v[68:71], v[164:167]
    s_cbranch_vccnz VR50
    buffer_store_dwordx4 v[224:227], v4, s[8:11], s40 offen offset:0 sc1
VR50:
    v_mfma_f32_16x16x32_bf16 v[168:171], v[40:43], v[68:71], v[168:171]
    s_cbranch_vccz VR47
    buffer_store_dwordx4 v[244:247], v4, s[8:11], s40 offen offset:1024 sc1
VR47:
    v_mfma_f32_16x16x32_bf16 v[172:175], v[44:47], v[68:71], v[172:175]
    ds_read_b128 v[68:71], v15 offset:2048
    ds_read_b64_tr_b16 v[60:61], v23 offset:8192
    s_waitcnt lgkmcnt(7)
    v_mfma_f32_16x16x32_bf16 v[176:179], v[32:35], v[72:75], v[176:179]
    v_mfma_f32_16x16x32_bf16 v[180:183], v[36:39], v[72:75], v[180:183]
    v_mfma_f32_16x16x32_bf16 v[184:187], v[40:43], v[72:75], v[184:187]
    ds_read_b64_tr_b16 v[62:63], v23 offset:9216
    v_mfma_f32_16x16x32_bf16 v[188:191], v[44:47], v[72:75], v[188:191]
    ds_read_b128 v[72:75], v15 offset:4096
    s_waitcnt lgkmcnt(6)
    v_mfma_f32_16x16x32_bf16 v[192:195], v[32:35], v[76:79], v[192:195]
    v_mfma_f32_16x16x32_bf16 v[196:199], v[36:39], v[76:79], v[196:199]
    v_mfma_f32_16x16x32_bf16 v[200:203], v[40:43], v[76:79], v[200:203]
    v_mfma_f32_16x16x32_bf16 v[204:207], v[44:47], v[76:79], v[204:207]
    ds_read_b128 v[76:79], v15 offset:6144
    s_waitcnt lgkmcnt(5)
    v_mfma_f32_16x16x32_bf16 v[80:83], v[48:51], v[64:67], v[80:83]
    s_cbranch_vccz VR48
    buffer_store_dwordx4 v[248:251], v4, s[8:11], s40 offen offset:2048 sc1
VR48:
    v_mfma_f32_16x16x32_bf16 v[84:87], v[52:55], v[64:67], v[84:87]
    v_mfma_f32_16x16x32_bf16 v[88:91], v[56:59], v[64:67], v[88:91]
    s_waitcnt lgkmcnt(1)
    v_mfma_f32_16x16x32_bf16 v[92:95], v[60:63], v[64:67], v[92:95]
    ds_read_b128 v[64:67], v15 offset:8192
    v_mfma_f32_16x16x32_bf16 v[96:99], v[48:51], v[68:71], v[96:99]
    v_mfma_f32_16x16x32_bf16 v[100:103], v[52:55], v[68:71], v[100:103]
    s_cbranch_vccnz VR51
    buffer_store_dwordx4 v[228:231], v4, s[8:11], s40 offen offset:1024 sc1
VR51:
    v_mfma_f32_16x16x32_bf16 v[104:107], v[56:59], v[68:71], v[104:107]
    v_mfma_f32_16x16x32_bf16 v[108:111], v[60:63], v[68:71], v[108:111]
    ds_read_b128 v[68:71], v15 offset:10240
    v_mfma_f32_16x16x32_bf16 v[112:115], v[48:51], v[72:75], v[112:115]
    v_mfma_f32_16x16x32_bf16 v[116:119], v[52:55], v[72:75], v[116:119]
    v_mfma_f32_16x16x32_bf16 v[120:123], v[56:59], v[72:75], v[120:123]
    s_cbranch_vccz VR49
    buffer_store_dwordx4 v[252:255], v4, s[8:11], s40 offen offset:3072 sc1
    s_add_u32 s40, s40, 8192
VR49:
    v_mfma_f32_16x16x32_bf16 v[124:127], v[60:63], v[72:75], v[124:127]
    ds_read_b128 v[72:75], v15 offset:12288
    s_waitcnt lgkmcnt(2)
    v_mfma_f32_16x16x32_bf16 v[128:131], v[48:51], v[76:79], v[128:131]
    v_mfma_f32_16x16x32_bf16 v[132:135], v[52:55], v[76:79], v[132:135]
    v_mfma_f32_16x16x32_bf16 v[136:139], v[56:59], v[76:79], v[136:139]
    v_mfma_f32_16x16x32_bf16 v[140:143], v[60:63], v[76:79], v[140:143]
    ds_read_b128 v[76:79], v15 offset:14336
    v_mfma_f32_16x16x32_bf16 v[144:147], v[48:51], v[64:67], v[144:147]
    v_mfma_f32_16x16x32_bf16 v[148:151], v[52:55], v[64:67], v[148:151]
    v_mfma_f32_16x16x32_bf16 v[152:155], v[56:59], v[64:67], v[152:155]
    v_mfma_f32_16x16x32_bf16 v[156:159], v[60:63], v[64:67], v[156:159]
    s_waitcnt lgkmcnt(1)
    v_mfma_f32_16x16x32_bf16 v[160:163], v[48:51], v[68:71], v[160:163]
    s_waitcnt vmcnt(3) lgkmcnt(0)
    s_cbranch_vccnz VR62
    s_waitcnt vmcnt(2)
VR62:
    s_barrier
    ds_read_b64_tr_b16 v[32:33], v16 offset:0
    ds_read_b64_tr_b16 v[34:35], v16 offset:1024
    ds_read_b128 v[64:67], v12 offset:0
    v_mfma_f32_16x16x32_bf16 v[164:167], v[52:55], v[68:71], v[164:167]
    ds_read_b64_tr_b16 v[36:37], v17 offset:0
    v_mfma_f32_16x16x32_bf16 v[168:171], v[56:59], v[68:71], v[168:171]
    ds_read_b64_tr_b16 v[38:39], v17 offset:1024
    s_add_u32 m0, s36, 65536
    s_nop 0
    buffer_load_dwordx4 v24, s[60:63], s34 offen offset:0 lds
    v_mfma_f32_16x16x32_bf16 v[172:175], v[60:63], v[68:71], v[172:175]
    ds_read_b64_tr_b16 v[40:41], v18 offset:0
    ds_read_b128 v[68:71], v12 offset:2048
    v_mfma_f32_16x16x32_bf16 v[176:179], v[48:51], v[72:75], v[176:179]
    ds_read_b64_tr_b16 v[42:43], v18 offset:1024
    v_mfma_f32_16x16x32_bf16 v[180:183], v[52:55], v[72:75], v[180:183]
    ds_read_b64_tr_b16 v[44:45], v19 offset:0
    buffer_load_dwordx4 v25, s[60:63], s34 offen offset:1024 lds
    v_mfma_f32_16x16x32_bf16 v[184:187], v[56:59], v[72:75], v[184:187]
    ds_read_b64_tr_b16 v[46:47], v19 offset:1024
    v_mfma_f32_16x16x32_bf16 v[188:191], v[60:63], v[72:75], v[188:191]
    ds_read_b128 v[72:75], v12 offset:4096
    v_mfma_f32_16x16x32_bf16 v[192:195], v[48:51], v[76:79], v[192:195]
    buffer_load_dwordx4 v26, s[60:63], s34 offen offset:2048 lds
    v_mfma_f32_16x16x32_bf16 v[196:199], v[52:55], v[76:79], v[196:199]
    v_mfma_f32_16x16x32_bf16 v[200:203], v[56:59], v[76:79], v[200:203]
    v_mfma_f32_16x16x32_bf16 v[204:207], v[60:63], v[76:79], v[204:207]
    ds_read_b128 v[76:79], v12 offset:6144
    s_waitcnt lgkmcnt(8)
    v_mfma_f32_16x16x32_bf16 v[80:83], v[32:35], v[64:67], v[80:83]
    buffer_load_dwordx4 v27, s[60:63], s34 offen offset:3072 lds
    s_add_u32 s34, s34, 128
    s_waitcnt lgkmcnt(6)
    v_mfma_f32_16x16x32_bf16 v[84:87], v[36:39], v[64:67], v[84:87]
    s_waitcnt lgkmcnt(3)
    v_mfma_f32_16x16x32_bf16 v[88:91], v[40:43], v[64:67], v[88:91]
    s_waitcnt lgkmcnt(1)
    v_mfma_f32_16x16x32_bf16 v[92:95], v[44:47], v[64:67], v[92:95]
    ds_read_b128 v[64:67], v12 offset:8192
    v_mfma_f32_16x16x32_bf16 v[96:99], v[32:35], v[68:71], v[96:99]
    s_add_u32 m0, s37, 65536
    s_nop 0
    buffer_load_dwordx4 v8, s[72:75], s35 offen offset:0 lds
    v_mfma_f32_16x16x32_bf16 v[100:103], v[36:39], v[68:71], v[100:103]
    ds_read_b64_tr_b16 v[48:49], v16 offset:8192
    v_mfma_f32_16x16x32_bf16 v[104:107], v[40:43], v[68:71], v[104:107]
    v_mfma_f32_16x16x32_bf16 v[108:111], v[44:47], v[68:71], v[108:111]
    ds_read_b128 v[68:71], v12 offset:10240
    v_mfma_f32_16x16x32_bf16 v[112:115], v[32:35], v[72:75], v[112:115]
    buffer_load_dwordx4 v9, s[72:75], s35 offen offset:1024 lds
    ds_read_b64_tr_b16 v[50:51], v16 offset:9216
    v_mfma_f32_16x16x32_bf16 v[116:119], v[36:39], v[72:75], v[116:119]
    v_mfma_f32_16x16x32_bf16 v[120:123], v[40:43], v[72:75], v[120:123]
    v_mfma_f32_16x16x32_bf16 v[124:127], v[44:47], v[72:75], v[124:127]
    ds_read_b128 v[72:75], v12 offset:12288
    ds_read_b64_tr_b16 v[52:53], v17 offset:8192
    s_waitcnt lgkmcnt(5)
    v_mfma_f32_16x16x32_bf16 v[128:131], v[32:35], v[76:79], v[128:131]
    buffer_load_dwordx4 v10, s[72:75], s35 offen offset:2048 lds
    v_mfma_f32_16x16x32_bf16 v[132:135], v[36:39], v[76:79], v[132:135]
    v_mfma_f32_16x16x32_bf16 v[136:139], v[40:43], v[76:79], v[136:139]
    ds_read_b64_tr_b16 v[54:55], v17 offset:9216
    v_mfma_f32_16x16x32_bf16 v[140:143], v[44:47], v[76:79], v[140:143]
    ds_read_b128 v[76:79], v12 offset:14336
    v_mfma_f32_16x16x32_bf16 v[144:147], v[32:35], v[64:67], v[144:147]
    buffer_load_dwordx4 v11, s[72:75], s35 offen offset:3072 lds
    s_add_u32 s35, s35, 524288
    v_mfma_f32_16x16x32_bf16 v[148:151], v[36:39], v[64:67], v[148:151]
    ds_read_b64_tr_b16 v[56:57], v18 offset:8192
    v_mfma_f32_16x16x32_bf16 v[152:155], v[40:43], v[64:67], v[152:155]
    v_mfma_f32_16x16x32_bf16 v[156:159], v[44:47], v[64:67], v[156:159]
    ds_read_b128 v[64:67], v13 offset:0
    s_waitcnt lgkmcnt(6)
    v_mfma_f32_16x16x32_bf16 v[160:163], v[32:35], v[68:71], v[160:163]
    ds_read_b64_tr_b16 v[58:59], v18 offset:9216
    v_mfma_f32_16x16x32_bf16 v[164:167], v[36:39], v[68:71], v[164:167]
    s_cbranch_vccnz VR52
    buffer_store_dwordx4 v[232:235], v4, s[8:11], s40 offen offset:2048 sc1
VR52:
    v_mfma_f32_16x16x32_bf16 v[168:171], v[40:43], v[68:71], v[168:171]
    v_mfma_f32_16x16x32_bf16 v[172:175], v[44:47], v[68:71], v[172:175]
    ds_read_b128 v[68:71], v13 offset:2048
    ds_read_b64_tr_b16 v[60:61], v19 offset:8192
    s_waitcnt lgkmcnt(7)
    v_mfma_f32_16x16x32_bf16 v[176:179], v[32:35], v[72:75], v[176:179]
    v_mfma_f32_16x16x32_bf16 v[180:183], v[36:39], v[72:75], v[180:183]
    v_mfma_f32_16x16x32_bf16 v[184:187], v[40:43], v[72:75], v[184:187]
    ds_read_b64_tr_b16 v[62:63], v19 offset:9216
    v_mfma_f32_16x16x32_bf16 v[188:191], v[44:47], v[72:75], v[188:191]
    ds_read_b128 v[72:75], v13 offset:4096
    s_waitcnt lgkmcnt(6)
    v_mfma_f32_16x16x32_bf16 v[192:195], v[32:35], v[76:79], v[192:195]
    v_mfma_f32_16x16x32_bf16 v[196:199], v[36:39], v[76:79], v[196:199]
    v_mfma_f32_16x16x32_bf16 v[200:203], v[40:43], v[76:79], v[200:203]
    v_mfma_f32_16x16x32_bf16 v[204:207], v[44:47], v[76:79], v[204:207]
    ds_read_b128 v[76:79], v13 offset:6144
    s_waitcnt lgkmcnt(5)
    v_mfma_f32_16x16x32_bf16 v[80:83], v[48:51], v[64:67], v[80:83]
    v_mfma_f32_16x16x32_bf16 v[84:87], v[52:55], v[64:67], v[84:87]
    v_mfma_f32_16x16x32_bf16 v[88:91], v[56:59], v[64:67], v[88:91]
    s_waitcnt lgkmcnt(1)
    v_mfma_f32_16x16x32_bf16 v[92:95], v[60:63], v[64:67], v[92:95]
    ds_read_b128 v[64:67], v13 offset:8192
    v_mfma_f32_16x16x32_bf16 v[96:99], v[48:51], v[68:71], v[96:99]
    v_mfma_f32_16x16x32_bf16 v[100:103], v[52:55], v[68:71], v[100:103]
    s_cbranch_vccnz VR53
    buffer_store_dwordx4 v[236:239], v4, s[8:11], s40 offen offset:3072 sc1
    s_add_u32 s40, s40, 8192
VR53:
    v_mfma_f32_16x16x32_bf16 v[104:107], v[56:59], v[68:71], v[104:107]
    v_mfma_f32_16x16x32_bf16 v[108:111], v[60:63], v[68:71], v[108:111]
    ds_read_b128 v[68:71], v13 offset:10240
    v_mfma_f32_16x16x32_bf16 v[112:115], v[48:51], v[72:75], v[112:115]
    v_mfma_f32_16x16x32_bf16 v[116:119], v[52:55], v[72:75], v[116:119]
    v_mfma_f32_16x16x32_bf16 v[120:123], v[56:59], v[72:75], v[120:123]
    v_mfma_f32_16x16x32_bf16 v[124:127], v[60:63], v[72:75], v[124:127]
    ds_read_b128 v[72:75], v13 offset:12288
    s_waitcnt lgkmcnt(2)
    v_mfma_f32_16x16x32_bf16 v[128:131], v[48:51], v[76:79], v[128:131]
    v_mfma_f32_16x16x32_bf16 v[132:135], v[52:55], v[76:79], v[132:135]
    v_mfma_f32_16x16x32_bf16 v[136:139], v[56:59], v[76:79], v[136:139]
    v_mfma_f32_16x16x32_bf16 v[140:143], v[60:63], v[76:79], v[140:143]
    ds_read_b128 v[76:79], v13 offset:14336
    v_mfma_f32_16x16x32_bf16 v[144:147], v[48:51], v[64:67], v[144:147]
    v_mfma_f32_16x16x32_bf16 v[148:151], v[52:55], v[64:67], v[148:151]
    v_mfma_f32_16x16x32_bf16 v[152:155], v[56:59], v[64:67], v[152:155]
    v_mfma_f32_16x16x32_bf16 v[156:159], v[60:63], v[64:67], v[156:159]
    s_waitcnt lgkmcnt(1)
    v_mfma_f32_16x16x32_bf16 v[160:163], v[48:51], v[68:71], v[160:163]
    s_waitcnt vmcnt(2) lgkmcnt(0)
    s_cbranch_vccz VR63
    s_waitcnt vmcnt(0)
VR63:
    s_barrier
    s_cbranch_vccz VR54
    s_cmp_lg_u32 s3, 0
    s_cbranch_scc1 SIG1_1
    v_mov_b32 v28, 1
    v_add_u32 v28, s38, v28
    s_mov_b64 exec, 1
    buffer_store_dword v28, off, s[8:11], s29 sc1
    s_mov_b64 exec, -1
SIG1_1:
VR54:
    ds_read_b64_tr_b16 v[32:33], v20 offset:0
    ds_read_b64_tr_b16 v[34:35], v20 offset:1024
    ds_read_b128 v[64:67], v14 offset:0
    v_mfma_f32_16x16x32_bf16 v[164:167], v[52:55], v[68:71], v[164:167]
    ds_read_b64_tr_b16 v[36:37], v21 offset:0
    v_mfma_f32_16x16x32_bf16 v[168:171], v[56:59], v[68:71], v[168:171]
    ds_read_b64_tr_b16 v[38:39], v21 offset:1024
    s_add_u32 m0, s36, 0
    s_nop 0
    buffer_load_dwordx4 v24, s[60:63], s34 offen offset:0 lds
    v_mfma_f32_16x16x32_bf16 v[172:175], v[60:63], v[68:71], v[172:175]
    ds_read_b64_tr_b16 v[40:41], v22 offset:0
    ds_read_b128 v[68:71], v14 offset:2048
    v_mfma_f32_16x16x32_bf16 v[176:179], v[48:51], v[72:75], v[176:179]
    ds_read_b64_tr_b16 v[42:43], v22 offset:1024
    v_mfma_f32_16x16x32_bf16 v[180:183], v[52:55], v[72:75], v[180:183]
    ds_read_b64_tr_b16 v[44:45], v23 offset:0
    buffer_load_dwordx4 v25, s[60:63], s34 offen offset:1024 lds
    v_mfma_f32_16x16x32_bf16 v[184:187], v[56:59], v[72:75], v[184:187]
    ds_read_b64_tr_b16 v[46:47], v23 offset:1024
    v_mfma_f32_16x16x32_bf16 v[188:191], v[60:63], v[72:75], v[188:191]
    ds_read_b128 v[72:75], v14 offset:4096
    v_mfma_f32_16x16x32_bf16 v[192:195], v[48:51], v[76:79], v[192:195]
    buffer_load_dwordx4 v26, s[60:63], s34 offen offset:2048 lds
    v_mfma_f32_16x16x32_bf16 v[196:199], v[52:55], v[76:79], v[196:199]
    v_mfma_f32_16x16x32_bf16 v[200:203], v[56:59], v[76:79], v[200:203]
    v_mfma_f32_16x16x32_bf16 v[204:207], v[60:63], v[76:79], v[204:207]
    ds_read_b128 v[76:79], v14 offset:6144
    s_waitcnt lgkmcnt(8)
    v_mfma_f32_16x16x32_bf16 v[80:83], v[32:35], v[64:67], v[80:83]
    buffer_load_dwordx4 v27, s[60:63], s34 offen offset:3072 lds
    s_add_u32 s34, s34, 128
    s_waitcnt lgkmcnt(6)
    v_mfma_f32_16x16x32_bf16 v[84:87], v[36:39], v[64:67], v[84:87]
    s_waitcnt lgkmcnt(3)
    v_mfma_f32_16x16x32_bf16 v[88:91], v[40:43], v[64:67], v[88:91]
    s_waitcnt lgkmcnt(1)
    v_mfma_f32_16x16x32_bf16 v[92:95], v[44:47], v[64:67], v[92:95]
    ds_read_b128 v[64:67], v14 offset:8192
    v_mfma_f32_16x16x32_bf16 v[96:99], v[32:35], v[68:71], v[96:99]
    s_add_u32 m0, s37, 0
    s_nop 0
    buffer_load_dwordx4 v8, s[72:75], s35 offen offset:0 lds
    v_mfma_f32_16x16x32_bf16 v[100:103], v[36:39], v[68:71], v[100:103]
    ds_read_b64_tr_b16 v[48:49], v20 offset:8192
    v_mfma_f32_16x16x32_bf16 v[104:107], v[40:43], v[68:71], v[104:107]
    v_mfma_f32_16x16x32_bf16 v[108:111], v[44:47], v[68:71], v[108:111]
    ds_read_b128 v[68:71], v14 offset:10240
    v_mfma_f32_16x16x32_bf16 v[112:115], v[32:35], v[72:75], v[112:115]
    buffer_load_dwordx4 v9, s[72:75], s35 offen offset:1024 lds
    ds_read_b64_tr_b16 v[50:51], v20 offset:9216
    v_mfma_f32_16x16x32_bf16 v[116:119], v[36:39], v[72:75], v[116:119]
    v_mfma_f32_16x16x32_bf16 v[120:123], v[40:43], v[72:75], v[120:123]
    v_mfma_f32_16x16x32_bf16 v[124:127], v[44:47], v[72:75], v[124:127]
    ds_read_b128 v[72:75], v14 offset:12288
    ds_read_b64_tr_b16 v[52:53], v21 offset:8192
    s_waitcnt lgkmcnt(5)
    v_mfma_f32_16x16x32_bf16 v[128:131], v[32:35], v[76:79], v[128:131]
    buffer_load_dwordx4 v10, s[72:75], s35 offen offset:2048 lds
    v_mfma_f32_16x16x32_bf16 v[132:135], v[36:39], v[76:79], v[132:135]
    v_mfma_f32_16x16x32_bf16 v[136:139], v[40:43], v[76:79], v[136:139]
    ds_read_b64_tr_b16 v[54:55], v21 offset:9216
    v_mfma_f32_16x16x32_bf16 v[140:143], v[44:47], v[76:79], v[140:143]
    ds_read_b128 v[76:79], v14 offset:14336
    v_mfma_f32_16x16x32_bf16 v[144:147], v[32:35], v[64:67], v[144:147]
    buffer_load_dwordx4 v11, s[72:75], s35 offen offset:3072 lds
    s_add_u32 s35, s35, 524288
    v_mfma_f32_16x16x32_bf16 v[148:151], v[36:39], v[64:67], v[148:151]
    ds_read_b64_tr_b16 v[56:57], v22 offset:8192
    v_mfma_f32_16x16x32_bf16 v[152:155], v[40:43], v[64:67], v[152:155]
    v_mfma_f32_16x16x32_bf16 v[156:159], v[44:47], v[64:67], v[156:159]
    ds_read_b128 v[64:67], v15 offset:0
    s_waitcnt lgkmcnt(6)
    v_mfma_f32_16x16x32_bf16 v[160:163], v[32:35], v[68:71], v[160:163]
    ds_read_b64_tr_b16 v[58:59], v22 offset:9216
    v_mfma_f32_16x16x32_bf16 v[164:167], v[36:39], v[68:71], v[164:167]
    s_cbranch_vccnz VR55
    buffer_store_dwordx4 v[240:243], v4, s[8:11], s40 offen offset:0 sc1
VR55:
    v_mfma_f32_16x16x32_bf16 v[168:171], v[40:43], v[68:71], v[168:171]
    v_mfma_f32_16x16x32_bf16 v[172:175], v[44:47], v[68:71], v[172:175]
    ds_read_b128 v[68:71], v15 offset:2048
    ds_read_b64_tr_b16 v[60:61], v23 offset:8192
    s_waitcnt lgkmcnt(7)
    v_mfma_f32_16x16x32_bf16 v[176:179], v[32:35], v[72:75], v[176:179]
    v_mfma_f32_16x16x32_bf16 v[180:183], v[36:39], v[72:75], v[180:183]
    v_mfma_f32_16x16x32_bf16 v[184:187], v[40:43], v[72:75], v[184:187]
    ds_read_b64_tr_b16 v[62:63], v23 offset:9216
    v_mfma_f32_16x16x32_bf16 v[188:191], v[44:47], v[72:75], v[188:191]
    ds_read_b128 v[72:75], v15 offset:4096
    s_waitcnt lgkmcnt(6)
    v_mfma_f32_16x16x32_bf16 v[192:195], v[32:35], v[76:79], v[192:195]
    v_mfma_f32_16x16x32_bf16 v[196:199], v[36:39], v[76:79], v[196:199]
    v_mfma_f32_16x16x32_bf16 v[200:203], v[40:43], v[76:79], v[200:203]
    v_mfma_f32_16x16x32_bf16 v[204:207], v[44:47], v[76:79], v[204:207]
    ds_read_b128 v[76:79], v15 offset:6144
    s_waitcnt lgkmcnt(5)
    v_mfma_f32_16x16x32_bf16 v[80:83], v[48:51], v[64:67], v[80:83]
    v_mfma_f32_16x16x32_bf16 v[84:87], v[52:55], v[64:67], v[84:87]
    v_mfma_f32_16x16x32_bf16 v[88:91], v[56:59], v[64:67], v[88:91]
    s_waitcnt lgkmcnt(1)
    v_mfma_f32_16x16x32_bf16 v[92:95], v[60:63], v[64:67], v[92:95]
    ds_read_b128 v[64:67], v15 offset:8192
    v_mfma_f32_16x16x32_bf16 v[96:99], v[48:51], v[68:71], v[96:99]
    v_mfma_f32_16x16x32_bf16 v[100:103], v[52:55], v[68:71], v[100:103]
    s_cbranch_vccnz VR56
    buffer_store_dwordx4 v[244:247], v4, s[8:11], s40 offen offset:1024 sc1
VR56:
    v_mfma_f32_16x16x32_bf16 v[104:107], v[56:59], v[68:71], v[104:107]
    v_mfma_f32_16x16x32_bf16 v[108:111], v[60:63], v[68:71], v[108:111]
    ds_read_b128 v[68:71], v15 offset:10240
    v_mfma_f32_16x16x32_bf16 v[112:115], v[48:51], v[72:75], v[112:115]
    v_mfma_f32_16x16x32_bf16 v[116:119], v[52:55], v[72:75], v[116:119]
    v_mfma_f32_16x16x32_bf16 v[120:123], v[56:59], v[72:75], v[120:123]
    v_mfma_f32_16x16x32_bf16 v[124:127], v[60:63], v[72:75], v[124:127]
    ds_read_b128 v[72:75], v15 offset:12288
    s_waitcnt lgkmcnt(2)
    v_mfma_f32_16x16x32_bf16 v[128:131], v[48:51], v[76:79], v[128:131]
    v_mfma_f32_16x16x32_bf16 v[132:135], v[52:55], v[76:79], v[132:135]
    v_mfma_f32_16x16x32_bf16 v[136:139], v[56:59], v[76:79], v[136:139]
    v_mfma_f32_16x16x32_bf16 v[140:143], v[60:63], v[76:79], v[140:143]
    ds_read_b128 v[76:79], v15 offset:14336
    v_mfma_f32_16x16x32_bf16 v[144:147], v[48:51], v[64:67], v[144:147]
    v_mfma_f32_16x16x32_bf16 v[148:151], v[52:55], v[64:67], v[148:151]
    v_mfma_f32_16x16x32_bf16 v[152:155], v[56:59], v[64:67], v[152:155]
    v_mfma_f32_16x16x32_bf16 v[156:159], v[60:63], v[64:67], v[156:159]
    s_waitcnt lgkmcnt(1)
    v_mfma_f32_16x16x32_bf16 v[160:163], v[48:51], v[68:71], v[160:163]
    s_waitcnt vmcnt(2) lgkmcnt(0)
    s_cbranch_vccz VR64
    s_waitcnt vmcnt(0)
VR64:
    s_barrier
    ds_read_b64_tr_b16 v[32:33], v16 offset:0
    ds_read_b64_tr_b16 v[34:35], v16 offset:1024
    ds_read_b128 v[64:67], v12 offset:0
    v_mfma_f32_16x16x32_bf16 v[164:167], v[52:55], v[68:71], v[164:167]
    ds_read_b64_tr_b16 v[36:37], v17 offset:0
    v_mfma_f32_16x16x32_bf16 v[168:171], v[56:59], v[68:71], v[168:171]
    ds_read_b64_tr_b16 v[38:39], v17 offset:1024
    s_add_u32 m0, s36, 65536
    s_nop 0
    buffer_load_dwordx4 v24, s[60:63], s34 offen offset:0 lds
    v_mfma_f32_16x16x32_bf16 v[172:175], v[60:63], v[68:71], v[172:175]
    ds_read_b64_tr_b16 v[40:41], v18 offset:0
    ds_read_b128 v[68:71], v12 offset:2048
    v_mfma_f32_16x16x32_bf16 v[176:179], v[48:51], v[72:75], v[176:179]
    ds_read_b64_tr_b16 v[42:43], v18 offset:1024
    v_mfma_f32_16x16x32_bf16 v[180:183], v[52:55], v[72:75], v[180:183]
    ds_read_b64_tr_b16 v[44:45], v19 offset:0
    buffer_load_dwordx4 v25, s[60:63], s34 offen offset:1024 lds
    v_mfma_f32_16x16x32_bf16 v[184:187], v[56:59], v[72:75], v[184:187]
    ds_read_b64_tr_b16 v[46:47], v19 offset:1024
    v_mfma_f32_16x16x32_bf16 v[188:191], v[60:63], v[72:75], v[188:191]
    ds_read_b128 v[72:75], v12 offset:4096
    v_mfma_f32_16x16x32_bf16 v[192:195], v[48:51], v[76:79], v[192:195]
    buffer_load_dwordx4 v26, s[60:63], s34 offen offset:2048 lds
    v_mfma_f32_16x16x32_bf16 v[196:199], v[52:55], v[76:79], v[196:199]
    v_mfma_f32_16x16x32_bf16 v[200:203], v[56:59], v[76:79], v[200:203]
    v_mfma_f32_16x16x32_bf16 v[204:207], v[60:63], v[76:79], v[204:207]
    ds_read_b128 v[76:79], v12 offset:6144
    s_waitcnt lgkmcnt(8)
    v_mfma_f32_16x16x32_bf16 v[80:83], v[32:35], v[64:67], v[80:83]
    buffer_load_dwordx4 v27, s[60:63], s34 offen offset:3072 lds
    s_add_u32 s34, s34, 128
    s_waitcnt lgkmcnt(6)
    v_mfma_f32_16x16x32_bf16 v[84:87], v[36:39], v[64:67], v[84:87]
    s_waitcnt lgkmcnt(3)
    v_mfma_f32_16x16x32_bf16 v[88:91], v[40:43], v[64:67], v[88:91]
    s_waitcnt lgkmcnt(1)
    v_mfma_f32_16x16x32_bf16 v[92:95], v[44:47], v[64:67], v[92:95]
    ds_read_b128 v[64:67], v12 offset:8192
    v_mfma_f32_16x16x32_bf16 v[96:99], v[32:35], v[68:71], v[96:99]
    s_add_u32 m0, s37, 65536
    s_nop 0
    buffer_load_dwordx4 v8, s[72:75], s35 offen offset:0 lds
    v_mfma_f32_16x16x32_bf16 v[100:103], v[36:39], v[68:71], v[100:103]
    ds_read_b64_tr_b16 v[48:49], v16 offset:8192
    v_mfma_f32_16x16x32_bf16 v[104:107], v[40:43], v[68:71], v[104:107]
    v_mfma_f32_16x16x32_bf16 v[108:111], v[44:47], v[68:71], v[108:111]
    ds_read_b128 v[68:71], v12 offset:10240
    v_mfma_f32_16x16x32_bf16 v[112:115], v[32:35], v[72:75], v[112:115]
    buffer_load_dwordx4 v9, s[72:75], s35 offen offset:1024 lds
    ds_read_b64_tr_b16 v[50:51], v16 offset:9216
    v_mfma_f32_16x16x32_bf16 v[116:119], v[36:39], v[72:75], v[116:119]
    v_mfma_f32_16x16x32_bf16 v[120:123], v[40:43], v[72:75], v[120:123]
    v_mfma_f32_16x16x32_bf16 v[124:127], v[44:47], v[72:75], v[124:127]
    ds_read_b128 v[72:75], v12 offset:12288
    ds_read_b64_tr_b16 v[52:53], v17 offset:8192
    s_waitcnt lgkmcnt(5)
    v_mfma_f32_16x16x32_bf16 v[128:131], v[32:35], v[76:79], v[128:131]
    buffer_load_dwordx4 v10, s[72:75], s35 offen offset:2048 lds
    v_mfma_f32_16x16x32_bf16 v[132:135], v[36:39], v[76:79], v[132:135]
    v_mfma_f32_16x16x32_bf16 v[136:139], v[40:43], v[76:79], v[136:139]
    ds_read_b64_tr_b16 v[54:55], v17 offset:9216
    v_mfma_f32_16x16x32_bf16 v[140:143], v[44:47], v[76:79], v[140:143]
    ds_read_b128 v[76:79], v12 offset:14336
    v_mfma_f32_16x16x32_bf16 v[144:147], v[32:35], v[64:67], v[144:147]
    buffer_load_dwordx4 v11, s[72:75], s35 offen offset:3072 lds
    s_add_u32 s35, s35, 524288
    v_mfma_f32_16x16x32_bf16 v[148:151], v[36:39], v[64:67], v[148:151]
    ds_read_b64_tr_b16 v[56:57], v18 offset:8192
    v_mfma_f32_16x16x32_bf16 v[152:155], v[40:43], v[64:67], v[152:155]
    v_mfma_f32_16x16x32_bf16 v[156:159], v[44:47], v[64:67], v[156:159]
    ds_read_b128 v[64:67], v13 offset:0
    s_waitcnt lgkmcnt(6)
    v_mfma_f32_16x16x32_bf16 v[160:163], v[32:35], v[68:71], v[160:163]
    ds_read_b64_tr_b16 v[58:59], v18 offset:9216
    v_mfma_f32_16x16x32_bf16 v[164:167], v[36:39], v[68:71], v[164:167]
    s_cbranch_vccnz VR57
    buffer_store_dwordx4 v[248:251], v4, s[8:11], s40 offen offset:2048 sc1
VR57:
    v_mfma_f32_16x16x32_bf16 v[168:171], v[40:43], v[68:71], v[168:171]
    v_mfma_f32_16x16x32_bf16 v[172:175], v[44:47], v[68:71], v[172:175]
    ds_read_b128 v[68:71], v13 offset:2048
    ds_read_b64_tr_b16 v[60:61], v19 offset:8192
    s_waitcnt lgkmcnt(7)
    v_mfma_f32_16x16x32_bf16 v[176:179], v[32:35], v[72:75], v[176:179]
    v_mfma_f32_16x16x32_bf16 v[180:183], v[36:39], v[72:75], v[180:183]
    v_mfma_f32_16x16x32_bf16 v[184:187], v[40:43], v[72:75], v[184:187]
    ds_read_b64_tr_b16 v[62:63], v19 offset:9216
    v_mfma_f32_16x16x32_bf16 v[188:191], v[44:47], v[72:75], v[188:191]
    ds_read_b128 v[72:75], v13 offset:4096
    s_waitcnt lgkmcnt(6)
    v_mfma_f32_16x16x32_bf16 v[192:195], v[32:35], v[76:79], v[192:195]
    v_mfma_f32_16x16x32_bf16 v[196:199], v[36:39], v[76:79], v[196:199]
    v_mfma_f32_16x16x32_bf16 v[200:203], v[40:43], v[76:79], v[200:203]
    v_mfma_f32_16x16x32_bf16 v[204:207], v[44:47], v[76:79], v[204:207]
    ds_read_b128 v[76:79], v13 offset:6144
    s_waitcnt lgkmcnt(5)
    v_mfma_f32_16x16x32_bf16 v[80:83], v[48:51], v[64:67], v[80:83]
    v_mfma_f32_16x16x32_bf16 v[84:87], v[52:55], v[64:67], v[84:87]
    v_mfma_f32_16x16x32_bf16 v[88:91], v[56:59], v[64:67], v[88:91]
    s_waitcnt lgkmcnt(1)
    v_mfma_f32_16x16x32_bf16 v[92:95], v[60:63], v[64:67], v[92:95]
    ds_read_b128 v[64:67], v13 offset:8192
    v_mfma_f32_16x16x32_bf16 v[96:99], v[48:51], v[68:71], v[96:99]
    v_mfma_f32_16x16x32_bf16 v[100:103], v[52:55], v[68:71], v[100:103]
    v_mfma_f32_16x16x32_bf16 v[104:107], v[56:59], v[68:71], v[104:107]
    v_mfma_f32_16x16x32_bf16 v[108:111], v[60:63], v[68:71], v[108:111]
    ds_read_b128 v[68:71], v13 offset:10240
    v_mfma_f32_16x16x32_bf16 v[112:115], v[48:51], v[72:75], v[112:115]
    v_mfma_f32_16x16x32_bf16 v[116:119], v[52:55], v[72:75], v[116:119]
    v_mfma_f32_16x16x32_bf16 v[120:123], v[56:59], v[72:75], v[120:123]
    v_mfma_f32_16x16x32_bf16 v[124:127], v[60:63], v[72:75], v[124:127]
    ds_read_b128 v[72:75], v13 offset:12288
    s_waitcnt lgkmcnt(2)
    v_mfma_f32_16x16x32_bf16 v[128:131], v[48:51], v[76:79], v[128:131]
    v_mfma_f32_16x16x32_bf16 v[132:135], v[52:55], v[76:79], v[132:135]
    v_mfma_f32_16x16x32_bf16 v[136:139], v[56:59], v[76:79], v[136:139]
    v_mfma_f32_16x16x32_bf16 v[140:143], v[60:63], v[76:79], v[140:143]
    ds_read_b128 v[76:79], v13 offset:14336
    v_mfma_f32_16x16x32_bf16 v[144:147], v[48:51], v[64:67], v[144:147]
    v_mfma_f32_16x16x32_bf16 v[148:151], v[52:55], v[64:67], v[148:151]
    v_mfma_f32_16x16x32_bf16 v[152:155], v[56:59], v[64:67], v[152:155]
    v_mfma_f32_16x16x32_bf16 v[156:159], v[60:63], v[64:67], v[156:159]
    s_waitcnt lgkmcnt(1)
    v_mfma_f32_16x16x32_bf16 v[160:163], v[48:51], v[68:71], v[160:163]
    s_waitcnt vmcnt(1) lgkmcnt(0)
    s_cbranch_vccz VR65
    s_waitcnt vmcnt(0)
VR65:
    s_barrier
    ds_read_b64_tr_b16 v[32:33], v20 offset:0
    ds_read_b64_tr_b16 v[34:35], v20 offset:1024
    ds_read_b128 v[64:67], v14 offset:0
    v_mfma_f32_16x16x32_bf16 v[164:167], v[52:55], v[68:71], v[164:167]
    ds_read_b64_tr_b16 v[36:37], v21 offset:0
    v_mfma_f32_16x16x32_bf16 v[168:171], v[56:59], v[68:71], v[168:171]
    ds_read_b64_tr_b16 v[38:39], v21 offset:1024
    s_add_u32 m0, s36, 0
    s_nop 0
    buffer_load_dwordx4 v24, s[60:63], s34 offen offset:0 lds
    v_mfma_f32_16x16x32_bf16 v[172:175], v[60:63], v[68:71], v[172:175]
    ds_read_b64_tr_b16 v[40:41], v22 offset:0
    ds_read_b128 v[68:71], v14 offset:2048
    v_mfma_f32_16x16x32_bf16 v[176:179], v[48:51], v[72:75], v[176:179]
    ds_read_b64_tr_b16 v[42:43], v22 offset:1024
    v_mfma_f32_16x16x32_bf16 v[180:183], v[52:55], v[72:75], v[180:183]
    ds_read_b64_tr_b16 v[44:45], v23 offset:0
    buffer_load_dwordx4 v25, s[60:63], s34 offen offset:1024 lds
    v_mfma_f32_16x16x32_bf16 v[184:187], v[56:59], v[72:75], v[184:187]
    ds_read_b64_tr_b16 v[46:47], v23 offset:1024
    v_mfma_f32_16x16x32_bf16 v[188:191], v[60:63], v[72:75], v[188:191]
    ds_read_b128 v[72:75], v14 offset:4096
    v_mfma_f32_16x16x32_bf16 v[192:195], v[48:51], v[76:79], v[192:195]
    buffer_load_dwordx4 v26, s[60:63], s34 offen offset:2048 lds
    v_mfma_f32_16x16x32_bf16 v[196:199], v[52:55], v[76:79], v[196:199]
    v_mfma_f32_16x16x32_bf16 v[200:203], v[56:59], v[76:79], v[200:203]
    v_mfma_f32_16x16x32_bf16 v[204:207], v[60:63], v[76:79], v[204:207]
    ds_read_b128 v[76:79], v14 offset:6144
    s_waitcnt lgkmcnt(8)
    v_mfma_f32_16x16x32_bf16 v[80:83], v[32:35], v[64:67], v[80:83]
    buffer_load_dwordx4 v27, s[60:63], s34 offen offset:3072 lds
    s_add_u32 s34, s34, 128
    s_waitcnt lgkmcnt(6)
    v_mfma_f32_16x16x32_bf16 v[84:87], v[36:39], v[64:67], v[84:87]
    s_waitcnt lgkmcnt(3)
    v_mfma_f32_16x16x32_bf16 v[88:91], v[40:43], v[64:67], v[88:91]
    s_waitcnt lgkmcnt(1)
    v_mfma_f32_16x16x32_bf16 v[92:95], v[44:47], v[64:67], v[92:95]
    ds_read_b128 v[64:67], v14 offset:8192
    v_mfma_f32_16x16x32_bf16 v[96:99], v[32:35], v[68:71], v[96:99]
    s_add_u32 m0, s37, 0
    s_nop 0
    buffer_load_dwordx4 v8, s[72:75], s35 offen offset:0 lds
    v_mfma_f32_16x16x32_bf16 v[100:103], v[36:39], v[68:71], v[100:103]
    ds_read_b64_tr_b16 v[48:49], v20 offset:8192
    v_mfma_f32_16x16x32_bf16 v[104:107], v[40:43], v[68:71], v[104:107]
    v_mfma_f32_16x16x32_bf16 v[108:111], v[44:47], v[68:71], v[108:111]
    ds_read_b128 v[68:71], v14 offset:10240
    v_mfma_f32_16x16x32_bf16 v[112:115], v[32:35], v[72:75], v[112:115]
    buffer_load_dwordx4 v9, s[72:75], s35 offen offset:1024 lds
    ds_read_b64_tr_b16 v[50:51], v20 offset:9216
    v_mfma_f32_16x16x32_bf16 v[116:119], v[36:39], v[72:75], v[116:119]
    v_mfma_f32_16x16x32_bf16 v[120:123], v[40:43], v[72:75], v[120:123]
    v_mfma_f32_16x16x32_bf16 v[124:127], v[44:47], v[72:75], v[124:127]
    ds_read_b128 v[72:75], v14 offset:12288
    ds_read_b64_tr_b16 v[52:53], v21 offset:8192
    s_waitcnt lgkmcnt(5)
    v_mfma_f32_16x16x32_bf16 v[128:131], v[32:35], v[76:79], v[128:131]
    buffer_load_dwordx4 v10, s[72:75], s35 offen offset:2048 lds
    v_mfma_f32_16x16x32_bf16 v[132:135], v[36:39], v[76:79], v[132:135]
    v_mfma_f32_16x16x32_bf16 v[136:139], v[40:43], v[76:79], v[136:139]
    ds_read_b64_tr_b16 v[54:55], v21 offset:9216
    v_mfma_f32_16x16x32_bf16 v[140:143], v[44:47], v[76:79], v[140:143]
    ds_read_b128 v[76:79], v14 offset:14336
    v_mfma_f32_16x16x32_bf16 v[144:147], v[32:35], v[64:67], v[144:147]
    buffer_load_dwordx4 v11, s[72:75], s35 offen offset:3072 lds
    s_add_u32 s35, s35, 524288
    v_mfma_f32_16x16x32_bf16 v[148:151], v[36:39], v[64:67], v[148:151]
    ds_read_b64_tr_b16 v[56:57], v22 offset:8192
    v_mfma_f32_16x16x32_bf16 v[152:155], v[40:43], v[64:67], v[152:155]
    v_mfma_f32_16x16x32_bf16 v[156:159], v[44:47], v[64:67], v[156:159]
    ds_read_b128 v[64:67], v15 offset:0
    s_waitcnt lgkmcnt(6)
    v_mfma_f32_16x16x32_bf16 v[160:163], v[32:35], v[68:71], v[160:163]
    ds_read_b64_tr_b16 v[58:59], v22 offset:9216
    v_mfma_f32_16x16x32_bf16 v[164:167], v[36:39], v[68:71], v[164:167]
    s_cbranch_vccnz VR58
    buffer_store_dwordx4 v[252:255], v4, s[8:11], s40 offen offset:3072 sc1
    s_add_u32 s40, s40, 8192
VR58:
    v_mfma_f32_16x16x32_bf16 v[168:171], v[40:43], v[68:71], v[168:171]
    v_mfma_f32_16x16x32_bf16 v[172:175], v[44:47], v[68:71], v[172:175]
    ds_read_b128 v[68:71], v15 offset:2048
    ds_read_b64_tr_b16 v[60:61], v23 offset:8192
    s_waitcnt lgkmcnt(7)
    v_mfma_f32_16x16x32_bf16 v[176:179], v[32:35], v[72:75], v[176:179]
    v_mfma_f32_16x16x32_bf16 v[180:183], v[36:39], v[72:75], v[180:183]
    v_mfma_f32_16x16x32_bf16 v[184:187], v[40:43], v[72:75], v[184:187]
    ds_read_b64_tr_b16 v[62:63], v23 offset:9216
    v_mfma_f32_16x16x32_bf16 v[188:191], v[44:47], v[72:75], v[188:191]
    ds_read_b128 v[72:75], v15 offset:4096
    s_waitcnt lgkmcnt(6)
    v_mfma_f32_16x16x32_bf16 v[192:195], v[32:35], v[76:79], v[192:195]
    v_mfma_f32_16x16x32_bf16 v[196:199], v[36:39], v[76:79], v[196:199]
    v_mfma_f32_16x16x32_bf16 v[200:203], v[40:43], v[76:79], v[200:203]
    v_mfma_f32_16x16x32_bf16 v[204:207], v[44:47], v[76:79], v[204:207]
    ds_read_b128 v[76:79], v15 offset:6144
    s_waitcnt lgkmcnt(5)
    v_mfma_f32_16x16x32_bf16 v[80:83], v[48:51], v[64:67], v[80:83]
    v_mfma_f32_16x16x32_bf16 v[84:87], v[52:55], v[64:67], v[84:87]
    v_mfma_f32_16x16x32_bf16 v[88:91], v[56:59], v[64:67], v[88:91]
    s_waitcnt lgkmcnt(1)
    v_mfma_f32_16x16x32_bf16 v[92:95], v[60:63], v[64:67], v[92:95]
    ds_read_b128 v[64:67], v15 offset:8192
    v_mfma_f32_16x16x32_bf16 v[96:99], v[48:51], v[68:71], v[96:99]
    v_mfma_f32_16x16x32_bf16 v[100:103], v[52:55], v[68:71], v[100:103]
    v_mfma_f32_16x16x32_bf16 v[104:107], v[56:59], v[68:71], v[104:107]
    v_mfma_f32_16x16x32_bf16 v[108:111], v[60:63], v[68:71], v[108:111]
    ds_read_b128 v[68:71], v15 offset:10240
    v_mfma_f32_16x16x32_bf16 v[112:115], v[48:51], v[72:75], v[112:115]
    s_lshl_b32 s44, s6, 19
    s_add_u32 s44, s44, s36
    s_add_u32 s44, s44, 0x0
    s_add_u32 s45, s44, 0x1000000
    s_mov_b32 s46, s36
    s_add_u32 s47, s36, 98304
    v_mfma_f32_16x16x32_bf16 v[116:119], v[52:55], v[72:75], v[116:119]
    v_mfma_f32_16x16x32_bf16 v[120:123], v[56:59], v[72:75], v[120:123]
    v_mfma_f32_16x16x32_bf16 v[124:127], v[60:63], v[72:75], v[124:127]
    ds_read_b128 v[72:75], v15 offset:12288
    s_waitcnt lgkmcnt(2)
    v_mfma_f32_16x16x32_bf16 v[128:131], v[48:51], v[76:79], v[128:131]
    v_mfma_f32_16x16x32_bf16 v[132:135], v[52:55], v[76:79], v[132:135]
    v_mfma_f32_16x16x32_bf16 v[136:139], v[56:59], v[76:79], v[136:139]
    v_mfma_f32_16x16x32_bf16 v[140:143], v[60:63], v[76:79], v[140:143]
    ds_read_b128 v[76:79], v15 offset:14336
    v_mfma_f32_16x16x32_bf16 v[144:147], v[48:51], v[64:67], v[144:147]
    v_mfma_f32_16x16x32_bf16 v[148:151], v[52:55], v[64:67], v[148:151]
    v_mfma_f32_16x16x32_bf16 v[152:155], v[56:59], v[64:67], v[152:155]
    v_mfma_f32_16x16x32_bf16 v[156:159], v[60:63], v[64:67], v[156:159]
    s_waitcnt lgkmcnt(1)
    v_mfma_f32_16x16x32_bf16 v[160:163], v[48:51], v[68:71], v[160:163]
    s_waitcnt vmcnt(1) lgkmcnt(0)
    s_cbranch_vccz VR66
    s_waitcnt vmcnt(0)
VR66:
    s_barrier
    ds_read_b64_tr_b16 v[32:33], v16 offset:0
    ds_read_b64_tr_b16 v[34:35], v16 offset:1024
    ds_read_b128 v[64:67], v12 offset:0
    v_mfma_f32_16x16x32_bf16 v[164:167], v[52:55], v[68:71], v[164:167]
    ds_read_b64_tr_b16 v[36:37], v17 offset:0
    v_mfma_f32_16x16x32_bf16 v[168:171], v[56:59], v[68:71], v[168:171]
    ds_read_b64_tr_b16 v[38:39], v17 offset:1024
    s_add_u32 m0, s36, 65536
    s_nop 0
    buffer_load_dwordx4 v24, s[60:63], s34 offen offset:0 lds
    v_mfma_f32_16x16x32_bf16 v[172:175], v[60:63], v[68:71], v[172:175]
    ds_read_b64_tr_b16 v[40:41], v18 offset:0
    ds_read_b128 v[68:71], v12 offset:2048
    v_mfma_f32_16x16x32_bf16 v[176:179], v[48:51], v[72:75], v[176:179]
    ds_read_b64_tr_b16 v[42:43], v18 offset:1024
    v_mfma_f32_16x16x32_bf16 v[180:183], v[52:55], v[72:75], v[180:183]
    ds_read_b64_tr_b16 v[44:45], v19 offset:0
    buffer_load_dwordx4 v25, s[60:63], s34 offen offset:1024 lds
    v_mfma_f32_16x16x32_bf16 v[184:187], v[56:59], v[72:75], v[184:187]
    ds_read_b64_tr_b16 v[46:47], v19 offset:1024
    v_mfma_f32_16x16x32_bf16 v[188:191], v[60:63], v[72:75], v[188:191]
    ds_read_b128 v[72:75], v12 offset:4096
    v_mfma_f32_16x16x32_bf16 v[192:195], v[48:51], v[76:79], v[192:195]
    buffer_load_dwordx4 v26, s[60:63], s34 offen offset:2048 lds
    v_mfma_f32_16x16x32_bf16 v[196:199], v[52:55], v[76:79], v[196:199]
    v_mfma_f32_16x16x32_bf16 v[200:203], v[56:59], v[76:79], v[200:203]
    v_mfma_f32_16x16x32_bf16 v[204:207], v[60:63], v[76:79], v[204:207]
    ds_read_b128 v[76:79], v12 offset:6144
    s_waitcnt lgkmcnt(8)
    v_mfma_f32_16x16x32_bf16 v[80:83], v[32:35], v[64:67], v[80:83]
    buffer_load_dwordx4 v27, s[60:63], s34 offen offset:3072 lds
    s_add_u32 s34, s34, 128
    s_waitcnt lgkmcnt(6)
    v_mfma_f32_16x16x32_bf16 v[84:87], v[36:39], v[64:67], v[84:87]
    s_waitcnt lgkmcnt(3)
    v_mfma_f32_16x16x32_bf16 v[88:91], v[40:43], v[64:67], v[88:91]
    s_waitcnt lgkmcnt(1)
    v_mfma_f32_16x16x32_bf16 v[92:95], v[44:47], v[64:67], v[92:95]
    ds_read_b128 v[64:67], v12 offset:8192
    v_mfma_f32_16x16x32_bf16 v[96:99], v[32:35], v[68:71], v[96:99]
    s_add_u32 m0, s37, 65536
    s_nop 0
    buffer_load_dwordx4 v8, s[72:75], s35 offen offset:0 lds
    v_mfma_f32_16x16x32_bf16 v[100:103], v[36:39], v[68:71], v[100:103]
    ds_read_b64_tr_b16 v[48:49], v16 offset:8192
    v_mfma_f32_16x16x32_bf16 v[104:107], v[40:43], v[68:71], v[104:107]
    s_and_b32 s80, s4, 3
    s_lshr_b32 s81, s4, 2
    s_lshl_b32 s81, s81, 3
    v_mfma_f32_16x16x32_bf16 v[108:111], v[44:47], v[68:71], v[108:111]
    ds_read_b128 v[68:71], v12 offset:10240
    s_add_u32 s81, s81, s7
    s_sub_u32 s82, 15, s81
    v_mfma_f32_16x16x32_bf16 v[112:115], v[32:35], v[72:75], v[112:115]
    buffer_load_dwordx4 v9, s[72:75], s35 offen offset:1024 lds
    ds_read_b64_tr_b16 v[50:51], v16 offset:9216
    s_min_u32 s82, s82, s81
    s_and_b32 s83, s5, 3
    v_mfma_f32_16x16x32_bf16 v[116:119], v[36:39], v[72:75], v[116:119]
    s_lshl_b32 s84, s7, 1
    s_sub_u32 s85, 30, s84
    v_mfma_f32_16x16x32_bf16 v[120:123], v[40:43], v[72:75], v[120:123]
    s_lshl_b32 s86, s81, 1
    s_mov_b32 s88, 0xcccc
    s_mov_b32 s89, 0
    v_mfma_f32_16x16x32_bf16 v[124:127], v[44:47], v[72:75], v[124:127]
    ds_read_b128 v[72:75], v12 offset:12288
    ds_read_b64_tr_b16 v[52:53], v17 offset:8192
    s_mov_b32 s90, 0xffff0000
    s_mov_b32 s91, -1
    s_waitcnt lgkmcnt(5)
    v_mfma_f32_16x16x32_bf16 v[128:131], v[32:35], v[76:79], v[128:131]
    buffer_load_dwordx4 v10, s[72:75], s35 offen offset:2048 lds
    v_mov_b32 v24, s85
    v_mov_b32 v25, s84
    v_mfma_f32_16x16x32_bf16 v[132:135], v[36:39], v[76:79], v[132:135]
    v_cndmask_b32 v24, v24, v25, s[88:89]
    v_mov_b32 v25, s86
    v_mfma_f32_16x16x32_bf16 v[136:139], v[40:43], v[76:79], v[136:139]
    ds_read_b64_tr_b16 v[54:55], v17 offset:9216
    v_cndmask_b32 v24, v24, v25, s[90:91]
    v_and_b32 v25, 1, v1
    v_add_u32 v24, v24, v25
    v_mfma_f32_16x16x32_bf16 v[140:143], v[44:47], v[76:79], v[140:143]
    ds_read_b128 v[76:79], v12 offset:14336
    v_mul_u32_u24 v25, 52, v24
    v_lshrrev_b32 v25, 8, v25
    v_mfma_f32_16x16x32_bf16 v[144:147], v[32:35], v[64:67], v[144:147]
    buffer_load_dwordx4 v11, s[72:75], s35 offen offset:3072 lds
    s_add_u32 s35, s35, 524288
    v_lshlrev_b32 v26, 1, v25
    v_sub_u32 v24, v24, v26
    v_mfma_f32_16x16x32_bf16 v[148:151], v[36:39], v[64:67], v[148:151]
    ds_read_b64_tr_b16 v[56:57], v18 offset:8192
    v_add_u32 v24, 3, v24
    v_and_b32 v24, 7, v24
    v_mfma_f32_16x16x32_bf16 v[152:155], v[40:43], v[64:67], v[152:155]
    v_lshl_add_u32 v24, v25, 5, v24
    v_add_u32 v24, 24, v24
    s_mul_i32 s84, s80, 7
    v_mfma_f32_16x16x32_bf16 v[156:159], v[44:47], v[64:67], v[156:159]
    ds_read_b128 v[64:67], v13 offset:0
    v_and_b32 v27, 7, v1
    v_min_u32 v25, 6, v27
    s_waitcnt lgkmcnt(6)
    v_mfma_f32_16x16x32_bf16 v[160:163], v[32:35], v[68:71], v[160:163]
    ds_read_b64_tr_b16 v[58:59], v18 offset:9216
    v_add_u32 v25, s84, v25
    v_min_u32 v25, 26, v25
    v_mfma_f32_16x16x32_bf16 v[164:167], v[36:39], v[68:71], v[164:167]
    v_and_b32 v26, 7, v25
    v_lshlrev_b32 v26, 2, v26
    v_mfma_f32_16x16x32_bf16 v[168:171], v[40:43], v[68:71], v[168:171]
    v_lshrrev_b32 v31, 3, v25
    v_add_u32 v26, v26, v31
    s_lshr_b32 s54, s4, 2
    v_mfma_f32_16x16x32_bf16 v[172:175], v[44:47], v[68:71], v[172:175]
    ds_read_b128 v[68:71], v13 offset:2048
    ds_read_b64_tr_b16 v[60:61], v19 offset:8192
    v_cmp_le_u32 s[88:89], 24, v25
    v_subrev_u32 v25, 24, v25
    v_lshlrev_b32 v25, 3, v25
    s_lshl_b32 s54, s54, 5
    s_waitcnt lgkmcnt(7)
    v_mfma_f32_16x16x32_bf16 v[176:179], v[32:35], v[72:75], v[176:179]
    v_add_u32 v25, s82, v25
    v_mul_u32_u24 v25, 86, v25
    s_add_u32 s54, s54, s5
    v_mfma_f32_16x16x32_bf16 v[180:183], v[36:39], v[72:75], v[180:183]
    v_lshrrev_b32 v25, 8, v25
    v_lshlrev_b32 v25, 2, v25
    s_lshl_b32 s54, s54, 2
    v_mfma_f32_16x16x32_bf16 v[184:187], v[40:43], v[72:75], v[184:187]
    ds_read_b64_tr_b16 v[62:63], v19 offset:9216
    v_add_u32 v25, 3, v25
    v_cndmask_b32 v26, v26, v25, s[88:89]
    v_mfma_f32_16x16x32_bf16 v[188:191], v[44:47], v[72:75], v[188:191]
    ds_read_b128 v[72:75], v13 offset:4096
    v_lshlrev_b32 v26, 3, v26
    v_add_u32 v26, s82, v26
    s_mov_b32 s88, 0x00ff0000
    s_and_b32 s55, s4, 3
    s_waitcnt lgkmcnt(6)
    v_mfma_f32_16x16x32_bf16 v[192:195], v[32:35], v[76:79], v[192:195]
    s_mov_b32 s89, 0
    v_cndmask_b32 v24, v24, v26, s[88:89]
    s_add_u32 s54, s54, s55
    v_mfma_f32_16x16x32_bf16 v[196:199], v[36:39], v[76:79], v[196:199]
    s_and_b32 s84, s4, 4
    s_lshl_b32 s84, s84, 2
    s_lshl_b32 s54, s54, 3
    v_mfma_f32_16x16x32_bf16 v[200:203], v[40:43], v[76:79], v[200:203]
    s_add_u32 s84, s84, s83
    s_lshl_b32 s84, s84, 3
    v_mfma_f32_16x16x32_bf16 v[204:207], v[44:47], v[76:79], v[204:207]
    ds_read_b128 v[76:79], v13 offset:6144
    s_add_u32 s84, s84, s7
    v_and_b32 v25, 3, v1
    v_lshlrev_b32 v25, 5, v25
    s_add_u32 s54, s54, s3
    s_waitcnt lgkmcnt(5)
    v_mfma_f32_16x16x32_bf16 v[80:83], v[48:51], v[64:67], v[80:83]
    v_add_u32 v25, s84, v25
    s_mov_b32 s90, 0xf0000000
    s_mul_i32 s54, s54, 3840
    v_mfma_f32_16x16x32_bf16 v[84:87], v[52:55], v[64:67], v[84:87]
    s_mov_b32 s91, 0
    v_cndmask_b32 v24, v24, v25, s[90:91]
    s_add_u32 s54, s54, 0x4000000
    v_mfma_f32_16x16x32_bf16 v[88:91], v[56:59], v[64:67], v[88:91]
    s_lshl_b32 s84, s6, 3
    v_add_u32 v25, s84, v27
    v_mov_b32 v252, -1
    s_waitcnt lgkmcnt(1)
    v_mfma_f32_16x16x32_bf16 v[92:95], v[60:63], v[64:67], v[92:95]
    ds_read_b128 v[64:67], v13 offset:8192
    s_mov_b32 s88, 0xff
    v_cndmask_b32 v24, v24, v25, s[88:89]
    s_lshl_b32 s84, s80, 6
    v_mfma_f32_16x16x32_bf16 v[96:99], v[48:51], v[68:71], v[96:99]
    s_add_u32 s84, s84, s82
    v_lshlrev_b32 v25, 3, v27
    v_mov_b32 v253, -1
    v_mfma_f32_16x16x32_bf16 v[100:103], v[52:55], v[68:71], v[100:103]
    v_add_u32 v25, s84, v25
    s_mov_b32 s90, 0
    v_mov_b32 v254, -1
    v_mfma_f32_16x16x32_bf16 v[104:107], v[56:59], v[68:71], v[104:107]
    s_mov_b32 s91, -1
    v_cndmask_b32 v24, v24, v25, s[90:91]
    v_mov_b32 v255, -1
    v_mfma_f32_16x16x32_bf16 v[108:111], v[60:63], v[68:71], v[108:111]
    ds_read_b128 v[68:71], v13 offset:10240
    v_lshlrev_b32 v24, 8, v24
    v_add_u32 v1, 0x3900000, v24
    v_mfma_f32_16x16x32_bf16 v[112:115], v[48:51], v[72:75], v[112:115]
    v_mfma_f32_16x16x32_bf16 v[116:119], v[52:55], v[72:75], v[116:119]
    s_mov_b32 exec_lo, 0x1
    s_mov_b32 exec_hi, 0x0
    buffer_load_dword v28, v1, s[8:11], 0 offen sc1
    s_mov_b64 exec, -1
    v_mfma_f32_16x16x32_bf16 v[120:123], v[56:59], v[72:75], v[120:123]
    v_mov_b32 v208, 0
    v_mov_b32 v209, 0
    v_mfma_f32_16x16x32_bf16 v[124:127], v[60:63], v[72:75], v[124:127]
    ds_read_b128 v[72:75], v13 offset:12288
    v_mov_b32 v210, 0
    v_mov_b32 v211, 0
    s_waitcnt lgkmcnt(2)
    v_mfma_f32_16x16x32_bf16 v[128:131], v[48:51], v[76:79], v[128:131]
    v_mov_b32 v212, 0
    v_mov_b32 v213, 0
    v_mfma_f32_16x16x32_bf16 v[132:135], v[52:55], v[76:79], v[132:135]
    v_mov_b32 v214, 0
    v_mov_b32 v215, 0
    v_mfma_f32_16x16x32_bf16 v[136:139], v[56:59], v[76:79], v[136:139]
    v_mov_b32 v216, 0
    v_mov_b32 v217, 0
    v_mfma_f32_16x16x32_bf16 v[140:143], v[60:63], v[76:79], v[140:143]
    ds_read_b128 v[76:79], v13 offset:14336
    v_mov_b32 v218, 0
    v_mov_b32 v219, 0
    v_mfma_f32_16x16x32_bf16 v[144:147], v[48:51], v[64:67], v[144:147]
    v_mov_b32 v220, 0
    v_mov_b32 v221, 0
    v_mfma_f32_16x16x32_bf16 v[148:151], v[52:55], v[64:67], v[148:151]
    v_mov_b32 v222, 0
    v_mov_b32 v223, 0
    v_mfma_f32_16x16x32_bf16 v[152:155], v[56:59], v[64:67], v[152:155]
    v_mov_b32 v224, 0
    v_mov_b32 v225, 0
    v_mfma_f32_16x16x32_bf16 v[156:159], v[60:63], v[64:67], v[156:159]
    v_mov_b32 v226, 0
    v_mov_b32 v227, 0
    s_waitcnt lgkmcnt(1)
    v_mfma_f32_16x16x32_bf16 v[160:163], v[48:51], v[68:71], v[160:163]
    s_waitcnt vmcnt(1) lgkmcnt(0)
    s_barrier
    s_waitcnt vmcnt(0)
    s_add_u32 s26, s38, 1
    v_subrev_u32 v28, s26, v28
    v_cmp_le_u32 vcc, 7, v28
    s_mov_b32 s26, 0x1
    s_mov_b32 s27, 0x0
    s_and_b64 vcc, s[26:27], vcc
    s_cbranch_vccnz PL1_1_S
PL1_1_C:
    ds_read_b64_tr_b16 v[32:33], v20 offset:0
    ds_read_b64_tr_b16 v[34:35], v20 offset:1024
    ds_read_b128 v[64:67], v14 offset:0
    v_mfma_f32_16x16x32_bf16 v[164:167], v[52:55], v[68:71], v[164:167]
    ds_read_b64_tr_b16 v[36:37], v21 offset:0
    v_mfma_f32_16x16x32_bf16 v[168:171], v[56:59], v[68:71], v[168:171]
    ds_read_b64_tr_b16 v[38:39], v21 offset:1024
    s_mov_b32 m0, s46
    s_nop 0
    buffer_load_dwordx4 v4, s[8:11], s44 offen offset:0 sc1 lds
    v_mfma_f32_16x16x32_bf16 v[172:175], v[60:63], v[68:71], v[172:175]
    ds_read_b64_tr_b16 v[40:41], v22 offset:0
    ds_read_b128 v[68:71], v14 offset:2048
    v_mfma_f32_16x16x32_bf16 v[176:179], v[48:51], v[72:75], v[176:179]
    ds_read_b64_tr_b16 v[42:43], v22 offset:1024
    v_mfma_f32_16x16x32_bf16 v[180:183], v[52:55], v[72:75], v[180:183]
    ds_read_b64_tr_b16 v[44:45], v23 offset:0
    buffer_load_dwordx4 v4, s[8:11], s44 offen offset:1024 sc1 lds
    v_mfma_f32_16x16x32_bf16 v[184:187], v[56:59], v[72:75], v[184:187]
    ds_read_b64_tr_b16 v[46:47], v23 offset:1024
    v_mfma_f32_16x16x32_bf16 v[188:191], v[60:63], v[72:75], v[188:191]
    ds_read_b128 v[72:75], v14 offset:4096
    v_mfma_f32_16x16x32_bf16 v[192:195], v[48:51], v[76:79], v[192:195]
    buffer_load_dwordx4 v4, s[8:11], s44 offen offset:2048 sc1 lds
    v_mfma_f32_16x16x32_bf16 v[196:199], v[52:55], v[76:79], v[196:199]
    v_mfma_f32_16x16x32_bf16 v[200:203], v[56:59], v[76:79], v[200:203]
    v_mfma_f32_16x16x32_bf16 v[204:207], v[60:63], v[76:79], v[204:207]
    ds_read_b128 v[76:79], v14 offset:6144
    s_waitcnt lgkmcnt(8)
    v_mfma_f32_16x16x32_bf16 v[80:83], v[32:35], v[64:67], v[80:83]
    buffer_load_dwordx4 v4, s[8:11], s44 offen offset:3072 sc1 lds
    s_add_u32 s44, s44, 32768
    s_xor_b32 s46, s46, 0x10000
    v_mov_b32 v228, 0
    v_mov_b32 v229, 0
    s_waitcnt lgkmcnt(6)
    v_mfma_f32_16x16x32_bf16 v[84:87], v[36:39], v[64:67], v[84:87]
    v_mov_b32 v230, 0
    s_waitcnt lgkmcnt(3)
    v_mfma_f32_16x16x32_bf16 v[88:91], v[40:43], v[64:67], v[88:91]
    v_mov_b32 v231, 0
    s_waitcnt lgkmcnt(1)
    v_mfma_f32_16x16x32_bf16 v[92:95], v[44:47], v[64:67], v[92:95]
    ds_read_b128 v[64:67], v14 offset:8192
    v_mov_b32 v232, 0
    v_mfma_f32_16x16x32_bf16 v[96:99], v[32:35], v[68:71], v[96:99]
    v_mov_b32 v233, 0
    v_mfma_f32_16x16x32_bf16 v[100:103], v[36:39], v[68:71], v[100:103]
    ds_read_b64_tr_b16 v[48:49], v20 offset:8192
    v_mov_b32 v234, 0
    v_mfma_f32_16x16x32_bf16 v[104:107], v[40:43], v[68:71], v[104:107]
    v_mov_b32 v235, 0
    v_mfma_f32_16x16x32_bf16 v[108:111], v[44:47], v[68:71], v[108:111]
    ds_read_b128 v[68:71], v14 offset:10240
    v_mov_b32 v236, 0
    v_mov_b32 v237, 0
    v_mfma_f32_16x16x32_bf16 v[112:115], v[32:35], v[72:75], v[112:115]
    ds_read_b64_tr_b16 v[50:51], v20 offset:9216
    v_mov_b32 v238, 0
    v_mfma_f32_16x16x32_bf16 v[116:119], v[36:39], v[72:75], v[116:119]
    v_mov_b32 v239, 0
    v_mfma_f32_16x16x32_bf16 v[120:123], v[40:43], v[72:75], v[120:123]
    v_mov_b32 v240, 0
    v_mfma_f32_16x16x32_bf16 v[124:127], v[44:47], v[72:75], v[124:127]
    ds_read_b128 v[72:75], v14 offset:12288
    ds_read_b64_tr_b16 v[52:53], v21 offset:8192
    v_mov_b32 v241, 0
    s_waitcnt lgkmcnt(5)
    v_mfma_f32_16x16x32_bf16 v[128:131], v[32:35], v[76:79], v[128:131]
    v_mov_b32 v242, 0
    v_mfma_f32_16x16x32_bf16 v[132:135], v[36:39], v[76:79], v[132:135]
    v_mov_b32 v243, 0
    v_mfma_f32_16x16x32_bf16 v[136:139], v[40:43], v[76:79], v[136:139]
    ds_read_b64_tr_b16 v[54:55], v21 offset:9216
    v_mov_b32 v244, 0
    v_mov_b32 v245, 0
    v_mfma_f32_16x16x32_bf16 v[140:143], v[44:47], v[76:79], v[140:143]
    ds_read_b128 v[76:79], v14 offset:14336
    v_mov_b32 v246, 0
    v_mfma_f32_16x16x32_bf16 v[144:147], v[32:35], v[64:67], v[144:147]
    v_mov_b32 v247, 0
    v_mfma_f32_16x16x32_bf16 v[148:151], v[36:39], v[64:67], v[148:151]
    ds_read_b64_tr_b16 v[56:57], v22 offset:8192
    v_mov_b32 v248, 0
    v_mfma_f32_16x16x32_bf16 v[152:155], v[40:43], v[64:67], v[152:155]
    v_mov_b32 v249, 0
    v_mfma_f32_16x16x32_bf16 v[156:159], v[44:47], v[64:67], v[156:159]
    ds_read_b128 v[64:67], v15 offset:0
    v_mov_b32 v250, 0
    s_waitcnt lgkmcnt(6)
    v_mfma_f32_16x16x32_bf16 v[160:163], v[32:35], v[68:71], v[160:163]
    ds_read_b64_tr_b16 v[58:59], v22 offset:9216
    v_mov_b32 v251, 0
    v_mfma_f32_16x16x32_bf16 v[164:167], v[36:39], v[68:71], v[164:167]
    v_mov_b32 v5, v4
    v_add_u32 v6, 98304, v4
    v_mfma_f32_16x16x32_bf16 v[168:171], v[40:43], v[68:71], v[168:171]
    s_and_b32 s24, s3, 3
    s_lshl_b32 s25, s24, 13
    buffer_store_dwordx4 v[252:255], v4, s[8:11], s54 offen offset:0 sc1
    v_mfma_f32_16x16x32_bf16 v[172:175], v[44:47], v[68:71], v[172:175]
    ds_read_b128 v[68:71], v15 offset:2048
    ds_read_b64_tr_b16 v[60:61], v23 offset:8192
    s_add_u32 s25, s25, 32768
    v_add_u32 v8, s25, v4
    s_waitcnt lgkmcnt(7)
    v_mfma_f32_16x16x32_bf16 v[176:179], v[32:35], v[72:75], v[176:179]
    s_add_u32 s48, s7, 0
    s_sub_u32 s49, 7, s7
    v_mfma_f32_16x16x32_bf16 v[180:183], v[36:39], v[72:75], v[180:183]
    s_mov_b32 s52, 0x4000
    s_mov_b32 s53, 0x43800000
    v_mfma_f32_16x16x32_bf16 v[184:187], v[40:43], v[72:75], v[184:187]
    ds_read_b64_tr_b16 v[62:63], v23 offset:9216
    s_lshl_b32 s25, s6, 15
    s_add_u32 s25, s25, 0x206c000
    v_mfma_f32_16x16x32_bf16 v[188:191], v[44:47], v[72:75], v[188:191]
    ds_read_b128 v[72:75], v15 offset:4096
    s_lshl_b32 s26, s24, 12
    s_add_u32 s25, s25, s26
    s_waitcnt lgkmcnt(6)
    v_mfma_f32_16x16x32_bf16 v[192:195], v[32:35], v[76:79], v[192:195]
    s_mul_i32 s26, s7, 1490944
    s_add_u32 s58, s25, s26
    buffer_store_dwordx4 v[252:255], v4, s[8:11], s54 offen offset:1024 sc1
    v_mfma_f32_16x16x32_bf16 v[196:199], v[36:39], v[76:79], v[196:199]
    s_sub_u32 s26, 15, s7
    v_mfma_f32_16x16x32_bf16 v[200:203], v[40:43], v[76:79], v[200:203]
    s_mul_i32 s26, s26, 1490944
    s_add_u32 s57, s25, s26
    v_mfma_f32_16x16x32_bf16 v[204:207], v[44:47], v[76:79], v[204:207]
    ds_read_b128 v[76:79], v15 offset:6144
    s_add_u32 s57, s57, 2048
    s_mov_b32 s50, 1
    s_waitcnt lgkmcnt(5)
    v_mfma_f32_16x16x32_bf16 v[80:83], v[48:51], v[64:67], v[80:83]
    s_mov_b32 s59, 0
    s_mov_b32 s56, 0
    v_mfma_f32_16x16x32_bf16 v[84:87], v[52:55], v[64:67], v[84:87]
    s_mov_b32 s31, 3
    s_and_b32 s27, s3, 3
    v_mfma_f32_16x16x32_bf16 v[88:91], v[56:59], v[64:67], v[88:91]
    s_lshl_b32 s27, s27, 5
    v_lshlrev_b32 v29, 2, v3
    buffer_store_dwordx4 v[252:255], v4, s[8:11], s54 offen offset:2048 sc1
    s_waitcnt lgkmcnt(1)
    v_mfma_f32_16x16x32_bf16 v[92:95], v[60:63], v[64:67], v[92:95]
    ds_read_b128 v[64:67], v15 offset:8192
    v_sub_u32 v29, v2, v29
    v_add_u32 v29, s27, v29
    v_mfma_f32_16x16x32_bf16 v[96:99], v[48:51], v[68:71], v[96:99]
    v_cmp_gt_i32 s[60:61], -16, v29
    v_cmp_gt_i32 s[62:63], -15, v29
    v_mfma_f32_16x16x32_bf16 v[100:103], v[52:55], v[68:71], v[100:103]
    v_cmp_gt_i32 s[64:65], -14, v29
    v_cmp_gt_i32 s[66:67], -13, v29
    v_mfma_f32_16x16x32_bf16 v[104:107], v[56:59], v[68:71], v[104:107]
    v_cmp_gt_i32 s[68:69], 0, v29
    v_mfma_f32_16x16x32_bf16 v[108:111], v[60:63], v[68:71], v[108:111]
    ds_read_b128 v[68:71], v15 offset:10240
    v_cmp_gt_i32 s[70:71], 1, v29
    v_cmp_gt_i32 s[72:73], 2, v29
    v_mfma_f32_16x16x32_bf16 v[112:115], v[48:51], v[72:75], v[112:115]
    v_cmp_gt_i32 s[74:75], 3, v29
    v_cmp_gt_i32 s[76:77], 16, v29
    s_mov_b32 exec_hi, 0xffff
    buffer_store_dwordx4 v[252:255], v4, s[8:11], s54 offen offset:3072 sc1
    s_mov_b32 exec_hi, -1
    v_mfma_f32_16x16x32_bf16 v[116:119], v[52:55], v[72:75], v[116:119]
    v_cmp_gt_i32 s[78:79], 17, v29
    v_cmp_gt_i32 s[80:81], 18, v29
    v_mfma_f32_16x16x32_bf16 v[120:123], v[56:59], v[72:75], v[120:123]
    v_cmp_gt_i32 s[82:83], 19, v29
    v_cmp_gt_i32 s[84:85], 32, v29
    v_mfma_f32_16x16x32_bf16 v[124:127], v[60:63], v[72:75], v[124:127]
    ds_read_b128 v[72:75], v15 offset:12288
    v_cmp_gt_i32 s[86:87], 33, v29
    v_cmp_gt_i32 s[88:89], 34, v29
    s_waitcnt lgkmcnt(2)
    v_mfma_f32_16x16x32_bf16 v[128:131], v[48:51], v[76:79], v[128:131]
    v_cmp_gt_i32 s[90:91], 35, v29
    v_cmp_gt_i32 s[92:93], 48, v29
    v_mfma_f32_16x16x32_bf16 v[132:135], v[52:55], v[76:79], v[132:135]
    v_cmp_gt_i32 s[94:95], 49, v29
    v_cmp_gt_i32 s[96:97], 50, v29
    v_mfma_f32_16x16x32_bf16 v[136:139], v[56:59], v[76:79], v[136:139]
    v_cmp_gt_i32 s[98:99], 51, v29
    v_mfma_f32_16x16x32_bf16 v[140:143], v[60:63], v[76:79], v[140:143]
    ds_read_b128 v[76:79], v15 offset:14336
    v_mfma_f32_16x16x32_bf16 v[144:147], v[48:51], v[64:67], v[144:147]
    s_waitcnt vmcnt(4) lgkmcnt(0)
    s_barrier
    v_mfma_f32_16x16x32_bf16 v[148:151], v[52:55], v[64:67], v[148:151]
    s_mov_b32 m0, s47
    s_nop 0
    buffer_load_dwordx4 v4, s[8:11], s45 offen offset:0 sc1 lds
    v_mfma_f32_16x16x32_bf16 v[152:155], v[56:59], v[64:67], v[152:155]
    v_mfma_f32_16x16x32_bf16 v[156:159], v[60:63], v[64:67], v[156:159]
    v_mfma_f32_16x16x32_bf16 v[160:163], v[48:51], v[68:71], v[160:163]
    buffer_load_dwordx4 v4, s[8:11], s45 offen offset:1024 sc1 lds
    v_mfma_f32_16x16x32_bf16 v[164:167], v[52:55], v[68:71], v[164:167]
    v_mfma_f32_16x16x32_bf16 v[168:171], v[56:59], v[68:71], v[168:171]
    v_mfma_f32_16x16x32_bf16 v[172:175], v[60:63], v[68:71], v[172:175]
    v_mfma_f32_16x16x32_bf16 v[176:179], v[48:51], v[72:75], v[176:179]
    buffer_load_dwordx4 v4, s[8:11], s45 offen offset:2048 sc1 lds
    v_mfma_f32_16x16x32_bf16 v[180:183], v[52:55], v[72:75], v[180:183]
    v_mfma_f32_16x16x32_bf16 v[184:187], v[56:59], v[72:75], v[184:187]
    v_mfma_f32_16x16x32_bf16 v[188:191], v[60:63], v[72:75], v[188:191]
    buffer_load_dwordx4 v4, s[8:11], s45 offen offset:3072 sc1 lds
    s_add_u32 s45, s45, 32768
    s_xor_b32 s47, s47, 0x10000
    v_mfma_f32_16x16x32_bf16 v[192:195], v[48:51], v[76:79], v[192:195]
    v_mfma_f32_16x16x32_bf16 v[196:199], v[52:55], v[76:79], v[196:199]
    v_mfma_f32_16x16x32_bf16 v[200:203], v[56:59], v[76:79], v[200:203]
    v_mfma_f32_16x16x32_bf16 v[204:207], v[60:63], v[76:79], v[204:207]
    s_nop 1
    v_mov_b32 v11, 0
    v_mov_b32 v12, 0
    v_mov_b32 v15, 0xff61b1e6
    ds_read_b128 v[64:67], v5 offset:0
    ds_read_b128 v[68:71], v5 offset:1024
    ds_read_b128 v[72:75], v5 offset:2048
    ds_read_b128 v[76:79], v5 offset:3072
    s_bitcmp1_b32 s3, 1
    s_cselect_b32 s24, 32, 0
    s_cselect_b32 s25, 0, 128
    s_add_u32 s24, s24, s25
    s_and_b32 s25, s3, 1
    s_lshl_b32 s25, s25, 1
    s_add_u32 s24, s24, s25
    s_lshl_b32 s24, s24, 10
    v_add_u32 v29, s24, v4
    s_mov_b32 s24, 0x3e0293ee
    s_mov_b32 s25, s24
    v_pk_mul_f32 v[80:81], v[80:81], s[24:25]
    v_pk_mul_f32 v[82:83], v[82:83], s[24:25]
    v_pk_mul_f32 v[84:85], v[84:85], s[24:25]
    v_pk_mul_f32 v[86:87], v[86:87], s[24:25]
    v_cvt_pk_bf16_f32 v32, v80, v81
    v_cvt_pk_bf16_f32 v33, v82, v83
    v_cvt_pk_bf16_f32 v34, v84, v85
    v_cvt_pk_bf16_f32 v35, v86, v87
    ds_write_b128 v29, v[32:35] offset:0
    v_pk_mul_f32 v[88:89], v[88:89], s[24:25]
    v_pk_mul_f32 v[90:91], v[90:91], s[24:25]
    v_pk_mul_f32 v[92:93], v[92:93], s[24:25]
    v_pk_mul_f32 v[94:95], v[94:95], s[24:25]
    v_cvt_pk_bf16_f32 v36, v88, v89
    v_cvt_pk_bf16_f32 v37, v90, v91
    v_cvt_pk_bf16_f32 v38, v92, v93
    v_cvt_pk_bf16_f32 v39, v94, v95
    ds_write_b128 v29, v[36:39] offset:1024
    ds_read_b128 v[80:83], v5 offset:4096
    ds_read_b128 v[84:87], v5 offset:5120
    v_pk_mul_f32 v[96:97], v[96:97], s[24:25]
    v_pk_mul_f32 v[98:99], v[98:99], s[24:25]
    v_pk_mul_f32 v[100:101], v[100:101], s[24:25]
    v_pk_mul_f32 v[102:103], v[102:103], s[24:25]
    v_cvt_pk_bf16_f32 v40, v96, v97
    v_cvt_pk_bf16_f32 v41, v98, v99
    v_cvt_pk_bf16_f32 v42, v100, v101
    v_cvt_pk_bf16_f32 v43, v102, v103
    ds_write_b128 v29, v[40:43] offset:4096
    v_pk_mul_f32 v[104:105], v[104:105], s[24:25]
    v_pk_mul_f32 v[106:107], v[106:107], s[24:25]
    v_pk_mul_f32 v[108:109], v[108:109], s[24:25]
    v_pk_mul_f32 v[110:111], v[110:111], s[24:25]
    v_cvt_pk_bf16_f32 v44, v104, v105
    v_cvt_pk_bf16_f32 v45, v106, v107
    v_cvt_pk_bf16_f32 v46, v108, v109
    v_cvt_pk_bf16_f32 v47, v110, v111
    ds_write_b128 v29, v[44:47] offset:5120
    v_pk_mul_f32 v[112:113], v[112:113], s[24:25]
    v_pk_mul_f32 v[114:115], v[114:115], s[24:25]
    v_pk_mul_f32 v[116:117], v[116:117], s[24:25]
    v_pk_mul_f32 v[118:119], v[118:119], s[24:25]
    v_cvt_pk_bf16_f32 v48, v112, v113
    v_cvt_pk_bf16_f32 v49, v114, v115
    v_cvt_pk_bf16_f32 v50, v116, v117
    v_cvt_pk_bf16_f32 v51, v118, v119
    ds_write_b128 v29, v[48:51] offset:8192
    v_pk_mul_f32 v[120:121], v[120:121], s[24:25]
    v_pk_mul_f32 v[122:123], v[122:123], s[24:25]
    v_pk_mul_f32 v[124:125], v[124:125], s[24:25]
    v_pk_mul_f32 v[126:127], v[126:127], s[24:25]
    v_cvt_pk_bf16_f32 v52, v120, v121
    v_cvt_pk_bf16_f32 v53, v122, v123
    v_cvt_pk_bf16_f32 v54, v124, v125
    v_cvt_pk_bf16_f32 v55, v126, v127
    ds_write_b128 v29, v[52:55] offset:9216
    v_pk_mul_f32 v[128:129], v[128:129], s[24:25]
    v_pk_mul_f32 v[130:131], v[130:131], s[24:25]
    v_pk_mul_f32 v[132:133], v[132:133], s[24:25]
    v_pk_mul_f32 v[134:135], v[134:135], s[24:25]
    v_cvt_pk_bf16_f32 v56, v128, v129
    v_cvt_pk_bf16_f32 v57, v130, v131
    v_cvt_pk_bf16_f32 v58, v132, v133
    v_cvt_pk_bf16_f32 v59, v134, v135
    ds_write_b128 v29, v[56:59] offset:12288
    v_pk_mul_f32 v[136:137], v[136:137], s[24:25]
    v_pk_mul_f32 v[138:139], v[138:139], s[24:25]
    v_pk_mul_f32 v[140:141], v[140:141], s[24:25]
    v_pk_mul_f32 v[142:143], v[142:143], s[24:25]
    v_cvt_pk_bf16_f32 v60, v136, v137
    v_cvt_pk_bf16_f32 v61, v138, v139
    v_cvt_pk_bf16_f32 v62, v140, v141
    v_cvt_pk_bf16_f32 v63, v142, v143
    ds_write_b128 v29, v[60:63] offset:13312
    v_pk_mul_f32 v[144:145], v[144:145], s[24:25]
    v_pk_mul_f32 v[146:147], v[146:147], s[24:25]
    v_pk_mul_f32 v[148:149], v[148:149], s[24:25]
    v_pk_mul_f32 v[150:151], v[150:151], s[24:25]
    v_cvt_pk_bf16_f32 v32, v144, v145
    v_cvt_pk_bf16_f32 v33, v146, v147
    v_cvt_pk_bf16_f32 v34, v148, v149
    v_cvt_pk_bf16_f32 v35, v150, v151
    ds_write_b128 v29, v[32:35] offset:16384
    v_pk_mul_f32 v[152:153], v[152:153], s[24:25]
    v_pk_mul_f32 v[154:155], v[154:155], s[24:25]
    v_pk_mul_f32 v[156:157], v[156:157], s[24:25]
    v_pk_mul_f32 v[158:159], v[158:159], s[24:25]
    v_cvt_pk_bf16_f32 v36, v152, v153
    v_cvt_pk_bf16_f32 v37, v154, v155
    v_cvt_pk_bf16_f32 v38, v156, v157
    v_cvt_pk_bf16_f32 v39, v158, v159
    ds_write_b128 v29, v[36:39] offset:17408
    v_pk_mul_f32 v[160:161], v[160:161], s[24:25]
    v_pk_mul_f32 v[162:163], v[162:163], s[24:25]
    v_pk_mul_f32 v[164:165], v[164:165], s[24:25]
    v_pk_mul_f32 v[166:167], v[166:167], s[24:25]
    v_cvt_pk_bf16_f32 v40, v160, v161
    v_cvt_pk_bf16_f32 v41, v162, v163
    v_cvt_pk_bf16_f32 v42, v164, v165
    v_cvt_pk_bf16_f32 v43, v166, v167
    ds_write_b128 v29, v[40:43] offset:20480
    v_pk_mul_f32 v[168:169], v[168:169], s[24:25]
    v_pk_mul_f32 v[170:171], v[170:171], s[24:25]
    v_pk_mul_f32 v[172:173], v[172:173], s[24:25]
    v_pk_mul_f32 v[174:175], v[174:175], s[24:25]
    v_cvt_pk_bf16_f32 v44, v168, v169
    v_cvt_pk_bf16_f32 v45, v170, v171
    v_cvt_pk_bf16_f32 v46, v172, v173
    v_cvt_pk_bf16_f32 v47, v174, v175
    ds_write_b128 v29, v[44:47] offset:21504
    v_pk_mul_f32 v[176:177], v[176:177], s[24:25]
    v_pk_mul_f32 v[178:179], v[178:179], s[24:25]
    v_pk_mul_f32 v[180:181], v[180:181], s[24:25]
    v_pk_mul_f32 v[182:183], v[182:183], s[24:25]
    v_cvt_pk_bf16_f32 v48, v176, v177
    v_cvt_pk_bf16_f32 v49, v178, v179
    v_cvt_pk_bf16_f32 v50, v180, v181
    v_cvt_pk_bf16_f32 v51, v182, v183
    ds_write_b128 v29, v[48:51] offset:24576
    v_pk_mul_f32 v[184:185], v[184:185], s[24:25]
    v_pk_mul_f32 v[186:187], v[186:187], s[24:25]
    v_pk_mul_f32 v[188:189], v[188:189], s[24:25]
    v_pk_mul_f32 v[190:191], v[190:191], s[24:25]
    v_cvt_pk_bf16_f32 v52, v184, v185
    v_cvt_pk_bf16_f32 v53, v186, v187
    v_cvt_pk_bf16_f32 v54, v188, v189
    v_cvt_pk_bf16_f32 v55, v190, v191
    ds_write_b128 v29, v[52:55] offset:25600
    v_pk_mul_f32 v[192:193], v[192:193], s[24:25]
    v_pk_mul_f32 v[194:195], v[194:195], s[24:25]
    v_pk_mul_f32 v[196:197], v[196:197], s[24:25]
    v_pk_mul_f32 v[198:199], v[198:199], s[24:25]
    v_cvt_pk_bf16_f32 v56, v192, v193
    v_cvt_pk_bf16_f32 v57, v194, v195
    v_cvt_pk_bf16_f32 v58, v196, v197
    v_cvt_pk_bf16_f32 v59, v198, v199
    ds_write_b128 v29, v[56:59] offset:28672
    v_pk_mul_f32 v[200:201], v[200:201], s[24:25]
    v_pk_mul_f32 v[202:203], v[202:203], s[24:25]
    v_pk_mul_f32 v[204:205], v[204:205], s[24:25]
    v_pk_mul_f32 v[206:207], v[206:207], s[24:25]
    v_cvt_pk_bf16_f32 v60, v200, v201
    v_cvt_pk_bf16_f32 v61, v202, v203
    v_cvt_pk_bf16_f32 v62, v204, v205
    v_cvt_pk_bf16_f32 v63, v206, v207
    ds_write_b128 v29, v[60:63] offset:29696
    v_mov_b64 v[192:193], 0
    v_mov_b64 v[194:195], 0
    v_mov_b64 v[196:197], 0
    v_mov_b64 v[198:199], 0
    v_mov_b64 v[200:201], 0
    v_mov_b64 v[202:203], 0
    v_mov_b64 v[204:205], 0
    v_mov_b64 v[206:207], 0
    v_mov_b64 v[252:253], 0
    v_mov_b64 v[254:255], 0
    s_waitcnt lgkmcnt(0)
    s_barrier
    s_setprio 0
    ds_read_b128 v[160:163], v8 offset:0
    ds_read_b128 v[164:167], v8 offset:1024
    ds_read_b128 v[168:171], v8 offset:2048
    ds_read_b128 v[172:175], v8 offset:3072
    ds_read_b128 v[176:179], v8 offset:4096
    ds_read_b128 v[180:183], v8 offset:5120
    ds_read_b128 v[184:187], v8 offset:6144
    ds_read_b128 v[188:191], v8 offset:7168
    s_waitcnt lgkmcnt(6)
    v_mfma_f32_16x16x32_bf16 v[128:131], v[64:67], v[160:163], 0
    ds_read_b128 v[88:91], v5 offset:6144
    s_waitcnt lgkmcnt(3)
    v_mfma_f32_16x16x32_bf16 v[132:135], v[64:67], v[176:179], 0
    v_mfma_f32_16x16x32_bf16 v[128:131], v[68:71], v[164:167], v[128:131]
    ds_read_b128 v[92:95], v5 offset:7168
    v_mfma_f32_16x16x32_bf16 v[132:135], v[68:71], v[180:183], v[132:135]
    v_mfma_f32_16x16x32_bf16 v[128:131], v[72:75], v[168:171], v[128:131]
    ds_read_b128 v[64:67], v5 offset:8192
    s_waitcnt lgkmcnt(3)
    v_mfma_f32_16x16x32_bf16 v[132:135], v[72:75], v[184:187], v[132:135]
    v_mfma_f32_16x16x32_bf16 v[128:131], v[76:79], v[172:175], v[128:131]
    ds_read_b128 v[68:71], v5 offset:9216
    v_mfma_f32_16x16x32_bf16 v[132:135], v[76:79], v[188:191], v[132:135]
    v_mfma_f32_16x16x32_bf16 v[136:139], v[80:83], v[160:163], 0
    ds_read_b128 v[72:75], v5 offset:10240
    v_mfma_f32_16x16x32_bf16 v[140:143], v[80:83], v[176:179], 0
    v_mfma_f32_16x16x32_bf16 v[136:139], v[84:87], v[164:167], v[136:139]
    ds_read_b128 v[76:79], v5 offset:11264
    v_mfma_f32_16x16x32_bf16 v[140:143], v[84:87], v[180:183], v[140:143]
    s_waitcnt lgkmcnt(4)
    v_mfma_f32_16x16x32_bf16 v[136:139], v[88:91], v[168:171], v[136:139]
    ds_read_b128 v[80:83], v5 offset:12288
    v_mfma_f32_16x16x32_bf16 v[140:143], v[88:91], v[184:187], v[140:143]
    v_mfma_f32_16x16x32_bf16 v[136:139], v[92:95], v[172:175], v[136:139]
    ds_read_b128 v[84:87], v5 offset:13312
    v_mfma_f32_16x16x32_bf16 v[140:143], v[92:95], v[188:191], v[140:143]
    s_waitcnt lgkmcnt(4)
    v_mfma_f32_16x16x32_bf16 v[144:147], v[64:67], v[160:163], 0
    ds_read_b128 v[88:91], v5 offset:14336
    v_mfma_f32_16x16x32_bf16 v[148:151], v[64:67], v[176:179], 0
    v_mfma_f32_16x16x32_bf16 v[144:147], v[68:71], v[164:167], v[144:147]
    ds_read_b128 v[92:95], v5 offset:15360
    v_mfma_f32_16x16x32_bf16 v[148:151], v[68:71], v[180:183], v[148:151]
    s_waitcnt lgkmcnt(4)
    v_mfma_f32_16x16x32_bf16 v[144:147], v[72:75], v[168:171], v[144:147]
    v_xor_b32 v5, 0x4000, v5
    ds_read_b128 v[64:67], v5 offset:0
    v_mfma_f32_16x16x32_bf16 v[148:151], v[72:75], v[184:187], v[148:151]
    v_mfma_f32_16x16x32_bf16 v[144:147], v[76:79], v[172:175], v[144:147]
    ds_read_b128 v[68:71], v5 offset:1024
    v_mfma_f32_16x16x32_bf16 v[148:151], v[76:79], v[188:191], v[148:151]
    s_waitcnt lgkmcnt(4)
    v_mfma_f32_16x16x32_bf16 v[152:155], v[80:83], v[160:163], 0
    ds_read_b128 v[72:75], v5 offset:2048
    v_mfma_f32_16x16x32_bf16 v[156:159], v[80:83], v[176:179], 0
    v_mfma_f32_16x16x32_bf16 v[152:155], v[84:87], v[164:167], v[152:155]
    ds_read_b128 v[76:79], v5 offset:3072
    v_mfma_f32_16x16x32_bf16 v[156:159], v[84:87], v[180:183], v[156:159]
    s_waitcnt lgkmcnt(4)
    v_mfma_f32_16x16x32_bf16 v[152:155], v[88:91], v[168:171], v[152:155]
    ds_read_b128 v[80:83], v5 offset:4096
    v_mfma_f32_16x16x32_bf16 v[156:159], v[88:91], v[184:187], v[156:159]
    v_mfma_f32_16x16x32_bf16 v[152:155], v[92:95], v[172:175], v[152:155]
    ds_read_b128 v[84:87], v5 offset:5120
    v_mfma_f32_16x16x32_bf16 v[156:159], v[92:95], v[188:191], v[156:159]
    s_cmp_eq_u32 s48, 0
    s_nop 0
    s_cbranch_scc1 PRO_M
PRO_MB:
    v_max3_f32 v16, v128, v129, v130
    v_max3_f32 v17, v132, v133, v134
    v_max3_f32 v16, v16, v131, v136
    v_max3_f32 v17, v17, v135, v140
    v_max3_f32 v16, v16, v137, v138
    v_max3_f32 v17, v17, v141, v142
    v_max3_f32 v16, v16, v139, v144
    v_max3_f32 v17, v17, v143, v148
    v_max3_f32 v16, v16, v145, v146
    v_max3_f32 v17, v17, v149, v150
    v_max3_f32 v16, v16, v147, v152
    v_max3_f32 v17, v17, v151, v156
    v_max3_f32 v16, v16, v153, v154
    v_max3_f32 v17, v17, v157, v158
    v_max_f32 v16, v16, v155
    v_max_f32 v17, v17, v159
    v_mov_b32 v18, v16
    s_nop 1
    v_permlane32_swap_b32 v18, v16
    s_nop 1
    v_max_f32 v16, v16, v18
    v_mov_b32 v18, v16
    s_nop 1
    v_permlane16_swap_b32 v18, v16
    s_nop 1
    v_max_f32 v16, v16, v18
    v_max_f32 v16, 0xf149f2ca, v16
    v_mov_b32 v19, v17
    s_nop 1
    v_permlane32_swap_b32 v19, v17
    s_nop 1
    v_max_f32 v17, v17, v19
    v_mov_b32 v19, v17
    s_nop 1
    v_permlane16_swap_b32 v19, v17
    s_nop 1
    v_max_f32 v17, v17, v19
    v_max_f32 v17, 0xf149f2ca, v17
    v_sub_f32 v32, 0, v16
    v_sub_f32 v33, 0, v16
    v_sub_f32 v34, 0, v16
    v_sub_f32 v35, 0, v16
    v_sub_f32 v36, 0, v17
    v_sub_f32 v37, 0, v17
    v_sub_f32 v38, 0, v17
    v_sub_f32 v39, 0, v17
    v_pk_add_f32 v[128:129], v[128:129], v[32:33]
    v_pk_add_f32 v[130:131], v[130:131], v[32:33]
    v_pk_add_f32 v[136:137], v[136:137], v[32:33]
    v_pk_add_f32 v[138:139], v[138:139], v[32:33]
    v_pk_add_f32 v[132:133], v[132:133], v[36:37]
    v_pk_add_f32 v[134:135], v[134:135], v[36:37]
    v_pk_add_f32 v[140:141], v[140:141], v[36:37]
    v_pk_add_f32 v[142:143], v[142:143], v[36:37]
    v_pk_add_f32 v[144:145], v[144:145], v[32:33]
    v_pk_add_f32 v[146:147], v[146:147], v[32:33]
    v_pk_add_f32 v[152:153], v[152:153], v[32:33]
    v_pk_add_f32 v[154:155], v[154:155], v[32:33]
    v_pk_add_f32 v[148:149], v[148:149], v[36:37]
    v_pk_add_f32 v[150:151], v[150:151], v[36:37]
    v_pk_add_f32 v[156:157], v[156:157], v[36:37]
    v_pk_add_f32 v[158:159], v[158:159], v[36:37]
    v_exp_f32 v24, v128
    s_mov_b32 m0, s46
    s_nop 0
    buffer_load_dwordx4 v4, s[8:11], s44 offen offset:0 sc1 lds
    v_exp_f32 v25, v129
    v_exp_f32 v26, v132
    v_exp_f32 v27, v133
    v_add_f32 v9, v24, v25
    v_cvt_pk_bf16_f32 v56, v24, v25
    v_exp_f32 v28, v130
    v_exp_f32 v29, v131
    v_add_f32 v10, v26, v27
    v_cvt_pk_bf16_f32 v60, v26, v27
    v_exp_f32 v30, v134
    buffer_load_dwordx4 v4, s[8:11], s44 offen offset:1024 sc1 lds
    v_exp_f32 v31, v135
    v_add_f32 v9, v9, v28
    v_add_f32 v9, v9, v29
    v_cvt_pk_bf16_f32 v57, v28, v29
    v_exp_f32 v24, v136
    v_exp_f32 v25, v137
    v_add_f32 v10, v10, v30
    v_add_f32 v10, v10, v31
    v_cvt_pk_bf16_f32 v61, v30, v31
    v_exp_f32 v26, v140
    buffer_load_dwordx4 v4, s[8:11], s44 offen offset:2048 sc1 lds
    v_exp_f32 v27, v141
    v_add_f32 v9, v9, v24
    v_add_f32 v9, v9, v25
    v_cvt_pk_bf16_f32 v58, v24, v25
    v_exp_f32 v28, v138
    v_exp_f32 v29, v139
    v_add_f32 v10, v10, v26
    v_add_f32 v10, v10, v27
    v_cvt_pk_bf16_f32 v62, v26, v27
    v_exp_f32 v30, v142
    buffer_load_dwordx4 v4, s[8:11], s44 offen offset:3072 sc1 lds
    s_add_u32 s44, s44, 32768
    s_xor_b32 s46, s46, 0x10000
    v_exp_f32 v31, v143
    v_add_f32 v9, v9, v28
    v_add_f32 v9, v9, v29
    v_cvt_pk_bf16_f32 v59, v28, v29
    s_nop 0
    v_add_f32 v10, v10, v30
    v_add_f32 v10, v10, v31
    v_cvt_pk_bf16_f32 v63, v30, v31
    s_mov_b32 exec_lo, 0xffff
    s_mov_b32 exec_hi, 0x0
    buffer_load_dword v22, v1, s[8:11], 0 offen sc1
    s_mov_b64 exec, -1
    s_setprio 0
    s_waitcnt vmcnt(5)
    s_barrier
K_ATT:
    s_cmp_eq_u32 s48, 0
    s_cbranch_scc1 K_E1S
.p2align 6
K_L1:
    s_waitcnt lgkmcnt(4)
    v_mfma_f32_16x16x32_bf16 v[96:99], v[64:67], v[160:163], v[32:35]
    ds_read_b128 v[88:91], v5 offset:6144
    v_exp_f32 v24, v144
    v_exp_f32 v25, v145
    v_mfma_f32_16x16x32_bf16 v[100:103], v[64:67], v[176:179], v[36:39]
    s_mov_b32 m0, s47
    s_nop 0
    buffer_load_dwordx4 v4, s[8:11], s45 offen offset:0 sc1 lds
    v_exp_f32 v26, v148
    v_mfma_f32_16x16x32_bf16 v[96:99], v[68:71], v[164:167], v[96:99]
    ds_read_b128 v[92:95], v5 offset:7168
    v_exp_f32 v27, v149
    v_add_f32 v9, v9, v24
    v_mfma_f32_16x16x32_bf16 v[100:103], v[68:71], v[180:183], v[100:103]
    v_add_f32 v9, v9, v25
    s_waitcnt lgkmcnt(4)
    v_mfma_f32_16x16x32_bf16 v[96:99], v[72:75], v[168:171], v[96:99]
    ds_read_b128 v[64:67], v5 offset:8192
    v_cvt_pk_bf16_f32 v40, v24, v25
    v_exp_f32 v28, v146
    v_mfma_f32_16x16x32_bf16 v[100:103], v[72:75], v[184:187], v[100:103]
    buffer_load_dwordx4 v4, s[8:11], s45 offen offset:1024 sc1 lds
    v_exp_f32 v29, v147
    v_mfma_f32_16x16x32_bf16 v[96:99], v[76:79], v[172:175], v[96:99]
    ds_read_b128 v[68:71], v5 offset:9216
    v_add_f32 v10, v10, v26
    v_mfma_f32_16x16x32_bf16 v[100:103], v[76:79], v[188:191], v[100:103]
    v_add_f32 v10, v10, v27
    v_cvt_pk_bf16_f32 v44, v26, v27
    s_waitcnt lgkmcnt(4)
    v_mfma_f32_16x16x32_bf16 v[104:107], v[80:83], v[160:163], v[32:35]
    ds_read_b128 v[72:75], v5 offset:10240
    v_exp_f32 v30, v150
    v_mfma_f32_16x16x32_bf16 v[108:111], v[80:83], v[176:179], v[36:39]
    buffer_load_dwordx4 v4, s[8:11], s45 offen offset:2048 sc1 lds
    v_exp_f32 v31, v151
    v_add_f32 v9, v9, v28
    v_mfma_f32_16x16x32_bf16 v[104:107], v[84:87], v[164:167], v[104:107]
    ds_read_b128 v[76:79], v5 offset:11264
    v_add_f32 v9, v9, v29
    v_mfma_f32_16x16x32_bf16 v[108:111], v[84:87], v[180:183], v[108:111]
    v_cvt_pk_bf16_f32 v41, v28, v29
    s_waitcnt lgkmcnt(4)
    v_mfma_f32_16x16x32_bf16 v[104:107], v[88:91], v[168:171], v[104:107]
    ds_read_b128 v[80:83], v5 offset:12288
    v_exp_f32 v24, v152
    v_exp_f32 v25, v153
    v_mfma_f32_16x16x32_bf16 v[108:111], v[88:91], v[184:187], v[108:111]
    buffer_load_dwordx4 v4, s[8:11], s45 offen offset:3072 sc1 lds
    s_add_u32 s45, s45, 32768
    s_xor_b32 s47, s47, 0x10000
    v_add_f32 v10, v10, v30
    v_mfma_f32_16x16x32_bf16 v[104:107], v[92:95], v[172:175], v[104:107]
    ds_read_b128 v[84:87], v5 offset:13312
    v_add_f32 v10, v10, v31
    v_cvt_pk_bf16_f32 v45, v30, v31
    v_mfma_f32_16x16x32_bf16 v[108:111], v[92:95], v[188:191], v[108:111]
    v_exp_f32 v26, v156
    s_waitcnt lgkmcnt(4)
    v_mfma_f32_16x16x32_bf16 v[112:115], v[64:67], v[160:163], v[32:35]
    ds_read_b128 v[88:91], v5 offset:14336
    v_exp_f32 v27, v157
    v_add_f32 v9, v9, v24
    v_mfma_f32_16x16x32_bf16 v[116:119], v[64:67], v[176:179], v[36:39]
    v_add_f32 v9, v9, v25
    v_mfma_f32_16x16x32_bf16 v[112:115], v[68:71], v[164:167], v[112:115]
    ds_read_b128 v[92:95], v5 offset:15360
    v_cvt_pk_bf16_f32 v42, v24, v25
    v_mfma_f32_16x16x32_bf16 v[116:119], v[68:71], v[180:183], v[116:119]
    v_exp_f32 v28, v154
    v_exp_f32 v29, v155
    s_waitcnt lgkmcnt(4)
    v_mfma_f32_16x16x32_bf16 v[112:115], v[72:75], v[168:171], v[112:115]
    ds_read_b128 v[64:67], v6 offset:0
    v_add_f32 v10, v10, v26
    v_mfma_f32_16x16x32_bf16 v[116:119], v[72:75], v[184:187], v[116:119]
    v_add_f32 v10, v10, v27
    v_cvt_pk_bf16_f32 v46, v26, v27
    v_mfma_f32_16x16x32_bf16 v[112:115], v[76:79], v[172:175], v[112:115]
    ds_read_b128 v[68:71], v6 offset:1024
    v_exp_f32 v30, v158
    v_mfma_f32_16x16x32_bf16 v[116:119], v[76:79], v[188:191], v[116:119]
    v_exp_f32 v31, v159
    s_waitcnt lgkmcnt(4)
    v_mfma_f32_16x16x32_bf16 v[120:123], v[80:83], v[160:163], v[32:35]
    ds_read_b128 v[72:75], v6 offset:2048
    v_add_f32 v9, v9, v28
    v_add_f32 v9, v9, v29
    v_mfma_f32_16x16x32_bf16 v[124:127], v[80:83], v[176:179], v[36:39]
    v_cvt_pk_bf16_f32 v43, v28, v29
    v_mfma_f32_16x16x32_bf16 v[120:123], v[84:87], v[164:167], v[120:123]
    ds_read_b128 v[76:79], v6 offset:3072
    s_nop 0
    v_add_f32 v10, v10, v30
    v_mfma_f32_16x16x32_bf16 v[124:127], v[84:87], v[180:183], v[124:127]
    v_add_f32 v10, v10, v31
    s_waitcnt lgkmcnt(4)
    v_mfma_f32_16x16x32_bf16 v[120:123], v[88:91], v[168:171], v[120:123]
    ds_read_b128 v[80:83], v6 offset:4096
    v_cvt_pk_bf16_f32 v47, v30, v31
    v_mfma_f32_16x16x32_bf16 v[124:127], v[88:91], v[184:187], v[124:127]
    v_max_f32 v16, v9, v10
    v_cmp_lt_f32 vcc, s53, v16
    v_mfma_f32_16x16x32_bf16 v[120:123], v[92:95], v[172:175], v[120:123]
    ds_read_b128 v[84:87], v6 offset:5120
    v_mfma_f32_16x16x32_bf16 v[124:127], v[92:95], v[188:191], v[124:127]
    s_cbranch_vccnz E1_R
E1_RB:
    s_waitcnt lgkmcnt(4)
    v_mfma_f32_16x16x32_bf16 v[192:195], v[64:67], v[56:59], v[192:195]
    ds_read_b128 v[88:91], v6 offset:6144
    v_add_f32 v11, v11, v9
    v_add_f32 v12, v12, v10
    v_mfma_f32_16x16x32_bf16 v[196:199], v[64:67], v[60:63], v[196:199]
    v_exp_f32 v24, v96
    v_mfma_f32_16x16x32_bf16 v[200:203], v[68:71], v[56:59], v[200:203]
    ds_read_b128 v[92:95], v6 offset:7168
    v_exp_f32 v25, v97
    v_exp_f32 v26, v100
    v_mfma_f32_16x16x32_bf16 v[204:207], v[68:71], v[60:63], v[204:207]
    v_exp_f32 v27, v101
    s_waitcnt lgkmcnt(4)
    v_mfma_f32_16x16x32_bf16 v[208:211], v[72:75], v[56:59], v[208:211]
    ds_read_b128 v[64:67], v6 offset:8192
    v_add_f32 v9, v24, v25
    v_mfma_f32_16x16x32_bf16 v[212:215], v[72:75], v[60:63], v[212:215]
    v_cvt_pk_bf16_f32 v48, v24, v25
    v_exp_f32 v28, v98
    v_mfma_f32_16x16x32_bf16 v[216:219], v[76:79], v[56:59], v[216:219]
    ds_read_b128 v[68:71], v6 offset:9216
    v_exp_f32 v29, v99
    v_mfma_f32_16x16x32_bf16 v[220:223], v[76:79], v[60:63], v[220:223]
    v_add_f32 v10, v26, v27
    s_waitcnt lgkmcnt(4)
    v_mfma_f32_16x16x32_bf16 v[224:227], v[80:83], v[56:59], v[224:227]
    ds_read_b128 v[72:75], v6 offset:10240
    v_cvt_pk_bf16_f32 v52, v26, v27
    v_exp_f32 v30, v102
    v_mfma_f32_16x16x32_bf16 v[228:231], v[80:83], v[60:63], v[228:231]
    v_exp_f32 v31, v103
    v_mfma_f32_16x16x32_bf16 v[232:235], v[84:87], v[56:59], v[232:235]
    ds_read_b128 v[76:79], v6 offset:11264
    v_add_f32 v9, v9, v28
    v_add_f32 v9, v9, v29
    v_mfma_f32_16x16x32_bf16 v[236:239], v[84:87], v[60:63], v[236:239]
    v_cvt_pk_bf16_f32 v49, v28, v29
    s_waitcnt lgkmcnt(4)
    v_mfma_f32_16x16x32_bf16 v[240:243], v[88:91], v[56:59], v[240:243]
    ds_read_b128 v[80:83], v6 offset:12288
    v_exp_f32 v24, v104
    v_mfma_f32_16x16x32_bf16 v[244:247], v[88:91], v[60:63], v[244:247]
    v_exp_f32 v25, v105
    v_add_f32 v10, v10, v30
    v_mfma_f32_16x16x32_bf16 v[248:251], v[92:95], v[56:59], v[248:251]
    ds_read_b128 v[84:87], v6 offset:13312
    v_add_f32 v10, v10, v31
    v_mfma_f32_16x16x32_bf16 v[252:255], v[92:95], v[60:63], v[252:255]
    v_cvt_pk_bf16_f32 v53, v30, v31
    s_waitcnt lgkmcnt(4)
    v_mfma_f32_16x16x32_bf16 v[192:195], v[64:67], v[40:43], v[192:195]
    ds_read_b128 v[88:91], v6 offset:14336
    v_exp_f32 v26, v108
    v_exp_f32 v27, v109
    v_mfma_f32_16x16x32_bf16 v[196:199], v[64:67], v[44:47], v[196:199]
    v_add_f32 v9, v9, v24
    v_mfma_f32_16x16x32_bf16 v[200:203], v[68:71], v[40:43], v[200:203]
    ds_read_b128 v[92:95], v6 offset:15360
    v_add_f32 v9, v9, v25
    v_mfma_f32_16x16x32_bf16 v[204:207], v[68:71], v[44:47], v[204:207]
    v_cvt_pk_bf16_f32 v50, v24, v25
    v_exp_f32 v28, v106
    s_waitcnt lgkmcnt(4)
    v_mfma_f32_16x16x32_bf16 v[208:211], v[72:75], v[40:43], v[208:211]
    v_exp_f32 v29, v107
    v_mfma_f32_16x16x32_bf16 v[212:215], v[72:75], v[44:47], v[212:215]
    v_add_f32 v10, v10, v26
    v_add_f32 v10, v10, v27
    v_mfma_f32_16x16x32_bf16 v[216:219], v[76:79], v[40:43], v[216:219]
    s_waitcnt vmcnt(4) lgkmcnt(0)
    s_barrier
    v_xor_b32 v5, 0x14000, v5
    v_xor_b32 v6, 0x4000, v6
    ds_read_b128 v[64:67], v5 offset:0
    ds_read_b128 v[68:71], v5 offset:1024
    s_cmp_lg_u32 s31, 0
    s_cbranch_scc1 E1_F
E1_FB:
    v_cvt_pk_bf16_f32 v54, v26, v27
    v_mfma_f32_16x16x32_bf16 v[220:223], v[76:79], v[44:47], v[220:223]
    v_exp_f32 v30, v110
    v_mfma_f32_16x16x32_bf16 v[224:227], v[80:83], v[40:43], v[224:227]
    ds_read_b128 v[72:75], v5 offset:2048
    v_exp_f32 v31, v111
    v_add_f32 v9, v9, v28
    v_mfma_f32_16x16x32_bf16 v[228:231], v[80:83], v[44:47], v[228:231]
    v_add_f32 v9, v9, v29
    v_mfma_f32_16x16x32_bf16 v[232:235], v[84:87], v[40:43], v[232:235]
    ds_read_b128 v[76:79], v5 offset:3072
    v_cvt_pk_bf16_f32 v51, v28, v29
    v_mfma_f32_16x16x32_bf16 v[236:239], v[84:87], v[44:47], v[236:239]
    s_nop 0
    v_add_f32 v10, v10, v30
    v_mfma_f32_16x16x32_bf16 v[240:243], v[88:91], v[40:43], v[240:243]
    ds_read_b128 v[80:83], v5 offset:4096
    v_add_f32 v10, v10, v31
    v_mfma_f32_16x16x32_bf16 v[244:247], v[88:91], v[44:47], v[244:247]
    v_cvt_pk_bf16_f32 v55, v30, v31
    v_mfma_f32_16x16x32_bf16 v[248:251], v[92:95], v[40:43], v[248:251]
    ds_read_b128 v[84:87], v5 offset:5120
    v_mfma_f32_16x16x32_bf16 v[252:255], v[92:95], v[44:47], v[252:255]
    s_waitcnt lgkmcnt(4)
    v_mfma_f32_16x16x32_bf16 v[128:131], v[64:67], v[160:163], v[32:35]
    ds_read_b128 v[88:91], v5 offset:6144
    s_cmp_eq_u32 s48, s59
    s_cselect_b64 vcc, -1, 0
    v_exp_f32 v24, v112
    v_exp_f32 v25, v113
    v_mfma_f32_16x16x32_bf16 v[132:135], v[64:67], v[176:179], v[36:39]
    s_cbranch_vccnz VR106
    s_mov_b32 m0, s46
    s_nop 0
    buffer_load_dwordx4 v4, s[8:11], s44 offen offset:0 sc1 lds
VR106:
    v_exp_f32 v26, v116
    v_mfma_f32_16x16x32_bf16 v[128:131], v[68:71], v[164:167], v[128:131]
    ds_read_b128 v[92:95], v5 offset:7168
    v_exp_f32 v27, v117
    v_add_f32 v9, v9, v24
    v_mfma_f32_16x16x32_bf16 v[132:135], v[68:71], v[180:183], v[132:135]
    v_add_f32 v9, v9, v25
    s_waitcnt lgkmcnt(4)
    v_mfma_f32_16x16x32_bf16 v[128:131], v[72:75], v[168:171], v[128:131]
    ds_read_b128 v[64:67], v5 offset:8192
    v_cvt_pk_bf16_f32 v40, v24, v25
    v_exp_f32 v28, v114
    v_mfma_f32_16x16x32_bf16 v[132:135], v[72:75], v[184:187], v[132:135]
    s_cbranch_vccnz VR107
    buffer_load_dwordx4 v4, s[8:11], s44 offen offset:1024 sc1 lds
VR107:
    v_exp_f32 v29, v115
    v_mfma_f32_16x16x32_bf16 v[128:131], v[76:79], v[172:175], v[128:131]
    ds_read_b128 v[68:71], v5 offset:9216
    v_add_f32 v10, v10, v26
    v_mfma_f32_16x16x32_bf16 v[132:135], v[76:79], v[188:191], v[132:135]
    v_add_f32 v10, v10, v27
    v_cvt_pk_bf16_f32 v44, v26, v27
    s_waitcnt lgkmcnt(4)
    v_mfma_f32_16x16x32_bf16 v[136:139], v[80:83], v[160:163], v[32:35]
    ds_read_b128 v[72:75], v5 offset:10240
    v_exp_f32 v30, v118
    v_mfma_f32_16x16x32_bf16 v[140:143], v[80:83], v[176:179], v[36:39]
    s_cbranch_vccnz VR108
    buffer_load_dwordx4 v4, s[8:11], s44 offen offset:2048 sc1 lds
VR108:
    v_exp_f32 v31, v119
    v_add_f32 v9, v9, v28
    v_mfma_f32_16x16x32_bf16 v[136:139], v[84:87], v[164:167], v[136:139]
    ds_read_b128 v[76:79], v5 offset:11264
    v_add_f32 v9, v9, v29
    v_mfma_f32_16x16x32_bf16 v[140:143], v[84:87], v[180:183], v[140:143]
    v_cvt_pk_bf16_f32 v41, v28, v29
    s_waitcnt lgkmcnt(4)
    v_mfma_f32_16x16x32_bf16 v[136:139], v[88:91], v[168:171], v[136:139]
    ds_read_b128 v[80:83], v5 offset:12288
    v_exp_f32 v24, v120
    v_exp_f32 v25, v121
    v_mfma_f32_16x16x32_bf16 v[140:143], v[88:91], v[184:187], v[140:143]
    s_cbranch_vccnz VR109
    buffer_load_dwordx4 v4, s[8:11], s44 offen offset:3072 sc1 lds
    s_add_u32 s44, s44, 32768
    s_xor_b32 s46, s46, 0x10000
VR109:
    v_add_f32 v10, v10, v30
    v_mfma_f32_16x16x32_bf16 v[136:139], v[92:95], v[172:175], v[136:139]
    ds_read_b128 v[84:87], v5 offset:13312
    v_add_f32 v10, v10, v31
    v_cvt_pk_bf16_f32 v45, v30, v31
    v_mfma_f32_16x16x32_bf16 v[140:143], v[92:95], v[188:191], v[140:143]
    v_exp_f32 v26, v124
    s_waitcnt lgkmcnt(4)
    v_mfma_f32_16x16x32_bf16 v[144:147], v[64:67], v[160:163], v[32:35]
    ds_read_b128 v[88:91], v5 offset:14336
    v_exp_f32 v27, v125
    v_add_f32 v9, v9, v24
    v_mfma_f32_16x16x32_bf16 v[148:151], v[64:67], v[176:179], v[36:39]
    v_add_f32 v9, v9, v25
    v_mfma_f32_16x16x32_bf16 v[144:147], v[68:71], v[164:167], v[144:147]
    ds_read_b128 v[92:95], v5 offset:15360
    v_cvt_pk_bf16_f32 v42, v24, v25
    v_mfma_f32_16x16x32_bf16 v[148:151], v[68:71], v[180:183], v[148:151]
    v_exp_f32 v28, v122
    v_exp_f32 v29, v123
    s_waitcnt lgkmcnt(4)
    v_mfma_f32_16x16x32_bf16 v[144:147], v[72:75], v[168:171], v[144:147]
    ds_read_b128 v[64:67], v6 offset:0
    v_add_f32 v10, v10, v26
    v_mfma_f32_16x16x32_bf16 v[148:151], v[72:75], v[184:187], v[148:151]
    v_add_f32 v10, v10, v27
    v_cvt_pk_bf16_f32 v46, v26, v27
    v_mfma_f32_16x16x32_bf16 v[144:147], v[76:79], v[172:175], v[144:147]
    ds_read_b128 v[68:71], v6 offset:1024
    v_exp_f32 v30, v126
    v_mfma_f32_16x16x32_bf16 v[148:151], v[76:79], v[188:191], v[148:151]
    v_exp_f32 v31, v127
    s_waitcnt lgkmcnt(4)
    v_mfma_f32_16x16x32_bf16 v[152:155], v[80:83], v[160:163], v[32:35]
    ds_read_b128 v[72:75], v6 offset:2048
    v_add_f32 v9, v9, v28
    v_add_f32 v9, v9, v29
    v_mfma_f32_16x16x32_bf16 v[156:159], v[80:83], v[176:179], v[36:39]
    v_cvt_pk_bf16_f32 v43, v28, v29
    v_mfma_f32_16x16x32_bf16 v[152:155], v[84:87], v[164:167], v[152:155]
    ds_read_b128 v[76:79], v6 offset:3072
    s_nop 0
    v_add_f32 v10, v10, v30
    v_mfma_f32_16x16x32_bf16 v[156:159], v[84:87], v[180:183], v[156:159]
    v_add_f32 v10, v10, v31
    s_waitcnt lgkmcnt(4)
    v_mfma_f32_16x16x32_bf16 v[152:155], v[88:91], v[168:171], v[152:155]
    ds_read_b128 v[80:83], v6 offset:4096
    v_cvt_pk_bf16_f32 v47, v30, v31
    v_mfma_f32_16x16x32_bf16 v[156:159], v[88:91], v[184:187], v[156:159]
    v_max_f32 v16, v9, v10
    v_cmp_lt_f32 vcc, s53, v16
    v_mfma_f32_16x16x32_bf16 v[152:155], v[92:95], v[172:175], v[152:155]
    ds_read_b128 v[84:87], v6 offset:5120
    s_cmp_eq_u32 s48, s50
    v_mfma_f32_16x16x32_bf16 v[156:159], v[92:95], v[188:191], v[156:159]
    s_cbranch_vccnz O1_R
O1_RB:
    s_cbranch_scc1 O1_M
O1_MB:
    s_waitcnt lgkmcnt(4)
    v_mfma_f32_16x16x32_bf16 v[192:195], v[64:67], v[48:51], v[192:195]
    ds_read_b128 v[88:91], v6 offset:6144
    v_add_f32 v11, v11, v9
    v_add_f32 v12, v12, v10
    v_mfma_f32_16x16x32_bf16 v[196:199], v[64:67], v[52:55], v[196:199]
    v_exp_f32 v24, v128
    v_mfma_f32_16x16x32_bf16 v[200:203], v[68:71], v[48:51], v[200:203]
    ds_read_b128 v[92:95], v6 offset:7168
    v_exp_f32 v25, v129
    v_exp_f32 v26, v132
    v_mfma_f32_16x16x32_bf16 v[204:207], v[68:71], v[52:55], v[204:207]
    v_exp_f32 v27, v133
    s_waitcnt lgkmcnt(4)
    v_mfma_f32_16x16x32_bf16 v[208:211], v[72:75], v[48:51], v[208:211]
    ds_read_b128 v[64:67], v6 offset:8192
    v_add_f32 v9, v24, v25
    v_mfma_f32_16x16x32_bf16 v[212:215], v[72:75], v[52:55], v[212:215]
    v_cvt_pk_bf16_f32 v56, v24, v25
    v_exp_f32 v28, v130
    v_mfma_f32_16x16x32_bf16 v[216:219], v[76:79], v[48:51], v[216:219]
    ds_read_b128 v[68:71], v6 offset:9216
    v_exp_f32 v29, v131
    v_mfma_f32_16x16x32_bf16 v[220:223], v[76:79], v[52:55], v[220:223]
    v_add_f32 v10, v26, v27
    s_waitcnt lgkmcnt(4)
    v_mfma_f32_16x16x32_bf16 v[224:227], v[80:83], v[48:51], v[224:227]
    ds_read_b128 v[72:75], v6 offset:10240
    v_cvt_pk_bf16_f32 v60, v26, v27
    v_exp_f32 v30, v134
    v_mfma_f32_16x16x32_bf16 v[228:231], v[80:83], v[52:55], v[228:231]
    v_exp_f32 v31, v135
    v_mfma_f32_16x16x32_bf16 v[232:235], v[84:87], v[48:51], v[232:235]
    ds_read_b128 v[76:79], v6 offset:11264
    v_add_f32 v9, v9, v28
    v_add_f32 v9, v9, v29
    s_cmp_eq_u32 s48, 1
    s_cselect_b32 s51, s52, 0x4000
    v_mfma_f32_16x16x32_bf16 v[236:239], v[84:87], v[52:55], v[236:239]
    v_cvt_pk_bf16_f32 v57, v28, v29
    s_waitcnt lgkmcnt(4)
    v_mfma_f32_16x16x32_bf16 v[240:243], v[88:91], v[48:51], v[240:243]
    ds_read_b128 v[80:83], v6 offset:12288
    v_exp_f32 v24, v136
    v_mfma_f32_16x16x32_bf16 v[244:247], v[88:91], v[52:55], v[244:247]
    v_exp_f32 v25, v137
    v_add_f32 v10, v10, v30
    v_mfma_f32_16x16x32_bf16 v[248:251], v[92:95], v[48:51], v[248:251]
    ds_read_b128 v[84:87], v6 offset:13312
    v_add_f32 v10, v10, v31
    v_mfma_f32_16x16x32_bf16 v[252:255], v[92:95], v[52:55], v[252:255]
    v_cvt_pk_bf16_f32 v61, v30, v31
    s_waitcnt lgkmcnt(4)
    v_mfma_f32_16x16x32_bf16 v[192:195], v[64:67], v[40:43], v[192:195]
    ds_read_b128 v[88:91], v6 offset:14336
    v_exp_f32 v26, v140
    v_exp_f32 v27, v141
    v_mfma_f32_16x16x32_bf16 v[196:199], v[64:67], v[44:47], v[196:199]
    v_add_f32 v9, v9, v24
    v_mfma_f32_16x16x32_bf16 v[200:203], v[68:71], v[40:43], v[200:203]
    ds_read_b128 v[92:95], v6 offset:15360
    v_add_f32 v9, v9, v25
    v_mfma_f32_16x16x32_bf16 v[204:207], v[68:71], v[44:47], v[204:207]
    v_cvt_pk_bf16_f32 v58, v24, v25
    v_exp_f32 v28, v138
    s_waitcnt lgkmcnt(4)
    v_mfma_f32_16x16x32_bf16 v[208:211], v[72:75], v[40:43], v[208:211]
    v_exp_f32 v29, v139
    v_mfma_f32_16x16x32_bf16 v[212:215], v[72:75], v[44:47], v[212:215]
    v_add_f32 v10, v10, v26
    v_add_f32 v10, v10, v27
    v_mfma_f32_16x16x32_bf16 v[216:219], v[76:79], v[40:43], v[216:219]
    s_waitcnt vmcnt(0) lgkmcnt(0)
    s_barrier
    v_xor_b32 v5, s51, v5
    v_xor_b32 v6, 0x14000, v6
    ds_read_b128 v[64:67], v5 offset:0
    ds_read_b128 v[68:71], v5 offset:1024
    s_cmp_lg_u32 s56, 0
    s_cbranch_scc1 O1_F
O1_FB:
    v_cvt_pk_bf16_f32 v62, v26, v27
    v_mfma_f32_16x16x32_bf16 v[220:223], v[76:79], v[44:47], v[220:223]
    v_exp_f32 v30, v142
    v_mfma_f32_16x16x32_bf16 v[224:227], v[80:83], v[40:43], v[224:227]
    ds_read_b128 v[72:75], v5 offset:2048
    v_exp_f32 v31, v143
    v_add_f32 v9, v9, v28
    v_mfma_f32_16x16x32_bf16 v[228:231], v[80:83], v[44:47], v[228:231]
    v_add_f32 v9, v9, v29
    v_mfma_f32_16x16x32_bf16 v[232:235], v[84:87], v[40:43], v[232:235]
    ds_read_b128 v[76:79], v5 offset:3072
    v_cvt_pk_bf16_f32 v59, v28, v29
    v_mfma_f32_16x16x32_bf16 v[236:239], v[84:87], v[44:47], v[236:239]
    s_nop 0
    v_add_f32 v10, v10, v30
    v_mfma_f32_16x16x32_bf16 v[240:243], v[88:91], v[40:43], v[240:243]
    ds_read_b128 v[80:83], v5 offset:4096
    v_add_f32 v10, v10, v31
    v_mfma_f32_16x16x32_bf16 v[244:247], v[88:91], v[44:47], v[244:247]
    v_cvt_pk_bf16_f32 v63, v30, v31
    s_sub_u32 s48, s48, 1
    s_cmp_eq_u32 s48, 0
    v_mfma_f32_16x16x32_bf16 v[248:251], v[92:95], v[40:43], v[248:251]
    ds_read_b128 v[84:87], v5 offset:5120
    v_mfma_f32_16x16x32_bf16 v[252:255], v[92:95], v[44:47], v[252:255]
    s_cbranch_scc0 K_L1
    s_cmp_eq_u32 s28, 0
    s_cbranch_scc1 K_PH2
K_E1S:
    s_waitcnt lgkmcnt(4)
    v_mfma_f32_16x16x32_bf16 v[96:99], v[64:67], v[160:163], v[32:35]
    ds_read_b128 v[88:91], v5 offset:6144
    v_exp_f32 v24, v144
    v_exp_f32 v25, v145
    v_mfma_f32_16x16x32_bf16 v[100:103], v[64:67], v[176:179], v[36:39]
    s_mov_b32 m0, s47
    s_nop 0
    buffer_load_dwordx4 v4, s[8:11], s45 offen offset:0 sc1 lds
    v_exp_f32 v26, v148
    v_mfma_f32_16x16x32_bf16 v[96:99], v[68:71], v[164:167], v[96:99]
    ds_read_b128 v[92:95], v5 offset:7168
    v_exp_f32 v27, v149
    v_add_f32 v9, v9, v24
    s_and_b32 s27, s3, 3
    s_lshl_b32 s27, s27, 5
    v_mfma_f32_16x16x32_bf16 v[100:103], v[68:71], v[180:183], v[100:103]
    v_add_f32 v9, v9, v25
    s_sub_i32 s27, s27, 64
    s_waitcnt lgkmcnt(4)
    v_mfma_f32_16x16x32_bf16 v[96:99], v[72:75], v[168:171], v[96:99]
    ds_read_b128 v[64:67], v5 offset:8192
    v_cvt_pk_bf16_f32 v40, v24, v25
    v_exp_f32 v28, v146
    v_lshlrev_b32 v19, 2, v3
    v_mfma_f32_16x16x32_bf16 v[100:103], v[72:75], v[184:187], v[100:103]
    buffer_load_dwordx4 v4, s[8:11], s45 offen offset:1024 sc1 lds
    v_exp_f32 v29, v147
    v_sub_u32 v19, v2, v19
    v_mfma_f32_16x16x32_bf16 v[96:99], v[76:79], v[172:175], v[96:99]
    ds_read_b128 v[68:71], v5 offset:9216
    v_add_f32 v10, v10, v26
    v_add_u32 v19, s27, v19
    v_mfma_f32_16x16x32_bf16 v[100:103], v[76:79], v[188:191], v[100:103]
    v_add_f32 v10, v10, v27
    v_cvt_pk_bf16_f32 v44, v26, v27
    v_cmp_gt_i32 s[60:61], -16, v19
    s_waitcnt lgkmcnt(4)
    v_mfma_f32_16x16x32_bf16 v[104:107], v[80:83], v[160:163], v[32:35]
    ds_read_b128 v[72:75], v5 offset:10240
    v_exp_f32 v30, v150
    v_cmp_gt_i32 s[62:63], -15, v19
    v_mfma_f32_16x16x32_bf16 v[108:111], v[80:83], v[176:179], v[36:39]
    buffer_load_dwordx4 v4, s[8:11], s45 offen offset:2048 sc1 lds
    v_exp_f32 v31, v151
    v_add_f32 v9, v9, v28
    v_cmp_gt_i32 s[64:65], -14, v19
    v_mfma_f32_16x16x32_bf16 v[104:107], v[84:87], v[164:167], v[104:107]
    ds_read_b128 v[76:79], v5 offset:11264
    v_add_f32 v9, v9, v29
    v_cmp_gt_i32 s[66:67], -13, v19
    v_mfma_f32_16x16x32_bf16 v[108:111], v[84:87], v[180:183], v[108:111]
    v_cvt_pk_bf16_f32 v41, v28, v29
    v_cmp_gt_i32 s[68:69], 0, v19
    s_waitcnt lgkmcnt(4)
    v_mfma_f32_16x16x32_bf16 v[104:107], v[88:91], v[168:171], v[104:107]
    ds_read_b128 v[80:83], v5 offset:12288
    v_exp_f32 v24, v152
    v_exp_f32 v25, v153
    v_cmp_gt_i32 s[70:71], 1, v19
    v_mfma_f32_16x16x32_bf16 v[108:111], v[88:91], v[184:187], v[108:111]
    buffer_load_dwordx4 v4, s[8:11], s45 offen offset:3072 sc1 lds
    s_add_u32 s45, s45, 32768
    s_xor_b32 s47, s47, 0x10000
    v_add_f32 v10, v10, v30
    v_cmp_gt_i32 s[72:73], 2, v19
    v_mfma_f32_16x16x32_bf16 v[104:107], v[92:95], v[172:175], v[104:107]
    ds_read_b128 v[84:87], v5 offset:13312
    v_add_f32 v10, v10, v31
    v_cvt_pk_bf16_f32 v45, v30, v31
    v_cmp_gt_i32 s[74:75], 3, v19
    v_cmp_gt_i32 s[76:77], 16, v19
    v_mfma_f32_16x16x32_bf16 v[108:111], v[92:95], v[188:191], v[108:111]
    v_exp_f32 v26, v156
    v_cmp_gt_i32 s[78:79], 17, v19
    s_waitcnt lgkmcnt(4)
    v_mfma_f32_16x16x32_bf16 v[112:115], v[64:67], v[160:163], v[32:35]
    ds_read_b128 v[88:91], v5 offset:14336
    v_exp_f32 v27, v157
    v_add_f32 v9, v9, v24
    v_cmp_gt_i32 s[80:81], 18, v19
    v_mfma_f32_16x16x32_bf16 v[116:119], v[64:67], v[176:179], v[36:39]
    v_add_f32 v9, v9, v25
    v_cmp_gt_i32 s[82:83], 19, v19
    v_mfma_f32_16x16x32_bf16 v[112:115], v[68:71], v[164:167], v[112:115]
    ds_read_b128 v[92:95], v5 offset:15360
    v_cvt_pk_bf16_f32 v42, v24, v25
    v_cmp_gt_i32 s[84:85], 32, v19
    v_mfma_f32_16x16x32_bf16 v[116:119], v[68:71], v[180:183], v[116:119]
    v_exp_f32 v28, v154
    v_exp_f32 v29, v155
    v_cmp_gt_i32 s[86:87], 33, v19
    s_waitcnt lgkmcnt(4)
    v_mfma_f32_16x16x32_bf16 v[112:115], v[72:75], v[168:171], v[112:115]
    ds_read_b128 v[64:67], v6 offset:0
    v_add_f32 v10, v10, v26
    v_cmp_gt_i32 s[88:89], 34, v19
    v_mfma_f32_16x16x32_bf16 v[116:119], v[72:75], v[184:187], v[116:119]
    v_add_f32 v10, v10, v27
    v_cvt_pk_bf16_f32 v46, v26, v27
    v_cmp_gt_i32 s[90:91], 35, v19
    v_mfma_f32_16x16x32_bf16 v[112:115], v[76:79], v[172:175], v[112:115]
    ds_read_b128 v[68:71], v6 offset:1024
    v_exp_f32 v30, v158
    v_cmp_gt_i32 s[92:93], 48, v19
    v_mfma_f32_16x16x32_bf16 v[116:119], v[76:79], v[188:191], v[116:119]
    v_exp_f32 v31, v159
    v_cmp_gt_i32 s[94:95], 49, v19
    s_waitcnt lgkmcnt(4)
    v_mfma_f32_16x16x32_bf16 v[120:123], v[80:83], v[160:163], v[32:35]
    ds_read_b128 v[72:75], v6 offset:2048
    v_add_f32 v9, v9, v28
    v_add_f32 v9, v9, v29
    v_cmp_gt_i32 s[96:97], 50, v19
    v_mfma_f32_16x16x32_bf16 v[124:127], v[80:83], v[176:179], v[36:39]
    v_cvt_pk_bf16_f32 v43, v28, v29
    v_cmp_gt_i32 s[98:99], 51, v19
    v_mfma_f32_16x16x32_bf16 v[120:123], v[84:87], v[164:167], v[120:123]
    ds_read_b128 v[76:79], v6 offset:3072
    s_nop 0
    v_add_f32 v10, v10, v30
    v_mfma_f32_16x16x32_bf16 v[124:127], v[84:87], v[180:183], v[124:127]
    v_add_f32 v10, v10, v31
    s_waitcnt lgkmcnt(4)
    v_mfma_f32_16x16x32_bf16 v[120:123], v[88:91], v[168:171], v[120:123]
    ds_read_b128 v[80:83], v6 offset:4096
    v_cvt_pk_bf16_f32 v47, v30, v31
    v_mfma_f32_16x16x32_bf16 v[124:127], v[88:91], v[184:187], v[124:127]
    v_max_f32 v16, v9, v10
    v_cmp_lt_f32 vcc, s53, v16
    v_mfma_f32_16x16x32_bf16 v[120:123], v[92:95], v[172:175], v[120:123]
    ds_read_b128 v[84:87], v6 offset:5120
    v_mfma_f32_16x16x32_bf16 v[124:127], v[92:95], v[188:191], v[124:127]
    s_cbranch_vccnz E1s_R
E1s_RB:
    s_nop 5
    v_cndmask_b32 v96, v96, v15, s[68:69]
    v_cndmask_b32 v97, v97, v15, s[70:71]
    v_cndmask_b32 v98, v98, v15, s[72:73]
    v_cndmask_b32 v99, v99, v15, s[74:75]
    v_cndmask_b32 v100, v100, v15, s[60:61]
    v_cndmask_b32 v101, v101, v15, s[62:63]
    v_cndmask_b32 v102, v102, v15, s[64:65]
    v_cndmask_b32 v103, v103, v15, s[66:67]
    v_cndmask_b32 v104, v104, v15, s[76:77]
    v_cndmask_b32 v105, v105, v15, s[78:79]
    v_cndmask_b32 v106, v106, v15, s[80:81]
    v_cndmask_b32 v107, v107, v15, s[82:83]
    v_cndmask_b32 v108, v108, v15, s[68:69]
    v_cndmask_b32 v109, v109, v15, s[70:71]
    v_cndmask_b32 v110, v110, v15, s[72:73]
    v_cndmask_b32 v111, v111, v15, s[74:75]
    v_cndmask_b32 v112, v112, v15, s[84:85]
    v_cndmask_b32 v113, v113, v15, s[86:87]
    v_cndmask_b32 v114, v114, v15, s[88:89]
    v_cndmask_b32 v115, v115, v15, s[90:91]
    v_cndmask_b32 v116, v116, v15, s[76:77]
    v_cndmask_b32 v117, v117, v15, s[78:79]
    v_cndmask_b32 v118, v118, v15, s[80:81]
    v_cndmask_b32 v119, v119, v15, s[82:83]
    v_cndmask_b32 v120, v120, v15, s[92:93]
    v_cndmask_b32 v121, v121, v15, s[94:95]
    v_cndmask_b32 v122, v122, v15, s[96:97]
    v_cndmask_b32 v123, v123, v15, s[98:99]
    v_cndmask_b32 v124, v124, v15, s[84:85]
    v_cndmask_b32 v125, v125, v15, s[86:87]
    v_cndmask_b32 v126, v126, v15, s[88:89]
    v_cndmask_b32 v127, v127, v15, s[90:91]
    s_waitcnt lgkmcnt(4)
    v_mfma_f32_16x16x32_bf16 v[192:195], v[64:67], v[56:59], v[192:195]
    ds_read_b128 v[88:91], v6 offset:6144
    v_add_f32 v11, v11, v9
    v_add_f32 v12, v12, v10
    v_add_u32 v8, 98304, v8
    v_mfma_f32_16x16x32_bf16 v[196:199], v[64:67], v[60:63], v[196:199]
    v_exp_f32 v24, v96
    ds_read_b128 v[160:163], v8 offset:0
    v_mfma_f32_16x16x32_bf16 v[200:203], v[68:71], v[56:59], v[200:203]
    ds_read_b128 v[92:95], v6 offset:7168
    v_exp_f32 v25, v97
    v_exp_f32 v26, v100
    v_mfma_f32_16x16x32_bf16 v[204:207], v[68:71], v[60:63], v[204:207]
    v_exp_f32 v27, v101
    ds_read_b128 v[164:167], v8 offset:1024
    s_waitcnt lgkmcnt(6)
    v_mfma_f32_16x16x32_bf16 v[208:211], v[72:75], v[56:59], v[208:211]
    ds_read_b128 v[64:67], v6 offset:8192
    v_add_f32 v9, v24, v25
    v_mfma_f32_16x16x32_bf16 v[212:215], v[72:75], v[60:63], v[212:215]
    v_cvt_pk_bf16_f32 v48, v24, v25
    v_exp_f32 v28, v98
    ds_read_b128 v[168:171], v8 offset:2048
    v_mfma_f32_16x16x32_bf16 v[216:219], v[76:79], v[56:59], v[216:219]
    ds_read_b128 v[68:71], v6 offset:9216
    v_exp_f32 v29, v99
    v_mfma_f32_16x16x32_bf16 v[220:223], v[76:79], v[60:63], v[220:223]
    v_add_f32 v10, v26, v27
    ds_read_b128 v[172:175], v8 offset:3072
    s_waitcnt lgkmcnt(8)
    v_mfma_f32_16x16x32_bf16 v[224:227], v[80:83], v[56:59], v[224:227]
    ds_read_b128 v[72:75], v6 offset:10240
    v_cvt_pk_bf16_f32 v52, v26, v27
    v_exp_f32 v30, v102
    v_mfma_f32_16x16x32_bf16 v[228:231], v[80:83], v[60:63], v[228:231]
    v_exp_f32 v31, v103
    ds_read_b128 v[176:179], v8 offset:4096
    v_mfma_f32_16x16x32_bf16 v[232:235], v[84:87], v[56:59], v[232:235]
    ds_read_b128 v[76:79], v6 offset:11264
    v_add_f32 v9, v9, v28
    v_add_f32 v9, v9, v29
    v_mfma_f32_16x16x32_bf16 v[236:239], v[84:87], v[60:63], v[236:239]
    v_cvt_pk_bf16_f32 v49, v28, v29
    ds_read_b128 v[180:183], v8 offset:5120
    s_waitcnt lgkmcnt(10)
    v_mfma_f32_16x16x32_bf16 v[240:243], v[88:91], v[56:59], v[240:243]
    ds_read_b128 v[80:83], v6 offset:12288
    v_exp_f32 v24, v104
    v_mfma_f32_16x16x32_bf16 v[244:247], v[88:91], v[60:63], v[244:247]
    v_exp_f32 v25, v105
    v_add_f32 v10, v10, v30
    ds_read_b128 v[184:187], v8 offset:6144
    s_waitcnt lgkmcnt(10)
    v_mfma_f32_16x16x32_bf16 v[248:251], v[92:95], v[56:59], v[248:251]
    ds_read_b128 v[84:87], v6 offset:13312
    v_add_f32 v10, v10, v31
    v_mfma_f32_16x16x32_bf16 v[252:255], v[92:95], v[60:63], v[252:255]
    v_cvt_pk_bf16_f32 v53, v30, v31
    ds_read_b128 v[188:191], v8 offset:7168
    s_waitcnt lgkmcnt(10)
    v_mfma_f32_16x16x32_bf16 v[192:195], v[64:67], v[40:43], v[192:195]
    ds_read_b128 v[88:91], v6 offset:14336
    v_exp_f32 v26, v108
    v_exp_f32 v27, v109
    v_mfma_f32_16x16x32_bf16 v[196:199], v[64:67], v[44:47], v[196:199]
    v_add_f32 v9, v9, v24
    s_waitcnt lgkmcnt(9)
    v_mfma_f32_16x16x32_bf16 v[200:203], v[68:71], v[40:43], v[200:203]
    ds_read_b128 v[92:95], v6 offset:15360
    v_add_f32 v9, v9, v25
    v_mfma_f32_16x16x32_bf16 v[204:207], v[68:71], v[44:47], v[204:207]
    v_cvt_pk_bf16_f32 v50, v24, v25
    v_exp_f32 v28, v106
    s_waitcnt lgkmcnt(8)
    v_mfma_f32_16x16x32_bf16 v[208:211], v[72:75], v[40:43], v[208:211]
    v_exp_f32 v29, v107
    v_mfma_f32_16x16x32_bf16 v[212:215], v[72:75], v[44:47], v[212:215]
    v_add_f32 v10, v10, v26
    v_add_f32 v10, v10, v27
    s_waitcnt lgkmcnt(6)
    v_mfma_f32_16x16x32_bf16 v[216:219], v[76:79], v[40:43], v[216:219]
    s_waitcnt vmcnt(4) lgkmcnt(0)
    s_barrier
    v_xor_b32 v5, 0x10000, v5
    v_xor_b32 v6, 0x4000, v6
    ds_read_b128 v[64:67], v5 offset:0
    ds_read_b128 v[68:71], v5 offset:1024
    s_cmp_lg_u32 s31, 0
    s_cbranch_scc1 E1s_F
E1s_FB:
    v_cvt_pk_bf16_f32 v54, v26, v27
    v_mfma_f32_16x16x32_bf16 v[220:223], v[76:79], v[44:47], v[220:223]
    v_exp_f32 v30, v110
    v_mfma_f32_16x16x32_bf16 v[224:227], v[80:83], v[40:43], v[224:227]
    ds_read_b128 v[72:75], v5 offset:2048
    v_exp_f32 v31, v111
    v_add_f32 v9, v9, v28
    v_mfma_f32_16x16x32_bf16 v[228:231], v[80:83], v[44:47], v[228:231]
    v_add_f32 v9, v9, v29
    v_mfma_f32_16x16x32_bf16 v[232:235], v[84:87], v[40:43], v[232:235]
    ds_read_b128 v[76:79], v5 offset:3072
    v_cvt_pk_bf16_f32 v51, v28, v29
    v_mfma_f32_16x16x32_bf16 v[236:239], v[84:87], v[44:47], v[236:239]
    s_nop 0
    v_add_f32 v10, v10, v30
    v_mfma_f32_16x16x32_bf16 v[240:243], v[88:91], v[40:43], v[240:243]
    ds_read_b128 v[80:83], v5 offset:4096
    v_add_f32 v10, v10, v31
    v_mfma_f32_16x16x32_bf16 v[244:247], v[88:91], v[44:47], v[244:247]
    v_cvt_pk_bf16_f32 v55, v30, v31
    v_mfma_f32_16x16x32_bf16 v[248:251], v[92:95], v[40:43], v[248:251]
    ds_read_b128 v[84:87], v5 offset:5120
    v_mfma_f32_16x16x32_bf16 v[252:255], v[92:95], v[44:47], v[252:255]
    s_waitcnt lgkmcnt(4)
    v_mfma_f32_16x16x32_bf16 v[128:131], v[64:67], v[160:163], 0
    ds_read_b128 v[88:91], v5 offset:6144
    s_cmp_eq_u32 s7, 7
    s_cselect_b64 vcc, -1, 0
    v_exp_f32 v24, v112
    v_exp_f32 v25, v113
    v_mfma_f32_16x16x32_bf16 v[132:135], v[64:67], v[176:179], 0
    s_cbranch_vccnz VR110
    s_mov_b32 m0, s46
    s_nop 0
    buffer_load_dwordx4 v4, s[8:11], s44 offen offset:0 sc1 lds
VR110:
    v_exp_f32 v26, v116
    v_mfma_f32_16x16x32_bf16 v[128:131], v[68:71], v[164:167], v[128:131]
    ds_read_b128 v[92:95], v5 offset:7168
    v_exp_f32 v27, v117
    v_add_f32 v9, v9, v24
    v_mfma_f32_16x16x32_bf16 v[132:135], v[68:71], v[180:183], v[132:135]
    v_add_f32 v9, v9, v25
    s_waitcnt lgkmcnt(4)
    v_mfma_f32_16x16x32_bf16 v[128:131], v[72:75], v[168:171], v[128:131]
    ds_read_b128 v[64:67], v5 offset:8192
    v_cvt_pk_bf16_f32 v40, v24, v25
    v_exp_f32 v28, v114
    v_mfma_f32_16x16x32_bf16 v[132:135], v[72:75], v[184:187], v[132:135]
    s_cbranch_vccnz VR111
    buffer_load_dwordx4 v4, s[8:11], s44 offen offset:1024 sc1 lds
VR111:
    v_exp_f32 v29, v115
    v_mfma_f32_16x16x32_bf16 v[128:131], v[76:79], v[172:175], v[128:131]
    ds_read_b128 v[68:71], v5 offset:9216
    v_add_f32 v10, v10, v26
    v_mfma_f32_16x16x32_bf16 v[132:135], v[76:79], v[188:191], v[132:135]
    v_add_f32 v10, v10, v27
    v_cvt_pk_bf16_f32 v44, v26, v27
    s_waitcnt lgkmcnt(4)
    v_mfma_f32_16x16x32_bf16 v[136:139], v[80:83], v[160:163], 0
    ds_read_b128 v[72:75], v5 offset:10240
    v_exp_f32 v30, v118
    v_mfma_f32_16x16x32_bf16 v[140:143], v[80:83], v[176:179], 0
    s_cbranch_vccnz VR112
    buffer_load_dwordx4 v4, s[8:11], s44 offen offset:2048 sc1 lds
VR112:
    v_exp_f32 v31, v119
    v_add_f32 v9, v9, v28
    v_mfma_f32_16x16x32_bf16 v[136:139], v[84:87], v[164:167], v[136:139]
    ds_read_b128 v[76:79], v5 offset:11264
    v_add_f32 v9, v9, v29
    v_mfma_f32_16x16x32_bf16 v[140:143], v[84:87], v[180:183], v[140:143]
    v_cvt_pk_bf16_f32 v41, v28, v29
    s_waitcnt lgkmcnt(4)
    v_mfma_f32_16x16x32_bf16 v[136:139], v[88:91], v[168:171], v[136:139]
    ds_read_b128 v[80:83], v5 offset:12288
    v_exp_f32 v24, v120
    v_exp_f32 v25, v121
    v_mfma_f32_16x16x32_bf16 v[140:143], v[88:91], v[184:187], v[140:143]
    s_cbranch_vccnz VR113
    buffer_load_dwordx4 v4, s[8:11], s44 offen offset:3072 sc1 lds
    s_add_u32 s44, s44, 32768
    s_xor_b32 s46, s46, 0x10000
VR113:
    v_add_f32 v10, v10, v30
    v_mfma_f32_16x16x32_bf16 v[136:139], v[92:95], v[172:175], v[136:139]
    ds_read_b128 v[84:87], v5 offset:13312
    v_add_f32 v10, v10, v31
    v_cvt_pk_bf16_f32 v45, v30, v31
    v_mfma_f32_16x16x32_bf16 v[140:143], v[92:95], v[188:191], v[140:143]
    v_exp_f32 v26, v124
    s_waitcnt lgkmcnt(4)
    v_mfma_f32_16x16x32_bf16 v[144:147], v[64:67], v[160:163], 0
    ds_read_b128 v[88:91], v5 offset:14336
    v_exp_f32 v27, v125
    v_add_f32 v9, v9, v24
    v_mfma_f32_16x16x32_bf16 v[148:151], v[64:67], v[176:179], 0
    v_add_f32 v9, v9, v25
    v_mfma_f32_16x16x32_bf16 v[144:147], v[68:71], v[164:167], v[144:147]
    ds_read_b128 v[92:95], v5 offset:15360
    v_cvt_pk_bf16_f32 v42, v24, v25
    v_mfma_f32_16x16x32_bf16 v[148:151], v[68:71], v[180:183], v[148:151]
    v_exp_f32 v28, v122
    v_exp_f32 v29, v123
    s_waitcnt lgkmcnt(4)
    v_mfma_f32_16x16x32_bf16 v[144:147], v[72:75], v[168:171], v[144:147]
    ds_read_b128 v[64:67], v6 offset:0
    v_add_f32 v10, v10, v26
    v_mfma_f32_16x16x32_bf16 v[148:151], v[72:75], v[184:187], v[148:151]
    v_add_f32 v10, v10, v27
    v_cvt_pk_bf16_f32 v46, v26, v27
    v_mfma_f32_16x16x32_bf16 v[144:147], v[76:79], v[172:175], v[144:147]
    ds_read_b128 v[68:71], v6 offset:1024
    v_exp_f32 v30, v126
    v_mfma_f32_16x16x32_bf16 v[148:151], v[76:79], v[188:191], v[148:151]
    v_exp_f32 v31, v127
    s_waitcnt lgkmcnt(4)
    v_mfma_f32_16x16x32_bf16 v[152:155], v[80:83], v[160:163], 0
    ds_read_b128 v[72:75], v6 offset:2048
    v_add_f32 v9, v9, v28
    v_add_f32 v9, v9, v29
    v_mfma_f32_16x16x32_bf16 v[156:159], v[80:83], v[176:179], 0
    v_cvt_pk_bf16_f32 v43, v28, v29
    v_mfma_f32_16x16x32_bf16 v[152:155], v[84:87], v[164:167], v[152:155]
    ds_read_b128 v[76:79], v6 offset:3072
    s_nop 0
    v_add_f32 v10, v10, v30
    v_mfma_f32_16x16x32_bf16 v[156:159], v[84:87], v[180:183], v[156:159]
    v_add_f32 v10, v10, v31
    s_waitcnt lgkmcnt(4)
    v_mfma_f32_16x16x32_bf16 v[152:155], v[88:91], v[168:171], v[152:155]
    ds_read_b128 v[80:83], v6 offset:4096
    v_cvt_pk_bf16_f32 v47, v30, v31
    v_mfma_f32_16x16x32_bf16 v[156:159], v[88:91], v[184:187], v[156:159]
    v_max_f32 v16, v9, v10
    v_cmp_lt_f32 vcc, s53, v16
    v_mfma_f32_16x16x32_bf16 v[152:155], v[92:95], v[172:175], v[152:155]
    ds_read_b128 v[84:87], v6 offset:5120
    s_cmp_eq_u32 s7, 7
    v_mfma_f32_16x16x32_bf16 v[156:159], v[92:95], v[188:191], v[156:159]
    s_cbranch_vccnz O1s_R
O1s_RB:
    s_cbranch_scc1 O1s_M
O1s_MB:
    s_waitcnt lgkmcnt(4)
    v_mfma_f32_16x16x32_bf16 v[192:195], v[64:67], v[48:51], v[192:195]
    ds_read_b128 v[88:91], v6 offset:6144
    v_add_f32 v22, v11, v9
    v_add_f32 v23, v12, v10
    v_mfma_f32_16x16x32_bf16 v[196:199], v[64:67], v[52:55], v[196:199]
    v_mov_b32 v11, 0
    v_mov_b32 v12, 0
    v_mfma_f32_16x16x32_bf16 v[200:203], v[68:71], v[48:51], v[200:203]
    ds_read_b128 v[92:95], v6 offset:7168
    v_max3_f32 v16, v128, v129, v130
    v_max3_f32 v17, v132, v133, v134
    v_max3_f32 v16, v16, v131, v136
    v_max3_f32 v17, v17, v135, v140
    v_max3_f32 v16, v16, v137, v138
    v_mfma_f32_16x16x32_bf16 v[204:207], v[68:71], v[52:55], v[204:207]
    v_max3_f32 v17, v17, v141, v142
    v_max3_f32 v16, v16, v139, v144
    v_max3_f32 v17, v17, v143, v148
    v_max3_f32 v16, v16, v145, v146
    s_waitcnt lgkmcnt(4)
    v_mfma_f32_16x16x32_bf16 v[208:211], v[72:75], v[48:51], v[208:211]
    ds_read_b128 v[64:67], v6 offset:8192
    v_max3_f32 v17, v17, v149, v150
    v_max3_f32 v16, v16, v147, v152
    v_max3_f32 v17, v17, v151, v156
    v_max3_f32 v16, v16, v153, v154
    v_max3_f32 v17, v17, v157, v158
    v_mfma_f32_16x16x32_bf16 v[212:215], v[72:75], v[52:55], v[212:215]
    v_max_f32 v16, v16, v155
    v_max_f32 v17, v17, v159
    v_mov_b32 v18, v16
    s_nop 1
    v_permlane32_swap_b32 v18, v16
    s_nop 1
    v_max_f32 v16, v16, v18
    v_mov_b32 v18, v16
    s_nop 1
    v_permlane16_swap_b32 v18, v16
    s_nop 1
    v_max_f32 v16, v16, v18
    v_mfma_f32_16x16x32_bf16 v[216:219], v[76:79], v[48:51], v[216:219]
    ds_read_b128 v[68:71], v6 offset:9216
    v_max_f32 v16, 0xf149f2ca, v16
    v_mov_b32 v19, v17
    s_nop 1
    v_permlane32_swap_b32 v19, v17
    s_nop 1
    v_max_f32 v17, v17, v19
    v_mov_b32 v19, v17
    s_nop 1
    v_permlane16_swap_b32 v19, v17
    s_nop 1
    v_max_f32 v17, v17, v19
    v_max_f32 v17, 0xf149f2ca, v17
    v_sub_f32 v128, v128, v16
    v_mfma_f32_16x16x32_bf16 v[220:223], v[76:79], v[52:55], v[220:223]
    v_sub_f32 v129, v129, v16
    v_sub_f32 v130, v130, v16
    v_sub_f32 v131, v131, v16
    v_sub_f32 v136, v136, v16
    s_waitcnt lgkmcnt(4)
    v_mfma_f32_16x16x32_bf16 v[224:227], v[80:83], v[48:51], v[224:227]
    ds_read_b128 v[72:75], v6 offset:10240
    v_sub_f32 v137, v137, v16
    v_sub_f32 v138, v138, v16
    v_sub_f32 v139, v139, v16
    v_sub_f32 v132, v132, v17
    v_mfma_f32_16x16x32_bf16 v[228:231], v[80:83], v[52:55], v[228:231]
    v_sub_f32 v133, v133, v17
    v_sub_f32 v134, v134, v17
    v_sub_f32 v135, v135, v17
    v_sub_f32 v140, v140, v17
    v_sub_f32 v141, v141, v17
    v_mfma_f32_16x16x32_bf16 v[232:235], v[84:87], v[48:51], v[232:235]
    ds_read_b128 v[76:79], v6 offset:11264
    v_sub_f32 v142, v142, v17
    v_sub_f32 v143, v143, v17
    v_sub_f32 v144, v144, v16
    v_sub_f32 v145, v145, v16
    v_mfma_f32_16x16x32_bf16 v[236:239], v[84:87], v[52:55], v[236:239]
    v_sub_f32 v146, v146, v16
    v_sub_f32 v147, v147, v16
    v_sub_f32 v152, v152, v16
    v_sub_f32 v153, v153, v16
    v_sub_f32 v154, v154, v16
    s_waitcnt lgkmcnt(4)
    v_mfma_f32_16x16x32_bf16 v[240:243], v[88:91], v[48:51], v[240:243]
    ds_read_b128 v[80:83], v6 offset:12288
    v_sub_f32 v155, v155, v16
    v_sub_f32 v32, 0, v16
    v_sub_f32 v33, 0, v16
    v_sub_f32 v34, 0, v16
    v_mfma_f32_16x16x32_bf16 v[244:247], v[88:91], v[52:55], v[244:247]
    v_sub_f32 v35, 0, v16
    v_sub_f32 v148, v148, v17
    v_sub_f32 v149, v149, v17
    v_sub_f32 v150, v150, v17
    v_sub_f32 v151, v151, v17
    v_mfma_f32_16x16x32_bf16 v[248:251], v[92:95], v[48:51], v[248:251]
    ds_read_b128 v[84:87], v6 offset:13312
    v_sub_f32 v156, v156, v17
    v_sub_f32 v157, v157, v17
    v_sub_f32 v158, v158, v17
    v_sub_f32 v159, v159, v17
    v_mfma_f32_16x16x32_bf16 v[252:255], v[92:95], v[52:55], v[252:255]
    v_sub_f32 v36, 0, v17
    v_sub_f32 v37, 0, v17
    v_sub_f32 v38, 0, v17
    v_sub_f32 v39, 0, v17
    s_waitcnt lgkmcnt(4)
    v_mfma_f32_16x16x32_bf16 v[192:195], v[64:67], v[40:43], v[192:195]
    ds_read_b128 v[88:91], v6 offset:14336
    v_exp_f32 v24, v128
    v_exp_f32 v25, v129
    v_exp_f32 v26, v132
    v_mfma_f32_16x16x32_bf16 v[196:199], v[64:67], v[44:47], v[196:199]
    v_exp_f32 v27, v133
    v_add_f32 v9, v24, v25
    v_cvt_pk_bf16_f32 v56, v24, v25
    v_mfma_f32_16x16x32_bf16 v[200:203], v[68:71], v[40:43], v[200:203]
    ds_read_b128 v[92:95], v6 offset:15360
    v_exp_f32 v28, v130
    v_exp_f32 v29, v131
    v_mfma_f32_16x16x32_bf16 v[204:207], v[68:71], v[44:47], v[204:207]
    v_add_f32 v10, v26, v27
    v_cvt_pk_bf16_f32 v60, v26, v27
    v_exp_f32 v30, v134
    s_waitcnt lgkmcnt(4)
    v_mfma_f32_16x16x32_bf16 v[208:211], v[72:75], v[40:43], v[208:211]
    v_exp_f32 v31, v135
    v_add_f32 v9, v9, v28
    v_mfma_f32_16x16x32_bf16 v[212:215], v[72:75], v[44:47], v[212:215]
    v_add_f32 v9, v9, v29
    v_cvt_pk_bf16_f32 v57, v28, v29
    v_exp_f32 v24, v136
    v_mfma_f32_16x16x32_bf16 v[216:219], v[76:79], v[40:43], v[216:219]
    s_waitcnt vmcnt(0) lgkmcnt(0)
    s_barrier
    v_xor_b32 v5, 0x10000, v5
    v_xor_b32 v6, 0x10000, v6
    ds_read_b128 v[64:67], v5 offset:0
    ds_read_b128 v[68:71], v5 offset:1024
    s_cmp_lg_u32 s56, 0
    s_cbranch_scc1 O1s_F
O1s_FB:
    v_exp_f32 v25, v137
    v_add_f32 v10, v10, v30
    v_add_f32 v10, v10, v31
    v_mfma_f32_16x16x32_bf16 v[220:223], v[76:79], v[44:47], v[220:223]
    v_cvt_pk_bf16_f32 v61, v30, v31
    v_exp_f32 v26, v140
    v_mfma_f32_16x16x32_bf16 v[224:227], v[80:83], v[40:43], v[224:227]
    ds_read_b128 v[72:75], v5 offset:2048
    v_exp_f32 v27, v141
    v_add_f32 v9, v9, v24
    v_add_f32 v9, v9, v25
    v_mfma_f32_16x16x32_bf16 v[228:231], v[80:83], v[44:47], v[228:231]
    v_cvt_pk_bf16_f32 v58, v24, v25
    v_exp_f32 v28, v138
    v_mfma_f32_16x16x32_bf16 v[232:235], v[84:87], v[40:43], v[232:235]
    ds_read_b128 v[76:79], v5 offset:3072
    v_exp_f32 v29, v139
    v_add_f32 v10, v10, v26
    v_add_f32 v10, v10, v27
    v_mfma_f32_16x16x32_bf16 v[236:239], v[84:87], v[44:47], v[236:239]
    v_cvt_pk_bf16_f32 v62, v26, v27
    v_exp_f32 v30, v142
    v_exp_f32 v31, v143
    v_mfma_f32_16x16x32_bf16 v[240:243], v[88:91], v[40:43], v[240:243]
    ds_read_b128 v[80:83], v5 offset:4096
    v_add_f32 v9, v9, v28
    v_add_f32 v9, v9, v29
    v_mfma_f32_16x16x32_bf16 v[244:247], v[88:91], v[44:47], v[244:247]
    v_cvt_pk_bf16_f32 v59, v28, v29
    s_nop 0
    v_add_f32 v10, v10, v30
    v_mfma_f32_16x16x32_bf16 v[248:251], v[92:95], v[40:43], v[248:251]
    ds_read_b128 v[84:87], v5 offset:5120
    v_add_f32 v10, v10, v31
    v_cvt_pk_bf16_f32 v63, v30, v31
    v_mfma_f32_16x16x32_bf16 v[252:255], v[92:95], v[44:47], v[252:255]
    v_mov_b32 v16, v22
    s_nop 1
    v_permlane32_swap_b32 v16, v22
    s_nop 1
    v_add_f32 v22, v22, v16
    v_mov_b32 v16, v22
    s_nop 1
    v_permlane16_swap_b32 v16, v22
    s_nop 1
    v_add_f32 v22, v22, v16
    v_mov_b32 v17, v23
    s_nop 1
    v_permlane32_swap_b32 v17, v23
    s_nop 1
    v_add_f32 v23, v23, v17
    v_mov_b32 v17, v23
    s_nop 1
    v_permlane16_swap_b32 v17, v23
    s_nop 1
    v_add_f32 v23, v23, v17
    v_rcp_f32 v22, v22
    v_rcp_f32 v23, v23
    s_nop 0
    v_mul_f32 v20, v22, v14
    v_mul_f32 v21, v22, v14
    v_mul_f32 v22, v23, v7
    v_mul_f32 v23, v23, v7
    v_pk_mul_f32 v[192:193], v[192:193], v[20:21]
    v_pk_mul_f32 v[194:195], v[194:195], v[20:21]
    v_pk_mul_f32 v[200:201], v[200:201], v[20:21]
    v_pk_mul_f32 v[202:203], v[202:203], v[20:21]
    v_cvt_pk_bf16_f32 v40, v192, v193
    v_cvt_pk_bf16_f32 v41, v194, v195
    v_cvt_pk_bf16_f32 v42, v200, v201
    v_cvt_pk_bf16_f32 v43, v202, v203
    buffer_store_dwordx4 v[40:43], v4, s[8:11], s58 offen offset:0 sc1
    v_mov_b64 v[192:193], 0
    v_mov_b64 v[194:195], 0
    v_mov_b64 v[200:201], 0
    v_mov_b64 v[202:203], 0
    v_pk_mul_f32 v[196:197], v[196:197], v[22:23]
    v_pk_mul_f32 v[198:199], v[198:199], v[22:23]
    v_pk_mul_f32 v[204:205], v[204:205], v[22:23]
    v_pk_mul_f32 v[206:207], v[206:207], v[22:23]
    v_cvt_pk_bf16_f32 v44, v196, v197
    v_cvt_pk_bf16_f32 v45, v198, v199
    v_cvt_pk_bf16_f32 v46, v204, v205
    v_cvt_pk_bf16_f32 v47, v206, v207
    buffer_store_dwordx4 v[44:47], v4, s[8:11], s58 offen offset:2048 sc1
    v_mov_b64 v[196:197], 0
    v_mov_b64 v[198:199], 0
    v_mov_b64 v[204:205], 0
    v_mov_b64 v[206:207], 0
    v_pk_mul_f32 v[208:209], v[208:209], v[20:21]
    v_pk_mul_f32 v[210:211], v[210:211], v[20:21]
    v_pk_mul_f32 v[216:217], v[216:217], v[20:21]
    v_pk_mul_f32 v[218:219], v[218:219], v[20:21]
    v_cvt_pk_bf16_f32 v48, v208, v209
    v_cvt_pk_bf16_f32 v49, v210, v211
    v_cvt_pk_bf16_f32 v50, v216, v217
    v_cvt_pk_bf16_f32 v51, v218, v219
    buffer_store_dwordx4 v[48:51], v4, s[8:11], s58 offen offset:1024 sc1
    v_mov_b64 v[208:209], 0
    v_mov_b64 v[210:211], 0
    v_mov_b64 v[216:217], 0
    v_mov_b64 v[218:219], 0
    v_pk_mul_f32 v[212:213], v[212:213], v[22:23]
    v_pk_mul_f32 v[214:215], v[214:215], v[22:23]
    v_pk_mul_f32 v[220:221], v[220:221], v[22:23]
    v_pk_mul_f32 v[222:223], v[222:223], v[22:23]
    v_cvt_pk_bf16_f32 v52, v212, v213
    v_cvt_pk_bf16_f32 v53, v214, v215
    v_cvt_pk_bf16_f32 v54, v220, v221
    v_cvt_pk_bf16_f32 v55, v222, v223
    buffer_store_dwordx4 v[52:55], v4, s[8:11], s58 offen offset:3072 sc1
    v_mov_b64 v[212:213], 0
    v_mov_b64 v[214:215], 0
    v_mov_b64 v[220:221], 0
    v_mov_b64 v[222:223], 0
    s_add_u32 s58, s58, 16384
    v_pk_mul_f32 v[224:225], v[224:225], v[20:21]
    v_pk_mul_f32 v[226:227], v[226:227], v[20:21]
    v_pk_mul_f32 v[232:233], v[232:233], v[20:21]
    v_pk_mul_f32 v[234:235], v[234:235], v[20:21]
    v_cvt_pk_bf16_f32 v88, v224, v225
    v_cvt_pk_bf16_f32 v89, v226, v227
    v_cvt_pk_bf16_f32 v90, v232, v233
    v_cvt_pk_bf16_f32 v91, v234, v235
    buffer_store_dwordx4 v[88:91], v4, s[8:11], s58 offen offset:0 sc1
    v_mov_b64 v[224:225], 0
    v_mov_b64 v[226:227], 0
    v_mov_b64 v[232:233], 0
    v_mov_b64 v[234:235], 0
    v_pk_mul_f32 v[228:229], v[228:229], v[22:23]
    v_pk_mul_f32 v[230:231], v[230:231], v[22:23]
    v_pk_mul_f32 v[236:237], v[236:237], v[22:23]
    v_pk_mul_f32 v[238:239], v[238:239], v[22:23]
    v_cvt_pk_bf16_f32 v92, v228, v229
    v_cvt_pk_bf16_f32 v93, v230, v231
    v_cvt_pk_bf16_f32 v94, v236, v237
    v_cvt_pk_bf16_f32 v95, v238, v239
    buffer_store_dwordx4 v[92:95], v4, s[8:11], s58 offen offset:2048 sc1
    v_mov_b64 v[228:229], 0
    v_mov_b64 v[230:231], 0
    v_mov_b64 v[236:237], 0
    v_mov_b64 v[238:239], 0
    v_pk_mul_f32 v[240:241], v[240:241], v[20:21]
    v_pk_mul_f32 v[242:243], v[242:243], v[20:21]
    v_pk_mul_f32 v[248:249], v[248:249], v[20:21]
    v_pk_mul_f32 v[250:251], v[250:251], v[20:21]
    v_cvt_pk_bf16_f32 v120, v240, v241
    v_cvt_pk_bf16_f32 v121, v242, v243
    v_cvt_pk_bf16_f32 v122, v248, v249
    v_cvt_pk_bf16_f32 v123, v250, v251
    buffer_store_dwordx4 v[120:123], v4, s[8:11], s58 offen offset:1024 sc1
    v_mov_b64 v[240:241], 0
    v_mov_b64 v[242:243], 0
    v_mov_b64 v[248:249], 0
    v_mov_b64 v[250:251], 0
    v_pk_mul_f32 v[244:245], v[244:245], v[22:23]
    v_pk_mul_f32 v[246:247], v[246:247], v[22:23]
    v_pk_mul_f32 v[252:253], v[252:253], v[22:23]
    v_pk_mul_f32 v[254:255], v[254:255], v[22:23]
    v_cvt_pk_bf16_f32 v124, v244, v245
    v_cvt_pk_bf16_f32 v125, v246, v247
    v_cvt_pk_bf16_f32 v126, v252, v253
    v_cvt_pk_bf16_f32 v127, v254, v255
    buffer_store_dwordx4 v[124:127], v4, s[8:11], s58 offen offset:3072 sc1
    v_mov_b64 v[244:245], 0
    v_mov_b64 v[246:247], 0
    v_mov_b64 v[252:253], 0
    v_mov_b64 v[254:255], 0
K_PH2:
    s_cmp_eq_u32 s49, 0
    s_cbranch_scc1 K_FIN
.p2align 6
K_L2:
    s_waitcnt lgkmcnt(4)
    v_mfma_f32_16x16x32_bf16 v[96:99], v[64:67], v[160:163], v[32:35]
    ds_read_b128 v[88:91], v5 offset:6144
    v_exp_f32 v24, v144
    v_exp_f32 v25, v145
    v_mfma_f32_16x16x32_bf16 v[100:103], v[64:67], v[176:179], v[36:39]
    s_mov_b32 m0, s46
    s_nop 0
    buffer_load_dwordx4 v4, s[8:11], s44 offen offset:0 sc1 lds
    v_exp_f32 v26, v148
    v_mfma_f32_16x16x32_bf16 v[96:99], v[68:71], v[164:167], v[96:99]
    ds_read_b128 v[92:95], v5 offset:7168
    v_exp_f32 v27, v149
    v_add_f32 v9, v9, v24
    v_mfma_f32_16x16x32_bf16 v[100:103], v[68:71], v[180:183], v[100:103]
    buffer_load_dwordx4 v4, s[8:11], s44 offen offset:1024 sc1 lds
    v_add_f32 v9, v9, v25
    s_waitcnt lgkmcnt(4)
    v_mfma_f32_16x16x32_bf16 v[96:99], v[72:75], v[168:171], v[96:99]
    ds_read_b128 v[64:67], v5 offset:8192
    v_cvt_pk_bf16_f32 v40, v24, v25
    v_exp_f32 v28, v146
    v_mfma_f32_16x16x32_bf16 v[100:103], v[72:75], v[184:187], v[100:103]
    buffer_load_dwordx4 v4, s[8:11], s44 offen offset:2048 sc1 lds
    v_exp_f32 v29, v147
    v_mfma_f32_16x16x32_bf16 v[96:99], v[76:79], v[172:175], v[96:99]
    ds_read_b128 v[68:71], v5 offset:9216
    v_add_f32 v10, v10, v26
    v_mfma_f32_16x16x32_bf16 v[100:103], v[76:79], v[188:191], v[100:103]
    buffer_load_dwordx4 v4, s[8:11], s44 offen offset:3072 sc1 lds
    s_add_u32 s44, s44, 32768
    s_xor_b32 s46, s46, 0x10000
    v_add_f32 v10, v10, v27
    v_cvt_pk_bf16_f32 v44, v26, v27
    s_waitcnt lgkmcnt(4)
    v_mfma_f32_16x16x32_bf16 v[104:107], v[80:83], v[160:163], v[32:35]
    ds_read_b128 v[72:75], v5 offset:10240
    v_exp_f32 v30, v150
    v_mfma_f32_16x16x32_bf16 v[108:111], v[80:83], v[176:179], v[36:39]
    s_mov_b32 m0, s47
    s_nop 0
    buffer_load_dwordx4 v4, s[8:11], s45 offen offset:0 sc1 lds
    v_exp_f32 v31, v151
    v_add_f32 v9, v9, v28
    v_mfma_f32_16x16x32_bf16 v[104:107], v[84:87], v[164:167], v[104:107]
    ds_read_b128 v[76:79], v5 offset:11264
    v_add_f32 v9, v9, v29
    v_mfma_f32_16x16x32_bf16 v[108:111], v[84:87], v[180:183], v[108:111]
    buffer_load_dwordx4 v4, s[8:11], s45 offen offset:1024 sc1 lds
    v_cvt_pk_bf16_f32 v41, v28, v29
    s_waitcnt lgkmcnt(4)
    v_mfma_f32_16x16x32_bf16 v[104:107], v[88:91], v[168:171], v[104:107]
    ds_read_b128 v[80:83], v5 offset:12288
    v_exp_f32 v24, v152
    v_exp_f32 v25, v153
    v_mfma_f32_16x16x32_bf16 v[108:111], v[88:91], v[184:187], v[108:111]
    buffer_load_dwordx4 v4, s[8:11], s45 offen offset:2048 sc1 lds
    v_add_f32 v10, v10, v30
    v_mfma_f32_16x16x32_bf16 v[104:107], v[92:95], v[172:175], v[104:107]
    ds_read_b128 v[84:87], v5 offset:13312
    v_add_f32 v10, v10, v31
    v_cvt_pk_bf16_f32 v45, v30, v31
    v_mfma_f32_16x16x32_bf16 v[108:111], v[92:95], v[188:191], v[108:111]
    buffer_load_dwordx4 v4, s[8:11], s45 offen offset:3072 sc1 lds
    s_add_u32 s45, s45, 32768
    s_xor_b32 s47, s47, 0x10000
    v_exp_f32 v26, v156
    s_waitcnt lgkmcnt(4)
    v_mfma_f32_16x16x32_bf16 v[112:115], v[64:67], v[160:163], v[32:35]
    ds_read_b128 v[88:91], v5 offset:14336
    v_exp_f32 v27, v157
    v_add_f32 v9, v9, v24
    v_mfma_f32_16x16x32_bf16 v[116:119], v[64:67], v[176:179], v[36:39]
    v_add_f32 v9, v9, v25
    v_mfma_f32_16x16x32_bf16 v[112:115], v[68:71], v[164:167], v[112:115]
    ds_read_b128 v[92:95], v5 offset:15360
    v_cvt_pk_bf16_f32 v42, v24, v25
    v_mfma_f32_16x16x32_bf16 v[116:119], v[68:71], v[180:183], v[116:119]
    v_exp_f32 v28, v154
    v_exp_f32 v29, v155
    s_waitcnt lgkmcnt(4)
    v_mfma_f32_16x16x32_bf16 v[112:115], v[72:75], v[168:171], v[112:115]
    ds_read_b128 v[64:67], v6 offset:0
    v_add_f32 v10, v10, v26
    v_mfma_f32_16x16x32_bf16 v[116:119], v[72:75], v[184:187], v[116:119]
    v_add_f32 v10, v10, v27
    v_cvt_pk_bf16_f32 v46, v26, v27
    v_mfma_f32_16x16x32_bf16 v[112:115], v[76:79], v[172:175], v[112:115]
    ds_read_b128 v[68:71], v6 offset:1024
    v_exp_f32 v30, v158
    v_mfma_f32_16x16x32_bf16 v[116:119], v[76:79], v[188:191], v[116:119]
    v_exp_f32 v31, v159
    s_waitcnt lgkmcnt(4)
    v_mfma_f32_16x16x32_bf16 v[120:123], v[80:83], v[160:163], v[32:35]
    ds_read_b128 v[72:75], v6 offset:2048
    v_add_f32 v9, v9, v28
    v_add_f32 v9, v9, v29
    v_mfma_f32_16x16x32_bf16 v[124:127], v[80:83], v[176:179], v[36:39]
    v_cvt_pk_bf16_f32 v43, v28, v29
    v_mfma_f32_16x16x32_bf16 v[120:123], v[84:87], v[164:167], v[120:123]
    ds_read_b128 v[76:79], v6 offset:3072
    s_nop 0
    v_add_f32 v10, v10, v30
    v_mfma_f32_16x16x32_bf16 v[124:127], v[84:87], v[180:183], v[124:127]
    v_add_f32 v10, v10, v31
    s_waitcnt lgkmcnt(4)
    v_mfma_f32_16x16x32_bf16 v[120:123], v[88:91], v[168:171], v[120:123]
    ds_read_b128 v[80:83], v6 offset:4096
    v_cvt_pk_bf16_f32 v47, v30, v31
    v_mfma_f32_16x16x32_bf16 v[124:127], v[88:91], v[184:187], v[124:127]
    v_max_f32 v16, v9, v10
    v_cmp_lt_f32 vcc, s53, v16
    v_mfma_f32_16x16x32_bf16 v[120:123], v[92:95], v[172:175], v[120:123]
    ds_read_b128 v[84:87], v6 offset:5120
    v_mfma_f32_16x16x32_bf16 v[124:127], v[92:95], v[188:191], v[124:127]
    s_cbranch_vccnz I0_R
I0_RB:
    s_waitcnt lgkmcnt(4)
    v_mfma_f32_16x16x32_bf16 v[192:195], v[64:67], v[56:59], v[192:195]
    ds_read_b128 v[88:91], v6 offset:6144
    v_add_f32 v11, v11, v9
    v_add_f32 v12, v12, v10
    v_mfma_f32_16x16x32_bf16 v[196:199], v[64:67], v[60:63], v[196:199]
    v_exp_f32 v24, v96
    v_mfma_f32_16x16x32_bf16 v[200:203], v[68:71], v[56:59], v[200:203]
    ds_read_b128 v[92:95], v6 offset:7168
    v_exp_f32 v25, v97
    v_exp_f32 v26, v100
    v_mfma_f32_16x16x32_bf16 v[204:207], v[68:71], v[60:63], v[204:207]
    v_exp_f32 v27, v101
    s_waitcnt lgkmcnt(4)
    v_mfma_f32_16x16x32_bf16 v[208:211], v[72:75], v[56:59], v[208:211]
    ds_read_b128 v[64:67], v6 offset:8192
    v_add_f32 v9, v24, v25
    v_mfma_f32_16x16x32_bf16 v[212:215], v[72:75], v[60:63], v[212:215]
    v_cvt_pk_bf16_f32 v48, v24, v25
    v_exp_f32 v28, v98
    v_mfma_f32_16x16x32_bf16 v[216:219], v[76:79], v[56:59], v[216:219]
    ds_read_b128 v[68:71], v6 offset:9216
    v_exp_f32 v29, v99
    v_mfma_f32_16x16x32_bf16 v[220:223], v[76:79], v[60:63], v[220:223]
    v_add_f32 v10, v26, v27
    s_waitcnt lgkmcnt(4)
    v_mfma_f32_16x16x32_bf16 v[224:227], v[80:83], v[56:59], v[224:227]
    ds_read_b128 v[72:75], v6 offset:10240
    v_cvt_pk_bf16_f32 v52, v26, v27
    v_exp_f32 v30, v102
    v_mfma_f32_16x16x32_bf16 v[228:231], v[80:83], v[60:63], v[228:231]
    v_exp_f32 v31, v103
    v_mfma_f32_16x16x32_bf16 v[232:235], v[84:87], v[56:59], v[232:235]
    ds_read_b128 v[76:79], v6 offset:11264
    v_add_f32 v9, v9, v28
    v_add_f32 v9, v9, v29
    v_mfma_f32_16x16x32_bf16 v[236:239], v[84:87], v[60:63], v[236:239]
    v_cvt_pk_bf16_f32 v49, v28, v29
    s_waitcnt lgkmcnt(4)
    v_mfma_f32_16x16x32_bf16 v[240:243], v[88:91], v[56:59], v[240:243]
    ds_read_b128 v[80:83], v6 offset:12288
    v_exp_f32 v24, v104
    v_mfma_f32_16x16x32_bf16 v[244:247], v[88:91], v[60:63], v[244:247]
    v_exp_f32 v25, v105
    v_add_f32 v10, v10, v30
    v_mfma_f32_16x16x32_bf16 v[248:251], v[92:95], v[56:59], v[248:251]
    ds_read_b128 v[84:87], v6 offset:13312
    v_add_f32 v10, v10, v31
    v_mfma_f32_16x16x32_bf16 v[252:255], v[92:95], v[60:63], v[252:255]
    v_cvt_pk_bf16_f32 v53, v30, v31
    s_waitcnt lgkmcnt(4)
    v_mfma_f32_16x16x32_bf16 v[192:195], v[64:67], v[40:43], v[192:195]
    ds_read_b128 v[88:91], v6 offset:14336
    v_exp_f32 v26, v108
    v_exp_f32 v27, v109
    v_mfma_f32_16x16x32_bf16 v[196:199], v[64:67], v[44:47], v[196:199]
    v_add_f32 v9, v9, v24
    v_mfma_f32_16x16x32_bf16 v[200:203], v[68:71], v[40:43], v[200:203]
    ds_read_b128 v[92:95], v6 offset:15360
    v_add_f32 v9, v9, v25
    v_mfma_f32_16x16x32_bf16 v[204:207], v[68:71], v[44:47], v[204:207]
    v_cvt_pk_bf16_f32 v50, v24, v25
    v_exp_f32 v28, v106
    s_waitcnt lgkmcnt(4)
    v_mfma_f32_16x16x32_bf16 v[208:211], v[72:75], v[40:43], v[208:211]
    v_exp_f32 v29, v107
    v_mfma_f32_16x16x32_bf16 v[212:215], v[72:75], v[44:47], v[212:215]
    v_add_f32 v10, v10, v26
    v_add_f32 v10, v10, v27
    v_mfma_f32_16x16x32_bf16 v[216:219], v[76:79], v[40:43], v[216:219]
    s_waitcnt vmcnt(0) lgkmcnt(0)
    s_barrier
    v_xor_b32 v5, 0x10000, v5
    v_xor_b32 v6, 0x10000, v6
    ds_read_b128 v[64:67], v5 offset:0
    ds_read_b128 v[68:71], v5 offset:1024
    s_cmp_lg_u32 s31, 0
    s_cbranch_scc1 I0_F
I0_FB:
    v_cvt_pk_bf16_f32 v54, v26, v27
    v_mfma_f32_16x16x32_bf16 v[220:223], v[76:79], v[44:47], v[220:223]
    v_exp_f32 v30, v110
    v_mfma_f32_16x16x32_bf16 v[224:227], v[80:83], v[40:43], v[224:227]
    ds_read_b128 v[72:75], v5 offset:2048
    v_exp_f32 v31, v111
    v_add_f32 v9, v9, v28
    v_mfma_f32_16x16x32_bf16 v[228:231], v[80:83], v[44:47], v[228:231]
    v_add_f32 v9, v9, v29
    v_mfma_f32_16x16x32_bf16 v[232:235], v[84:87], v[40:43], v[232:235]
    ds_read_b128 v[76:79], v5 offset:3072
    v_cvt_pk_bf16_f32 v51, v28, v29
    v_mfma_f32_16x16x32_bf16 v[236:239], v[84:87], v[44:47], v[236:239]
    s_nop 0
    v_add_f32 v10, v10, v30
    v_mfma_f32_16x16x32_bf16 v[240:243], v[88:91], v[40:43], v[240:243]
    ds_read_b128 v[80:83], v5 offset:4096
    v_add_f32 v10, v10, v31
    v_mfma_f32_16x16x32_bf16 v[244:247], v[88:91], v[44:47], v[244:247]
    v_cvt_pk_bf16_f32 v55, v30, v31
    v_mfma_f32_16x16x32_bf16 v[248:251], v[92:95], v[40:43], v[248:251]
    ds_read_b128 v[84:87], v5 offset:5120
    v_mfma_f32_16x16x32_bf16 v[252:255], v[92:95], v[44:47], v[252:255]
    s_waitcnt lgkmcnt(4)
    v_mfma_f32_16x16x32_bf16 v[128:131], v[64:67], v[160:163], v[32:35]
    ds_read_b128 v[88:91], v5 offset:6144
    s_cmp_eq_u32 s49, 1
    s_cselect_b64 vcc, -1, 0
    v_exp_f32 v24, v112
    v_exp_f32 v25, v113
    v_mfma_f32_16x16x32_bf16 v[132:135], v[64:67], v[176:179], v[36:39]
    s_cbranch_vccnz VR114
    s_mov_b32 m0, s46
    s_nop 0
    buffer_load_dwordx4 v4, s[8:11], s44 offen offset:0 sc1 lds
VR114:
    v_exp_f32 v26, v116
    v_mfma_f32_16x16x32_bf16 v[128:131], v[68:71], v[164:167], v[128:131]
    ds_read_b128 v[92:95], v5 offset:7168
    v_exp_f32 v27, v117
    v_add_f32 v9, v9, v24
    v_mfma_f32_16x16x32_bf16 v[132:135], v[68:71], v[180:183], v[132:135]
    s_cbranch_vccnz VR115
    buffer_load_dwordx4 v4, s[8:11], s44 offen offset:1024 sc1 lds
VR115:
    v_add_f32 v9, v9, v25
    s_waitcnt lgkmcnt(4)
    v_mfma_f32_16x16x32_bf16 v[128:131], v[72:75], v[168:171], v[128:131]
    ds_read_b128 v[64:67], v5 offset:8192
    v_cvt_pk_bf16_f32 v40, v24, v25
    v_exp_f32 v28, v114
    v_mfma_f32_16x16x32_bf16 v[132:135], v[72:75], v[184:187], v[132:135]
    s_cbranch_vccnz VR116
    buffer_load_dwordx4 v4, s[8:11], s44 offen offset:2048 sc1 lds
VR116:
    v_exp_f32 v29, v115
    v_mfma_f32_16x16x32_bf16 v[128:131], v[76:79], v[172:175], v[128:131]
    ds_read_b128 v[68:71], v5 offset:9216
    v_add_f32 v10, v10, v26
    v_mfma_f32_16x16x32_bf16 v[132:135], v[76:79], v[188:191], v[132:135]
    s_cbranch_vccnz VR117
    buffer_load_dwordx4 v4, s[8:11], s44 offen offset:3072 sc1 lds
    s_add_u32 s44, s44, 32768
    s_xor_b32 s46, s46, 0x10000
VR117:
    v_add_f32 v10, v10, v27
    v_cvt_pk_bf16_f32 v44, v26, v27
    s_waitcnt lgkmcnt(4)
    v_mfma_f32_16x16x32_bf16 v[136:139], v[80:83], v[160:163], v[32:35]
    ds_read_b128 v[72:75], v5 offset:10240
    v_exp_f32 v30, v118
    v_mfma_f32_16x16x32_bf16 v[140:143], v[80:83], v[176:179], v[36:39]
    s_mov_b32 m0, s47
    s_nop 0
    buffer_load_dwordx4 v4, s[8:11], s45 offen offset:0 sc1 lds
    v_exp_f32 v31, v119
    v_add_f32 v9, v9, v28
    v_mfma_f32_16x16x32_bf16 v[136:139], v[84:87], v[164:167], v[136:139]
    ds_read_b128 v[76:79], v5 offset:11264
    v_add_f32 v9, v9, v29
    v_mfma_f32_16x16x32_bf16 v[140:143], v[84:87], v[180:183], v[140:143]
    buffer_load_dwordx4 v4, s[8:11], s45 offen offset:1024 sc1 lds
    v_cvt_pk_bf16_f32 v41, v28, v29
    s_waitcnt lgkmcnt(4)
    v_mfma_f32_16x16x32_bf16 v[136:139], v[88:91], v[168:171], v[136:139]
    ds_read_b128 v[80:83], v5 offset:12288
    v_exp_f32 v24, v120
    v_exp_f32 v25, v121
    v_mfma_f32_16x16x32_bf16 v[140:143], v[88:91], v[184:187], v[140:143]
    buffer_load_dwordx4 v4, s[8:11], s45 offen offset:2048 sc1 lds
    v_add_f32 v10, v10, v30
    v_mfma_f32_16x16x32_bf16 v[136:139], v[92:95], v[172:175], v[136:139]
    ds_read_b128 v[84:87], v5 offset:13312
    v_add_f32 v10, v10, v31
    v_cvt_pk_bf16_f32 v45, v30, v31
    v_mfma_f32_16x16x32_bf16 v[140:143], v[92:95], v[188:191], v[140:143]
    buffer_load_dwordx4 v4, s[8:11], s45 offen offset:3072 sc1 lds
    s_add_u32 s45, s45, 32768
    s_xor_b32 s47, s47, 0x10000
    v_exp_f32 v26, v124
    s_waitcnt lgkmcnt(4)
    v_mfma_f32_16x16x32_bf16 v[144:147], v[64:67], v[160:163], v[32:35]
    ds_read_b128 v[88:91], v5 offset:14336
    v_exp_f32 v27, v125
    v_add_f32 v9, v9, v24
    v_mfma_f32_16x16x32_bf16 v[148:151], v[64:67], v[176:179], v[36:39]
    v_add_f32 v9, v9, v25
    v_mfma_f32_16x16x32_bf16 v[144:147], v[68:71], v[164:167], v[144:147]
    ds_read_b128 v[92:95], v5 offset:15360
    v_cvt_pk_bf16_f32 v42, v24, v25
    v_mfma_f32_16x16x32_bf16 v[148:151], v[68:71], v[180:183], v[148:151]
    v_exp_f32 v28, v122
    v_exp_f32 v29, v123
    s_waitcnt lgkmcnt(4)
    v_mfma_f32_16x16x32_bf16 v[144:147], v[72:75], v[168:171], v[144:147]
    ds_read_b128 v[64:67], v6 offset:0
    v_add_f32 v10, v10, v26
    v_mfma_f32_16x16x32_bf16 v[148:151], v[72:75], v[184:187], v[148:151]
    v_add_f32 v10, v10, v27
    v_cvt_pk_bf16_f32 v46, v26, v27
    v_mfma_f32_16x16x32_bf16 v[144:147], v[76:79], v[172:175], v[144:147]
    ds_read_b128 v[68:71], v6 offset:1024
    v_exp_f32 v30, v126
    v_mfma_f32_16x16x32_bf16 v[148:151], v[76:79], v[188:191], v[148:151]
    v_exp_f32 v31, v127
    s_waitcnt lgkmcnt(4)
    v_mfma_f32_16x16x32_bf16 v[152:155], v[80:83], v[160:163], v[32:35]
    ds_read_b128 v[72:75], v6 offset:2048
    v_add_f32 v9, v9, v28
    v_add_f32 v9, v9, v29
    v_mfma_f32_16x16x32_bf16 v[156:159], v[80:83], v[176:179], v[36:39]
    v_cvt_pk_bf16_f32 v43, v28, v29
    v_mfma_f32_16x16x32_bf16 v[152:155], v[84:87], v[164:167], v[152:155]
    ds_read_b128 v[76:79], v6 offset:3072
    s_nop 0
    v_add_f32 v10, v10, v30
    v_mfma_f32_16x16x32_bf16 v[156:159], v[84:87], v[180:183], v[156:159]
    v_add_f32 v10, v10, v31
    s_waitcnt lgkmcnt(4)
    v_mfma_f32_16x16x32_bf16 v[152:155], v[88:91], v[168:171], v[152:155]
    ds_read_b128 v[80:83], v6 offset:4096
    v_cvt_pk_bf16_f32 v47, v30, v31
    v_mfma_f32_16x16x32_bf16 v[156:159], v[88:91], v[184:187], v[156:159]
    v_max_f32 v16, v9, v10
    v_cmp_lt_f32 vcc, s53, v16
    v_mfma_f32_16x16x32_bf16 v[152:155], v[92:95], v[172:175], v[152:155]
    ds_read_b128 v[84:87], v6 offset:5120
    s_cmp_eq_u32 s49, 1
    v_mfma_f32_16x16x32_bf16 v[156:159], v[92:95], v[188:191], v[156:159]
    s_cbranch_vccnz I1_R
I1_RB:
    s_cbranch_scc1 I1_M
I1_MB:
    s_waitcnt lgkmcnt(4)
    v_mfma_f32_16x16x32_bf16 v[192:195], v[64:67], v[48:51], v[192:195]
    ds_read_b128 v[88:91], v6 offset:6144
    v_add_f32 v11, v11, v9
    v_add_f32 v12, v12, v10
    v_mfma_f32_16x16x32_bf16 v[196:199], v[64:67], v[52:55], v[196:199]
    v_exp_f32 v24, v128
    v_mfma_f32_16x16x32_bf16 v[200:203], v[68:71], v[48:51], v[200:203]
    ds_read_b128 v[92:95], v6 offset:7168
    v_exp_f32 v25, v129
    v_exp_f32 v26, v132
    v_mfma_f32_16x16x32_bf16 v[204:207], v[68:71], v[52:55], v[204:207]
    v_exp_f32 v27, v133
    s_waitcnt lgkmcnt(4)
    v_mfma_f32_16x16x32_bf16 v[208:211], v[72:75], v[48:51], v[208:211]
    ds_read_b128 v[64:67], v6 offset:8192
    v_add_f32 v9, v24, v25
    v_mfma_f32_16x16x32_bf16 v[212:215], v[72:75], v[52:55], v[212:215]
    v_cvt_pk_bf16_f32 v56, v24, v25
    v_exp_f32 v28, v130
    v_mfma_f32_16x16x32_bf16 v[216:219], v[76:79], v[48:51], v[216:219]
    ds_read_b128 v[68:71], v6 offset:9216
    v_exp_f32 v29, v131
    v_mfma_f32_16x16x32_bf16 v[220:223], v[76:79], v[52:55], v[220:223]
    v_add_f32 v10, v26, v27
    s_waitcnt lgkmcnt(4)
    v_mfma_f32_16x16x32_bf16 v[224:227], v[80:83], v[48:51], v[224:227]
    ds_read_b128 v[72:75], v6 offset:10240
    v_cvt_pk_bf16_f32 v60, v26, v27
    v_exp_f32 v30, v134
    v_mfma_f32_16x16x32_bf16 v[228:231], v[80:83], v[52:55], v[228:231]
    v_exp_f32 v31, v135
    v_mfma_f32_16x16x32_bf16 v[232:235], v[84:87], v[48:51], v[232:235]
    ds_read_b128 v[76:79], v6 offset:11264
    v_add_f32 v9, v9, v28
    v_add_f32 v9, v9, v29
    v_mfma_f32_16x16x32_bf16 v[236:239], v[84:87], v[52:55], v[236:239]
    v_cvt_pk_bf16_f32 v57, v28, v29
    s_waitcnt lgkmcnt(4)
    v_mfma_f32_16x16x32_bf16 v[240:243], v[88:91], v[48:51], v[240:243]
    ds_read_b128 v[80:83], v6 offset:12288
    v_exp_f32 v24, v136
    v_mfma_f32_16x16x32_bf16 v[244:247], v[88:91], v[52:55], v[244:247]
    v_exp_f32 v25, v137
    v_add_f32 v10, v10, v30
    v_mfma_f32_16x16x32_bf16 v[248:251], v[92:95], v[48:51], v[248:251]
    ds_read_b128 v[84:87], v6 offset:13312
    v_add_f32 v10, v10, v31
    v_mfma_f32_16x16x32_bf16 v[252:255], v[92:95], v[52:55], v[252:255]
    v_cvt_pk_bf16_f32 v61, v30, v31
    s_waitcnt lgkmcnt(4)
    v_mfma_f32_16x16x32_bf16 v[192:195], v[64:67], v[40:43], v[192:195]
    ds_read_b128 v[88:91], v6 offset:14336
    v_exp_f32 v26, v140
    v_exp_f32 v27, v141
    v_mfma_f32_16x16x32_bf16 v[196:199], v[64:67], v[44:47], v[196:199]
    v_add_f32 v9, v9, v24
    v_mfma_f32_16x16x32_bf16 v[200:203], v[68:71], v[40:43], v[200:203]
    ds_read_b128 v[92:95], v6 offset:15360
    v_add_f32 v9, v9, v25
    v_mfma_f32_16x16x32_bf16 v[204:207], v[68:71], v[44:47], v[204:207]
    v_cvt_pk_bf16_f32 v58, v24, v25
    v_exp_f32 v28, v138
    s_waitcnt lgkmcnt(4)
    v_mfma_f32_16x16x32_bf16 v[208:211], v[72:75], v[40:43], v[208:211]
    v_exp_f32 v29, v139
    v_mfma_f32_16x16x32_bf16 v[212:215], v[72:75], v[44:47], v[212:215]
    v_add_f32 v10, v10, v26
    v_add_f32 v10, v10, v27
    v_mfma_f32_16x16x32_bf16 v[216:219], v[76:79], v[40:43], v[216:219]
    s_waitcnt vmcnt(0) lgkmcnt(0)
    s_barrier
    v_xor_b32 v5, 0x10000, v5
    v_xor_b32 v6, 0x10000, v6
    ds_read_b128 v[64:67], v5 offset:0
    ds_read_b128 v[68:71], v5 offset:1024
    s_cmp_lg_u32 s56, 0
    s_cbranch_scc1 I1_F
I1_FB:
    v_cvt_pk_bf16_f32 v62, v26, v27
    v_mfma_f32_16x16x32_bf16 v[220:223], v[76:79], v[44:47], v[220:223]
    v_exp_f32 v30, v142
    v_mfma_f32_16x16x32_bf16 v[224:227], v[80:83], v[40:43], v[224:227]
    ds_read_b128 v[72:75], v5 offset:2048
    v_exp_f32 v31, v143
    v_add_f32 v9, v9, v28
    v_mfma_f32_16x16x32_bf16 v[228:231], v[80:83], v[44:47], v[228:231]
    v_add_f32 v9, v9, v29
    v_mfma_f32_16x16x32_bf16 v[232:235], v[84:87], v[40:43], v[232:235]
    ds_read_b128 v[76:79], v5 offset:3072
    v_cvt_pk_bf16_f32 v59, v28, v29
    v_mfma_f32_16x16x32_bf16 v[236:239], v[84:87], v[44:47], v[236:239]
    s_nop 0
    v_add_f32 v10, v10, v30
    v_mfma_f32_16x16x32_bf16 v[240:243], v[88:91], v[40:43], v[240:243]
    ds_read_b128 v[80:83], v5 offset:4096
    v_add_f32 v10, v10, v31
    v_mfma_f32_16x16x32_bf16 v[244:247], v[88:91], v[44:47], v[244:247]
    v_cvt_pk_bf16_f32 v63, v30, v31
    s_sub_u32 s49, s49, 1
    s_cmp_eq_u32 s49, 0
    v_mfma_f32_16x16x32_bf16 v[248:251], v[92:95], v[40:43], v[248:251]
    ds_read_b128 v[84:87], v5 offset:5120
    v_mfma_f32_16x16x32_bf16 v[252:255], v[92:95], v[44:47], v[252:255]
    s_cbranch_scc0 K_L2
K_FIN:
    s_cmp_eq_u32 s28, 1
    s_cbranch_scc1 K_FIN1
    ds_read_b128 v[64:67], v6 offset:0
    ds_read_b128 v[68:71], v6 offset:1024
    ds_read_b128 v[72:75], v6 offset:2048
    ds_read_b128 v[76:79], v6 offset:3072
    ds_read_b128 v[80:83], v6 offset:4096
    ds_read_b128 v[84:87], v6 offset:5120
    v_exp_f32 v24, v144
    v_exp_f32 v25, v145
    v_exp_f32 v26, v148
    s_add_u32 m0, s64, 135168
    s_nop 0
    buffer_load_dwordx4 v96, s[16:19], s63 offen offset:0 lds
    v_exp_f32 v27, v149
    v_add_f32 v9, v9, v24
    v_add_f32 v9, v9, v25
    v_cvt_pk_bf16_f32 v40, v24, v25
    v_exp_f32 v28, v146
    v_exp_f32 v29, v147
    v_add_f32 v10, v10, v26
    buffer_load_dwordx4 v97, s[16:19], s63 offen offset:1024 lds
    v_add_f32 v10, v10, v27
    v_cvt_pk_bf16_f32 v44, v26, v27
    v_exp_f32 v30, v150
    v_exp_f32 v31, v151
    v_add_f32 v9, v9, v28
    v_add_f32 v9, v9, v29
    v_cvt_pk_bf16_f32 v41, v28, v29
    v_exp_f32 v24, v152
    buffer_load_dwordx4 v98, s[16:19], s63 offen offset:2048 lds
    v_exp_f32 v25, v153
    v_add_f32 v10, v10, v30
    v_add_f32 v10, v10, v31
    v_cvt_pk_bf16_f32 v45, v30, v31
    v_exp_f32 v26, v156
    v_exp_f32 v27, v157
    v_add_f32 v9, v9, v24
    buffer_load_dwordx4 v99, s[16:19], s63 offen offset:3072 lds
    v_add_f32 v9, v9, v25
    v_cvt_pk_bf16_f32 v42, v24, v25
    v_exp_f32 v28, v154
    v_exp_f32 v29, v155
    v_add_f32 v10, v10, v26
    v_add_f32 v10, v10, v27
    v_cvt_pk_bf16_f32 v46, v26, v27
    v_exp_f32 v30, v158
    s_add_u32 m0, s64, 139264
    s_nop 0
    buffer_load_dwordx4 v100, s[16:19], s63 offen offset:0 lds
    s_add_u32 s63, s63, 81920
    v_exp_f32 v31, v159
    v_add_f32 v9, v9, v28
    v_add_f32 v9, v9, v29
    v_cvt_pk_bf16_f32 v43, v28, v29
    s_nop 0
    v_add_f32 v10, v10, v30
    v_add_f32 v10, v10, v31
    v_cvt_pk_bf16_f32 v47, v30, v31
    v_max_f32 v16, v9, v10
    v_cmp_lt_f32 vcc, s53, v16
    s_and_b32 s24, s3, 3
    s_and_b32 s32, s47, 0x10000
    s_xor_b32 s32, s32, 0x18000
    s_lshl_b32 s33, s3, 12
    s_add_u32 s32, s32, s33
    s_xor_b32 s33, s32, 16384
    s_lshl_b32 s34, s3, 9
    s_add_u32 s34, s34, 155648
    s_lshl_b32 s35, s24, 9
    s_add_u32 s35, s35, 157696
    s_cbranch_vccnz FIN0_R
FIN0_RB:
    s_waitcnt lgkmcnt(4)
    v_mfma_f32_16x16x32_bf16 v[192:195], v[64:67], v[56:59], v[192:195]
    ds_read_b128 v[88:91], v6 offset:6144
    v_add_f32 v11, v11, v9
    s_add_u32 m0, s69, 49152
    s_nop 0
    buffer_load_dwordx4 v96, s[16:19], s63 offen offset:0 lds
    v_mfma_f32_16x16x32_bf16 v[196:199], v[64:67], v[60:63], v[196:199]
    v_add_f32 v12, v12, v10
    v_mfma_f32_16x16x32_bf16 v[200:203], v[68:71], v[56:59], v[200:203]
    ds_read_b128 v[92:95], v6 offset:7168
    v_mov_b32 v16, v11
    s_nop 1
    v_permlane32_swap_b32 v16, v11
    s_nop 1
    v_add_f32 v11, v11, v16
    v_mfma_f32_16x16x32_bf16 v[204:207], v[68:71], v[60:63], v[204:207]
    v_mov_b32 v16, v11
    s_nop 1
    v_permlane16_swap_b32 v16, v11
    s_nop 1
    v_add_f32 v11, v11, v16
    s_waitcnt lgkmcnt(4)
    v_mfma_f32_16x16x32_bf16 v[208:211], v[72:75], v[56:59], v[208:211]
    ds_read_b128 v[64:67], v6 offset:8192
    buffer_load_dwordx4 v97, s[16:19], s63 offen offset:1024 lds
    v_mfma_f32_16x16x32_bf16 v[212:215], v[72:75], v[60:63], v[212:215]
    v_mov_b32 v17, v12
    s_nop 1
    v_permlane32_swap_b32 v17, v12
    s_nop 1
    v_add_f32 v12, v12, v17
    v_mfma_f32_16x16x32_bf16 v[216:219], v[76:79], v[56:59], v[216:219]
    ds_read_b128 v[68:71], v6 offset:9216
    v_mov_b32 v17, v12
    s_nop 1
    v_permlane16_swap_b32 v17, v12
    s_nop 1
    v_add_f32 v12, v12, v17
    v_mfma_f32_16x16x32_bf16 v[220:223], v[76:79], v[60:63], v[220:223]
    v_add_u32 v20, s32, v4
    s_waitcnt lgkmcnt(4)
    v_mfma_f32_16x16x32_bf16 v[224:227], v[80:83], v[56:59], v[224:227]
    ds_read_b128 v[72:75], v6 offset:10240
    v_add_u32 v21, s33, v4
    buffer_load_dwordx4 v98, s[16:19], s63 offen offset:2048 lds
    v_mfma_f32_16x16x32_bf16 v[228:231], v[80:83], v[60:63], v[228:231]
    v_mfma_f32_16x16x32_bf16 v[232:235], v[84:87], v[56:59], v[232:235]
    ds_read_b128 v[76:79], v6 offset:11264
    v_lshrrev_b32 v23, 1, v4
    v_mfma_f32_16x16x32_bf16 v[236:239], v[84:87], v[60:63], v[236:239]
    v_add_u32 v22, s34, v23
    s_waitcnt lgkmcnt(4)
    v_mfma_f32_16x16x32_bf16 v[240:243], v[88:91], v[56:59], v[240:243]
    ds_read_b128 v[80:83], v6 offset:12288
    v_add_u32 v23, s35, v23
    buffer_load_dwordx4 v99, s[16:19], s63 offen offset:3072 lds
    v_mfma_f32_16x16x32_bf16 v[244:247], v[88:91], v[60:63], v[244:247]
    v_mov_b32 v24, v36
    v_mfma_f32_16x16x32_bf16 v[248:251], v[92:95], v[56:59], v[248:251]
    ds_read_b128 v[84:87], v6 offset:13312
    v_mfma_f32_16x16x32_bf16 v[252:255], v[92:95], v[60:63], v[252:255]
    v_mov_b32 v25, v12
    s_waitcnt lgkmcnt(4)
    v_mfma_f32_16x16x32_bf16 v[192:195], v[64:67], v[40:43], v[192:195]
    ds_read_b128 v[88:91], v6 offset:14336
    ds_write_b64 v22, v[24:25]
    s_add_u32 m0, s69, 53248
    s_nop 0
    buffer_load_dwordx4 v100, s[16:19], s63 offen offset:0 lds
    s_add_u32 s63, s63, 81920
    v_mfma_f32_16x16x32_bf16 v[196:199], v[64:67], v[44:47], v[196:199]
    v_mov_b32 v10, v32
    v_mfma_f32_16x16x32_bf16 v[200:203], v[68:71], v[40:43], v[200:203]
    ds_read_b128 v[92:95], v6 offset:15360
    s_mov_b32 s34, 0xffff0000
    s_lshl_b32 s24, s71, 13
    s_add_u32 s24, s24, 0
    v_mfma_f32_16x16x32_bf16 v[204:207], v[68:71], v[44:47], v[204:207]
    v_add_u32 v101, s24, v101
    s_waitcnt lgkmcnt(5)
    v_mfma_f32_16x16x32_bf16 v[208:211], v[72:75], v[40:43], v[208:211]
    v_add_u32 v104, 16384, v101
    v_mfma_f32_16x16x32_bf16 v[212:215], v[72:75], v[44:47], v[212:215]
    v_add_u32 v107, 57344, v102
    v_add_u32 v108, 57344, v103
    v_mfma_f32_16x16x32_bf16 v[216:219], v[76:79], v[40:43], v[216:219]
    s_add_u32 s24, s73, 32768
    v_mfma_f32_16x16x32_bf16 v[220:223], v[76:79], v[44:47], v[220:223]
    v_add_u32 v105, s24, v101
    s_waitcnt lgkmcnt(3)
    v_mfma_f32_16x16x32_bf16 v[224:227], v[80:83], v[40:43], v[224:227]
    s_xor_b32 s24, s24, 0x10000
    v_add_u32 v106, s24, v101
    v_mfma_f32_16x16x32_bf16 v[228:231], v[80:83], v[44:47], v[228:231]
    s_sub_u32 s24, s73, 28672
    v_mfma_f32_16x16x32_bf16 v[232:235], v[84:87], v[40:43], v[232:235]
    v_add_u32 v109, s24, v102
    v_mfma_f32_16x16x32_bf16 v[236:239], v[84:87], v[44:47], v[236:239]
    v_add_u32 v110, s24, v103
    s_xor_b32 s24, s73, 0x10000
    s_waitcnt lgkmcnt(1)
    v_mfma_f32_16x16x32_bf16 v[240:243], v[88:91], v[40:43], v[240:243]
    s_sub_u32 s24, s24, 28672
    v_mfma_f32_16x16x32_bf16 v[244:247], v[88:91], v[44:47], v[244:247]
    v_add_u32 v111, s24, v102
    s_waitcnt lgkmcnt(0)
    v_mfma_f32_16x16x32_bf16 v[248:251], v[92:95], v[40:43], v[248:251]
    v_add_u32 v112, s24, v103
    v_mfma_f32_16x16x32_bf16 v[252:255], v[92:95], v[44:47], v[252:255]
    s_waitcnt vmcnt(10) lgkmcnt(0)
    s_barrier
    ds_read_b64 v[18:19], v23
    s_nop 2
    v_cvt_pk_bf16_f32 v196, v196, v197
    v_cvt_pk_bf16_f32 v197, v198, v199
    v_cvt_pk_bf16_f32 v198, v204, v205
    v_cvt_pk_bf16_f32 v199, v206, v207
    ds_write_b128 v20, v[196:199] offset:0
    v_cvt_pk_bf16_f32 v212, v212, v213
    v_cvt_pk_bf16_f32 v213, v214, v215
    v_cvt_pk_bf16_f32 v214, v220, v221
    v_cvt_pk_bf16_f32 v215, v222, v223
    ds_write_b128 v20, v[212:215] offset:1024
    v_cvt_pk_bf16_f32 v228, v228, v229
    v_cvt_pk_bf16_f32 v229, v230, v231
    v_cvt_pk_bf16_f32 v230, v236, v237
    v_cvt_pk_bf16_f32 v231, v238, v239
    ds_write_b128 v20, v[228:231] offset:2048
    v_cvt_pk_bf16_f32 v244, v244, v245
    v_cvt_pk_bf16_f32 v245, v246, v247
    v_cvt_pk_bf16_f32 v246, v252, v253
    v_cvt_pk_bf16_f32 v247, v254, v255
    ds_write_b128 v20, v[244:247] offset:3072
    ds_read_b64_tr_b16 v[40:41], v102 offset:0
    s_waitcnt lgkmcnt(4)
    v_min_f32 v9, v10, v18
    ds_read_b64_tr_b16 v[42:43], v102 offset:5120
    v_sub_f32 v10, v9, v10
    ds_read_b128 v[24:27], v101 offset:0
    v_sub_f32 v9, v9, v18
    ds_read_b64_tr_b16 v[44:45], v103 offset:32
    v_exp_f32 v10, v10
    ds_read_b64_tr_b16 v[46:47], v103 offset:5152
    v_exp_f32 v9, v9
    ds_read_b64_tr_b16 v[48:49], v102 offset:64
    s_nop 0
    ds_read_b64_tr_b16 v[50:51], v102 offset:5184
    v_mul_f32 v15, v11, v10
    ds_read_b64_tr_b16 v[52:53], v103 offset:96
    v_fma_f32 v15, v19, v9, v15
    ds_read_b64_tr_b16 v[54:55], v103 offset:5216
    v_rcp_f32 v15, v15
    ds_read_b64_tr_b16 v[56:57], v102 offset:128
    s_nop 0
    ds_read_b64_tr_b16 v[58:59], v102 offset:5248
    v_mul_f32 v15, v15, v13
    ds_read_b128 v[28:31], v101 offset:2048
    v_mul_f32 v18, v10, v15
    ds_read_b128 v[32:35], v101 offset:4096
    v_mul_f32 v19, v10, v15
    ds_read_b128 v[36:39], v101 offset:6144
    v_mul_f32 v16, v9, v15
    v_pk_mul_f32 v[192:193], v[192:193], v[18:19]
    v_pk_mul_f32 v[194:195], v[194:195], v[18:19]
    v_pk_mul_f32 v[200:201], v[200:201], v[18:19]
    v_pk_mul_f32 v[202:203], v[202:203], v[18:19]
    v_pk_mul_f32 v[208:209], v[208:209], v[18:19]
    v_pk_mul_f32 v[210:211], v[210:211], v[18:19]
    v_pk_mul_f32 v[216:217], v[216:217], v[18:19]
    v_pk_mul_f32 v[218:219], v[218:219], v[18:19]
    v_pk_mul_f32 v[224:225], v[224:225], v[18:19]
    v_pk_mul_f32 v[226:227], v[226:227], v[18:19]
    v_pk_mul_f32 v[232:233], v[232:233], v[18:19]
    v_pk_mul_f32 v[234:235], v[234:235], v[18:19]
    v_pk_mul_f32 v[240:241], v[240:241], v[18:19]
    v_pk_mul_f32 v[242:243], v[242:243], v[18:19]
    v_pk_mul_f32 v[248:249], v[248:249], v[18:19]
    v_pk_mul_f32 v[250:251], v[250:251], v[18:19]
    s_waitcnt lgkmcnt(14)
    s_barrier
    ds_read_b128 v[228:231], v21 offset:0
    ds_read_b128 v[236:239], v21 offset:1024
    ds_read_b128 v[244:247], v21 offset:2048
    ds_read_b128 v[252:255], v21 offset:3072
    s_waitcnt lgkmcnt(14)
    v_mfma_f32_16x16x32_bf16 v[128:131], v[40:43], v[24:27], 0
    s_waitcnt lgkmcnt(12)
    v_mfma_f32_16x16x32_bf16 v[132:135], v[44:47], v[24:27], 0
    s_waitcnt lgkmcnt(10)
    v_mfma_f32_16x16x32_bf16 v[136:139], v[48:51], v[24:27], 0
    s_waitcnt lgkmcnt(8)
    v_mfma_f32_16x16x32_bf16 v[140:143], v[52:55], v[24:27], 0
    s_waitcnt vmcnt(5) lgkmcnt(0)
    s_barrier
    ds_read_b64_tr_b16 v[76:77], v107 offset:0
    v_mfma_f32_16x16x32_bf16 v[144:147], v[56:59], v[24:27], 0
    ds_read_b64_tr_b16 v[78:79], v107 offset:5120
    v_lshlrev_b32 v9, 16, v228
    v_and_b32 v10, s34, v228
    v_fma_f32 v192, v9, v16, v192
    v_fma_f32 v193, v10, v16, v193
    v_lshlrev_b32 v9, 16, v229
    v_and_b32 v10, s34, v229
    v_fma_f32 v194, v9, v16, v194
    v_fma_f32 v195, v10, v16, v195
    v_mfma_f32_16x16x32_bf16 v[148:151], v[40:43], v[28:31], 0
    ds_read_b128 v[60:63], v104 offset:0
    v_lshlrev_b32 v9, 16, v230
    v_and_b32 v10, s34, v230
    v_fma_f32 v200, v9, v16, v200
    v_fma_f32 v201, v10, v16, v201
    v_lshlrev_b32 v9, 16, v231
    v_and_b32 v10, s34, v231
    v_fma_f32 v202, v9, v16, v202
    v_mfma_f32_16x16x32_bf16 v[152:155], v[44:47], v[28:31], 0
    ds_read_b64_tr_b16 v[80:81], v108 offset:32
    v_fma_f32 v203, v10, v16, v203
    v_cvt_pk_bf16_f32 v212, v192, v193
    v_cvt_pk_bf16_f32 v213, v194, v195
    v_cvt_pk_bf16_f32 v214, v200, v201
    v_cvt_pk_bf16_f32 v215, v202, v203
    buffer_store_dwordx4 v[212:215], v4, s[8:11], s57 offen offset:0 sc1
    v_lshlrev_b32 v9, 16, v236
    v_mfma_f32_16x16x32_bf16 v[156:159], v[48:51], v[28:31], 0
    ds_read_b64_tr_b16 v[82:83], v108 offset:5152
    v_and_b32 v10, s34, v236
    v_fma_f32 v208, v9, v16, v208
    v_fma_f32 v209, v10, v16, v209
    v_lshlrev_b32 v9, 16, v237
    v_and_b32 v10, s34, v237
    v_fma_f32 v210, v9, v16, v210
    v_fma_f32 v211, v10, v16, v211
    v_mfma_f32_16x16x32_bf16 v[160:163], v[52:55], v[28:31], 0
    ds_read_b64_tr_b16 v[84:85], v107 offset:64
    v_lshlrev_b32 v9, 16, v238
    v_and_b32 v10, s34, v238
    v_fma_f32 v216, v9, v16, v216
    v_fma_f32 v217, v10, v16, v217
    v_lshlrev_b32 v9, 16, v239
    v_and_b32 v10, s34, v239
    v_fma_f32 v218, v9, v16, v218
    v_mfma_f32_16x16x32_bf16 v[164:167], v[56:59], v[28:31], 0
    ds_read_b64_tr_b16 v[86:87], v107 offset:5184
    v_fma_f32 v219, v10, v16, v219
    v_cvt_pk_bf16_f32 v220, v208, v209
    v_cvt_pk_bf16_f32 v221, v210, v211
    v_cvt_pk_bf16_f32 v222, v216, v217
    v_cvt_pk_bf16_f32 v223, v218, v219
    buffer_store_dwordx4 v[220:223], v4, s[8:11], s57 offen offset:1024 sc1
    v_lshlrev_b32 v9, 16, v244
    v_mfma_f32_16x16x32_bf16 v[168:171], v[40:43], v[32:35], 0
    ds_read_b64_tr_b16 v[88:89], v108 offset:96
    v_and_b32 v10, s34, v244
    v_fma_f32 v224, v9, v16, v224
    v_fma_f32 v225, v10, v16, v225
    v_lshlrev_b32 v9, 16, v245
    v_and_b32 v10, s34, v245
    v_fma_f32 v226, v9, v16, v226
    v_fma_f32 v227, v10, v16, v227
    v_mfma_f32_16x16x32_bf16 v[172:175], v[44:47], v[32:35], 0
    ds_read_b64_tr_b16 v[90:91], v108 offset:5216
    v_lshlrev_b32 v9, 16, v246
    v_and_b32 v10, s34, v246
    v_fma_f32 v232, v9, v16, v232
    v_fma_f32 v233, v10, v16, v233
    v_lshlrev_b32 v9, 16, v247
    v_and_b32 v10, s34, v247
    v_fma_f32 v234, v9, v16, v234
    v_mfma_f32_16x16x32_bf16 v[176:179], v[48:51], v[32:35], 0
    ds_read_b64_tr_b16 v[92:93], v107 offset:128
    v_fma_f32 v235, v10, v16, v235
    v_cvt_pk_bf16_f32 v212, v224, v225
    v_cvt_pk_bf16_f32 v213, v226, v227
    v_cvt_pk_bf16_f32 v214, v232, v233
    v_cvt_pk_bf16_f32 v215, v234, v235
    s_add_u32 s57, s57, 16384
    buffer_store_dwordx4 v[212:215], v4, s[8:11], s57 offen offset:0 sc1
    v_mfma_f32_16x16x32_bf16 v[180:183], v[52:55], v[32:35], 0
    ds_read_b64_tr_b16 v[94:95], v107 offset:5248
    v_lshlrev_b32 v9, 16, v252
    v_and_b32 v10, s34, v252
    v_fma_f32 v240, v9, v16, v240
    v_fma_f32 v241, v10, v16, v241
    v_lshlrev_b32 v9, 16, v253
    v_and_b32 v10, s34, v253
    v_fma_f32 v242, v9, v16, v242
    v_mfma_f32_16x16x32_bf16 v[184:187], v[56:59], v[32:35], 0
    ds_read_b128 v[64:67], v104 offset:2048
    v_fma_f32 v243, v10, v16, v243
    v_lshlrev_b32 v9, 16, v254
    v_and_b32 v10, s34, v254
    v_fma_f32 v248, v9, v16, v248
    v_fma_f32 v249, v10, v16, v249
    v_lshlrev_b32 v9, 16, v255
    v_and_b32 v10, s34, v255
    v_mfma_f32_16x16x32_bf16 v[188:191], v[40:43], v[36:39], 0
    ds_read_b128 v[68:71], v104 offset:4096
    v_fma_f32 v250, v9, v16, v250
    v_fma_f32 v251, v10, v16, v251
    v_cvt_pk_bf16_f32 v220, v240, v241
    v_cvt_pk_bf16_f32 v221, v242, v243
    v_cvt_pk_bf16_f32 v222, v248, v249
    v_cvt_pk_bf16_f32 v223, v250, v251
    buffer_store_dwordx4 v[220:223], v4, s[8:11], s57 offen offset:1024 sc1
    v_mfma_f32_16x16x32_bf16 v[192:195], v[44:47], v[36:39], 0
    ds_read_b128 v[72:75], v104 offset:6144
    s_add_u32 m0, s70, 49152
    s_nop 0
    buffer_load_dwordx4 v96, s[16:19], s63 offen offset:0 lds
    buffer_load_dwordx4 v97, s[16:19], s63 offen offset:1024 lds
    v_mfma_f32_16x16x32_bf16 v[196:199], v[48:51], v[36:39], 0
    buffer_load_dwordx4 v98, s[16:19], s63 offen offset:2048 lds
    v_mfma_f32_16x16x32_bf16 v[200:203], v[52:55], v[36:39], 0
    buffer_load_dwordx4 v99, s[16:19], s63 offen offset:3072 lds
    v_mfma_f32_16x16x32_bf16 v[204:207], v[56:59], v[36:39], 0
    s_add_u32 m0, s70, 53248
    s_nop 0
    buffer_load_dwordx4 v100, s[16:19], s63 offen offset:0 lds
    s_add_u32 s63, s63, 81920
    s_waitcnt lgkmcnt(10)
    v_mfma_f32_16x16x32_bf16 v[128:131], v[76:79], v[60:63], v[128:131]
    s_waitcnt lgkmcnt(8)
    v_mfma_f32_16x16x32_bf16 v[132:135], v[80:83], v[60:63], v[132:135]
    s_waitcnt lgkmcnt(6)
    v_mfma_f32_16x16x32_bf16 v[136:139], v[84:87], v[60:63], v[136:139]
    s_waitcnt vmcnt(9) lgkmcnt(0)
    s_barrier
    ds_read_b64_tr_b16 v[40:41], v109 offset:0
    v_mfma_f32_16x16x32_bf16 v[140:143], v[88:91], v[60:63], v[140:143]
    ds_read_b64_tr_b16 v[42:43], v109 offset:5120
    s_add_u32 m0, s64, 77824
    s_nop 0
    buffer_load_dwordx4 v96, s[16:19], s63 offen offset:0 lds
    v_mfma_f32_16x16x32_bf16 v[144:147], v[92:95], v[60:63], v[144:147]
    ds_read_b128 v[24:27], v105 offset:0
    v_mfma_f32_16x16x32_bf16 v[148:151], v[76:79], v[64:67], v[148:151]
    ds_read_b64_tr_b16 v[44:45], v110 offset:32
    buffer_load_dwordx4 v97, s[16:19], s63 offen offset:1024 lds
    v_mfma_f32_16x16x32_bf16 v[152:155], v[80:83], v[64:67], v[152:155]
    ds_read_b64_tr_b16 v[46:47], v110 offset:5152
    v_mfma_f32_16x16x32_bf16 v[156:159], v[84:87], v[64:67], v[156:159]
    ds_read_b64_tr_b16 v[48:49], v109 offset:64
    v_mfma_f32_16x16x32_bf16 v[160:163], v[88:91], v[64:67], v[160:163]
    ds_read_b64_tr_b16 v[50:51], v109 offset:5184
    buffer_load_dwordx4 v98, s[16:19], s63 offen offset:2048 lds
    v_mfma_f32_16x16x32_bf16 v[164:167], v[92:95], v[64:67], v[164:167]
    v_mfma_f32_16x16x32_bf16 v[168:171], v[76:79], v[68:71], v[168:171]
    ds_read_b64_tr_b16 v[52:53], v110 offset:96
    v_mfma_f32_16x16x32_bf16 v[172:175], v[80:83], v[68:71], v[172:175]
    ds_read_b64_tr_b16 v[54:55], v110 offset:5216
    buffer_load_dwordx4 v99, s[16:19], s63 offen offset:3072 lds
    v_mfma_f32_16x16x32_bf16 v[176:179], v[84:87], v[68:71], v[176:179]
    ds_read_b64_tr_b16 v[56:57], v109 offset:128
    v_mfma_f32_16x16x32_bf16 v[180:183], v[88:91], v[68:71], v[180:183]
    ds_read_b64_tr_b16 v[58:59], v109 offset:5248
    v_mfma_f32_16x16x32_bf16 v[184:187], v[92:95], v[68:71], v[184:187]
    ds_read_b128 v[28:31], v105 offset:2048
    s_add_u32 m0, s64, 81920
    s_nop 0
    buffer_load_dwordx4 v100, s[16:19], s63 offen offset:0 lds
    s_add_u32 s63, s63, 81920
    v_mfma_f32_16x16x32_bf16 v[188:191], v[76:79], v[72:75], v[188:191]
    ds_read_b128 v[32:35], v105 offset:4096
    v_mfma_f32_16x16x32_bf16 v[192:195], v[80:83], v[72:75], v[192:195]
    ds_read_b128 v[36:39], v105 offset:6144
    v_mfma_f32_16x16x32_bf16 v[196:199], v[84:87], v[72:75], v[196:199]
    v_mfma_f32_16x16x32_bf16 v[200:203], v[88:91], v[72:75], v[200:203]
    v_mfma_f32_16x16x32_bf16 v[204:207], v[92:95], v[72:75], v[204:207]
    s_waitcnt lgkmcnt(10)
    v_mfma_f32_16x16x32_bf16 v[128:131], v[40:43], v[24:27], v[128:131]
    s_waitcnt lgkmcnt(8)
    v_mfma_f32_16x16x32_bf16 v[132:135], v[44:47], v[24:27], v[132:135]
    s_waitcnt lgkmcnt(6)
    v_mfma_f32_16x16x32_bf16 v[136:139], v[48:51], v[24:27], v[136:139]
    s_waitcnt vmcnt(10)
    s_waitcnt vmcnt(5) lgkmcnt(0)
    s_barrier
    s_cmp_lg_u32 s3, 0
    s_cbranch_scc1 SIG4
    v_mov_b32 v118, 4
    v_add_u32 v118, s38, v118
    s_mov_b64 exec, 1
    buffer_store_dword v118, off, s[8:11], s29 sc1
    s_mov_b64 exec, -1
SIG4:
    ds_read_b64_tr_b16 v[76:77], v111 offset:0
    v_mfma_f32_16x16x32_bf16 v[140:143], v[52:55], v[24:27], v[140:143]
    ds_read_b64_tr_b16 v[78:79], v111 offset:5120
    s_add_u32 m0, s64, 135168
    s_nop 0
    buffer_load_dwordx4 v96, s[16:19], s63 offen offset:0 lds
    v_mfma_f32_16x16x32_bf16 v[144:147], v[56:59], v[24:27], v[144:147]
    ds_read_b128 v[60:63], v106 offset:0
    v_mfma_f32_16x16x32_bf16 v[148:151], v[40:43], v[28:31], v[148:151]
    ds_read_b64_tr_b16 v[80:81], v112 offset:32
    buffer_load_dwordx4 v97, s[16:19], s63 offen offset:1024 lds
    v_mfma_f32_16x16x32_bf16 v[152:155], v[44:47], v[28:31], v[152:155]
    ds_read_b64_tr_b16 v[82:83], v112 offset:5152
    v_mfma_f32_16x16x32_bf16 v[156:159], v[48:51], v[28:31], v[156:159]
    ds_read_b64_tr_b16 v[84:85], v111 offset:64
    v_mfma_f32_16x16x32_bf16 v[160:163], v[52:55], v[28:31], v[160:163]
    ds_read_b64_tr_b16 v[86:87], v111 offset:5184
    buffer_load_dwordx4 v98, s[16:19], s63 offen offset:2048 lds
    v_mfma_f32_16x16x32_bf16 v[164:167], v[56:59], v[28:31], v[164:167]
    v_mfma_f32_16x16x32_bf16 v[168:171], v[40:43], v[32:35], v[168:171]
    ds_read_b64_tr_b16 v[88:89], v112 offset:96
    v_mfma_f32_16x16x32_bf16 v[172:175], v[44:47], v[32:35], v[172:175]
    ds_read_b64_tr_b16 v[90:91], v112 offset:5216
    buffer_load_dwordx4 v99, s[16:19], s63 offen offset:3072 lds
    v_mfma_f32_16x16x32_bf16 v[176:179], v[48:51], v[32:35], v[176:179]
    ds_read_b64_tr_b16 v[92:93], v111 offset:128
    v_mfma_f32_16x16x32_bf16 v[180:183], v[52:55], v[32:35], v[180:183]
    ds_read_b64_tr_b16 v[94:95], v111 offset:5248
    v_mfma_f32_16x16x32_bf16 v[184:187], v[56:59], v[32:35], v[184:187]
    ds_read_b128 v[64:67], v106 offset:2048
    s_add_u32 m0, s64, 139264
    s_nop 0
    buffer_load_dwordx4 v100, s[16:19], s63 offen offset:0 lds
    s_add_u32 s63, s63, 81920
    v_mfma_f32_16x16x32_bf16 v[188:191], v[40:43], v[36:39], v[188:191]
    ds_read_b128 v[68:71], v106 offset:4096
    v_mfma_f32_16x16x32_bf16 v[192:195], v[44:47], v[36:39], v[192:195]
    ds_read_b128 v[72:75], v106 offset:6144
    v_mfma_f32_16x16x32_bf16 v[196:199], v[48:51], v[36:39], v[196:199]
    v_mfma_f32_16x16x32_bf16 v[200:203], v[52:55], v[36:39], v[200:203]
    v_mfma_f32_16x16x32_bf16 v[204:207], v[56:59], v[36:39], v[204:207]
    s_waitcnt lgkmcnt(10)
    v_mfma_f32_16x16x32_bf16 v[128:131], v[76:79], v[60:63], v[128:131]
    s_waitcnt lgkmcnt(8)
    v_mfma_f32_16x16x32_bf16 v[132:135], v[80:83], v[60:63], v[132:135]
    s_waitcnt lgkmcnt(6)
    v_mfma_f32_16x16x32_bf16 v[136:139], v[84:87], v[60:63], v[136:139]
    s_waitcnt vmcnt(5) lgkmcnt(0)
    s_barrier
    ds_read_b64_tr_b16 v[40:41], v102 offset:0
    v_mfma_f32_16x16x32_bf16 v[140:143], v[88:91], v[60:63], v[140:143]
    ds_read_b64_tr_b16 v[42:43], v102 offset:5120
    s_add_u32 m0, s69, 49152
    s_nop 0
    buffer_load_dwordx4 v96, s[16:19], s63 offen offset:0 lds
    v_mfma_f32_16x16x32_bf16 v[144:147], v[92:95], v[60:63], v[144:147]
    ds_read_b128 v[24:27], v101 offset:0
    buffer_load_dwordx4 v97, s[16:19], s63 offen offset:1024 lds
    v_mfma_f32_16x16x32_bf16 v[148:151], v[76:79], v[64:67], v[148:151]
    ds_read_b64_tr_b16 v[44:45], v103 offset:32
    buffer_load_dwordx4 v98, s[16:19], s63 offen offset:2048 lds
    v_mfma_f32_16x16x32_bf16 v[152:155], v[80:83], v[64:67], v[152:155]
    ds_read_b64_tr_b16 v[46:47], v103 offset:5152
    v_mfma_f32_16x16x32_bf16 v[156:159], v[84:87], v[64:67], v[156:159]
    ds_read_b64_tr_b16 v[48:49], v102 offset:64
    buffer_load_dwordx4 v99, s[16:19], s63 offen offset:3072 lds
    v_mfma_f32_16x16x32_bf16 v[160:163], v[88:91], v[64:67], v[160:163]
    ds_read_b64_tr_b16 v[50:51], v102 offset:5184
    s_add_u32 m0, s69, 53248
    s_nop 0
    buffer_load_dwordx4 v100, s[16:19], s63 offen offset:0 lds
    s_add_u32 s63, s63, 81920
    v_mfma_f32_16x16x32_bf16 v[164:167], v[92:95], v[64:67], v[164:167]
    v_mfma_f32_16x16x32_bf16 v[168:171], v[76:79], v[68:71], v[168:171]
    ds_read_b64_tr_b16 v[52:53], v103 offset:96
    s_add_u32 m0, s70, 49152
    s_nop 0
    buffer_load_dwordx4 v96, s[20:23], s65 offen offset:0 lds
    v_mfma_f32_16x16x32_bf16 v[172:175], v[80:83], v[68:71], v[172:175]
    ds_read_b64_tr_b16 v[54:55], v103 offset:5216
    buffer_load_dwordx4 v97, s[20:23], s65 offen offset:1024 lds
    v_mfma_f32_16x16x32_bf16 v[176:179], v[84:87], v[68:71], v[176:179]
    ds_read_b64_tr_b16 v[56:57], v102 offset:128
    buffer_load_dwordx4 v98, s[20:23], s65 offen offset:2048 lds
    v_mfma_f32_16x16x32_bf16 v[180:183], v[88:91], v[68:71], v[180:183]
    ds_read_b64_tr_b16 v[58:59], v102 offset:5248
    v_mfma_f32_16x16x32_bf16 v[184:187], v[92:95], v[68:71], v[184:187]
    ds_read_b128 v[28:31], v101 offset:2048
    buffer_load_dwordx4 v99, s[20:23], s65 offen offset:3072 lds
    v_mfma_f32_16x16x32_bf16 v[188:191], v[76:79], v[72:75], v[188:191]
    ds_read_b128 v[32:35], v101 offset:4096
    s_add_u32 m0, s70, 53248
    s_nop 0
    buffer_load_dwordx4 v100, s[20:23], s65 offen offset:0 lds
    s_add_u32 s65, s65, 81920
    v_mfma_f32_16x16x32_bf16 v[192:195], v[80:83], v[72:75], v[192:195]
    ds_read_b128 v[36:39], v101 offset:6144
    v_mfma_f32_16x16x32_bf16 v[196:199], v[84:87], v[72:75], v[196:199]
    v_mfma_f32_16x16x32_bf16 v[200:203], v[88:91], v[72:75], v[200:203]
    v_mfma_f32_16x16x32_bf16 v[204:207], v[92:95], v[72:75], v[204:207]
    s_waitcnt lgkmcnt(10)
    v_mfma_f32_16x16x32_bf16 v[128:131], v[40:43], v[24:27], v[128:131]
    s_waitcnt lgkmcnt(8)
    v_mfma_f32_16x16x32_bf16 v[132:135], v[44:47], v[24:27], v[132:135]
    s_waitcnt lgkmcnt(6)
    v_mfma_f32_16x16x32_bf16 v[136:139], v[48:51], v[24:27], v[136:139]
    s_waitcnt vmcnt(10) lgkmcnt(0)
    s_barrier
    ds_read_b64_tr_b16 v[76:77], v107 offset:0
    v_mfma_f32_16x16x32_bf16 v[140:143], v[52:55], v[24:27], v[140:143]
    ds_read_b64_tr_b16 v[78:79], v107 offset:5120
    s_add_u32 m0, s64, 77824
    s_nop 0
    buffer_load_dwordx4 v96, s[20:23], s65 offen offset:0 lds
    v_mfma_f32_16x16x32_bf16 v[144:147], v[56:59], v[24:27], v[144:147]
    ds_read_b128 v[60:63], v104 offset:0
    v_mfma_f32_16x16x32_bf16 v[148:151], v[40:43], v[28:31], v[148:151]
    ds_read_b64_tr_b16 v[80:81], v108 offset:32
    buffer_load_dwordx4 v97, s[20:23], s65 offen offset:1024 lds
    v_mfma_f32_16x16x32_bf16 v[152:155], v[44:47], v[28:31], v[152:155]
    ds_read_b64_tr_b16 v[82:83], v108 offset:5152
    v_mfma_f32_16x16x32_bf16 v[156:159], v[48:51], v[28:31], v[156:159]
    ds_read_b64_tr_b16 v[84:85], v107 offset:64
    v_mfma_f32_16x16x32_bf16 v[160:163], v[52:55], v[28:31], v[160:163]
    ds_read_b64_tr_b16 v[86:87], v107 offset:5184
    buffer_load_dwordx4 v98, s[20:23], s65 offen offset:2048 lds
    v_mfma_f32_16x16x32_bf16 v[164:167], v[56:59], v[28:31], v[164:167]
    v_mfma_f32_16x16x32_bf16 v[168:171], v[40:43], v[32:35], v[168:171]
    ds_read_b64_tr_b16 v[88:89], v108 offset:96
    v_mfma_f32_16x16x32_bf16 v[172:175], v[44:47], v[32:35], v[172:175]
    ds_read_b64_tr_b16 v[90:91], v108 offset:5216
    buffer_load_dwordx4 v99, s[20:23], s65 offen offset:3072 lds
    v_mfma_f32_16x16x32_bf16 v[176:179], v[48:51], v[32:35], v[176:179]
    ds_read_b64_tr_b16 v[92:93], v107 offset:128
    v_mfma_f32_16x16x32_bf16 v[180:183], v[52:55], v[32:35], v[180:183]
    ds_read_b64_tr_b16 v[94:95], v107 offset:5248
    v_mfma_f32_16x16x32_bf16 v[184:187], v[56:59], v[32:35], v[184:187]
    ds_read_b128 v[64:67], v104 offset:2048
    s_add_u32 m0, s64, 81920
    s_nop 0
    buffer_load_dwordx4 v100, s[20:23], s65 offen offset:0 lds
    s_add_u32 s65, s65, 81920
    v_mfma_f32_16x16x32_bf16 v[188:191], v[40:43], v[36:39], v[188:191]
    ds_read_b128 v[68:71], v104 offset:4096
    v_mfma_f32_16x16x32_bf16 v[192:195], v[44:47], v[36:39], v[192:195]
    ds_read_b128 v[72:75], v104 offset:6144
    v_mfma_f32_16x16x32_bf16 v[196:199], v[48:51], v[36:39], v[196:199]
    v_mfma_f32_16x16x32_bf16 v[200:203], v[52:55], v[36:39], v[200:203]
    v_mfma_f32_16x16x32_bf16 v[204:207], v[56:59], v[36:39], v[204:207]
    s_waitcnt lgkmcnt(10)
    v_mfma_f32_16x16x32_bf16 v[128:131], v[76:79], v[60:63], v[128:131]
    s_waitcnt lgkmcnt(8)
    v_mfma_f32_16x16x32_bf16 v[132:135], v[80:83], v[60:63], v[132:135]
    s_waitcnt lgkmcnt(6)
    v_mfma_f32_16x16x32_bf16 v[136:139], v[84:87], v[60:63], v[136:139]
    s_waitcnt vmcnt(10) lgkmcnt(0)
    s_barrier
    ds_read_b64_tr_b16 v[40:41], v109 offset:0
    v_mfma_f32_16x16x32_bf16 v[140:143], v[88:91], v[60:63], v[140:143]
    ds_read_b64_tr_b16 v[42:43], v109 offset:5120
    s_add_u32 m0, s64, 135168
    s_nop 0
    buffer_load_dwordx4 v96, s[20:23], s65 offen offset:0 lds
    v_mfma_f32_16x16x32_bf16 v[144:147], v[92:95], v[60:63], v[144:147]
    ds_read_b128 v[24:27], v105 offset:0
    v_mfma_f32_16x16x32_bf16 v[148:151], v[76:79], v[64:67], v[148:151]
    ds_read_b64_tr_b16 v[44:45], v110 offset:32
    buffer_load_dwordx4 v97, s[20:23], s65 offen offset:1024 lds
    v_mfma_f32_16x16x32_bf16 v[152:155], v[80:83], v[64:67], v[152:155]
    ds_read_b64_tr_b16 v[46:47], v110 offset:5152
    v_mfma_f32_16x16x32_bf16 v[156:159], v[84:87], v[64:67], v[156:159]
    ds_read_b64_tr_b16 v[48:49], v109 offset:64
    v_mfma_f32_16x16x32_bf16 v[160:163], v[88:91], v[64:67], v[160:163]
    ds_read_b64_tr_b16 v[50:51], v109 offset:5184
    buffer_load_dwordx4 v98, s[20:23], s65 offen offset:2048 lds
    v_mfma_f32_16x16x32_bf16 v[164:167], v[92:95], v[64:67], v[164:167]
    v_mfma_f32_16x16x32_bf16 v[168:171], v[76:79], v[68:71], v[168:171]
    ds_read_b64_tr_b16 v[52:53], v110 offset:96
    v_mfma_f32_16x16x32_bf16 v[172:175], v[80:83], v[68:71], v[172:175]
    ds_read_b64_tr_b16 v[54:55], v110 offset:5216
    buffer_load_dwordx4 v99, s[20:23], s65 offen offset:3072 lds
    v_mfma_f32_16x16x32_bf16 v[176:179], v[84:87], v[68:71], v[176:179]
    ds_read_b64_tr_b16 v[56:57], v109 offset:128
    v_mfma_f32_16x16x32_bf16 v[180:183], v[88:91], v[68:71], v[180:183]
    ds_read_b64_tr_b16 v[58:59], v109 offset:5248
    v_mfma_f32_16x16x32_bf16 v[184:187], v[92:95], v[68:71], v[184:187]
    ds_read_b128 v[28:31], v105 offset:2048
    s_add_u32 m0, s64, 139264
    s_nop 0
    buffer_load_dwordx4 v100, s[20:23], s65 offen offset:0 lds
    s_add_u32 s65, s65, 81920
    v_mfma_f32_16x16x32_bf16 v[188:191], v[76:79], v[72:75], v[188:191]
    ds_read_b128 v[32:35], v105 offset:4096
    v_mfma_f32_16x16x32_bf16 v[192:195], v[80:83], v[72:75], v[192:195]
    ds_read_b128 v[36:39], v105 offset:6144
    v_mfma_f32_16x16x32_bf16 v[196:199], v[84:87], v[72:75], v[196:199]
    v_mfma_f32_16x16x32_bf16 v[200:203], v[88:91], v[72:75], v[200:203]
    v_mfma_f32_16x16x32_bf16 v[204:207], v[92:95], v[72:75], v[204:207]
    s_waitcnt lgkmcnt(10)
    v_mfma_f32_16x16x32_bf16 v[128:131], v[40:43], v[24:27], v[128:131]
    s_waitcnt lgkmcnt(8)
    v_mfma_f32_16x16x32_bf16 v[132:135], v[44:47], v[24:27], v[132:135]
    s_waitcnt lgkmcnt(6)
    v_mfma_f32_16x16x32_bf16 v[136:139], v[48:51], v[24:27], v[136:139]
    s_waitcnt vmcnt(10) lgkmcnt(0)
    s_barrier
    ds_read_b64_tr_b16 v[76:77], v111 offset:0
    v_mfma_f32_16x16x32_bf16 v[140:143], v[52:55], v[24:27], v[140:143]
    ds_read_b64_tr_b16 v[78:79], v111 offset:5120
    s_add_u32 m0, s69, 49152
    s_nop 0
    buffer_load_dwordx4 v96, s[20:23], s65 offen offset:0 lds
    v_mfma_f32_16x16x32_bf16 v[144:147], v[56:59], v[24:27], v[144:147]
    ds_read_b128 v[60:63], v106 offset:0
    v_mfma_f32_16x16x32_bf16 v[148:151], v[40:43], v[28:31], v[148:151]
    ds_read_b64_tr_b16 v[80:81], v112 offset:32
    buffer_load_dwordx4 v97, s[20:23], s65 offen offset:1024 lds
    v_mfma_f32_16x16x32_bf16 v[152:155], v[44:47], v[28:31], v[152:155]
    ds_read_b64_tr_b16 v[82:83], v112 offset:5152
    v_mfma_f32_16x16x32_bf16 v[156:159], v[48:51], v[28:31], v[156:159]
    ds_read_b64_tr_b16 v[84:85], v111 offset:64
    v_mfma_f32_16x16x32_bf16 v[160:163], v[52:55], v[28:31], v[160:163]
    ds_read_b64_tr_b16 v[86:87], v111 offset:5184
    buffer_load_dwordx4 v98, s[20:23], s65 offen offset:2048 lds
    v_mfma_f32_16x16x32_bf16 v[164:167], v[56:59], v[28:31], v[164:167]
    v_mfma_f32_16x16x32_bf16 v[168:171], v[40:43], v[32:35], v[168:171]
    ds_read_b64_tr_b16 v[88:89], v112 offset:96
    v_mfma_f32_16x16x32_bf16 v[172:175], v[44:47], v[32:35], v[172:175]
    ds_read_b64_tr_b16 v[90:91], v112 offset:5216
    buffer_load_dwordx4 v99, s[20:23], s65 offen offset:3072 lds
    v_mfma_f32_16x16x32_bf16 v[176:179], v[48:51], v[32:35], v[176:179]
    ds_read_b64_tr_b16 v[92:93], v111 offset:128
    v_mfma_f32_16x16x32_bf16 v[180:183], v[52:55], v[32:35], v[180:183]
    ds_read_b64_tr_b16 v[94:95], v111 offset:5248
    v_mfma_f32_16x16x32_bf16 v[184:187], v[56:59], v[32:35], v[184:187]
    ds_read_b128 v[64:67], v106 offset:2048
    s_add_u32 m0, s69, 53248
    s_nop 0
    buffer_load_dwordx4 v100, s[20:23], s65 offen offset:0 lds
    s_add_u32 s65, s65, 81920
    v_mfma_f32_16x16x32_bf16 v[188:191], v[40:43], v[36:39], v[188:191]
    ds_read_b128 v[68:71], v106 offset:4096
    v_mfma_f32_16x16x32_bf16 v[192:195], v[44:47], v[36:39], v[192:195]
    ds_read_b128 v[72:75], v106 offset:6144
    v_mfma_f32_16x16x32_bf16 v[196:199], v[48:51], v[36:39], v[196:199]
    v_mul_f32 v128, v128, v113
    v_mul_f32 v129, v129, v113
    v_mul_f32 v130, v130, v113
    v_mul_f32 v131, v131, v113
    v_mfma_f32_16x16x32_bf16 v[200:203], v[52:55], v[36:39], v[200:203]
    v_mul_f32 v132, v132, v113
    v_mul_f32 v133, v133, v113
    v_mul_f32 v134, v134, v113
    v_mul_f32 v135, v135, v113
    v_mfma_f32_16x16x32_bf16 v[204:207], v[56:59], v[36:39], v[204:207]
    v_mul_f32 v136, v136, v113
    v_mul_f32 v137, v137, v113
    v_mul_f32 v138, v138, v113
    v_mul_f32 v139, v139, v113
    s_waitcnt lgkmcnt(10)
    v_mfma_f32_16x16x32_bf16 v[128:131], v[76:79], v[60:63], v[128:131]
    v_mul_f32 v140, v140, v113
    v_mul_f32 v141, v141, v113
    v_mul_f32 v142, v142, v113
    v_mul_f32 v143, v143, v113
    s_waitcnt lgkmcnt(8)
    v_mfma_f32_16x16x32_bf16 v[132:135], v[80:83], v[60:63], v[132:135]
    v_mul_f32 v144, v144, v113
    v_mul_f32 v145, v145, v113
    v_mul_f32 v146, v146, v113
    v_mul_f32 v147, v147, v113
    s_waitcnt lgkmcnt(6)
    v_mfma_f32_16x16x32_bf16 v[136:139], v[84:87], v[60:63], v[136:139]
    s_waitcnt vmcnt(10) lgkmcnt(0)
    s_barrier
    ds_read_b64_tr_b16 v[40:41], v102 offset:0
    v_mul_f32 v148, v148, v114
    v_mul_f32 v149, v149, v114
    v_mul_f32 v150, v150, v114
    v_mul_f32 v151, v151, v114
    v_mfma_f32_16x16x32_bf16 v[140:143], v[88:91], v[60:63], v[140:143]
    ds_read_b64_tr_b16 v[42:43], v102 offset:5120
    s_add_u32 m0, s70, 49152
    s_nop 0
    buffer_load_dwordx4 v96, s[20:23], s65 offen offset:0 lds
    v_mul_f32 v152, v152, v114
    v_mul_f32 v153, v153, v114
    v_mul_f32 v154, v154, v114
    v_mul_f32 v155, v155, v114
    v_mfma_f32_16x16x32_bf16 v[144:147], v[92:95], v[60:63], v[144:147]
    ds_read_b128 v[24:27], v101 offset:0
    v_mul_f32 v156, v156, v114
    v_mul_f32 v157, v157, v114
    v_mul_f32 v158, v158, v114
    v_mul_f32 v159, v159, v114
    v_mfma_f32_16x16x32_bf16 v[148:151], v[76:79], v[64:67], v[148:151]
    ds_read_b64_tr_b16 v[44:45], v103 offset:32
    buffer_load_dwordx4 v97, s[20:23], s65 offen offset:1024 lds
    v_mul_f32 v160, v160, v114
    v_mul_f32 v161, v161, v114
    v_mul_f32 v162, v162, v114
    v_mul_f32 v163, v163, v114
    v_mfma_f32_16x16x32_bf16 v[152:155], v[80:83], v[64:67], v[152:155]
    ds_read_b64_tr_b16 v[46:47], v103 offset:5152
    v_mul_f32 v164, v164, v114
    v_mul_f32 v165, v165, v114
    v_mul_f32 v166, v166, v114
    v_mul_f32 v167, v167, v114
    v_mfma_f32_16x16x32_bf16 v[156:159], v[84:87], v[64:67], v[156:159]
    ds_read_b64_tr_b16 v[48:49], v102 offset:64
    v_mul_f32 v168, v168, v115
    v_mul_f32 v169, v169, v115
    v_mul_f32 v170, v170, v115
    v_mul_f32 v171, v171, v115
    v_mfma_f32_16x16x32_bf16 v[160:163], v[88:91], v[64:67], v[160:163]
    ds_read_b64_tr_b16 v[50:51], v102 offset:5184
    buffer_load_dwordx4 v98, s[20:23], s65 offen offset:2048 lds
    v_mul_f32 v172, v172, v115
    v_mul_f32 v173, v173, v115
    v_mul_f32 v174, v174, v115
    v_mul_f32 v175, v175, v115
    v_mfma_f32_16x16x32_bf16 v[164:167], v[92:95], v[64:67], v[164:167]
    v_mul_f32 v176, v176, v115
    v_mul_f32 v177, v177, v115
    v_mul_f32 v178, v178, v115
    v_mul_f32 v179, v179, v115
    v_mfma_f32_16x16x32_bf16 v[168:171], v[76:79], v[68:71], v[168:171]
    ds_read_b64_tr_b16 v[52:53], v103 offset:96
    v_mul_f32 v180, v180, v115
    v_mul_f32 v181, v181, v115
    v_mul_f32 v182, v182, v115
    v_mul_f32 v183, v183, v115
    v_mfma_f32_16x16x32_bf16 v[172:175], v[80:83], v[68:71], v[172:175]
    ds_read_b64_tr_b16 v[54:55], v103 offset:5216
    buffer_load_dwordx4 v99, s[20:23], s65 offen offset:3072 lds
    v_mul_f32 v184, v184, v115
    v_mul_f32 v185, v185, v115
    v_mul_f32 v186, v186, v115
    v_mul_f32 v187, v187, v115
    v_mfma_f32_16x16x32_bf16 v[176:179], v[84:87], v[68:71], v[176:179]
    ds_read_b64_tr_b16 v[56:57], v102 offset:128
    v_mul_f32 v188, v188, v116
    v_mul_f32 v189, v189, v116
    v_mul_f32 v190, v190, v116
    v_mul_f32 v191, v191, v116
    v_mfma_f32_16x16x32_bf16 v[180:183], v[88:91], v[68:71], v[180:183]
    ds_read_b64_tr_b16 v[58:59], v102 offset:5248
    v_mul_f32 v192, v192, v116
    v_mul_f32 v193, v193, v116
    v_mul_f32 v194, v194, v116
    v_mul_f32 v195, v195, v116
    v_mfma_f32_16x16x32_bf16 v[184:187], v[92:95], v[68:71], v[184:187]
    ds_read_b128 v[28:31], v101 offset:2048
    s_add_u32 m0, s70, 53248
    s_nop 0
    buffer_load_dwordx4 v100, s[20:23], s65 offen offset:0 lds
    s_add_u32 s65, s65, 81920
    v_mul_f32 v196, v196, v116
    v_mul_f32 v197, v197, v116
    v_mul_f32 v198, v198, v116
    v_mul_f32 v199, v199, v116
    v_mfma_f32_16x16x32_bf16 v[188:191], v[76:79], v[72:75], v[188:191]
    ds_read_b128 v[32:35], v101 offset:4096
    v_mul_f32 v200, v200, v116
    v_mul_f32 v201, v201, v116
    v_mul_f32 v202, v202, v116
    v_mul_f32 v203, v203, v116
    v_mfma_f32_16x16x32_bf16 v[192:195], v[80:83], v[72:75], v[192:195]
    ds_read_b128 v[36:39], v101 offset:6144
    v_mul_f32 v204, v204, v116
    v_mul_f32 v205, v205, v116
    v_mul_f32 v206, v206, v116
    v_mul_f32 v207, v207, v116
    v_mfma_f32_16x16x32_bf16 v[196:199], v[84:87], v[72:75], v[196:199]
    v_mfma_f32_16x16x32_bf16 v[200:203], v[88:91], v[72:75], v[200:203]
    v_mfma_f32_16x16x32_bf16 v[204:207], v[92:95], v[72:75], v[204:207]
    s_waitcnt lgkmcnt(10)
    v_mfma_f32_16x16x32_bf16 v[128:131], v[40:43], v[24:27], v[128:131]
    s_waitcnt lgkmcnt(8)
    v_mfma_f32_16x16x32_bf16 v[132:135], v[44:47], v[24:27], v[132:135]
    s_waitcnt lgkmcnt(6)
    v_mfma_f32_16x16x32_bf16 v[136:139], v[48:51], v[24:27], v[136:139]
    s_waitcnt vmcnt(10) lgkmcnt(0)
    s_barrier
    ds_read_b64_tr_b16 v[76:77], v107 offset:0
    v_mfma_f32_16x16x32_bf16 v[140:143], v[52:55], v[24:27], v[140:143]
    ds_read_b64_tr_b16 v[78:79], v107 offset:5120
    s_add_u32 m0, s64, 77824
    s_nop 0
    buffer_load_dwordx4 v96, s[20:23], s65 offen offset:0 lds
    v_mfma_f32_16x16x32_bf16 v[144:147], v[56:59], v[24:27], v[144:147]
    ds_read_b128 v[60:63], v104 offset:0
    v_mfma_f32_16x16x32_bf16 v[148:151], v[40:43], v[28:31], v[148:151]
    ds_read_b64_tr_b16 v[80:81], v108 offset:32
    buffer_load_dwordx4 v97, s[20:23], s65 offen offset:1024 lds
    v_mfma_f32_16x16x32_bf16 v[152:155], v[44:47], v[28:31], v[152:155]
    ds_read_b64_tr_b16 v[82:83], v108 offset:5152
    v_mfma_f32_16x16x32_bf16 v[156:159], v[48:51], v[28:31], v[156:159]
    ds_read_b64_tr_b16 v[84:85], v107 offset:64
    v_mfma_f32_16x16x32_bf16 v[160:163], v[52:55], v[28:31], v[160:163]
    ds_read_b64_tr_b16 v[86:87], v107 offset:5184
    buffer_load_dwordx4 v98, s[20:23], s65 offen offset:2048 lds
    v_mfma_f32_16x16x32_bf16 v[164:167], v[56:59], v[28:31], v[164:167]
    v_mfma_f32_16x16x32_bf16 v[168:171], v[40:43], v[32:35], v[168:171]
    ds_read_b64_tr_b16 v[88:89], v108 offset:96
    v_mfma_f32_16x16x32_bf16 v[172:175], v[44:47], v[32:35], v[172:175]
    ds_read_b64_tr_b16 v[90:91], v108 offset:5216
    buffer_load_dwordx4 v99, s[20:23], s65 offen offset:3072 lds
    v_mfma_f32_16x16x32_bf16 v[176:179], v[48:51], v[32:35], v[176:179]
    ds_read_b64_tr_b16 v[92:93], v107 offset:128
    v_mfma_f32_16x16x32_bf16 v[180:183], v[52:55], v[32:35], v[180:183]
    ds_read_b64_tr_b16 v[94:95], v107 offset:5248
    v_mfma_f32_16x16x32_bf16 v[184:187], v[56:59], v[32:35], v[184:187]
    ds_read_b128 v[64:67], v104 offset:2048
    s_add_u32 m0, s64, 81920
    s_nop 0
    buffer_load_dwordx4 v100, s[20:23], s65 offen offset:0 lds
    s_add_u32 s65, s65, 81920
    v_mfma_f32_16x16x32_bf16 v[188:191], v[40:43], v[36:39], v[188:191]
    ds_read_b128 v[68:71], v104 offset:4096
    v_mfma_f32_16x16x32_bf16 v[192:195], v[44:47], v[36:39], v[192:195]
    ds_read_b128 v[72:75], v104 offset:6144
    v_mfma_f32_16x16x32_bf16 v[196:199], v[48:51], v[36:39], v[196:199]
    v_mfma_f32_16x16x32_bf16 v[200:203], v[52:55], v[36:39], v[200:203]
    v_mfma_f32_16x16x32_bf16 v[204:207], v[56:59], v[36:39], v[204:207]
    s_waitcnt lgkmcnt(10)
    v_mfma_f32_16x16x32_bf16 v[128:131], v[76:79], v[60:63], v[128:131]
    s_waitcnt lgkmcnt(8)
    v_mfma_f32_16x16x32_bf16 v[132:135], v[80:83], v[60:63], v[132:135]
    s_waitcnt lgkmcnt(6)
    v_mfma_f32_16x16x32_bf16 v[136:139], v[84:87], v[60:63], v[136:139]
    s_waitcnt vmcnt(10) lgkmcnt(0)
    s_barrier
    ds_read_b64_tr_b16 v[40:41], v109 offset:0
    v_mfma_f32_16x16x32_bf16 v[140:143], v[88:91], v[60:63], v[140:143]
    ds_read_b64_tr_b16 v[42:43], v109 offset:5120
    s_add_u32 m0, s64, 135168
    s_nop 0
    buffer_load_dwordx4 v96, s[20:23], s65 offen offset:0 lds
    v_mfma_f32_16x16x32_bf16 v[144:147], v[92:95], v[60:63], v[144:147]
    ds_read_b128 v[24:27], v105 offset:0
    v_mfma_f32_16x16x32_bf16 v[148:151], v[76:79], v[64:67], v[148:151]
    ds_read_b64_tr_b16 v[44:45], v110 offset:32
    buffer_load_dwordx4 v97, s[20:23], s65 offen offset:1024 lds
    v_mfma_f32_16x16x32_bf16 v[152:155], v[80:83], v[64:67], v[152:155]
    ds_read_b64_tr_b16 v[46:47], v110 offset:5152
    v_mfma_f32_16x16x32_bf16 v[156:159], v[84:87], v[64:67], v[156:159]
    ds_read_b64_tr_b16 v[48:49], v109 offset:64
    v_mfma_f32_16x16x32_bf16 v[160:163], v[88:91], v[64:67], v[160:163]
    ds_read_b64_tr_b16 v[50:51], v109 offset:5184
    buffer_load_dwordx4 v98, s[20:23], s65 offen offset:2048 lds
    v_mfma_f32_16x16x32_bf16 v[164:167], v[92:95], v[64:67], v[164:167]
    v_mfma_f32_16x16x32_bf16 v[168:171], v[76:79], v[68:71], v[168:171]
    ds_read_b64_tr_b16 v[52:53], v110 offset:96
    v_mfma_f32_16x16x32_bf16 v[172:175], v[80:83], v[68:71], v[172:175]
    ds_read_b64_tr_b16 v[54:55], v110 offset:5216
    buffer_load_dwordx4 v99, s[20:23], s65 offen offset:3072 lds
    v_mfma_f32_16x16x32_bf16 v[176:179], v[84:87], v[68:71], v[176:179]
    ds_read_b64_tr_b16 v[56:57], v109 offset:128
    v_mfma_f32_16x16x32_bf16 v[180:183], v[88:91], v[68:71], v[180:183]
    ds_read_b64_tr_b16 v[58:59], v109 offset:5248
    v_mfma_f32_16x16x32_bf16 v[184:187], v[92:95], v[68:71], v[184:187]
    ds_read_b128 v[28:31], v105 offset:2048
    s_add_u32 m0, s64, 139264
    s_nop 0
    buffer_load_dwordx4 v100, s[20:23], s65 offen offset:0 lds
    s_add_u32 s65, s65, 81920
    v_mfma_f32_16x16x32_bf16 v[188:191], v[76:79], v[72:75], v[188:191]
    ds_read_b128 v[32:35], v105 offset:4096
    v_mfma_f32_16x16x32_bf16 v[192:195], v[80:83], v[72:75], v[192:195]
    ds_read_b128 v[36:39], v105 offset:6144
    v_mfma_f32_16x16x32_bf16 v[196:199], v[84:87], v[72:75], v[196:199]
    v_mfma_f32_16x16x32_bf16 v[200:203], v[88:91], v[72:75], v[200:203]
    v_mfma_f32_16x16x32_bf16 v[204:207], v[92:95], v[72:75], v[204:207]
    s_waitcnt lgkmcnt(10)
    v_mfma_f32_16x16x32_bf16 v[128:131], v[40:43], v[24:27], v[128:131]
    s_waitcnt lgkmcnt(8)
    v_mfma_f32_16x16x32_bf16 v[132:135], v[44:47], v[24:27], v[132:135]
    s_waitcnt lgkmcnt(6)
    v_mfma_f32_16x16x32_bf16 v[136:139], v[48:51], v[24:27], v[136:139]
    s_waitcnt vmcnt(10) lgkmcnt(0)
    s_barrier
    ds_read_b64_tr_b16 v[76:77], v111 offset:0
    v_mfma_f32_16x16x32_bf16 v[140:143], v[52:55], v[24:27], v[140:143]
    ds_read_b64_tr_b16 v[78:79], v111 offset:5120
    s_add_u32 m0, s69, 49152
    s_nop 0
    buffer_load_dwordx4 v96, s[20:23], s65 offen offset:0 lds
    v_mfma_f32_16x16x32_bf16 v[144:147], v[56:59], v[24:27], v[144:147]
    ds_read_b128 v[60:63], v106 offset:0
    v_mfma_f32_16x16x32_bf16 v[148:151], v[40:43], v[28:31], v[148:151]
    ds_read_b64_tr_b16 v[80:81], v112 offset:32
    buffer_load_dwordx4 v97, s[20:23], s65 offen offset:1024 lds
    v_mfma_f32_16x16x32_bf16 v[152:155], v[44:47], v[28:31], v[152:155]
    ds_read_b64_tr_b16 v[82:83], v112 offset:5152
    v_mfma_f32_16x16x32_bf16 v[156:159], v[48:51], v[28:31], v[156:159]
    ds_read_b64_tr_b16 v[84:85], v111 offset:64
    v_mfma_f32_16x16x32_bf16 v[160:163], v[52:55], v[28:31], v[160:163]
    ds_read_b64_tr_b16 v[86:87], v111 offset:5184
    buffer_load_dwordx4 v98, s[20:23], s65 offen offset:2048 lds
    v_mfma_f32_16x16x32_bf16 v[164:167], v[56:59], v[28:31], v[164:167]
    v_mfma_f32_16x16x32_bf16 v[168:171], v[40:43], v[32:35], v[168:171]
    ds_read_b64_tr_b16 v[88:89], v112 offset:96
    v_mfma_f32_16x16x32_bf16 v[172:175], v[44:47], v[32:35], v[172:175]
    ds_read_b64_tr_b16 v[90:91], v112 offset:5216
    buffer_load_dwordx4 v99, s[20:23], s65 offen offset:3072 lds
    v_mfma_f32_16x16x32_bf16 v[176:179], v[48:51], v[32:35], v[176:179]
    ds_read_b64_tr_b16 v[92:93], v111 offset:128
    v_mfma_f32_16x16x32_bf16 v[180:183], v[52:55], v[32:35], v[180:183]
    ds_read_b64_tr_b16 v[94:95], v111 offset:5248
    v_mfma_f32_16x16x32_bf16 v[184:187], v[56:59], v[32:35], v[184:187]
    ds_read_b128 v[64:67], v106 offset:2048
    s_add_u32 m0, s69, 53248
    s_nop 0
    buffer_load_dwordx4 v100, s[20:23], s65 offen offset:0 lds
    s_add_u32 s65, s65, 81920
    v_mfma_f32_16x16x32_bf16 v[188:191], v[40:43], v[36:39], v[188:191]
    ds_read_b128 v[68:71], v106 offset:4096
    v_mfma_f32_16x16x32_bf16 v[192:195], v[44:47], v[36:39], v[192:195]
    ds_read_b128 v[72:75], v106 offset:6144
    v_mfma_f32_16x16x32_bf16 v[196:199], v[48:51], v[36:39], v[196:199]
    v_mfma_f32_16x16x32_bf16 v[200:203], v[52:55], v[36:39], v[200:203]
    v_mfma_f32_16x16x32_bf16 v[204:207], v[56:59], v[36:39], v[204:207]
    s_waitcnt lgkmcnt(10)
    v_mfma_f32_16x16x32_bf16 v[128:131], v[76:79], v[60:63], v[128:131]
    s_waitcnt lgkmcnt(8)
    v_mfma_f32_16x16x32_bf16 v[132:135], v[80:83], v[60:63], v[132:135]
    s_waitcnt lgkmcnt(6)
    v_mfma_f32_16x16x32_bf16 v[136:139], v[84:87], v[60:63], v[136:139]
    s_waitcnt vmcnt(10) lgkmcnt(0)
    s_barrier
    ds_read_b64_tr_b16 v[40:41], v102 offset:0
    v_mfma_f32_16x16x32_bf16 v[140:143], v[88:91], v[60:63], v[140:143]
    ds_read_b64_tr_b16 v[42:43], v102 offset:5120
    s_add_u32 m0, s70, 49152
    s_nop 0
    buffer_load_dwordx4 v96, s[20:23], s65 offen offset:0 lds
    v_mfma_f32_16x16x32_bf16 v[144:147], v[92:95], v[60:63], v[144:147]
    ds_read_b128 v[24:27], v101 offset:0
    v_mfma_f32_16x16x32_bf16 v[148:151], v[76:79], v[64:67], v[148:151]
    ds_read_b64_tr_b16 v[44:45], v103 offset:32
    buffer_load_dwordx4 v97, s[20:23], s65 offen offset:1024 lds
    v_mfma_f32_16x16x32_bf16 v[152:155], v[80:83], v[64:67], v[152:155]
    ds_read_b64_tr_b16 v[46:47], v103 offset:5152
    v_mfma_f32_16x16x32_bf16 v[156:159], v[84:87], v[64:67], v[156:159]
    ds_read_b64_tr_b16 v[48:49], v102 offset:64
    v_mfma_f32_16x16x32_bf16 v[160:163], v[88:91], v[64:67], v[160:163]
    ds_read_b64_tr_b16 v[50:51], v102 offset:5184
    buffer_load_dwordx4 v98, s[20:23], s65 offen offset:2048 lds
    v_mfma_f32_16x16x32_bf16 v[164:167], v[92:95], v[64:67], v[164:167]
    v_mfma_f32_16x16x32_bf16 v[168:171], v[76:79], v[68:71], v[168:171]
    ds_read_b64_tr_b16 v[52:53], v103 offset:96
    v_mfma_f32_16x16x32_bf16 v[172:175], v[80:83], v[68:71], v[172:175]
    ds_read_b64_tr_b16 v[54:55], v103 offset:5216
    buffer_load_dwordx4 v99, s[20:23], s65 offen offset:3072 lds
    v_mfma_f32_16x16x32_bf16 v[176:179], v[84:87], v[68:71], v[176:179]
    ds_read_b64_tr_b16 v[56:57], v102 offset:128
    v_mfma_f32_16x16x32_bf16 v[180:183], v[88:91], v[68:71], v[180:183]
    ds_read_b64_tr_b16 v[58:59], v102 offset:5248
    v_mfma_f32_16x16x32_bf16 v[184:187], v[92:95], v[68:71], v[184:187]
    ds_read_b128 v[28:31], v101 offset:2048
    s_add_u32 m0, s70, 53248
    s_nop 0
    buffer_load_dwordx4 v100, s[20:23], s65 offen offset:0 lds
    s_add_u32 s65, s65, 81920
    v_mfma_f32_16x16x32_bf16 v[188:191], v[76:79], v[72:75], v[188:191]
    ds_read_b128 v[32:35], v101 offset:4096
    v_mfma_f32_16x16x32_bf16 v[192:195], v[80:83], v[72:75], v[192:195]
    ds_read_b128 v[36:39], v101 offset:6144
    v_mfma_f32_16x16x32_bf16 v[196:199], v[84:87], v[72:75], v[196:199]
    v_mfma_f32_16x16x32_bf16 v[200:203], v[88:91], v[72:75], v[200:203]
    v_mfma_f32_16x16x32_bf16 v[204:207], v[92:95], v[72:75], v[204:207]
    s_waitcnt lgkmcnt(10)
    v_mfma_f32_16x16x32_bf16 v[128:131], v[40:43], v[24:27], v[128:131]
    s_waitcnt lgkmcnt(8)
    v_mfma_f32_16x16x32_bf16 v[132:135], v[44:47], v[24:27], v[132:135]
    s_waitcnt lgkmcnt(6)
    v_mfma_f32_16x16x32_bf16 v[136:139], v[48:51], v[24:27], v[136:139]
    s_waitcnt vmcnt(10) lgkmcnt(0)
    s_barrier
    ds_read_b64_tr_b16 v[76:77], v107 offset:0
    v_mfma_f32_16x16x32_bf16 v[140:143], v[52:55], v[24:27], v[140:143]
    ds_read_b64_tr_b16 v[78:79], v107 offset:5120
    s_add_u32 m0, s64, 77824
    s_nop 0
    buffer_load_dwordx4 v96, s[20:23], s65 offen offset:0 lds
    v_mfma_f32_16x16x32_bf16 v[144:147], v[56:59], v[24:27], v[144:147]
    ds_read_b128 v[60:63], v104 offset:0
    v_mfma_f32_16x16x32_bf16 v[148:151], v[40:43], v[28:31], v[148:151]
    ds_read_b64_tr_b16 v[80:81], v108 offset:32
    buffer_load_dwordx4 v97, s[20:23], s65 offen offset:1024 lds
    v_mfma_f32_16x16x32_bf16 v[152:155], v[44:47], v[28:31], v[152:155]
    ds_read_b64_tr_b16 v[82:83], v108 offset:5152
    v_mfma_f32_16x16x32_bf16 v[156:159], v[48:51], v[28:31], v[156:159]
    ds_read_b64_tr_b16 v[84:85], v107 offset:64
    v_mfma_f32_16x16x32_bf16 v[160:163], v[52:55], v[28:31], v[160:163]
    ds_read_b64_tr_b16 v[86:87], v107 offset:5184
    buffer_load_dwordx4 v98, s[20:23], s65 offen offset:2048 lds
    v_mfma_f32_16x16x32_bf16 v[164:167], v[56:59], v[28:31], v[164:167]
    v_mfma_f32_16x16x32_bf16 v[168:171], v[40:43], v[32:35], v[168:171]
    ds_read_b64_tr_b16 v[88:89], v108 offset:96
    v_mfma_f32_16x16x32_bf16 v[172:175], v[44:47], v[32:35], v[172:175]
    ds_read_b64_tr_b16 v[90:91], v108 offset:5216
    buffer_load_dwordx4 v99, s[20:23], s65 offen offset:3072 lds
    v_mfma_f32_16x16x32_bf16 v[176:179], v[48:51], v[32:35], v[176:179]
    ds_read_b64_tr_b16 v[92:93], v107 offset:128
    v_mfma_f32_16x16x32_bf16 v[180:183], v[52:55], v[32:35], v[180:183]
    ds_read_b64_tr_b16 v[94:95], v107 offset:5248
    v_mfma_f32_16x16x32_bf16 v[184:187], v[56:59], v[32:35], v[184:187]
    ds_read_b128 v[64:67], v104 offset:2048
    s_add_u32 m0, s64, 81920
    s_nop 0
    buffer_load_dwordx4 v100, s[20:23], s65 offen offset:0 lds
    s_add_u32 s65, s65, 81920
    v_mfma_f32_16x16x32_bf16 v[188:191], v[40:43], v[36:39], v[188:191]
    ds_read_b128 v[68:71], v104 offset:4096
    v_mfma_f32_16x16x32_bf16 v[192:195], v[44:47], v[36:39], v[192:195]
    ds_read_b128 v[72:75], v104 offset:6144
    v_mfma_f32_16x16x32_bf16 v[196:199], v[48:51], v[36:39], v[196:199]
    v_mfma_f32_16x16x32_bf16 v[200:203], v[52:55], v[36:39], v[200:203]
    v_mfma_f32_16x16x32_bf16 v[204:207], v[56:59], v[36:39], v[204:207]
    s_waitcnt lgkmcnt(10)
    v_mfma_f32_16x16x32_bf16 v[128:131], v[76:79], v[60:63], v[128:131]
    s_waitcnt lgkmcnt(8)
    v_mfma_f32_16x16x32_bf16 v[132:135], v[80:83], v[60:63], v[132:135]
    s_waitcnt lgkmcnt(6)
    v_mfma_f32_16x16x32_bf16 v[136:139], v[84:87], v[60:63], v[136:139]
    s_waitcnt vmcnt(10) lgkmcnt(0)
    s_barrier
    ds_read_b64_tr_b16 v[40:41], v109 offset:0
    v_mfma_f32_16x16x32_bf16 v[140:143], v[88:91], v[60:63], v[140:143]
    ds_read_b64_tr_b16 v[42:43], v109 offset:5120
    s_add_u32 m0, s64, 135168
    s_nop 0
    buffer_load_dwordx4 v96, s[20:23], s65 offen offset:0 lds
    v_mfma_f32_16x16x32_bf16 v[144:147], v[92:95], v[60:63], v[144:147]
    ds_read_b128 v[24:27], v105 offset:0
    v_mfma_f32_16x16x32_bf16 v[148:151], v[76:79], v[64:67], v[148:151]
    ds_read_b64_tr_b16 v[44:45], v110 offset:32
    buffer_load_dwordx4 v97, s[20:23], s65 offen offset:1024 lds
    v_mfma_f32_16x16x32_bf16 v[152:155], v[80:83], v[64:67], v[152:155]
    ds_read_b64_tr_b16 v[46:47], v110 offset:5152
    v_mfma_f32_16x16x32_bf16 v[156:159], v[84:87], v[64:67], v[156:159]
    ds_read_b64_tr_b16 v[48:49], v109 offset:64
    v_mfma_f32_16x16x32_bf16 v[160:163], v[88:91], v[64:67], v[160:163]
    ds_read_b64_tr_b16 v[50:51], v109 offset:5184
    buffer_load_dwordx4 v98, s[20:23], s65 offen offset:2048 lds
    v_mfma_f32_16x16x32_bf16 v[164:167], v[92:95], v[64:67], v[164:167]
    v_mfma_f32_16x16x32_bf16 v[168:171], v[76:79], v[68:71], v[168:171]
    ds_read_b64_tr_b16 v[52:53], v110 offset:96
    v_mfma_f32_16x16x32_bf16 v[172:175], v[80:83], v[68:71], v[172:175]
    ds_read_b64_tr_b16 v[54:55], v110 offset:5216
    buffer_load_dwordx4 v99, s[20:23], s65 offen offset:3072 lds
    v_mfma_f32_16x16x32_bf16 v[176:179], v[84:87], v[68:71], v[176:179]
    ds_read_b64_tr_b16 v[56:57], v109 offset:128
    v_mfma_f32_16x16x32_bf16 v[180:183], v[88:91], v[68:71], v[180:183]
    ds_read_b64_tr_b16 v[58:59], v109 offset:5248
    v_mfma_f32_16x16x32_bf16 v[184:187], v[92:95], v[68:71], v[184:187]
    ds_read_b128 v[28:31], v105 offset:2048
    s_add_u32 m0, s64, 139264
    s_nop 0
    buffer_load_dwordx4 v100, s[20:23], s65 offen offset:0 lds
    s_add_u32 s65, s65, 81920
    v_mfma_f32_16x16x32_bf16 v[188:191], v[76:79], v[72:75], v[188:191]
    ds_read_b128 v[32:35], v105 offset:4096
    v_mfma_f32_16x16x32_bf16 v[192:195], v[80:83], v[72:75], v[192:195]
    ds_read_b128 v[36:39], v105 offset:6144
    v_mfma_f32_16x16x32_bf16 v[196:199], v[84:87], v[72:75], v[196:199]
    v_mfma_f32_16x16x32_bf16 v[200:203], v[88:91], v[72:75], v[200:203]
    v_mfma_f32_16x16x32_bf16 v[204:207], v[92:95], v[72:75], v[204:207]
    s_waitcnt lgkmcnt(10)
    v_mfma_f32_16x16x32_bf16 v[128:131], v[40:43], v[24:27], v[128:131]
    s_waitcnt lgkmcnt(8)
    v_mfma_f32_16x16x32_bf16 v[132:135], v[44:47], v[24:27], v[132:135]
    s_waitcnt lgkmcnt(6)
    v_mfma_f32_16x16x32_bf16 v[136:139], v[48:51], v[24:27], v[136:139]
    s_waitcnt vmcnt(10) lgkmcnt(0)
    s_barrier
    ds_read_b64_tr_b16 v[76:77], v111 offset:0
    v_mfma_f32_16x16x32_bf16 v[140:143], v[52:55], v[24:27], v[140:143]
    ds_read_b64_tr_b16 v[78:79], v111 offset:5120
    s_add_u32 m0, s69, 49152
    s_nop 0
    buffer_load_dwordx4 v96, s[20:23], s65 offen offset:0 lds
    v_mfma_f32_16x16x32_bf16 v[144:147], v[56:59], v[24:27], v[144:147]
    ds_read_b128 v[60:63], v106 offset:0
    v_mfma_f32_16x16x32_bf16 v[148:151], v[40:43], v[28:31], v[148:151]
    ds_read_b64_tr_b16 v[80:81], v112 offset:32
    buffer_load_dwordx4 v97, s[20:23], s65 offen offset:1024 lds
    v_mfma_f32_16x16x32_bf16 v[152:155], v[44:47], v[28:31], v[152:155]
    ds_read_b64_tr_b16 v[82:83], v112 offset:5152
    v_mfma_f32_16x16x32_bf16 v[156:159], v[48:51], v[28:31], v[156:159]
    ds_read_b64_tr_b16 v[84:85], v111 offset:64
    v_mfma_f32_16x16x32_bf16 v[160:163], v[52:55], v[28:31], v[160:163]
    ds_read_b64_tr_b16 v[86:87], v111 offset:5184
    buffer_load_dwordx4 v98, s[20:23], s65 offen offset:2048 lds
    v_mfma_f32_16x16x32_bf16 v[164:167], v[56:59], v[28:31], v[164:167]
    v_mfma_f32_16x16x32_bf16 v[168:171], v[40:43], v[32:35], v[168:171]
    ds_read_b64_tr_b16 v[88:89], v112 offset:96
    v_mfma_f32_16x16x32_bf16 v[172:175], v[44:47], v[32:35], v[172:175]
    ds_read_b64_tr_b16 v[90:91], v112 offset:5216
    buffer_load_dwordx4 v99, s[20:23], s65 offen offset:3072 lds
    v_mfma_f32_16x16x32_bf16 v[176:179], v[48:51], v[32:35], v[176:179]
    ds_read_b64_tr_b16 v[92:93], v111 offset:128
    v_mfma_f32_16x16x32_bf16 v[180:183], v[52:55], v[32:35], v[180:183]
    ds_read_b64_tr_b16 v[94:95], v111 offset:5248
    v_mfma_f32_16x16x32_bf16 v[184:187], v[56:59], v[32:35], v[184:187]
    ds_read_b128 v[64:67], v106 offset:2048
    s_add_u32 m0, s69, 53248
    s_nop 0
    buffer_load_dwordx4 v100, s[20:23], s65 offen offset:0 lds
    s_add_u32 s65, s65, 81920
    v_mfma_f32_16x16x32_bf16 v[188:191], v[40:43], v[36:39], v[188:191]
    ds_read_b128 v[68:71], v106 offset:4096
    v_mfma_f32_16x16x32_bf16 v[192:195], v[44:47], v[36:39], v[192:195]
    ds_read_b128 v[72:75], v106 offset:6144
    v_mfma_f32_16x16x32_bf16 v[196:199], v[48:51], v[36:39], v[196:199]
    v_mfma_f32_16x16x32_bf16 v[200:203], v[52:55], v[36:39], v[200:203]
    v_mfma_f32_16x16x32_bf16 v[204:207], v[56:59], v[36:39], v[204:207]
    s_waitcnt lgkmcnt(10)
    v_mfma_f32_16x16x32_bf16 v[128:131], v[76:79], v[60:63], v[128:131]
    s_waitcnt lgkmcnt(8)
    v_mfma_f32_16x16x32_bf16 v[132:135], v[80:83], v[60:63], v[132:135]
    s_waitcnt lgkmcnt(6)
    v_mfma_f32_16x16x32_bf16 v[136:139], v[84:87], v[60:63], v[136:139]
    s_waitcnt vmcnt(10) lgkmcnt(0)
    s_barrier
    ds_read_b64_tr_b16 v[40:41], v102 offset:0
    v_mfma_f32_16x16x32_bf16 v[140:143], v[88:91], v[60:63], v[140:143]
    ds_read_b64_tr_b16 v[42:43], v102 offset:5120
    s_add_u32 m0, s70, 49152
    s_nop 0
    buffer_load_dwordx4 v96, s[20:23], s65 offen offset:0 lds
    v_mfma_f32_16x16x32_bf16 v[144:147], v[92:95], v[60:63], v[144:147]
    ds_read_b128 v[24:27], v101 offset:0
    v_mfma_f32_16x16x32_bf16 v[148:151], v[76:79], v[64:67], v[148:151]
    ds_read_b64_tr_b16 v[44:45], v103 offset:32
    buffer_load_dwordx4 v97, s[20:23], s65 offen offset:1024 lds
    v_mfma_f32_16x16x32_bf16 v[152:155], v[80:83], v[64:67], v[152:155]
    ds_read_b64_tr_b16 v[46:47], v103 offset:5152
    v_mfma_f32_16x16x32_bf16 v[156:159], v[84:87], v[64:67], v[156:159]
    ds_read_b64_tr_b16 v[48:49], v102 offset:64
    v_mfma_f32_16x16x32_bf16 v[160:163], v[88:91], v[64:67], v[160:163]
    ds_read_b64_tr_b16 v[50:51], v102 offset:5184
    buffer_load_dwordx4 v98, s[20:23], s65 offen offset:2048 lds
    v_mfma_f32_16x16x32_bf16 v[164:167], v[92:95], v[64:67], v[164:167]
    v_mfma_f32_16x16x32_bf16 v[168:171], v[76:79], v[68:71], v[168:171]
    ds_read_b64_tr_b16 v[52:53], v103 offset:96
    v_mfma_f32_16x16x32_bf16 v[172:175], v[80:83], v[68:71], v[172:175]
    ds_read_b64_tr_b16 v[54:55], v103 offset:5216
    buffer_load_dwordx4 v99, s[20:23], s65 offen offset:3072 lds
    v_mfma_f32_16x16x32_bf16 v[176:179], v[84:87], v[68:71], v[176:179]
    ds_read_b64_tr_b16 v[56:57], v102 offset:128
    v_mfma_f32_16x16x32_bf16 v[180:183], v[88:91], v[68:71], v[180:183]
    ds_read_b64_tr_b16 v[58:59], v102 offset:5248
    v_mfma_f32_16x16x32_bf16 v[184:187], v[92:95], v[68:71], v[184:187]
    ds_read_b128 v[28:31], v101 offset:2048
    s_add_u32 m0, s70, 53248
    s_nop 0
    buffer_load_dwordx4 v100, s[20:23], s65 offen offset:0 lds
    s_add_u32 s65, s65, 81920
    v_mfma_f32_16x16x32_bf16 v[188:191], v[76:79], v[72:75], v[188:191]
    ds_read_b128 v[32:35], v101 offset:4096
    v_mfma_f32_16x16x32_bf16 v[192:195], v[80:83], v[72:75], v[192:195]
    ds_read_b128 v[36:39], v101 offset:6144
    v_mfma_f32_16x16x32_bf16 v[196:199], v[84:87], v[72:75], v[196:199]
    v_mfma_f32_16x16x32_bf16 v[200:203], v[88:91], v[72:75], v[200:203]
    v_mfma_f32_16x16x32_bf16 v[204:207], v[92:95], v[72:75], v[204:207]
    s_waitcnt lgkmcnt(10)
    v_mfma_f32_16x16x32_bf16 v[128:131], v[40:43], v[24:27], v[128:131]
    s_waitcnt lgkmcnt(8)
    v_mfma_f32_16x16x32_bf16 v[132:135], v[44:47], v[24:27], v[132:135]
    s_waitcnt lgkmcnt(6)
    v_mfma_f32_16x16x32_bf16 v[136:139], v[48:51], v[24:27], v[136:139]
    s_waitcnt vmcnt(10) lgkmcnt(0)
    s_barrier
    ds_read_b64_tr_b16 v[76:77], v107 offset:0
    v_mfma_f32_16x16x32_bf16 v[140:143], v[52:55], v[24:27], v[140:143]
    ds_read_b64_tr_b16 v[78:79], v107 offset:5120
    s_add_u32 m0, s64, 77824
    s_nop 0
    buffer_load_dwordx4 v96, s[20:23], s65 offen offset:0 lds
    v_mfma_f32_16x16x32_bf16 v[144:147], v[56:59], v[24:27], v[144:147]
    ds_read_b128 v[60:63], v104 offset:0
    v_mfma_f32_16x16x32_bf16 v[148:151], v[40:43], v[28:31], v[148:151]
    ds_read_b64_tr_b16 v[80:81], v108 offset:32
    buffer_load_dwordx4 v97, s[20:23], s65 offen offset:1024 lds
    v_mfma_f32_16x16x32_bf16 v[152:155], v[44:47], v[28:31], v[152:155]
    ds_read_b64_tr_b16 v[82:83], v108 offset:5152
    v_mfma_f32_16x16x32_bf16 v[156:159], v[48:51], v[28:31], v[156:159]
    ds_read_b64_tr_b16 v[84:85], v107 offset:64
    v_mfma_f32_16x16x32_bf16 v[160:163], v[52:55], v[28:31], v[160:163]
    ds_read_b64_tr_b16 v[86:87], v107 offset:5184
    buffer_load_dwordx4 v98, s[20:23], s65 offen offset:2048 lds
    v_mfma_f32_16x16x32_bf16 v[164:167], v[56:59], v[28:31], v[164:167]
    v_mfma_f32_16x16x32_bf16 v[168:171], v[40:43], v[32:35], v[168:171]
    ds_read_b64_tr_b16 v[88:89], v108 offset:96
    v_mfma_f32_16x16x32_bf16 v[172:175], v[44:47], v[32:35], v[172:175]
    ds_read_b64_tr_b16 v[90:91], v108 offset:5216
    buffer_load_dwordx4 v99, s[20:23], s65 offen offset:3072 lds
    v_mfma_f32_16x16x32_bf16 v[176:179], v[48:51], v[32:35], v[176:179]
    ds_read_b64_tr_b16 v[92:93], v107 offset:128
    v_mfma_f32_16x16x32_bf16 v[180:183], v[52:55], v[32:35], v[180:183]
    ds_read_b64_tr_b16 v[94:95], v107 offset:5248
    v_mfma_f32_16x16x32_bf16 v[184:187], v[56:59], v[32:35], v[184:187]
    ds_read_b128 v[64:67], v104 offset:2048
    s_add_u32 m0, s64, 81920
    s_nop 0
    buffer_load_dwordx4 v100, s[20:23], s65 offen offset:0 lds
    s_add_u32 s65, s65, 81920
    v_mfma_f32_16x16x32_bf16 v[188:191], v[40:43], v[36:39], v[188:191]
    ds_read_b128 v[68:71], v104 offset:4096
    v_mfma_f32_16x16x32_bf16 v[192:195], v[44:47], v[36:39], v[192:195]
    ds_read_b128 v[72:75], v104 offset:6144
    v_mfma_f32_16x16x32_bf16 v[196:199], v[48:51], v[36:39], v[196:199]
    v_mfma_f32_16x16x32_bf16 v[200:203], v[52:55], v[36:39], v[200:203]
    v_mfma_f32_16x16x32_bf16 v[204:207], v[56:59], v[36:39], v[204:207]
    s_waitcnt lgkmcnt(10)
    v_mfma_f32_16x16x32_bf16 v[128:131], v[76:79], v[60:63], v[128:131]
    s_waitcnt lgkmcnt(8)
    v_mfma_f32_16x16x32_bf16 v[132:135], v[80:83], v[60:63], v[132:135]
    s_waitcnt lgkmcnt(6)
    v_mfma_f32_16x16x32_bf16 v[136:139], v[84:87], v[60:63], v[136:139]
    s_waitcnt vmcnt(10) lgkmcnt(0)
    s_barrier
    ds_read_b64_tr_b16 v[40:41], v109 offset:0
    v_mfma_f32_16x16x32_bf16 v[140:143], v[88:91], v[60:63], v[140:143]
    ds_read_b64_tr_b16 v[42:43], v109 offset:5120
    s_add_u32 m0, s64, 135168
    s_nop 0
    buffer_load_dwordx4 v96, s[20:23], s65 offen offset:0 lds
    v_mfma_f32_16x16x32_bf16 v[144:147], v[92:95], v[60:63], v[144:147]
    ds_read_b128 v[24:27], v105 offset:0
    v_mfma_f32_16x16x32_bf16 v[148:151], v[76:79], v[64:67], v[148:151]
    ds_read_b64_tr_b16 v[44:45], v110 offset:32
    buffer_load_dwordx4 v97, s[20:23], s65 offen offset:1024 lds
    v_mfma_f32_16x16x32_bf16 v[152:155], v[80:83], v[64:67], v[152:155]
    ds_read_b64_tr_b16 v[46:47], v110 offset:5152
    v_mfma_f32_16x16x32_bf16 v[156:159], v[84:87], v[64:67], v[156:159]
    ds_read_b64_tr_b16 v[48:49], v109 offset:64
    v_mfma_f32_16x16x32_bf16 v[160:163], v[88:91], v[64:67], v[160:163]
    ds_read_b64_tr_b16 v[50:51], v109 offset:5184
    buffer_load_dwordx4 v98, s[20:23], s65 offen offset:2048 lds
    v_mfma_f32_16x16x32_bf16 v[164:167], v[92:95], v[64:67], v[164:167]
    v_mfma_f32_16x16x32_bf16 v[168:171], v[76:79], v[68:71], v[168:171]
    ds_read_b64_tr_b16 v[52:53], v110 offset:96
    v_mfma_f32_16x16x32_bf16 v[172:175], v[80:83], v[68:71], v[172:175]
    ds_read_b64_tr_b16 v[54:55], v110 offset:5216
    buffer_load_dwordx4 v99, s[20:23], s65 offen offset:3072 lds
    v_mfma_f32_16x16x32_bf16 v[176:179], v[84:87], v[68:71], v[176:179]
    ds_read_b64_tr_b16 v[56:57], v109 offset:128
    v_mfma_f32_16x16x32_bf16 v[180:183], v[88:91], v[68:71], v[180:183]
    ds_read_b64_tr_b16 v[58:59], v109 offset:5248
    v_mfma_f32_16x16x32_bf16 v[184:187], v[92:95], v[68:71], v[184:187]
    ds_read_b128 v[28:31], v105 offset:2048
    s_add_u32 m0, s64, 139264
    s_nop 0
    buffer_load_dwordx4 v100, s[20:23], s65 offen offset:0 lds
    s_add_u32 s65, s65, 81920
    v_mfma_f32_16x16x32_bf16 v[188:191], v[76:79], v[72:75], v[188:191]
    ds_read_b128 v[32:35], v105 offset:4096
    v_mfma_f32_16x16x32_bf16 v[192:195], v[80:83], v[72:75], v[192:195]
    ds_read_b128 v[36:39], v105 offset:6144
    v_mfma_f32_16x16x32_bf16 v[196:199], v[84:87], v[72:75], v[196:199]
    v_mfma_f32_16x16x32_bf16 v[200:203], v[88:91], v[72:75], v[200:203]
    v_mfma_f32_16x16x32_bf16 v[204:207], v[92:95], v[72:75], v[204:207]
    s_waitcnt lgkmcnt(10)
    v_mfma_f32_16x16x32_bf16 v[128:131], v[40:43], v[24:27], v[128:131]
    s_waitcnt lgkmcnt(8)
    v_mfma_f32_16x16x32_bf16 v[132:135], v[44:47], v[24:27], v[132:135]
    s_waitcnt lgkmcnt(6)
    v_mfma_f32_16x16x32_bf16 v[136:139], v[48:51], v[24:27], v[136:139]
    s_waitcnt vmcnt(10) lgkmcnt(0)
    s_barrier
    ds_read_b64_tr_b16 v[76:77], v111 offset:0
    v_mfma_f32_16x16x32_bf16 v[140:143], v[52:55], v[24:27], v[140:143]
    ds_read_b64_tr_b16 v[78:79], v111 offset:5120
    s_add_u32 m0, s69, 49152
    s_nop 0
    buffer_load_dwordx4 v96, s[20:23], s65 offen offset:0 lds
    v_mfma_f32_16x16x32_bf16 v[144:147], v[56:59], v[24:27], v[144:147]
    ds_read_b128 v[60:63], v106 offset:0
    v_mfma_f32_16x16x32_bf16 v[148:151], v[40:43], v[28:31], v[148:151]
    ds_read_b64_tr_b16 v[80:81], v112 offset:32
    buffer_load_dwordx4 v97, s[20:23], s65 offen offset:1024 lds
    v_mfma_f32_16x16x32_bf16 v[152:155], v[44:47], v[28:31], v[152:155]
    ds_read_b64_tr_b16 v[82:83], v112 offset:5152
    v_mfma_f32_16x16x32_bf16 v[156:159], v[48:51], v[28:31], v[156:159]
    ds_read_b64_tr_b16 v[84:85], v111 offset:64
    v_mfma_f32_16x16x32_bf16 v[160:163], v[52:55], v[28:31], v[160:163]
    ds_read_b64_tr_b16 v[86:87], v111 offset:5184
    buffer_load_dwordx4 v98, s[20:23], s65 offen offset:2048 lds
    v_mfma_f32_16x16x32_bf16 v[164:167], v[56:59], v[28:31], v[164:167]
    v_mfma_f32_16x16x32_bf16 v[168:171], v[40:43], v[32:35], v[168:171]
    ds_read_b64_tr_b16 v[88:89], v112 offset:96
    v_mfma_f32_16x16x32_bf16 v[172:175], v[44:47], v[32:35], v[172:175]
    ds_read_b64_tr_b16 v[90:91], v112 offset:5216
    buffer_load_dwordx4 v99, s[20:23], s65 offen offset:3072 lds
    v_mfma_f32_16x16x32_bf16 v[176:179], v[48:51], v[32:35], v[176:179]
    ds_read_b64_tr_b16 v[92:93], v111 offset:128
    v_mfma_f32_16x16x32_bf16 v[180:183], v[52:55], v[32:35], v[180:183]
    ds_read_b64_tr_b16 v[94:95], v111 offset:5248
    v_mfma_f32_16x16x32_bf16 v[184:187], v[56:59], v[32:35], v[184:187]
    ds_read_b128 v[64:67], v106 offset:2048
    s_add_u32 m0, s69, 53248
    s_nop 0
    buffer_load_dwordx4 v100, s[20:23], s65 offen offset:0 lds
    s_add_u32 s65, s65, 81920
    v_mfma_f32_16x16x32_bf16 v[188:191], v[40:43], v[36:39], v[188:191]
    ds_read_b128 v[68:71], v106 offset:4096
    v_mfma_f32_16x16x32_bf16 v[192:195], v[44:47], v[36:39], v[192:195]
    ds_read_b128 v[72:75], v106 offset:6144
    v_mfma_f32_16x16x32_bf16 v[196:199], v[48:51], v[36:39], v[196:199]
    v_mfma_f32_16x16x32_bf16 v[200:203], v[52:55], v[36:39], v[200:203]
    v_mfma_f32_16x16x32_bf16 v[204:207], v[56:59], v[36:39], v[204:207]
    s_waitcnt lgkmcnt(10)
    v_mfma_f32_16x16x32_bf16 v[128:131], v[76:79], v[60:63], v[128:131]
    s_waitcnt lgkmcnt(8)
    v_mfma_f32_16x16x32_bf16 v[132:135], v[80:83], v[60:63], v[132:135]
    s_waitcnt lgkmcnt(6)
    v_mfma_f32_16x16x32_bf16 v[136:139], v[84:87], v[60:63], v[136:139]
    s_waitcnt vmcnt(10) lgkmcnt(0)
    s_barrier
    ds_read_b64_tr_b16 v[40:41], v102 offset:0
    v_mfma_f32_16x16x32_bf16 v[140:143], v[88:91], v[60:63], v[140:143]
    ds_read_b64_tr_b16 v[42:43], v102 offset:5120
    v_mfma_f32_16x16x32_bf16 v[144:147], v[92:95], v[60:63], v[144:147]
    ds_read_b128 v[24:27], v101 offset:0
    v_mfma_f32_16x16x32_bf16 v[148:151], v[76:79], v[64:67], v[148:151]
    ds_read_b64_tr_b16 v[44:45], v103 offset:32
    v_mfma_f32_16x16x32_bf16 v[152:155], v[80:83], v[64:67], v[152:155]
    ds_read_b64_tr_b16 v[46:47], v103 offset:5152
    v_mfma_f32_16x16x32_bf16 v[156:159], v[84:87], v[64:67], v[156:159]
    ds_read_b64_tr_b16 v[48:49], v102 offset:64
    v_mfma_f32_16x16x32_bf16 v[160:163], v[88:91], v[64:67], v[160:163]
    ds_read_b64_tr_b16 v[50:51], v102 offset:5184
    v_mfma_f32_16x16x32_bf16 v[164:167], v[92:95], v[64:67], v[164:167]
    v_mfma_f32_16x16x32_bf16 v[168:171], v[76:79], v[68:71], v[168:171]
    ds_read_b64_tr_b16 v[52:53], v103 offset:96
    v_mfma_f32_16x16x32_bf16 v[172:175], v[80:83], v[68:71], v[172:175]
    ds_read_b64_tr_b16 v[54:55], v103 offset:5216
    v_mfma_f32_16x16x32_bf16 v[176:179], v[84:87], v[68:71], v[176:179]
    ds_read_b64_tr_b16 v[56:57], v102 offset:128
    v_mfma_f32_16x16x32_bf16 v[180:183], v[88:91], v[68:71], v[180:183]
    ds_read_b64_tr_b16 v[58:59], v102 offset:5248
    v_mfma_f32_16x16x32_bf16 v[184:187], v[92:95], v[68:71], v[184:187]
    ds_read_b128 v[28:31], v101 offset:2048
    v_mfma_f32_16x16x32_bf16 v[188:191], v[76:79], v[72:75], v[188:191]
    ds_read_b128 v[32:35], v101 offset:4096
    v_mfma_f32_16x16x32_bf16 v[192:195], v[80:83], v[72:75], v[192:195]
    ds_read_b128 v[36:39], v101 offset:6144
    v_mfma_f32_16x16x32_bf16 v[196:199], v[84:87], v[72:75], v[196:199]
    v_mfma_f32_16x16x32_bf16 v[200:203], v[88:91], v[72:75], v[200:203]
    v_mfma_f32_16x16x32_bf16 v[204:207], v[92:95], v[72:75], v[204:207]
    s_waitcnt lgkmcnt(10)
    v_mfma_f32_16x16x32_bf16 v[128:131], v[40:43], v[24:27], v[128:131]
    s_waitcnt lgkmcnt(8)
    v_mfma_f32_16x16x32_bf16 v[132:135], v[44:47], v[24:27], v[132:135]
    s_waitcnt lgkmcnt(6)
    v_mfma_f32_16x16x32_bf16 v[136:139], v[48:51], v[24:27], v[136:139]
    s_waitcnt vmcnt(5) lgkmcnt(0)
    s_barrier
    ds_read_b64_tr_b16 v[76:77], v107 offset:0
    v_mfma_f32_16x16x32_bf16 v[140:143], v[52:55], v[24:27], v[140:143]
    ds_read_b64_tr_b16 v[78:79], v107 offset:5120
    s_cmp_eq_u32 s73, 0
    s_cselect_b32 s26, 69632, 0
    s_mul_i32 s24, s3, 10240
    s_add_u32 s24, s24, s26
    v_mfma_f32_16x16x32_bf16 v[144:147], v[56:59], v[24:27], v[144:147]
    ds_read_b128 v[68:71], v104 offset:4096
    v_add_u32 v117, s24, v4
    s_xor_b32 s25, s3, 4
    v_mfma_f32_16x16x32_bf16 v[148:151], v[40:43], v[28:31], v[148:151]
    ds_read_b64_tr_b16 v[80:81], v108 offset:32
    s_mul_i32 s25, s25, 10240
    s_add_u32 s25, s25, s26
    v_add_u32 v118, s25, v4
    v_mfma_f32_16x16x32_bf16 v[152:155], v[44:47], v[28:31], v[152:155]
    ds_read_b64_tr_b16 v[82:83], v108 offset:5152
    v_add_u32 v111, 0x2800, v109
    v_add_u32 v112, 0x2800, v110
    v_mfma_f32_16x16x32_bf16 v[156:159], v[48:51], v[28:31], v[156:159]
    ds_read_b64_tr_b16 v[84:85], v107 offset:64
    s_lshl_b32 s66, s61, 2
    s_add_u32 s66, s66, s62
    s_mul_i32 s66, s66, 122880
    v_mfma_f32_16x16x32_bf16 v[160:163], v[52:55], v[28:31], v[160:163]
    ds_read_b64_tr_b16 v[86:87], v107 offset:5184
    s_and_b32 s24, s3, 3
    s_mul_i32 s24, s24, 2560
    v_mfma_f32_16x16x32_bf16 v[164:167], v[56:59], v[28:31], v[164:167]
    s_add_u32 s66, s66, s24
    s_add_u32 s66, s66, 0x4000000
    s_mov_b32 s68, 0xffff0000
    v_mfma_f32_16x16x32_bf16 v[168:171], v[40:43], v[32:35], v[168:171]
    ds_read_b64_tr_b16 v[88:89], v108 offset:96
    s_lshl_b32 s24, s61, 7
    s_lshl_b32 s65, s71, 6
    v_mfma_f32_16x16x32_bf16 v[172:175], v[44:47], v[32:35], v[172:175]
    ds_read_b64_tr_b16 v[90:91], v108 offset:5216
    s_add_u32 s24, s24, s65
    s_lshl_b32 s65, s60, 4
    s_add_u32 s24, s24, s65
    v_mfma_f32_16x16x32_bf16 v[176:179], v[48:51], v[32:35], v[176:179]
    ds_read_b64_tr_b16 v[92:93], v107 offset:128
    s_mul_i32 s24, s24, 1280
    s_mul_i32 s65, s62, 320
    v_mfma_f32_16x16x32_bf16 v[180:183], v[52:55], v[32:35], v[180:183]
    ds_read_b64_tr_b16 v[94:95], v107 offset:5248
    s_add_u32 s24, s24, s65
    s_mul_i32 s65, s72, 160
    s_add_u32 s65, s24, s65
    v_mfma_f32_16x16x32_bf16 v[184:187], v[56:59], v[32:35], v[184:187]
    ds_read_b128 v[72:75], v104 offset:6144
    v_lshrrev_b32 v125, 1, v4
    v_mul_u32_u24 v123, 1280, v2
    v_mfma_f32_16x16x32_bf16 v[188:191], v[40:43], v[36:39], v[188:191]
    ds_read_b128 v[60:63], v104 offset:0
    v_and_b32 v124, 1, v3
    v_lshlrev_b32 v124, 5, v124
    v_lshrrev_b32 v119, 1, v3
    v_mfma_f32_16x16x32_bf16 v[192:195], v[44:47], v[36:39], v[192:195]
    ds_read_b128 v[64:67], v104 offset:2048
    v_lshl_add_u32 v124, v119, 4, v124
    v_add_u32 v124, v123, v124
    v_mfma_f32_16x16x32_bf16 v[196:199], v[48:51], v[36:39], v[196:199]
    v_lshl_add_u32 v123, v3, 3, v123
    s_mov_b32 s76, s42
    s_and_b32 s77, s43, 0xffff
    v_mfma_f32_16x16x32_bf16 v[200:203], v[52:55], v[36:39], v[200:203]
    s_mov_b32 s78, 0x280000
    s_mov_b32 s79, 0x20000
    v_mfma_f32_16x16x32_bf16 v[204:207], v[56:59], v[36:39], v[204:207]
    s_waitcnt lgkmcnt(10)
    v_mfma_f32_16x16x32_bf16 v[168:171], v[76:79], v[68:71], v[168:171]
    s_waitcnt lgkmcnt(8)
    v_mfma_f32_16x16x32_bf16 v[172:175], v[80:83], v[68:71], v[172:175]
    s_waitcnt lgkmcnt(6)
    v_mfma_f32_16x16x32_bf16 v[176:179], v[84:87], v[68:71], v[176:179]
    s_waitcnt vmcnt(0) lgkmcnt(0)
    s_barrier
    ds_read_b64_tr_b16 v[40:41], v109 offset:0
    ds_read_b64_tr_b16 v[42:43], v109 offset:5120
    v_mfma_f32_16x16x32_bf16 v[180:183], v[88:91], v[68:71], v[180:183]
    ds_read_b128 v[24:27], v105 offset:0
    v_mfma_f32_16x16x32_bf16 v[184:187], v[92:95], v[68:71], v[184:187]
    ds_read_b64_tr_b16 v[44:45], v110 offset:32
    ds_read_b64_tr_b16 v[46:47], v110 offset:5152
    v_mfma_f32_16x16x32_bf16 v[188:191], v[76:79], v[72:75], v[188:191]
    ds_read_b64_tr_b16 v[48:49], v109 offset:64
    v_mfma_f32_16x16x32_bf16 v[192:195], v[80:83], v[72:75], v[192:195]
    ds_read_b64_tr_b16 v[50:51], v109 offset:5184
    ds_read_b64_tr_b16 v[52:53], v110 offset:96
    v_mfma_f32_16x16x32_bf16 v[196:199], v[84:87], v[72:75], v[196:199]
    ds_read_b64_tr_b16 v[54:55], v110 offset:5216
    ds_write_b128 v117, v[168:171] offset:0
    v_mfma_f32_16x16x32_bf16 v[200:203], v[88:91], v[72:75], v[200:203]
    ds_read_b64_tr_b16 v[56:57], v109 offset:128
    ds_read_b64_tr_b16 v[58:59], v109 offset:5248
    ds_write_b128 v117, v[172:175] offset:1024
    v_mfma_f32_16x16x32_bf16 v[204:207], v[92:95], v[72:75], v[204:207]
    ds_read_b128 v[28:31], v105 offset:1024
    ds_write_b128 v117, v[176:179] offset:2048
    v_mfma_f32_16x16x32_bf16 v[128:131], v[76:79], v[60:63], v[128:131]
    ds_read_b64_tr_b16 v[228:229], v111 offset:0
    ds_read_b64_tr_b16 v[230:231], v111 offset:5120
    ds_write_b128 v117, v[180:183] offset:3072
    v_mfma_f32_16x16x32_bf16 v[132:135], v[80:83], v[60:63], v[132:135]
    ds_read_b64_tr_b16 v[232:233], v112 offset:32
    ds_write_b128 v117, v[184:187] offset:4096
    v_mfma_f32_16x16x32_bf16 v[136:139], v[84:87], v[60:63], v[136:139]
    ds_read_b64_tr_b16 v[234:235], v112 offset:5152
    ds_read_b64_tr_b16 v[236:237], v111 offset:64
    v_mfma_f32_16x16x32_bf16 v[140:143], v[88:91], v[60:63], v[140:143]
    ds_read_b64_tr_b16 v[238:239], v111 offset:5184
    ds_write_b128 v117, v[188:191] offset:5120
    v_mfma_f32_16x16x32_bf16 v[144:147], v[92:95], v[60:63], v[144:147]
    ds_read_b64_tr_b16 v[240:241], v112 offset:96
    ds_read_b64_tr_b16 v[242:243], v112 offset:5216
    ds_write_b128 v117, v[192:195] offset:6144
    v_mfma_f32_16x16x32_bf16 v[148:151], v[76:79], v[64:67], v[148:151]
    ds_read_b64_tr_b16 v[244:245], v111 offset:128
    ds_write_b128 v117, v[196:199] offset:7168
    v_mfma_f32_16x16x32_bf16 v[152:155], v[80:83], v[64:67], v[152:155]
    ds_read_b64_tr_b16 v[246:247], v111 offset:5248
    ds_read_b128 v[32:35], v105 offset:2048
    ds_write_b128 v117, v[200:203] offset:8192
    v_mfma_f32_16x16x32_bf16 v[156:159], v[84:87], v[64:67], v[156:159]
    ds_read_b128 v[36:39], v105 offset:3072
    ds_write_b128 v117, v[204:207] offset:9216
    v_mfma_f32_16x16x32_bf16 v[160:163], v[88:91], v[64:67], v[160:163]
    v_mfma_f32_16x16x32_bf16 v[164:167], v[92:95], v[64:67], v[164:167]
    s_waitcnt lgkmcnt(15)
    v_mfma_f32_16x16x32_bf16 v[128:131], v[40:43], v[24:27], v[128:131]
    v_mfma_f32_16x16x32_bf16 v[132:135], v[44:47], v[24:27], v[132:135]
    v_mfma_f32_16x16x32_bf16 v[136:139], v[48:51], v[24:27], v[136:139]
    s_waitcnt lgkmcnt(0)
    s_barrier
    ds_read_b128 v[208:211], v118 offset:0
    ds_read_b128 v[212:215], v118 offset:1024
    v_mfma_f32_16x16x32_bf16 v[140:143], v[52:55], v[24:27], v[140:143]
    ds_read_b128 v[216:219], v118 offset:2048
    ds_read_b128 v[220:223], v118 offset:3072
    s_sub_u32 s24, s60, 1
    s_and_b32 s24, s24, 3
    s_mul_i32 s24, s24, 10240
    s_add_u32 s24, s24, s66
    s_add_u32 s24, s24, 0
    s_cmp_eq_u32 s60, 0
    s_cselect_b64 s[80:81], 0, -1
    v_mfma_f32_16x16x32_bf16 v[144:147], v[56:59], v[24:27], v[144:147]
    ds_read_b128 v[224:227], v118 offset:4096
    ds_read_b128 v[168:171], v118 offset:5120
    v_mfma_f32_16x16x32_bf16 v[128:131], v[228:231], v[28:31], v[128:131]
    ds_read_b128 v[172:175], v118 offset:6144
    ds_read_b128 v[176:179], v118 offset:7168
    v_mfma_f32_16x16x32_bf16 v[132:135], v[232:235], v[28:31], v[132:135]
    ds_read_b128 v[180:183], v118 offset:8192
    ds_read_b128 v[184:187], v118 offset:9216
    v_mfma_f32_16x16x32_bf16 v[136:139], v[236:239], v[28:31], v[136:139]
    v_mfma_f32_16x16x32_bf16 v[140:143], v[240:243], v[28:31], v[140:143]
    v_mfma_f32_16x16x32_bf16 v[144:147], v[244:247], v[28:31], v[144:147]
    s_waitcnt lgkmcnt(8)
    v_add_f32 v128, v128, v208
    v_add_f32 v129, v129, v209
    v_add_f32 v130, v130, v210
    v_add_f32 v131, v131, v211
    v_mfma_f32_16x16x32_bf16 v[148:151], v[40:43], v[32:35], v[148:151]
    v_add_f32 v132, v132, v212
    v_add_f32 v133, v133, v213
    v_add_f32 v134, v134, v214
    v_add_f32 v135, v135, v215
    v_mfma_f32_16x16x32_bf16 v[152:155], v[44:47], v[32:35], v[152:155]
    s_waitcnt lgkmcnt(6)
    v_add_f32 v136, v136, v216
    v_add_f32 v137, v137, v217
    v_add_f32 v138, v138, v218
    v_add_f32 v139, v139, v219
    v_cvt_pk_bf16_f32 v60, v128, v129
    v_cvt_pk_bf16_f32 v61, v130, v131
    v_cvt_pk_bf16_f32 v62, v132, v133
    v_cvt_pk_bf16_f32 v63, v134, v135
    s_mov_b64 exec, s[80:81]
    buffer_store_dwordx4 v[60:63], v4, s[8:11], s24 offen offset:0 sc1
    s_mov_b64 exec, -1
    v_mfma_f32_16x16x32_bf16 v[156:159], v[48:51], v[32:35], v[156:159]
    v_add_f32 v140, v140, v220
    v_add_f32 v141, v141, v221
    v_add_f32 v142, v142, v222
    v_add_f32 v143, v143, v223
    s_waitcnt lgkmcnt(3)
    v_add_f32 v148, v148, v168
    v_add_f32 v149, v149, v169
    v_add_f32 v150, v150, v170
    v_add_f32 v151, v151, v171
    v_mfma_f32_16x16x32_bf16 v[160:163], v[52:55], v[32:35], v[160:163]
    v_add_f32 v144, v144, v224
    v_add_f32 v145, v145, v225
    v_add_f32 v146, v146, v226
    v_add_f32 v147, v147, v227
    v_add_f32 v152, v152, v172
    v_add_f32 v153, v153, v173
    v_add_f32 v154, v154, v174
    v_add_f32 v155, v155, v175
    v_cvt_pk_bf16_f32 v64, v136, v137
    v_cvt_pk_bf16_f32 v65, v138, v139
    v_cvt_pk_bf16_f32 v66, v140, v141
    v_cvt_pk_bf16_f32 v67, v142, v143
    s_mov_b64 exec, s[80:81]
    buffer_store_dwordx4 v[64:67], v4, s[8:11], s24 offen offset:1024 sc1
    s_mov_b64 exec, -1
    v_mfma_f32_16x16x32_bf16 v[164:167], v[56:59], v[32:35], v[164:167]
    s_waitcnt lgkmcnt(1)
    v_add_f32 v156, v156, v176
    v_add_f32 v157, v157, v177
    v_add_f32 v158, v158, v178
    v_add_f32 v159, v159, v179
    v_cvt_pk_bf16_f32 v68, v144, v145
    v_cvt_pk_bf16_f32 v69, v146, v147
    s_mov_b64 exec, s[80:81]
    buffer_store_dwordx2 v[68:69], v125, s[8:11], s24 offen offset:2048 sc1
    s_mov_b64 exec, -1
    v_mfma_f32_16x16x32_bf16 v[148:151], v[228:231], v[36:39], v[148:151]
    v_add_f32 v160, v160, v180
    v_add_f32 v161, v161, v181
    v_add_f32 v162, v162, v182
    v_add_f32 v163, v163, v183
    v_mfma_f32_16x16x32_bf16 v[152:155], v[232:235], v[36:39], v[152:155]
    s_waitcnt lgkmcnt(0)
    v_add_f32 v164, v164, v184
    v_add_f32 v165, v165, v185
    v_add_f32 v166, v166, v186
    v_add_f32 v167, v167, v187
    v_mfma_f32_16x16x32_bf16 v[156:159], v[236:239], v[36:39], v[156:159]
    v_mfma_f32_16x16x32_bf16 v[160:163], v[240:243], v[36:39], v[160:163]
    v_mfma_f32_16x16x32_bf16 v[164:167], v[244:247], v[36:39], v[164:167]
    s_nop 7
    s_cmp_eq_u32 s60, 1
    s_cbranch_scc1 P3_S1
    s_sub_u32 s24, s60, 2
    s_and_b32 s24, s24, 3
    s_mul_i32 s24, s24, 10240
    s_add_u32 s24, s24, s66
    s_add_u32 s24, s24, 30720
    v_cvt_pk_bf16_f32 v72, v148, v149
    v_cvt_pk_bf16_f32 v73, v150, v151
    v_cvt_pk_bf16_f32 v74, v152, v153
    v_cvt_pk_bf16_f32 v75, v154, v155
    buffer_store_dwordx4 v[72:75], v4, s[8:11], s24 offen offset:0 sc1
    v_cvt_pk_bf16_f32 v76, v156, v157
    v_cvt_pk_bf16_f32 v77, v158, v159
    v_cvt_pk_bf16_f32 v78, v160, v161
    v_cvt_pk_bf16_f32 v79, v162, v163
    buffer_store_dwordx4 v[76:79], v4, s[8:11], s24 offen offset:1024 sc1
    v_cvt_pk_bf16_f32 v80, v164, v165
    v_cvt_pk_bf16_f32 v81, v166, v167
    buffer_store_dwordx2 v[80:81], v125, s[8:11], s24 offen offset:2048 sc1
P3_S1:
    s_lshr_b32 s24, s60, 1
    s_cmp_lg_u32 s24, 0
    s_cbranch_scc1 K_END
    s_bitcmp0_b32 s60, 0
    s_cbranch_scc1 P3_R0
    v_mov_b64 v[128:129], v[148:149]
    v_mov_b64 v[130:131], v[150:151]
    v_mov_b64 v[132:133], v[152:153]
    v_mov_b64 v[134:135], v[154:155]
    v_mov_b64 v[136:137], v[156:157]
    v_mov_b64 v[138:139], v[158:159]
    v_mov_b64 v[140:141], v[160:161]
    v_mov_b64 v[142:143], v[162:163]
    v_mov_b64 v[144:145], v[164:165]
    v_mov_b64 v[146:147], v[166:167]
P3_R0:
    s_mul_i32 s24, s60, 30720
    s_add_u32 s66, s66, s24
    s_add_u32 s25, s66, 10240
    s_add_u32 s26, s66, 20480
    s_mov_b32 s67, 0
    s_mov_b32 s24, 0
    buffer_load_dwordx4 v[24:27], v4, s[8:11], s66 offen offset:0 sc1
    buffer_load_dwordx4 v[28:31], v4, s[8:11], s66 offen offset:1024 sc1
    buffer_load_dwordx2 v[32:33], v125, s[8:11], s66 offen offset:2048 sc1
    buffer_load_dwordx4 v[36:39], v4, s[8:11], s25 offen offset:0 sc1
    buffer_load_dwordx4 v[40:43], v4, s[8:11], s25 offen offset:1024 sc1
    buffer_load_dwordx2 v[44:45], v125, s[8:11], s25 offen offset:2048 sc1
    buffer_load_dwordx4 v[48:51], v4, s[8:11], s26 offen offset:0 sc1
    buffer_load_dwordx4 v[52:55], v4, s[8:11], s26 offen offset:1024 sc1
    buffer_load_dwordx2 v[56:57], v125, s[8:11], s26 offen offset:2048 sc1
P3_P0:
    s_waitcnt vmcnt(0)
    s_bitcmp1_b32 s24, 0
    s_cbranch_scc1 P3_P0_N0
    v_max3_u32 v119, v24, v25, v26
    v_max3_u32 v119, v119, v27, v28
    v_max3_u32 v119, v119, v29, v30
    v_max3_u32 v119, v119, v31, v32
    v_max_u32 v119, v119, v33
    v_cmp_eq_u32 vcc, -1, v119
    s_cbranch_vccnz P3_P0_R0
    v_lshlrev_b32 v208, 16, v24
    v_and_b32 v209, s68, v24
    v_lshlrev_b32 v210, 16, v25
    v_and_b32 v211, s68, v25
    v_lshlrev_b32 v212, 16, v26
    v_and_b32 v213, s68, v26
    v_lshlrev_b32 v214, 16, v27
    v_and_b32 v215, s68, v27
    v_lshlrev_b32 v216, 16, v28
    v_and_b32 v217, s68, v28
    v_lshlrev_b32 v218, 16, v29
    v_and_b32 v219, s68, v29
    v_lshlrev_b32 v220, 16, v30
    v_and_b32 v221, s68, v30
    v_lshlrev_b32 v222, 16, v31
    v_and_b32 v223, s68, v31
    v_lshlrev_b32 v224, 16, v32
    v_and_b32 v225, s68, v32
    v_lshlrev_b32 v226, 16, v33
    v_and_b32 v227, s68, v33
    v_pk_add_f32 v[128:129], v[128:129], v[208:209]
    v_pk_add_f32 v[130:131], v[130:131], v[210:211]
    v_pk_add_f32 v[132:133], v[132:133], v[212:213]
    v_pk_add_f32 v[134:135], v[134:135], v[214:215]
    v_pk_add_f32 v[136:137], v[136:137], v[216:217]
    v_pk_add_f32 v[138:139], v[138:139], v[218:219]
    v_pk_add_f32 v[140:141], v[140:141], v[220:221]
    v_pk_add_f32 v[142:143], v[142:143], v[222:223]
    v_pk_add_f32 v[144:145], v[144:145], v[224:225]
    v_pk_add_f32 v[146:147], v[146:147], v[226:227]
    s_bitset1_b32 s24, 0
    s_branch P3_P0_N0
P3_P0_R0:
    buffer_load_dwordx4 v[24:27], v4, s[8:11], s66 offen offset:0 sc1
    buffer_load_dwordx4 v[28:31], v4, s[8:11], s66 offen offset:1024 sc1
    buffer_load_dwordx2 v[32:33], v125, s[8:11], s66 offen offset:2048 sc1
P3_P0_N0:
    s_bitcmp1_b32 s24, 1
    s_cbranch_scc1 P3_P0_N1
    v_max3_u32 v119, v36, v37, v38
    v_max3_u32 v119, v119, v39, v40
    v_max3_u32 v119, v119, v41, v42
    v_max3_u32 v119, v119, v43, v44
    v_max_u32 v119, v119, v45
    v_cmp_eq_u32 vcc, -1, v119
    s_cbranch_vccnz P3_P0_R1
    v_lshlrev_b32 v228, 16, v36
    v_and_b32 v229, s68, v36
    v_lshlrev_b32 v230, 16, v37
    v_and_b32 v231, s68, v37
    v_lshlrev_b32 v232, 16, v38
    v_and_b32 v233, s68, v38
    v_lshlrev_b32 v234, 16, v39
    v_and_b32 v235, s68, v39
    v_lshlrev_b32 v236, 16, v40
    v_and_b32 v237, s68, v40
    v_lshlrev_b32 v238, 16, v41
    v_and_b32 v239, s68, v41
    v_lshlrev_b32 v240, 16, v42
    v_and_b32 v241, s68, v42
    v_lshlrev_b32 v242, 16, v43
    v_and_b32 v243, s68, v43
    v_lshlrev_b32 v244, 16, v44
    v_and_b32 v245, s68, v44
    v_lshlrev_b32 v246, 16, v45
    v_and_b32 v247, s68, v45
    v_pk_add_f32 v[128:129], v[128:129], v[228:229]
    v_pk_add_f32 v[130:131], v[130:131], v[230:231]
    v_pk_add_f32 v[132:133], v[132:133], v[232:233]
    v_pk_add_f32 v[134:135], v[134:135], v[234:235]
    v_pk_add_f32 v[136:137], v[136:137], v[236:237]
    v_pk_add_f32 v[138:139], v[138:139], v[238:239]
    v_pk_add_f32 v[140:141], v[140:141], v[240:241]
    v_pk_add_f32 v[142:143], v[142:143], v[242:243]
    v_pk_add_f32 v[144:145], v[144:145], v[244:245]
    v_pk_add_f32 v[146:147], v[146:147], v[246:247]
    s_bitset1_b32 s24, 1
    s_branch P3_P0_N1
P3_P0_R1:
    buffer_load_dwordx4 v[36:39], v4, s[8:11], s25 offen offset:0 sc1
    buffer_load_dwordx4 v[40:43], v4, s[8:11], s25 offen offset:1024 sc1
    buffer_load_dwordx2 v[44:45], v125, s[8:11], s25 offen offset:2048 sc1
P3_P0_N1:
    s_bitcmp1_b32 s24, 2
    s_cbranch_scc1 P3_P0_N2
    v_max3_u32 v119, v48, v49, v50
    v_max3_u32 v119, v119, v51, v52
    v_max3_u32 v119, v119, v53, v54
    v_max3_u32 v119, v119, v55, v56
    v_max_u32 v119, v119, v57
    v_cmp_eq_u32 vcc, -1, v119
    s_cbranch_vccnz P3_P0_R2
    v_lshlrev_b32 v168, 16, v48
    v_and_b32 v169, s68, v48
    v_lshlrev_b32 v170, 16, v49
    v_and_b32 v171, s68, v49
    v_lshlrev_b32 v172, 16, v50
    v_and_b32 v173, s68, v50
    v_lshlrev_b32 v174, 16, v51
    v_and_b32 v175, s68, v51
    v_lshlrev_b32 v176, 16, v52
    v_and_b32 v177, s68, v52
    v_lshlrev_b32 v178, 16, v53
    v_and_b32 v179, s68, v53
    v_lshlrev_b32 v180, 16, v54
    v_and_b32 v181, s68, v54
    v_lshlrev_b32 v182, 16, v55
    v_and_b32 v183, s68, v55
    v_lshlrev_b32 v184, 16, v56
    v_and_b32 v185, s68, v56
    v_lshlrev_b32 v186, 16, v57
    v_and_b32 v187, s68, v57
    v_pk_add_f32 v[128:129], v[128:129], v[168:169]
    v_pk_add_f32 v[130:131], v[130:131], v[170:171]
    v_pk_add_f32 v[132:133], v[132:133], v[172:173]
    v_pk_add_f32 v[134:135], v[134:135], v[174:175]
    v_pk_add_f32 v[136:137], v[136:137], v[176:177]
    v_pk_add_f32 v[138:139], v[138:139], v[178:179]
    v_pk_add_f32 v[140:141], v[140:141], v[180:181]
    v_pk_add_f32 v[142:143], v[142:143], v[182:183]
    v_pk_add_f32 v[144:145], v[144:145], v[184:185]
    v_pk_add_f32 v[146:147], v[146:147], v[186:187]
    s_bitset1_b32 s24, 2
    s_branch P3_P0_N2
P3_P0_R2:
    buffer_load_dwordx4 v[48:51], v4, s[8:11], s26 offen offset:0 sc1
    buffer_load_dwordx4 v[52:55], v4, s[8:11], s26 offen offset:1024 sc1
    buffer_load_dwordx2 v[56:57], v125, s[8:11], s26 offen offset:2048 sc1
P3_P0_N2:
    s_cmp_eq_u32 s24, 7
    s_cbranch_scc1 P3_P0_GO
    s_add_u32 s67, s67, 1
    s_cmp_lt_u32 s67, 0x20000
    s_cbranch_scc1 P3_P0
    s_waitcnt vmcnt(0)
P3_P0_GO:
    v_cvt_pk_bf16_f32 v60, v128, v129
    v_cvt_pk_bf16_f32 v61, v130, v131
    v_cvt_pk_bf16_f32 v62, v132, v133
    v_cvt_pk_bf16_f32 v63, v134, v135
    v_cvt_pk_bf16_f32 v64, v136, v137
    v_cvt_pk_bf16_f32 v65, v138, v139
    v_cvt_pk_bf16_f32 v66, v140, v141
    v_cvt_pk_bf16_f32 v67, v142, v143
    v_cvt_pk_bf16_f32 v68, v144, v145
    v_cvt_pk_bf16_f32 v69, v146, v147
    s_nop 1
    v_permlane16_swap_b32 v60, v62
    v_permlane16_swap_b32 v61, v63
    v_permlane16_swap_b32 v64, v66
    v_permlane16_swap_b32 v65, v67
    s_nop 1
    buffer_store_dwordx4 v[60:63], v124, s[76:79], s65 offen nt
    buffer_store_dwordx4 v[64:67], v124, s[76:79], s65 offen offset:64 nt
    buffer_store_dwordx2 v[68:69], v123, s[76:79], s65 offen offset:128 nt
    s_branch K_END
PRO_M:
    s_nop 4
    v_cndmask_b32 v128, v128, v15, s[68:69]
    v_cndmask_b32 v129, v129, v15, s[70:71]
    v_cndmask_b32 v130, v130, v15, s[72:73]
    v_cndmask_b32 v131, v131, v15, s[74:75]
    v_cndmask_b32 v132, v132, v15, s[60:61]
    v_cndmask_b32 v133, v133, v15, s[62:63]
    v_cndmask_b32 v134, v134, v15, s[64:65]
    v_cndmask_b32 v135, v135, v15, s[66:67]
    v_cndmask_b32 v136, v136, v15, s[76:77]
    v_cndmask_b32 v137, v137, v15, s[78:79]
    v_cndmask_b32 v138, v138, v15, s[80:81]
    v_cndmask_b32 v139, v139, v15, s[82:83]
    v_cndmask_b32 v140, v140, v15, s[68:69]
    v_cndmask_b32 v141, v141, v15, s[70:71]
    v_cndmask_b32 v142, v142, v15, s[72:73]
    v_cndmask_b32 v143, v143, v15, s[74:75]
    v_cndmask_b32 v144, v144, v15, s[84:85]
    v_cndmask_b32 v145, v145, v15, s[86:87]
    v_cndmask_b32 v146, v146, v15, s[88:89]
    v_cndmask_b32 v147, v147, v15, s[90:91]
    v_cndmask_b32 v148, v148, v15, s[76:77]
    v_cndmask_b32 v149, v149, v15, s[78:79]
    v_cndmask_b32 v150, v150, v15, s[80:81]
    v_cndmask_b32 v151, v151, v15, s[82:83]
    v_cndmask_b32 v152, v152, v15, s[92:93]
    v_cndmask_b32 v153, v153, v15, s[94:95]
    v_cndmask_b32 v154, v154, v15, s[96:97]
    v_cndmask_b32 v155, v155, v15, s[98:99]
    v_cndmask_b32 v156, v156, v15, s[84:85]
    v_cndmask_b32 v157, v157, v15, s[86:87]
    v_cndmask_b32 v158, v158, v15, s[88:89]
    v_cndmask_b32 v159, v159, v15, s[90:91]
    s_branch PRO_MB
E1_R:
    s_call_b64 s[54:55], RARE0
    s_branch E1_RB
E1_F:
    s_cmp_eq_u32 s31, 3
    s_cbranch_scc1 E1_F1
    s_lshl_b32 s24, s2, 3
    s_add_u32 s24, s24, s3
    s_and_b32 s25, s31, 1
    s_lshl_b32 s25, s25, 11
    s_add_u32 s24, s24, s25
    s_mul_i32 s24, s24, 1280
    v_lshlrev_b32 v20, 3, v4
    v_subrev_u32 v20, 6400, v20
    s_mov_b32 exec_lo, 0
    s_mov_b32 exec_hi, 0xffc0000
    buffer_load_dword v0, v20, s[20:23], s24 offen
    s_mov_b64 exec, -1
    s_and_b32 s24, s31, 1
    s_mul_i32 s24, s24, 1536
    s_sub_u32 s24, s24, 6400
    v_lshlrev_b32 v20, 3, v4
    v_add_u32 v20, s24, v20
    s_getpc_b64 s[24:25]
    s_add_u32 s24, s24, P3_TBL@rel32@lo+4
    s_addc_u32 s25, s25, P3_TBL@rel32@hi+12
    v_mov_b32 v21, s25
    v_add_co_u32 v20, s[26:27], s24, v20
    s_nop 1
    v_addc_co_u32 v21, s[26:27], 0, v21, s[26:27]
    s_mov_b32 exec_lo, 0
    s_mov_b32 exec_hi, 0x3ffc0000
    global_load_dword v0, v[20:21], off
    s_mov_b64 exec, -1
    s_sub_u32 s31, s31, 1
    s_branch E1_FB
E1_F1:
    s_cmp_lg_u32 s3, 0
    s_cbranch_scc1 E1_F_SG
    v_mov_b32 v16, 3
    v_add_u32 v16, s38, v16
    s_mov_b64 exec, 1
    buffer_store_dword v16, off, s[8:11], s29 sc1
    s_mov_b64 exec, -1
E1_F_SG:
    s_add_u32 s26, s38, 2
    v_subrev_u32 v22, s26, v22
    v_cmp_le_u32 vcc, 6, v22
    s_mov_b32 s26, 0xffff
    s_mov_b32 s27, 0x0
    s_and_b64 vcc, s[26:27], vcc
    s_cbranch_vccz E1_F_C
    s_mov_b32 s30, 0
E1_F_L:
    s_mov_b32 exec_lo, 0xffff
    s_mov_b32 exec_hi, 0x0
    buffer_load_dword v22, v1, s[8:11], 0 offen sc1
    s_mov_b64 exec, -1
    s_add_u32 s30, s30, 1
    s_waitcnt vmcnt(0)
    s_add_u32 s26, s38, 2
    v_subrev_u32 v22, s26, v22
    v_cmp_le_u32 vcc, 6, v22
    s_mov_b32 s26, 0xffff
    s_mov_b32 s27, 0x0
    s_and_b64 vcc, s[26:27], vcc
    s_cbranch_vccz E1_F_C
    s_cmp_ge_u32 s30, 0x40000
    s_cbranch_scc1 E1_F_C
    s_sleep 3
    s_branch E1_F_L
E1_F_C:
    s_and_b32 s24, s3, 3
    s_lshl_b32 s24, s24, 7
    s_add_u32 s24, s24, 0x3800000
    s_sub_u32 s25, 15, s7
    s_lshl_b32 s25, s25, 9
    s_add_u32 s25, s25, s24
    s_lshl_b32 s26, s28, 6
    s_add_u32 s25, s25, s26
    v_lshlrev_b32 v23, 2, v2
    buffer_load_dword v13, v23, s[8:11], s25 offen sc1
    s_lshl_b32 s25, s7, 9
    s_add_u32 s25, s25, s24
    buffer_load_dword v14, v23, s[8:11], s25 offen sc1
    buffer_load_dword v7, v23, s[8:11], s25 offen offset:64 sc1
    s_lshl_b32 s24, s2, 3
    s_add_u32 s24, s24, s3
    s_mul_i32 s24, s24, 1152
    v_lshlrev_b32 v20, 3, v4
    v_subrev_u32 v20, 6400, v20
    s_mov_b32 exec_lo, 0
    s_mov_b32 exec_hi, 0x7fc0000
    buffer_load_dword v0, v20, s[16:19], s24 offen
    s_mov_b64 exec, -1
    s_mov_b32 s31, 2
    s_branch E1_FB
O1_R:
    s_call_b64 s[54:55], RARE1
    s_cmp_eq_u32 s48, s50
    s_branch O1_RB
O1_M:
    s_nop 7
    v_cndmask_b32 v128, v128, v15, s[68:69]
    v_cndmask_b32 v129, v129, v15, s[70:71]
    v_cndmask_b32 v130, v130, v15, s[72:73]
    v_cndmask_b32 v131, v131, v15, s[74:75]
    v_cndmask_b32 v132, v132, v15, s[60:61]
    v_cndmask_b32 v133, v133, v15, s[62:63]
    v_cndmask_b32 v134, v134, v15, s[64:65]
    v_cndmask_b32 v135, v135, v15, s[66:67]
    v_cndmask_b32 v136, v136, v15, s[76:77]
    v_cndmask_b32 v137, v137, v15, s[78:79]
    v_cndmask_b32 v138, v138, v15, s[80:81]
    v_cndmask_b32 v139, v139, v15, s[82:83]
    v_cndmask_b32 v140, v140, v15, s[68:69]
    v_cndmask_b32 v141, v141, v15, s[70:71]
    v_cndmask_b32 v142, v142, v15, s[72:73]
    v_cndmask_b32 v143, v143, v15, s[74:75]
    v_cndmask_b32 v144, v144, v15, s[84:85]
    v_cndmask_b32 v145, v145, v15, s[86:87]
    v_cndmask_b32 v146, v146, v15, s[88:89]
    v_cndmask_b32 v147, v147, v15, s[90:91]
    v_cndmask_b32 v148, v148, v15, s[76:77]
    v_cndmask_b32 v149, v149, v15, s[78:79]
    v_cndmask_b32 v150, v150, v15, s[80:81]
    v_cndmask_b32 v151, v151, v15, s[82:83]
    v_cndmask_b32 v152, v152, v15, s[92:93]
    v_cndmask_b32 v153, v153, v15, s[94:95]
    v_cndmask_b32 v154, v154, v15, s[96:97]
    v_cndmask_b32 v155, v155, v15, s[98:99]
    v_cndmask_b32 v156, v156, v15, s[84:85]
    v_cndmask_b32 v157, v157, v15, s[86:87]
    v_cndmask_b32 v158, v158, v15, s[88:89]
    v_cndmask_b32 v159, v159, v15, s[90:91]
    s_cmp_eq_u32 s28, 1
    s_cbranch_scc1 O1_MB
    s_mov_b32 s56, 1
    s_and_b32 s60, s4, 3
    s_lshr_b32 s61, s4, 2
    s_lshl_b32 s61, s61, 3
    s_add_u32 s61, s61, s7
    s_and_b32 s62, s5, 3
    s_lshr_b32 s71, s3, 1
    s_and_b32 s71, s71, 1
    s_and_b32 s72, s3, 1
    s_getpc_b64 s[24:25]
    s_add_u32 s24, s24, P3_TBL@rel32@lo+4
    s_addc_u32 s25, s25, P3_TBL@rel32@hi+12
    v_mov_b32 v119, s25
    v_add_co_u32 v118, s[26:27], s24, v4
    s_nop 1
    v_addc_co_u32 v119, s[26:27], 0, v119, s[26:27]
    global_load_dwordx4 v[96:99], v[118:119], off
    s_lshl_b32 s24, s72, 10
    v_add_co_u32 v118, s[26:27], s24, v118
    s_nop 1
    v_addc_co_u32 v119, s[26:27], 0, v119, s[26:27]
    global_load_dwordx4 v[100:103], v[118:119], off offset:1024
    s_lshl_b32 s24, s61, 9
    s_lshl_b32 s25, s71, 8
    s_add_u32 s24, s24, s25
    s_add_u32 s24, s24, 0x3802000
    v_lshlrev_b32 v117, 2, v2
    s_mov_b32 exec_lo, 0xffff0000
    s_mov_b32 exec_hi, 0x0
    buffer_load_dword v8, v1, s[8:11], 0 offen sc1
    s_mov_b64 exec, -1
    s_branch O1_MB
O1_F:
    s_add_u32 s26, s38, 3
    v_subrev_u32 v8, s26, v8
    v_cmp_le_u32 vcc, 5, v8
    s_mov_b32 s26, 0xffff0000
    s_mov_b32 s27, 0x0
    s_and_b64 vcc, s[26:27], vcc
    s_cbranch_vccz O1_F_C
    s_mov_b32 s30, 0
O1_F_L:
    s_mov_b32 exec_lo, 0xffff0000
    s_mov_b32 exec_hi, 0x0
    buffer_load_dword v8, v1, s[8:11], 0 offen sc1
    s_mov_b64 exec, -1
    s_add_u32 s30, s30, 1
    s_waitcnt vmcnt(0)
    s_add_u32 s26, s38, 3
    v_subrev_u32 v8, s26, v8
    v_cmp_le_u32 vcc, 5, v8
    s_mov_b32 s26, 0xffff0000
    s_mov_b32 s27, 0x0
    s_and_b64 vcc, s[26:27], vcc
    s_cbranch_vccz O1_F_C
    s_cmp_ge_u32 s30, 0x40000
    s_cbranch_scc1 O1_F_C
    s_sleep 3
    s_branch O1_F_L
O1_F_C:
    buffer_load_dword v113, v117, s[8:11], s24 offen offset:0 sc1
    buffer_load_dword v114, v117, s[8:11], s24 offen offset:64 sc1
    buffer_load_dword v115, v117, s[8:11], s24 offen offset:128 sc1
    buffer_load_dword v116, v117, s[8:11], s24 offen offset:192 sc1
    s_mul_i32 s24, s62, 320
    s_mul_i32 s63, s3, 20480
    s_add_u32 s24, s24, s63
    s_mul_i32 s63, s60, 573440
    s_add_u32 s63, s63, s24
    s_mul_i32 s65, s60, 1310720
    s_add_u32 s65, s65, s24
    s_mul_i32 s64, s3, 5120
    s_and_b32 s73, s47, 0x10000
    s_add_u32 s69, s64, s73
    s_xor_b32 s70, s69, 0x10000
    s_add_u32 m0, s64, 77824
    s_nop 0
    buffer_load_dwordx4 v96, s[16:19], s63 offen offset:0 lds
    buffer_load_dwordx4 v97, s[16:19], s63 offen offset:1024 lds
    buffer_load_dwordx4 v98, s[16:19], s63 offen offset:2048 lds
    buffer_load_dwordx4 v99, s[16:19], s63 offen offset:3072 lds
    s_add_u32 m0, s64, 81920
    s_nop 0
    buffer_load_dwordx4 v100, s[16:19], s63 offen offset:0 lds
    s_add_u32 s63, s63, 81920
    s_branch O1_FB
E1s_R:
    s_call_b64 s[54:55], RARE0
    s_branch E1s_RB
E1s_F:
    s_cmp_eq_u32 s31, 3
    s_cbranch_scc1 E1s_F1
    s_lshl_b32 s24, s2, 3
    s_add_u32 s24, s24, s3
    s_and_b32 s25, s31, 1
    s_lshl_b32 s25, s25, 11
    s_add_u32 s24, s24, s25
    s_mul_i32 s24, s24, 1280
    v_lshlrev_b32 v20, 3, v4
    v_subrev_u32 v20, 6400, v20
    s_mov_b32 exec_lo, 0
    s_mov_b32 exec_hi, 0xffc0000
    buffer_load_dword v0, v20, s[20:23], s24 offen
    s_mov_b64 exec, -1
    s_and_b32 s24, s31, 1
    s_mul_i32 s24, s24, 1536
    s_sub_u32 s24, s24, 6400
    v_lshlrev_b32 v20, 3, v4
    v_add_u32 v20, s24, v20
    s_getpc_b64 s[24:25]
    s_add_u32 s24, s24, P3_TBL@rel32@lo+4
    s_addc_u32 s25, s25, P3_TBL@rel32@hi+12
    v_mov_b32 v21, s25
    v_add_co_u32 v20, s[26:27], s24, v20
    s_nop 1
    v_addc_co_u32 v21, s[26:27], 0, v21, s[26:27]
    s_mov_b32 exec_lo, 0
    s_mov_b32 exec_hi, 0x3ffc0000
    global_load_dword v0, v[20:21], off
    s_mov_b64 exec, -1
    s_sub_u32 s31, s31, 1
    s_branch E1s_FB
E1s_F1:
    s_cmp_lg_u32 s3, 0
    s_cbranch_scc1 E1s_F_SG
    v_mov_b32 v16, 3
    v_add_u32 v16, s38, v16
    s_mov_b64 exec, 1
    buffer_store_dword v16, off, s[8:11], s29 sc1
    s_mov_b64 exec, -1
E1s_F_SG:
    s_add_u32 s26, s38, 2
    v_subrev_u32 v22, s26, v22
    v_cmp_le_u32 vcc, 6, v22
    s_mov_b32 s26, 0xffff
    s_mov_b32 s27, 0x0
    s_and_b64 vcc, s[26:27], vcc
    s_cbranch_vccz E1s_F_C
    s_mov_b32 s30, 0
E1s_F_L:
    s_mov_b32 exec_lo, 0xffff
    s_mov_b32 exec_hi, 0x0
    buffer_load_dword v22, v1, s[8:11], 0 offen sc1
    s_mov_b64 exec, -1
    s_add_u32 s30, s30, 1
    s_waitcnt vmcnt(0)
    s_add_u32 s26, s38, 2
    v_subrev_u32 v22, s26, v22
    v_cmp_le_u32 vcc, 6, v22
    s_mov_b32 s26, 0xffff
    s_mov_b32 s27, 0x0
    s_and_b64 vcc, s[26:27], vcc
    s_cbranch_vccz E1s_F_C
    s_cmp_ge_u32 s30, 0x40000
    s_cbranch_scc1 E1s_F_C
    s_sleep 3
    s_branch E1s_F_L
E1s_F_C:
    s_and_b32 s24, s3, 3
    s_lshl_b32 s24, s24, 7
    s_add_u32 s24, s24, 0x3800000
    s_sub_u32 s25, 15, s7
    s_lshl_b32 s25, s25, 9
    s_add_u32 s25, s25, s24
    s_lshl_b32 s26, s28, 6
    s_add_u32 s25, s25, s26
    v_lshlrev_b32 v23, 2, v2
    buffer_load_dword v13, v23, s[8:11], s25 offen sc1
    s_lshl_b32 s25, s7, 9
    s_add_u32 s25, s25, s24
    buffer_load_dword v14, v23, s[8:11], s25 offen sc1
    buffer_load_dword v7, v23, s[8:11], s25 offen offset:64 sc1
    s_lshl_b32 s24, s2, 3
    s_add_u32 s24, s24, s3
    s_mul_i32 s24, s24, 1152
    v_lshlrev_b32 v20, 3, v4
    v_subrev_u32 v20, 6400, v20
    s_mov_b32 exec_lo, 0
    s_mov_b32 exec_hi, 0x7fc0000
    buffer_load_dword v0, v20, s[16:19], s24 offen
    s_mov_b64 exec, -1
    s_mov_b32 s31, 2
    s_branch E1s_FB
O1s_R:
    s_call_b64 s[54:55], RARE1B
    s_cmp_eq_u32 s7, 7
    s_branch O1s_RB
O1s_M:
    s_nop 7
    v_cndmask_b32 v128, v128, v15, s[68:69]
    v_cndmask_b32 v129, v129, v15, s[70:71]
    v_cndmask_b32 v130, v130, v15, s[72:73]
    v_cndmask_b32 v131, v131, v15, s[74:75]
    v_cndmask_b32 v132, v132, v15, s[60:61]
    v_cndmask_b32 v133, v133, v15, s[62:63]
    v_cndmask_b32 v134, v134, v15, s[64:65]
    v_cndmask_b32 v135, v135, v15, s[66:67]
    v_cndmask_b32 v136, v136, v15, s[76:77]
    v_cndmask_b32 v137, v137, v15, s[78:79]
    v_cndmask_b32 v138, v138, v15, s[80:81]
    v_cndmask_b32 v139, v139, v15, s[82:83]
    v_cndmask_b32 v140, v140, v15, s[68:69]
    v_cndmask_b32 v141, v141, v15, s[70:71]
    v_cndmask_b32 v142, v142, v15, s[72:73]
    v_cndmask_b32 v143, v143, v15, s[74:75]
    v_cndmask_b32 v144, v144, v15, s[84:85]
    v_cndmask_b32 v145, v145, v15, s[86:87]
    v_cndmask_b32 v146, v146, v15, s[88:89]
    v_cndmask_b32 v147, v147, v15, s[90:91]
    v_cndmask_b32 v148, v148, v15, s[76:77]
    v_cndmask_b32 v149, v149, v15, s[78:79]
    v_cndmask_b32 v150, v150, v15, s[80:81]
    v_cndmask_b32 v151, v151, v15, s[82:83]
    v_cndmask_b32 v152, v152, v15, s[92:93]
    v_cndmask_b32 v153, v153, v15, s[94:95]
    v_cndmask_b32 v154, v154, v15, s[96:97]
    v_cndmask_b32 v155, v155, v15, s[98:99]
    v_cndmask_b32 v156, v156, v15, s[84:85]
    v_cndmask_b32 v157, v157, v15, s[86:87]
    v_cndmask_b32 v158, v158, v15, s[88:89]
    v_cndmask_b32 v159, v159, v15, s[90:91]
    s_mov_b32 s56, 1
    s_and_b32 s60, s4, 3
    s_lshr_b32 s61, s4, 2
    s_lshl_b32 s61, s61, 3
    s_add_u32 s61, s61, s7
    s_and_b32 s62, s5, 3
    s_lshr_b32 s71, s3, 1
    s_and_b32 s71, s71, 1
    s_and_b32 s72, s3, 1
    s_getpc_b64 s[24:25]
    s_add_u32 s24, s24, P3_TBL@rel32@lo+4
    s_addc_u32 s25, s25, P3_TBL@rel32@hi+12
    v_mov_b32 v119, s25
    v_add_co_u32 v118, s[26:27], s24, v4
    s_nop 1
    v_addc_co_u32 v119, s[26:27], 0, v119, s[26:27]
    global_load_dwordx4 v[96:99], v[118:119], off
    s_lshl_b32 s24, s72, 10
    v_add_co_u32 v118, s[26:27], s24, v118
    s_nop 1
    v_addc_co_u32 v119, s[26:27], 0, v119, s[26:27]
    global_load_dwordx4 v[100:103], v[118:119], off offset:1024
    s_lshl_b32 s24, s61, 9
    s_lshl_b32 s25, s71, 8
    s_add_u32 s24, s24, s25
    s_add_u32 s24, s24, 0x3802000
    v_lshlrev_b32 v117, 2, v2
    s_mov_b32 exec_lo, 0xffff0000
    s_mov_b32 exec_hi, 0x0
    buffer_load_dword v8, v1, s[8:11], 0 offen sc1
    s_mov_b64 exec, -1
    s_branch O1s_MB
O1s_F:
    s_add_u32 s26, s38, 3
    v_subrev_u32 v8, s26, v8
    v_cmp_le_u32 vcc, 5, v8
    s_mov_b32 s26, 0xffff0000
    s_mov_b32 s27, 0x0
    s_and_b64 vcc, s[26:27], vcc
    s_cbranch_vccz O1s_F_C
    s_mov_b32 s30, 0
O1s_F_L:
    s_mov_b32 exec_lo, 0xffff0000
    s_mov_b32 exec_hi, 0x0
    buffer_load_dword v8, v1, s[8:11], 0 offen sc1
    s_mov_b64 exec, -1
    s_add_u32 s30, s30, 1
    s_waitcnt vmcnt(0)
    s_add_u32 s26, s38, 3
    v_subrev_u32 v8, s26, v8
    v_cmp_le_u32 vcc, 5, v8
    s_mov_b32 s26, 0xffff0000
    s_mov_b32 s27, 0x0
    s_and_b64 vcc, s[26:27], vcc
    s_cbranch_vccz O1s_F_C
    s_cmp_ge_u32 s30, 0x40000
    s_cbranch_scc1 O1s_F_C
    s_sleep 3
    s_branch O1s_F_L
O1s_F_C:
    buffer_load_dword v113, v117, s[8:11], s24 offen offset:0 sc1
    buffer_load_dword v114, v117, s[8:11], s24 offen offset:64 sc1
    buffer_load_dword v115, v117, s[8:11], s24 offen offset:128 sc1
    buffer_load_dword v116, v117, s[8:11], s24 offen offset:192 sc1
    s_mul_i32 s24, s61, 1490944
    s_add_u32 s24, s24, 0x2000000
    s_sub_u32 s64, s3, 4
    s_lshl_b32 s64, s64, 12
    s_add_u32 s24, s24, s64
    s_mul_i32 s63, s60, 114688
    s_add_u32 s63, s63, s24
    s_lshl_b32 s65, s60, 18
    s_add_u32 s65, s65, s24
    s_add_u32 s65, s65, 442368
    s_and_b32 s73, s47, 0x10000
    s_add_u32 s69, s64, s73
    s_xor_b32 s70, s69, 0x10000
    s_add_u32 m0, s64, 0
    s_nop 0
    buffer_load_dwordx4 v4, s[8:11], s63 offen offset:0 sc1 lds
    buffer_load_dwordx4 v4, s[8:11], s63 offen offset:1024 sc1 lds
    buffer_load_dwordx4 v4, s[8:11], s63 offen offset:2048 sc1 lds
    buffer_load_dwordx4 v4, s[8:11], s63 offen offset:3072 sc1 lds
    s_add_u32 s63, s63, 16384
    s_branch O1s_FB
I0_R:
    s_call_b64 s[54:55], RARE0
    s_branch I0_RB
I0_F:
    s_lshl_b32 s24, s2, 3
    s_add_u32 s24, s24, s3
    s_and_b32 s25, s31, 1
    s_lshl_b32 s25, s25, 11
    s_add_u32 s24, s24, s25
    s_mul_i32 s24, s24, 1280
    v_lshlrev_b32 v20, 3, v4
    v_subrev_u32 v20, 6400, v20
    s_mov_b32 exec_lo, 0
    s_mov_b32 exec_hi, 0xffc0000
    buffer_load_dword v0, v20, s[20:23], s24 offen
    s_mov_b64 exec, -1
    s_and_b32 s24, s31, 1
    s_mul_i32 s24, s24, 1536
    s_sub_u32 s24, s24, 6400
    v_lshlrev_b32 v20, 3, v4
    v_add_u32 v20, s24, v20
    s_getpc_b64 s[24:25]
    s_add_u32 s24, s24, P3_TBL@rel32@lo+4
    s_addc_u32 s25, s25, P3_TBL@rel32@hi+12
    v_mov_b32 v21, s25
    v_add_co_u32 v20, s[26:27], s24, v20
    s_nop 1
    v_addc_co_u32 v21, s[26:27], 0, v21, s[26:27]
    s_mov_b32 exec_lo, 0
    s_mov_b32 exec_hi, 0x3ffc0000
    global_load_dword v0, v[20:21], off
    s_mov_b64 exec, -1
    s_sub_u32 s31, s31, 1
    s_branch I0_FB
I1_R:
    s_call_b64 s[54:55], RARE1
    s_cmp_eq_u32 s49, 1
    s_branch I1_RB
I1_M:
    s_nop 7
    v_cndmask_b32 v128, v128, v15, s[68:69]
    v_cndmask_b32 v129, v129, v15, s[70:71]
    v_cndmask_b32 v130, v130, v15, s[72:73]
    v_cndmask_b32 v131, v131, v15, s[74:75]
    v_cndmask_b32 v132, v132, v15, s[60:61]
    v_cndmask_b32 v133, v133, v15, s[62:63]
    v_cndmask_b32 v134, v134, v15, s[64:65]
    v_cndmask_b32 v135, v135, v15, s[66:67]
    v_cndmask_b32 v136, v136, v15, s[76:77]
    v_cndmask_b32 v137, v137, v15, s[78:79]
    v_cndmask_b32 v138, v138, v15, s[80:81]
    v_cndmask_b32 v139, v139, v15, s[82:83]
    v_cndmask_b32 v140, v140, v15, s[68:69]
    v_cndmask_b32 v141, v141, v15, s[70:71]
    v_cndmask_b32 v142, v142, v15, s[72:73]
    v_cndmask_b32 v143, v143, v15, s[74:75]
    v_cndmask_b32 v144, v144, v15, s[84:85]
    v_cndmask_b32 v145, v145, v15, s[86:87]
    v_cndmask_b32 v146, v146, v15, s[88:89]
    v_cndmask_b32 v147, v147, v15, s[90:91]
    v_cndmask_b32 v148, v148, v15, s[76:77]
    v_cndmask_b32 v149, v149, v15, s[78:79]
    v_cndmask_b32 v150, v150, v15, s[80:81]
    v_cndmask_b32 v151, v151, v15, s[82:83]
    v_cndmask_b32 v152, v152, v15, s[92:93]
    v_cndmask_b32 v153, v153, v15, s[94:95]
    v_cndmask_b32 v154, v154, v15, s[96:97]
    v_cndmask_b32 v155, v155, v15, s[98:99]
    v_cndmask_b32 v156, v156, v15, s[84:85]
    v_cndmask_b32 v157, v157, v15, s[86:87]
    v_cndmask_b32 v158, v158, v15, s[88:89]
    v_cndmask_b32 v159, v159, v15, s[90:91]
    s_mov_b32 s56, 1
    s_and_b32 s60, s4, 3
    s_lshr_b32 s61, s4, 2
    s_lshl_b32 s61, s61, 3
    s_add_u32 s61, s61, s7
    s_and_b32 s62, s5, 3
    s_lshr_b32 s71, s3, 1
    s_and_b32 s71, s71, 1
    s_and_b32 s72, s3, 1
    s_getpc_b64 s[24:25]
    s_add_u32 s24, s24, P3_TBL@rel32@lo+4
    s_addc_u32 s25, s25, P3_TBL@rel32@hi+12
    v_mov_b32 v119, s25
    v_add_co_u32 v118, s[26:27], s24, v4
    s_nop 1
    v_addc_co_u32 v119, s[26:27], 0, v119, s[26:27]
    global_load_dwordx4 v[96:99], v[118:119], off
    s_lshl_b32 s24, s72, 10
    v_add_co_u32 v118, s[26:27], s24, v118
    s_nop 1
    v_addc_co_u32 v119, s[26:27], 0, v119, s[26:27]
    global_load_dwordx4 v[100:103], v[118:119], off offset:1024
    s_lshl_b32 s24, s61, 9
    s_lshl_b32 s25, s71, 8
    s_add_u32 s24, s24, s25
    s_add_u32 s24, s24, 0x3802000
    v_lshlrev_b32 v117, 2, v2
    s_mov_b32 exec_lo, 0xffff0000
    s_mov_b32 exec_hi, 0x0
    buffer_load_dword v8, v1, s[8:11], 0 offen sc1
    s_mov_b64 exec, -1
    s_branch I1_MB
I1_F:
    s_add_u32 s26, s38, 3
    v_subrev_u32 v8, s26, v8
    v_cmp_le_u32 vcc, 5, v8
    s_mov_b32 s26, 0xffff0000
    s_mov_b32 s27, 0x0
    s_and_b64 vcc, s[26:27], vcc
    s_cbranch_vccz I1_F_C
    s_mov_b32 s30, 0
I1_F_L:
    s_mov_b32 exec_lo, 0xffff0000
    s_mov_b32 exec_hi, 0x0
    buffer_load_dword v8, v1, s[8:11], 0 offen sc1
    s_mov_b64 exec, -1
    s_add_u32 s30, s30, 1
    s_waitcnt vmcnt(0)
    s_add_u32 s26, s38, 3
    v_subrev_u32 v8, s26, v8
    v_cmp_le_u32 vcc, 5, v8
    s_mov_b32 s26, 0xffff0000
    s_mov_b32 s27, 0x0
    s_and_b64 vcc, s[26:27], vcc
    s_cbranch_vccz I1_F_C
    s_cmp_ge_u32 s30, 0x40000
    s_cbranch_scc1 I1_F_C
    s_sleep 3
    s_branch I1_F_L
I1_F_C:
    s_cmp_eq_u32 s28, 0
    s_cbranch_scc1 I1_F_0
    buffer_load_dword v113, v117, s[8:11], s24 offen offset:0 sc1
    buffer_load_dword v114, v117, s[8:11], s24 offen offset:64 sc1
    buffer_load_dword v115, v117, s[8:11], s24 offen offset:128 sc1
    buffer_load_dword v116, v117, s[8:11], s24 offen offset:192 sc1
    s_mul_i32 s24, s61, 1490944
    s_add_u32 s24, s24, 0x2000000
    s_sub_u32 s64, s3, 4
    s_lshl_b32 s64, s64, 12
    s_add_u32 s24, s24, s64
    s_mul_i32 s63, s60, 114688
    s_add_u32 s63, s63, s24
    s_lshl_b32 s65, s60, 18
    s_add_u32 s65, s65, s24
    s_add_u32 s65, s65, 442368
    s_and_b32 s73, s47, 0x10000
    s_add_u32 s69, s64, s73
    s_xor_b32 s70, s69, 0x10000
    s_add_u32 m0, s64, 0
    s_nop 0
    buffer_load_dwordx4 v4, s[8:11], s63 offen offset:0 sc1 lds
    buffer_load_dwordx4 v4, s[8:11], s63 offen offset:1024 sc1 lds
    buffer_load_dwordx4 v4, s[8:11], s63 offen offset:2048 sc1 lds
    buffer_load_dwordx4 v4, s[8:11], s63 offen offset:3072 sc1 lds
    s_add_u32 s63, s63, 16384
    s_branch I1_FB
I1_F_0:
    buffer_load_dword v113, v117, s[8:11], s24 offen offset:0 sc1
    buffer_load_dword v114, v117, s[8:11], s24 offen offset:64 sc1
    buffer_load_dword v115, v117, s[8:11], s24 offen offset:128 sc1
    buffer_load_dword v116, v117, s[8:11], s24 offen offset:192 sc1
    s_mul_i32 s24, s62, 320
    s_mul_i32 s63, s3, 20480
    s_add_u32 s24, s24, s63
    s_mul_i32 s63, s60, 573440
    s_add_u32 s63, s63, s24
    s_mul_i32 s65, s60, 1310720
    s_add_u32 s65, s65, s24
    s_mul_i32 s64, s3, 5120
    s_and_b32 s73, s47, 0x10000
    s_add_u32 s69, s64, s73
    s_xor_b32 s70, s69, 0x10000
    s_add_u32 m0, s64, 77824
    s_nop 0
    buffer_load_dwordx4 v96, s[16:19], s63 offen offset:0 lds
    buffer_load_dwordx4 v97, s[16:19], s63 offen offset:1024 lds
    buffer_load_dwordx4 v98, s[16:19], s63 offen offset:2048 lds
    buffer_load_dwordx4 v99, s[16:19], s63 offen offset:3072 lds
    s_add_u32 m0, s64, 81920
    s_nop 0
    buffer_load_dwordx4 v100, s[16:19], s63 offen offset:0 lds
    s_add_u32 s63, s63, 81920
    s_branch I1_FB
RARE0:
    s_nop 7
    v_max3_f32 v16, v128, v129, v130
    v_max3_f32 v16, v16, v131, v136
    v_max3_f32 v16, v16, v137, v138
    v_max3_f32 v16, v16, v139, v144
    v_max3_f32 v16, v16, v145, v146
    v_max3_f32 v16, v16, v147, v152
    v_max3_f32 v16, v16, v153, v154
    v_max_f32 v16, v16, v155
    v_mov_b32 v18, v16
    s_nop 1
    v_permlane32_swap_b32 v18, v16
    s_nop 1
    v_max_f32 v16, v16, v18
    v_mov_b32 v18, v16
    s_nop 1
    v_permlane16_swap_b32 v18, v16
    s_nop 1
    v_max_f32 v16, v16, v18
    v_max_f32 v16, 0, v16
    v_max3_f32 v17, v132, v133, v134
    v_max3_f32 v17, v17, v135, v140
    v_max3_f32 v17, v17, v141, v142
    v_max3_f32 v17, v17, v143, v148
    v_max3_f32 v17, v17, v149, v150
    v_max3_f32 v17, v17, v151, v156
    v_max3_f32 v17, v17, v157, v158
    v_max_f32 v17, v17, v159
    v_mov_b32 v18, v17
    s_nop 1
    v_permlane32_swap_b32 v18, v17
    s_nop 1
    v_max_f32 v17, v17, v18
    v_mov_b32 v18, v17
    s_nop 1
    v_permlane16_swap_b32 v18, v17
    s_nop 1
    v_max_f32 v17, v17, v18
    v_max_f32 v17, 0, v17
    v_exp_f32 v20, -v16
    v_sub_f32 v128, v128, v16
    v_sub_f32 v129, v129, v16
    v_sub_f32 v130, v130, v16
    v_sub_f32 v131, v131, v16
    v_sub_f32 v136, v136, v16
    v_sub_f32 v137, v137, v16
    v_sub_f32 v138, v138, v16
    v_sub_f32 v139, v139, v16
    v_sub_f32 v144, v144, v16
    v_sub_f32 v145, v145, v16
    v_sub_f32 v146, v146, v16
    v_sub_f32 v147, v147, v16
    v_sub_f32 v152, v152, v16
    v_sub_f32 v153, v153, v16
    v_sub_f32 v154, v154, v16
    v_sub_f32 v155, v155, v16
    v_sub_f32 v96, v96, v16
    v_sub_f32 v97, v97, v16
    v_sub_f32 v98, v98, v16
    v_sub_f32 v99, v99, v16
    v_sub_f32 v104, v104, v16
    v_sub_f32 v105, v105, v16
    v_sub_f32 v106, v106, v16
    v_sub_f32 v107, v107, v16
    v_sub_f32 v112, v112, v16
    v_sub_f32 v113, v113, v16
    v_sub_f32 v114, v114, v16
    v_sub_f32 v115, v115, v16
    v_sub_f32 v120, v120, v16
    v_sub_f32 v121, v121, v16
    v_sub_f32 v122, v122, v16
    v_sub_f32 v123, v123, v16
    v_sub_f32 v32, v32, v16
    v_sub_f32 v33, v33, v16
    v_sub_f32 v34, v34, v16
    v_sub_f32 v35, v35, v16
    v_mul_f32 v192, v192, v20
    v_mul_f32 v193, v193, v20
    v_mul_f32 v194, v194, v20
    v_mul_f32 v195, v195, v20
    v_mul_f32 v200, v200, v20
    v_mul_f32 v201, v201, v20
    v_mul_f32 v202, v202, v20
    v_mul_f32 v203, v203, v20
    v_mul_f32 v208, v208, v20
    v_mul_f32 v209, v209, v20
    v_mul_f32 v210, v210, v20
    v_mul_f32 v211, v211, v20
    v_mul_f32 v216, v216, v20
    v_mul_f32 v217, v217, v20
    v_mul_f32 v218, v218, v20
    v_mul_f32 v219, v219, v20
    v_mul_f32 v224, v224, v20
    v_mul_f32 v225, v225, v20
    v_mul_f32 v226, v226, v20
    v_mul_f32 v227, v227, v20
    v_mul_f32 v232, v232, v20
    v_mul_f32 v233, v233, v20
    v_mul_f32 v234, v234, v20
    v_mul_f32 v235, v235, v20
    v_mul_f32 v240, v240, v20
    v_mul_f32 v241, v241, v20
    v_mul_f32 v242, v242, v20
    v_mul_f32 v243, v243, v20
    v_mul_f32 v248, v248, v20
    v_mul_f32 v249, v249, v20
    v_mul_f32 v250, v250, v20
    v_mul_f32 v251, v251, v20
    v_mul_f32 v11, v11, v20
    v_exp_f32 v21, -v17
    v_sub_f32 v132, v132, v17
    v_sub_f32 v133, v133, v17
    v_sub_f32 v134, v134, v17
    v_sub_f32 v135, v135, v17
    v_sub_f32 v140, v140, v17
    v_sub_f32 v141, v141, v17
    v_sub_f32 v142, v142, v17
    v_sub_f32 v143, v143, v17
    v_sub_f32 v148, v148, v17
    v_sub_f32 v149, v149, v17
    v_sub_f32 v150, v150, v17
    v_sub_f32 v151, v151, v17
    v_sub_f32 v156, v156, v17
    v_sub_f32 v157, v157, v17
    v_sub_f32 v158, v158, v17
    v_sub_f32 v159, v159, v17
    v_sub_f32 v100, v100, v17
    v_sub_f32 v101, v101, v17
    v_sub_f32 v102, v102, v17
    v_sub_f32 v103, v103, v17
    v_sub_f32 v108, v108, v17
    v_sub_f32 v109, v109, v17
    v_sub_f32 v110, v110, v17
    v_sub_f32 v111, v111, v17
    v_sub_f32 v116, v116, v17
    v_sub_f32 v117, v117, v17
    v_sub_f32 v118, v118, v17
    v_sub_f32 v119, v119, v17
    v_sub_f32 v124, v124, v17
    v_sub_f32 v125, v125, v17
    v_sub_f32 v126, v126, v17
    v_sub_f32 v127, v127, v17
    v_sub_f32 v36, v36, v17
    v_sub_f32 v37, v37, v17
    v_sub_f32 v38, v38, v17
    v_sub_f32 v39, v39, v17
    v_mul_f32 v196, v196, v21
    v_mul_f32 v197, v197, v21
    v_mul_f32 v198, v198, v21
    v_mul_f32 v199, v199, v21
    v_mul_f32 v204, v204, v21
    v_mul_f32 v205, v205, v21
    v_mul_f32 v206, v206, v21
    v_mul_f32 v207, v207, v21
    v_mul_f32 v212, v212, v21
    v_mul_f32 v213, v213, v21
    v_mul_f32 v214, v214, v21
    v_mul_f32 v215, v215, v21
    v_mul_f32 v220, v220, v21
    v_mul_f32 v221, v221, v21
    v_mul_f32 v222, v222, v21
    v_mul_f32 v223, v223, v21
    v_mul_f32 v228, v228, v21
    v_mul_f32 v229, v229, v21
    v_mul_f32 v230, v230, v21
    v_mul_f32 v231, v231, v21
    v_mul_f32 v236, v236, v21
    v_mul_f32 v237, v237, v21
    v_mul_f32 v238, v238, v21
    v_mul_f32 v239, v239, v21
    v_mul_f32 v244, v244, v21
    v_mul_f32 v245, v245, v21
    v_mul_f32 v246, v246, v21
    v_mul_f32 v247, v247, v21
    v_mul_f32 v252, v252, v21
    v_mul_f32 v253, v253, v21
    v_mul_f32 v254, v254, v21
    v_mul_f32 v255, v255, v21
    v_mul_f32 v12, v12, v21
    v_exp_f32 v24, v128
    v_exp_f32 v25, v129
    v_exp_f32 v26, v132
    v_exp_f32 v27, v133
    v_add_f32 v9, v24, v25
    v_cvt_pk_bf16_f32 v56, v24, v25
    v_exp_f32 v28, v130
    v_exp_f32 v29, v131
    v_add_f32 v10, v26, v27
    v_cvt_pk_bf16_f32 v60, v26, v27
    v_exp_f32 v30, v134
    v_exp_f32 v31, v135
    v_add_f32 v9, v9, v28
    v_add_f32 v9, v9, v29
    v_cvt_pk_bf16_f32 v57, v28, v29
    v_exp_f32 v24, v136
    v_exp_f32 v25, v137
    v_add_f32 v10, v10, v30
    v_add_f32 v10, v10, v31
    v_cvt_pk_bf16_f32 v61, v30, v31
    v_exp_f32 v26, v140
    v_exp_f32 v27, v141
    v_add_f32 v9, v9, v24
    v_add_f32 v9, v9, v25
    v_cvt_pk_bf16_f32 v58, v24, v25
    v_exp_f32 v28, v138
    v_exp_f32 v29, v139
    v_add_f32 v10, v10, v26
    v_add_f32 v10, v10, v27
    v_cvt_pk_bf16_f32 v62, v26, v27
    v_exp_f32 v30, v142
    v_exp_f32 v31, v143
    v_add_f32 v9, v9, v28
    v_add_f32 v9, v9, v29
    v_cvt_pk_bf16_f32 v59, v28, v29
    s_nop 0
    v_add_f32 v10, v10, v30
    v_add_f32 v10, v10, v31
    v_cvt_pk_bf16_f32 v63, v30, v31
    v_exp_f32 v24, v144
    v_exp_f32 v25, v145
    v_exp_f32 v26, v148
    v_exp_f32 v27, v149
    v_add_f32 v9, v9, v24
    v_add_f32 v9, v9, v25
    v_cvt_pk_bf16_f32 v40, v24, v25
    v_exp_f32 v28, v146
    v_exp_f32 v29, v147
    v_add_f32 v10, v10, v26
    v_add_f32 v10, v10, v27
    v_cvt_pk_bf16_f32 v44, v26, v27
    v_exp_f32 v30, v150
    v_exp_f32 v31, v151
    v_add_f32 v9, v9, v28
    v_add_f32 v9, v9, v29
    v_cvt_pk_bf16_f32 v41, v28, v29
    v_exp_f32 v24, v152
    v_exp_f32 v25, v153
    v_add_f32 v10, v10, v30
    v_add_f32 v10, v10, v31
    v_cvt_pk_bf16_f32 v45, v30, v31
    v_exp_f32 v26, v156
    v_exp_f32 v27, v157
    v_add_f32 v9, v9, v24
    v_add_f32 v9, v9, v25
    v_cvt_pk_bf16_f32 v42, v24, v25
    v_exp_f32 v28, v154
    v_exp_f32 v29, v155
    v_add_f32 v10, v10, v26
    v_add_f32 v10, v10, v27
    v_cvt_pk_bf16_f32 v46, v26, v27
    v_exp_f32 v30, v158
    v_exp_f32 v31, v159
    v_add_f32 v9, v9, v28
    v_add_f32 v9, v9, v29
    v_cvt_pk_bf16_f32 v43, v28, v29
    s_nop 0
    v_add_f32 v10, v10, v30
    v_add_f32 v10, v10, v31
    v_cvt_pk_bf16_f32 v47, v30, v31
    s_nop 1
    s_setpc_b64 s[54:55]
RARE1:
    s_nop 7
    v_max3_f32 v16, v96, v97, v98
    v_max3_f32 v16, v16, v99, v104
    v_max3_f32 v16, v16, v105, v106
    v_max3_f32 v16, v16, v107, v112
    v_max3_f32 v16, v16, v113, v114
    v_max3_f32 v16, v16, v115, v120
    v_max3_f32 v16, v16, v121, v122
    v_max_f32 v16, v16, v123
    v_mov_b32 v18, v16
    s_nop 1
    v_permlane32_swap_b32 v18, v16
    s_nop 1
    v_max_f32 v16, v16, v18
    v_mov_b32 v18, v16
    s_nop 1
    v_permlane16_swap_b32 v18, v16
    s_nop 1
    v_max_f32 v16, v16, v18
    v_max_f32 v16, 0, v16
    v_max3_f32 v17, v100, v101, v102
    v_max3_f32 v17, v17, v103, v108
    v_max3_f32 v17, v17, v109, v110
    v_max3_f32 v17, v17, v111, v116
    v_max3_f32 v17, v17, v117, v118
    v_max3_f32 v17, v17, v119, v124
    v_max3_f32 v17, v17, v125, v126
    v_max_f32 v17, v17, v127
    v_mov_b32 v18, v17
    s_nop 1
    v_permlane32_swap_b32 v18, v17
    s_nop 1
    v_max_f32 v17, v17, v18
    v_mov_b32 v18, v17
    s_nop 1
    v_permlane16_swap_b32 v18, v17
    s_nop 1
    v_max_f32 v17, v17, v18
    v_max_f32 v17, 0, v17
    v_exp_f32 v20, -v16
    v_sub_f32 v96, v96, v16
    v_sub_f32 v97, v97, v16
    v_sub_f32 v98, v98, v16
    v_sub_f32 v99, v99, v16
    v_sub_f32 v104, v104, v16
    v_sub_f32 v105, v105, v16
    v_sub_f32 v106, v106, v16
    v_sub_f32 v107, v107, v16
    v_sub_f32 v112, v112, v16
    v_sub_f32 v113, v113, v16
    v_sub_f32 v114, v114, v16
    v_sub_f32 v115, v115, v16
    v_sub_f32 v120, v120, v16
    v_sub_f32 v121, v121, v16
    v_sub_f32 v122, v122, v16
    v_sub_f32 v123, v123, v16
    v_sub_f32 v128, v128, v16
    v_sub_f32 v129, v129, v16
    v_sub_f32 v130, v130, v16
    v_sub_f32 v131, v131, v16
    v_sub_f32 v136, v136, v16
    v_sub_f32 v137, v137, v16
    v_sub_f32 v138, v138, v16
    v_sub_f32 v139, v139, v16
    v_sub_f32 v144, v144, v16
    v_sub_f32 v145, v145, v16
    v_sub_f32 v146, v146, v16
    v_sub_f32 v147, v147, v16
    v_sub_f32 v152, v152, v16
    v_sub_f32 v153, v153, v16
    v_sub_f32 v154, v154, v16
    v_sub_f32 v155, v155, v16
    v_sub_f32 v32, v32, v16
    v_sub_f32 v33, v33, v16
    v_sub_f32 v34, v34, v16
    v_sub_f32 v35, v35, v16
    v_mul_f32 v192, v192, v20
    v_mul_f32 v193, v193, v20
    v_mul_f32 v194, v194, v20
    v_mul_f32 v195, v195, v20
    v_mul_f32 v200, v200, v20
    v_mul_f32 v201, v201, v20
    v_mul_f32 v202, v202, v20
    v_mul_f32 v203, v203, v20
    v_mul_f32 v208, v208, v20
    v_mul_f32 v209, v209, v20
    v_mul_f32 v210, v210, v20
    v_mul_f32 v211, v211, v20
    v_mul_f32 v216, v216, v20
    v_mul_f32 v217, v217, v20
    v_mul_f32 v218, v218, v20
    v_mul_f32 v219, v219, v20
    v_mul_f32 v224, v224, v20
    v_mul_f32 v225, v225, v20
    v_mul_f32 v226, v226, v20
    v_mul_f32 v227, v227, v20
    v_mul_f32 v232, v232, v20
    v_mul_f32 v233, v233, v20
    v_mul_f32 v234, v234, v20
    v_mul_f32 v235, v235, v20
    v_mul_f32 v240, v240, v20
    v_mul_f32 v241, v241, v20
    v_mul_f32 v242, v242, v20
    v_mul_f32 v243, v243, v20
    v_mul_f32 v248, v248, v20
    v_mul_f32 v249, v249, v20
    v_mul_f32 v250, v250, v20
    v_mul_f32 v251, v251, v20
    v_mul_f32 v11, v11, v20
    v_exp_f32 v21, -v17
    v_sub_f32 v100, v100, v17
    v_sub_f32 v101, v101, v17
    v_sub_f32 v102, v102, v17
    v_sub_f32 v103, v103, v17
    v_sub_f32 v108, v108, v17
    v_sub_f32 v109, v109, v17
    v_sub_f32 v110, v110, v17
    v_sub_f32 v111, v111, v17
    v_sub_f32 v116, v116, v17
    v_sub_f32 v117, v117, v17
    v_sub_f32 v118, v118, v17
    v_sub_f32 v119, v119, v17
    v_sub_f32 v124, v124, v17
    v_sub_f32 v125, v125, v17
    v_sub_f32 v126, v126, v17
    v_sub_f32 v127, v127, v17
    v_sub_f32 v132, v132, v17
    v_sub_f32 v133, v133, v17
    v_sub_f32 v134, v134, v17
    v_sub_f32 v135, v135, v17
    v_sub_f32 v140, v140, v17
    v_sub_f32 v141, v141, v17
    v_sub_f32 v142, v142, v17
    v_sub_f32 v143, v143, v17
    v_sub_f32 v148, v148, v17
    v_sub_f32 v149, v149, v17
    v_sub_f32 v150, v150, v17
    v_sub_f32 v151, v151, v17
    v_sub_f32 v156, v156, v17
    v_sub_f32 v157, v157, v17
    v_sub_f32 v158, v158, v17
    v_sub_f32 v159, v159, v17
    v_sub_f32 v36, v36, v17
    v_sub_f32 v37, v37, v17
    v_sub_f32 v38, v38, v17
    v_sub_f32 v39, v39, v17
    v_mul_f32 v196, v196, v21
    v_mul_f32 v197, v197, v21
    v_mul_f32 v198, v198, v21
    v_mul_f32 v199, v199, v21
    v_mul_f32 v204, v204, v21
    v_mul_f32 v205, v205, v21
    v_mul_f32 v206, v206, v21
    v_mul_f32 v207, v207, v21
    v_mul_f32 v212, v212, v21
    v_mul_f32 v213, v213, v21
    v_mul_f32 v214, v214, v21
    v_mul_f32 v215, v215, v21
    v_mul_f32 v220, v220, v21
    v_mul_f32 v221, v221, v21
    v_mul_f32 v222, v222, v21
    v_mul_f32 v223, v223, v21
    v_mul_f32 v228, v228, v21
    v_mul_f32 v229, v229, v21
    v_mul_f32 v230, v230, v21
    v_mul_f32 v231, v231, v21
    v_mul_f32 v236, v236, v21
    v_mul_f32 v237, v237, v21
    v_mul_f32 v238, v238, v21
    v_mul_f32 v239, v239, v21
    v_mul_f32 v244, v244, v21
    v_mul_f32 v245, v245, v21
    v_mul_f32 v246, v246, v21
    v_mul_f32 v247, v247, v21
    v_mul_f32 v252, v252, v21
    v_mul_f32 v253, v253, v21
    v_mul_f32 v254, v254, v21
    v_mul_f32 v255, v255, v21
    v_mul_f32 v12, v12, v21
    v_exp_f32 v24, v96
    v_exp_f32 v25, v97
    v_exp_f32 v26, v100
    v_exp_f32 v27, v101
    v_add_f32 v9, v24, v25
    v_cvt_pk_bf16_f32 v48, v24, v25
    v_exp_f32 v28, v98
    v_exp_f32 v29, v99
    v_add_f32 v10, v26, v27
    v_cvt_pk_bf16_f32 v52, v26, v27
    v_exp_f32 v30, v102
    v_exp_f32 v31, v103
    v_add_f32 v9, v9, v28
    v_add_f32 v9, v9, v29
    v_cvt_pk_bf16_f32 v49, v28, v29
    v_exp_f32 v24, v104
    v_exp_f32 v25, v105
    v_add_f32 v10, v10, v30
    v_add_f32 v10, v10, v31
    v_cvt_pk_bf16_f32 v53, v30, v31
    v_exp_f32 v26, v108
    v_exp_f32 v27, v109
    v_add_f32 v9, v9, v24
    v_add_f32 v9, v9, v25
    v_cvt_pk_bf16_f32 v50, v24, v25
    v_exp_f32 v28, v106
    v_exp_f32 v29, v107
    v_add_f32 v10, v10, v26
    v_add_f32 v10, v10, v27
    v_cvt_pk_bf16_f32 v54, v26, v27
    v_exp_f32 v30, v110
    v_exp_f32 v31, v111
    v_add_f32 v9, v9, v28
    v_add_f32 v9, v9, v29
    v_cvt_pk_bf16_f32 v51, v28, v29
    s_nop 0
    v_add_f32 v10, v10, v30
    v_add_f32 v10, v10, v31
    v_cvt_pk_bf16_f32 v55, v30, v31
    v_exp_f32 v24, v112
    v_exp_f32 v25, v113
    v_exp_f32 v26, v116
    v_exp_f32 v27, v117
    v_add_f32 v9, v9, v24
    v_add_f32 v9, v9, v25
    v_cvt_pk_bf16_f32 v40, v24, v25
    v_exp_f32 v28, v114
    v_exp_f32 v29, v115
    v_add_f32 v10, v10, v26
    v_add_f32 v10, v10, v27
    v_cvt_pk_bf16_f32 v44, v26, v27
    v_exp_f32 v30, v118
    v_exp_f32 v31, v119
    v_add_f32 v9, v9, v28
    v_add_f32 v9, v9, v29
    v_cvt_pk_bf16_f32 v41, v28, v29
    v_exp_f32 v24, v120
    v_exp_f32 v25, v121
    v_add_f32 v10, v10, v30
    v_add_f32 v10, v10, v31
    v_cvt_pk_bf16_f32 v45, v30, v31
    v_exp_f32 v26, v124
    v_exp_f32 v27, v125
    v_add_f32 v9, v9, v24
    v_add_f32 v9, v9, v25
    v_cvt_pk_bf16_f32 v42, v24, v25
    v_exp_f32 v28, v122
    v_exp_f32 v29, v123
    v_add_f32 v10, v10, v26
    v_add_f32 v10, v10, v27
    v_cvt_pk_bf16_f32 v46, v26, v27
    v_exp_f32 v30, v126
    v_exp_f32 v31, v127
    v_add_f32 v9, v9, v28
    v_add_f32 v9, v9, v29
    v_cvt_pk_bf16_f32 v43, v28, v29
    s_nop 0
    v_add_f32 v10, v10, v30
    v_add_f32 v10, v10, v31
    v_cvt_pk_bf16_f32 v47, v30, v31
    s_nop 1
    s_setpc_b64 s[54:55]
RARE1B:
    s_nop 7
    v_max3_f32 v16, v96, v97, v98
    v_max3_f32 v16, v16, v99, v104
    v_max3_f32 v16, v16, v105, v106
    v_max3_f32 v16, v16, v107, v112
    v_max3_f32 v16, v16, v113, v114
    v_max3_f32 v16, v16, v115, v120
    v_max3_f32 v16, v16, v121, v122
    v_max_f32 v16, v16, v123
    v_mov_b32 v18, v16
    s_nop 1
    v_permlane32_swap_b32 v18, v16
    s_nop 1
    v_max_f32 v16, v16, v18
    v_mov_b32 v18, v16
    s_nop 1
    v_permlane16_swap_b32 v18, v16
    s_nop 1
    v_max_f32 v16, v16, v18
    v_max_f32 v16, 0, v16
    v_max3_f32 v17, v100, v101, v102
    v_max3_f32 v17, v17, v103, v108
    v_max3_f32 v17, v17, v109, v110
    v_max3_f32 v17, v17, v111, v116
    v_max3_f32 v17, v17, v117, v118
    v_max3_f32 v17, v17, v119, v124
    v_max3_f32 v17, v17, v125, v126
    v_max_f32 v17, v17, v127
    v_mov_b32 v18, v17
    s_nop 1
    v_permlane32_swap_b32 v18, v17
    s_nop 1
    v_max_f32 v17, v17, v18
    v_mov_b32 v18, v17
    s_nop 1
    v_permlane16_swap_b32 v18, v17
    s_nop 1
    v_max_f32 v17, v17, v18
    v_max_f32 v17, 0, v17
    v_exp_f32 v20, -v16
    v_sub_f32 v96, v96, v16
    v_sub_f32 v97, v97, v16
    v_sub_f32 v98, v98, v16
    v_sub_f32 v99, v99, v16
    v_sub_f32 v104, v104, v16
    v_sub_f32 v105, v105, v16
    v_sub_f32 v106, v106, v16
    v_sub_f32 v107, v107, v16
    v_sub_f32 v112, v112, v16
    v_sub_f32 v113, v113, v16
    v_sub_f32 v114, v114, v16
    v_sub_f32 v115, v115, v16
    v_sub_f32 v120, v120, v16
    v_sub_f32 v121, v121, v16
    v_sub_f32 v122, v122, v16
    v_sub_f32 v123, v123, v16
    v_sub_f32 v32, v32, v16
    v_sub_f32 v33, v33, v16
    v_sub_f32 v34, v34, v16
    v_sub_f32 v35, v35, v16
    v_mul_f32 v192, v192, v20
    v_mul_f32 v193, v193, v20
    v_mul_f32 v194, v194, v20
    v_mul_f32 v195, v195, v20
    v_mul_f32 v200, v200, v20
    v_mul_f32 v201, v201, v20
    v_mul_f32 v202, v202, v20
    v_mul_f32 v203, v203, v20
    v_mul_f32 v208, v208, v20
    v_mul_f32 v209, v209, v20
    v_mul_f32 v210, v210, v20
    v_mul_f32 v211, v211, v20
    v_mul_f32 v216, v216, v20
    v_mul_f32 v217, v217, v20
    v_mul_f32 v218, v218, v20
    v_mul_f32 v219, v219, v20
    v_mul_f32 v224, v224, v20
    v_mul_f32 v225, v225, v20
    v_mul_f32 v226, v226, v20
    v_mul_f32 v227, v227, v20
    v_mul_f32 v232, v232, v20
    v_mul_f32 v233, v233, v20
    v_mul_f32 v234, v234, v20
    v_mul_f32 v235, v235, v20
    v_mul_f32 v240, v240, v20
    v_mul_f32 v241, v241, v20
    v_mul_f32 v242, v242, v20
    v_mul_f32 v243, v243, v20
    v_mul_f32 v248, v248, v20
    v_mul_f32 v249, v249, v20
    v_mul_f32 v250, v250, v20
    v_mul_f32 v251, v251, v20
    v_mul_f32 v11, v11, v20
    v_exp_f32 v21, -v17
    v_sub_f32 v100, v100, v17
    v_sub_f32 v101, v101, v17
    v_sub_f32 v102, v102, v17
    v_sub_f32 v103, v103, v17
    v_sub_f32 v108, v108, v17
    v_sub_f32 v109, v109, v17
    v_sub_f32 v110, v110, v17
    v_sub_f32 v111, v111, v17
    v_sub_f32 v116, v116, v17
    v_sub_f32 v117, v117, v17
    v_sub_f32 v118, v118, v17
    v_sub_f32 v119, v119, v17
    v_sub_f32 v124, v124, v17
    v_sub_f32 v125, v125, v17
    v_sub_f32 v126, v126, v17
    v_sub_f32 v127, v127, v17
    v_sub_f32 v36, v36, v17
    v_sub_f32 v37, v37, v17
    v_sub_f32 v38, v38, v17
    v_sub_f32 v39, v39, v17
    v_mul_f32 v196, v196, v21
    v_mul_f32 v197, v197, v21
    v_mul_f32 v198, v198, v21
    v_mul_f32 v199, v199, v21
    v_mul_f32 v204, v204, v21
    v_mul_f32 v205, v205, v21
    v_mul_f32 v206, v206, v21
    v_mul_f32 v207, v207, v21
    v_mul_f32 v212, v212, v21
    v_mul_f32 v213, v213, v21
    v_mul_f32 v214, v214, v21
    v_mul_f32 v215, v215, v21
    v_mul_f32 v220, v220, v21
    v_mul_f32 v221, v221, v21
    v_mul_f32 v222, v222, v21
    v_mul_f32 v223, v223, v21
    v_mul_f32 v228, v228, v21
    v_mul_f32 v229, v229, v21
    v_mul_f32 v230, v230, v21
    v_mul_f32 v231, v231, v21
    v_mul_f32 v236, v236, v21
    v_mul_f32 v237, v237, v21
    v_mul_f32 v238, v238, v21
    v_mul_f32 v239, v239, v21
    v_mul_f32 v244, v244, v21
    v_mul_f32 v245, v245, v21
    v_mul_f32 v246, v246, v21
    v_mul_f32 v247, v247, v21
    v_mul_f32 v252, v252, v21
    v_mul_f32 v253, v253, v21
    v_mul_f32 v254, v254, v21
    v_mul_f32 v255, v255, v21
    v_mul_f32 v12, v12, v21
    v_exp_f32 v24, v96
    v_exp_f32 v25, v97
    v_exp_f32 v26, v100
    v_exp_f32 v27, v101
    v_add_f32 v9, v24, v25
    v_cvt_pk_bf16_f32 v48, v24, v25
    v_exp_f32 v28, v98
    v_exp_f32 v29, v99
    v_add_f32 v10, v26, v27
    v_cvt_pk_bf16_f32 v52, v26, v27
    v_exp_f32 v30, v102
    v_exp_f32 v31, v103
    v_add_f32 v9, v9, v28
    v_add_f32 v9, v9, v29
    v_cvt_pk_bf16_f32 v49, v28, v29
    v_exp_f32 v24, v104
    v_exp_f32 v25, v105
    v_add_f32 v10, v10, v30
    v_add_f32 v10, v10, v31
    v_cvt_pk_bf16_f32 v53, v30, v31
    v_exp_f32 v26, v108
    v_exp_f32 v27, v109
    v_add_f32 v9, v9, v24
    v_add_f32 v9, v9, v25
    v_cvt_pk_bf16_f32 v50, v24, v25
    v_exp_f32 v28, v106
    v_exp_f32 v29, v107
    v_add_f32 v10, v10, v26
    v_add_f32 v10, v10, v27
    v_cvt_pk_bf16_f32 v54, v26, v27
    v_exp_f32 v30, v110
    v_exp_f32 v31, v111
    v_add_f32 v9, v9, v28
    v_add_f32 v9, v9, v29
    v_cvt_pk_bf16_f32 v51, v28, v29
    s_nop 0
    v_add_f32 v10, v10, v30
    v_add_f32 v10, v10, v31
    v_cvt_pk_bf16_f32 v55, v30, v31
    v_exp_f32 v24, v112
    v_exp_f32 v25, v113
    v_exp_f32 v26, v116
    v_exp_f32 v27, v117
    v_add_f32 v9, v9, v24
    v_add_f32 v9, v9, v25
    v_cvt_pk_bf16_f32 v40, v24, v25
    v_exp_f32 v28, v114
    v_exp_f32 v29, v115
    v_add_f32 v10, v10, v26
    v_add_f32 v10, v10, v27
    v_cvt_pk_bf16_f32 v44, v26, v27
    v_exp_f32 v30, v118
    v_exp_f32 v31, v119
    v_add_f32 v9, v9, v28
    v_add_f32 v9, v9, v29
    v_cvt_pk_bf16_f32 v41, v28, v29
    v_exp_f32 v24, v120
    v_exp_f32 v25, v121
    v_add_f32 v10, v10, v30
    v_add_f32 v10, v10, v31
    v_cvt_pk_bf16_f32 v45, v30, v31
    v_exp_f32 v26, v124
    v_exp_f32 v27, v125
    v_add_f32 v9, v9, v24
    v_add_f32 v9, v9, v25
    v_cvt_pk_bf16_f32 v42, v24, v25
    v_exp_f32 v28, v122
    v_exp_f32 v29, v123
    v_add_f32 v10, v10, v26
    v_add_f32 v10, v10, v27
    v_cvt_pk_bf16_f32 v46, v26, v27
    v_exp_f32 v30, v126
    v_exp_f32 v31, v127
    v_add_f32 v9, v9, v28
    v_add_f32 v9, v9, v29
    v_cvt_pk_bf16_f32 v43, v28, v29
    s_nop 0
    v_add_f32 v10, v10, v30
    v_add_f32 v10, v10, v31
    v_cvt_pk_bf16_f32 v47, v30, v31
    s_nop 1
    s_setpc_b64 s[54:55]
RARE0B:
    s_nop 7
    v_max3_f32 v16, v128, v129, v130
    v_max3_f32 v16, v16, v131, v136
    v_max3_f32 v16, v16, v137, v138
    v_max3_f32 v16, v16, v139, v144
    v_max3_f32 v16, v16, v145, v146
    v_max3_f32 v16, v16, v147, v152
    v_max3_f32 v16, v16, v153, v154
    v_max_f32 v16, v16, v155
    v_mov_b32 v18, v16
    s_nop 1
    v_permlane32_swap_b32 v18, v16
    s_nop 1
    v_max_f32 v16, v16, v18
    v_mov_b32 v18, v16
    s_nop 1
    v_permlane16_swap_b32 v18, v16
    s_nop 1
    v_max_f32 v16, v16, v18
    v_max_f32 v16, 0, v16
    v_max3_f32 v17, v132, v133, v134
    v_max3_f32 v17, v17, v135, v140
    v_max3_f32 v17, v17, v141, v142
    v_max3_f32 v17, v17, v143, v148
    v_max3_f32 v17, v17, v149, v150
    v_max3_f32 v17, v17, v151, v156
    v_max3_f32 v17, v17, v157, v158
    v_max_f32 v17, v17, v159
    v_mov_b32 v18, v17
    s_nop 1
    v_permlane32_swap_b32 v18, v17
    s_nop 1
    v_max_f32 v17, v17, v18
    v_mov_b32 v18, v17
    s_nop 1
    v_permlane16_swap_b32 v18, v17
    s_nop 1
    v_max_f32 v17, v17, v18
    v_max_f32 v17, 0, v17
    v_exp_f32 v20, -v16
    v_sub_f32 v128, v128, v16
    v_sub_f32 v129, v129, v16
    v_sub_f32 v130, v130, v16
    v_sub_f32 v131, v131, v16
    v_sub_f32 v136, v136, v16
    v_sub_f32 v137, v137, v16
    v_sub_f32 v138, v138, v16
    v_sub_f32 v139, v139, v16
    v_sub_f32 v144, v144, v16
    v_sub_f32 v145, v145, v16
    v_sub_f32 v146, v146, v16
    v_sub_f32 v147, v147, v16
    v_sub_f32 v152, v152, v16
    v_sub_f32 v153, v153, v16
    v_sub_f32 v154, v154, v16
    v_sub_f32 v155, v155, v16
    v_sub_f32 v32, v32, v16
    v_sub_f32 v33, v33, v16
    v_sub_f32 v34, v34, v16
    v_sub_f32 v35, v35, v16
    v_mul_f32 v192, v192, v20
    v_mul_f32 v193, v193, v20
    v_mul_f32 v194, v194, v20
    v_mul_f32 v195, v195, v20
    v_mul_f32 v200, v200, v20
    v_mul_f32 v201, v201, v20
    v_mul_f32 v202, v202, v20
    v_mul_f32 v203, v203, v20
    v_mul_f32 v208, v208, v20
    v_mul_f32 v209, v209, v20
    v_mul_f32 v210, v210, v20
    v_mul_f32 v211, v211, v20
    v_mul_f32 v216, v216, v20
    v_mul_f32 v217, v217, v20
    v_mul_f32 v218, v218, v20
    v_mul_f32 v219, v219, v20
    v_mul_f32 v224, v224, v20
    v_mul_f32 v225, v225, v20
    v_mul_f32 v226, v226, v20
    v_mul_f32 v227, v227, v20
    v_mul_f32 v232, v232, v20
    v_mul_f32 v233, v233, v20
    v_mul_f32 v234, v234, v20
    v_mul_f32 v235, v235, v20
    v_mul_f32 v240, v240, v20
    v_mul_f32 v241, v241, v20
    v_mul_f32 v242, v242, v20
    v_mul_f32 v243, v243, v20
    v_mul_f32 v248, v248, v20
    v_mul_f32 v249, v249, v20
    v_mul_f32 v250, v250, v20
    v_mul_f32 v251, v251, v20
    v_mul_f32 v11, v11, v20
    v_exp_f32 v21, -v17
    v_sub_f32 v132, v132, v17
    v_sub_f32 v133, v133, v17
    v_sub_f32 v134, v134, v17
    v_sub_f32 v135, v135, v17
    v_sub_f32 v140, v140, v17
    v_sub_f32 v141, v141, v17
    v_sub_f32 v142, v142, v17
    v_sub_f32 v143, v143, v17
    v_sub_f32 v148, v148, v17
    v_sub_f32 v149, v149, v17
    v_sub_f32 v150, v150, v17
    v_sub_f32 v151, v151, v17
    v_sub_f32 v156, v156, v17
    v_sub_f32 v157, v157, v17
    v_sub_f32 v158, v158, v17
    v_sub_f32 v159, v159, v17
    v_sub_f32 v36, v36, v17
    v_sub_f32 v37, v37, v17
    v_sub_f32 v38, v38, v17
    v_sub_f32 v39, v39, v17
    v_mul_f32 v196, v196, v21
    v_mul_f32 v197, v197, v21
    v_mul_f32 v198, v198, v21
    v_mul_f32 v199, v199, v21
    v_mul_f32 v204, v204, v21
    v_mul_f32 v205, v205, v21
    v_mul_f32 v206, v206, v21
    v_mul_f32 v207, v207, v21
    v_mul_f32 v212, v212, v21
    v_mul_f32 v213, v213, v21
    v_mul_f32 v214, v214, v21
    v_mul_f32 v215, v215, v21
    v_mul_f32 v220, v220, v21
    v_mul_f32 v221, v221, v21
    v_mul_f32 v222, v222, v21
    v_mul_f32 v223, v223, v21
    v_mul_f32 v228, v228, v21
    v_mul_f32 v229, v229, v21
    v_mul_f32 v230, v230, v21
    v_mul_f32 v231, v231, v21
    v_mul_f32 v236, v236, v21
    v_mul_f32 v237, v237, v21
    v_mul_f32 v238, v238, v21
    v_mul_f32 v239, v239, v21
    v_mul_f32 v244, v244, v21
    v_mul_f32 v245, v245, v21
    v_mul_f32 v246, v246, v21
    v_mul_f32 v247, v247, v21
    v_mul_f32 v252, v252, v21
    v_mul_f32 v253, v253, v21
    v_mul_f32 v254, v254, v21
    v_mul_f32 v255, v255, v21
    v_mul_f32 v12, v12, v21
    v_exp_f32 v24, v128
    v_exp_f32 v25, v129
    v_exp_f32 v26, v132
    v_exp_f32 v27, v133
    v_add_f32 v9, v24, v25
    v_cvt_pk_bf16_f32 v56, v24, v25
    v_exp_f32 v28, v130
    v_exp_f32 v29, v131
    v_add_f32 v10, v26, v27
    v_cvt_pk_bf16_f32 v60, v26, v27
    v_exp_f32 v30, v134
    v_exp_f32 v31, v135
    v_add_f32 v9, v9, v28
    v_add_f32 v9, v9, v29
    v_cvt_pk_bf16_f32 v57, v28, v29
    v_exp_f32 v24, v136
    v_exp_f32 v25, v137
    v_add_f32 v10, v10, v30
    v_add_f32 v10, v10, v31
    v_cvt_pk_bf16_f32 v61, v30, v31
    v_exp_f32 v26, v140
    v_exp_f32 v27, v141
    v_add_f32 v9, v9, v24
    v_add_f32 v9, v9, v25
    v_cvt_pk_bf16_f32 v58, v24, v25
    v_exp_f32 v28, v138
    v_exp_f32 v29, v139
    v_add_f32 v10, v10, v26
    v_add_f32 v10, v10, v27
    v_cvt_pk_bf16_f32 v62, v26, v27
    v_exp_f32 v30, v142
    v_exp_f32 v31, v143
    v_add_f32 v9, v9, v28
    v_add_f32 v9, v9, v29
    v_cvt_pk_bf16_f32 v59, v28, v29
    s_nop 0
    v_add_f32 v10, v10, v30
    v_add_f32 v10, v10, v31
    v_cvt_pk_bf16_f32 v63, v30, v31
    v_exp_f32 v24, v144
    v_exp_f32 v25, v145
    v_exp_f32 v26, v148
    v_exp_f32 v27, v149
    v_add_f32 v9, v9, v24
    v_add_f32 v9, v9, v25
    v_cvt_pk_bf16_f32 v40, v24, v25
    v_exp_f32 v28, v146
    v_exp_f32 v29, v147
    v_add_f32 v10, v10, v26
    v_add_f32 v10, v10, v27
    v_cvt_pk_bf16_f32 v44, v26, v27
    v_exp_f32 v30, v150
    v_exp_f32 v31, v151
    v_add_f32 v9, v9, v28
    v_add_f32 v9, v9, v29
    v_cvt_pk_bf16_f32 v41, v28, v29
    v_exp_f32 v24, v152
    v_exp_f32 v25, v153
    v_add_f32 v10, v10, v30
    v_add_f32 v10, v10, v31
    v_cvt_pk_bf16_f32 v45, v30, v31
    v_exp_f32 v26, v156
    v_exp_f32 v27, v157
    v_add_f32 v9, v9, v24
    v_add_f32 v9, v9, v25
    v_cvt_pk_bf16_f32 v42, v24, v25
    v_exp_f32 v28, v154
    v_exp_f32 v29, v155
    v_add_f32 v10, v10, v26
    v_add_f32 v10, v10, v27
    v_cvt_pk_bf16_f32 v46, v26, v27
    v_exp_f32 v30, v158
    v_exp_f32 v31, v159
    v_add_f32 v9, v9, v28
    v_add_f32 v9, v9, v29
    v_cvt_pk_bf16_f32 v43, v28, v29
    s_nop 0
    v_add_f32 v10, v10, v30
    v_add_f32 v10, v10, v31
    v_cvt_pk_bf16_f32 v47, v30, v31
    s_nop 1
    s_setpc_b64 s[54:55]
FIN0_R:
    s_call_b64 s[54:55], RARE0B
    s_branch FIN0_RB
FIN1_R:
    s_call_b64 s[54:55], RARE0B
    s_branch FIN1_RB
TAG0_S:
    s_mov_b32 s30, 0
TAG0_L:
    s_sleep 8
    buffer_load_dword v31, off, s[12:15], 0 sc1
    s_add_u32 s30, s30, 1
    s_cmp_ge_u32 s30, 0x40000
    s_waitcnt vmcnt(0)
    s_cbranch_scc1 TAG0_C
    v_readfirstlane_b32 s38, v31
    s_cmp_eq_u32 s38, 0
    s_cbranch_scc1 TAG0_L
    s_branch TAG0_C
PL1_0_S:
    s_mov_b32 s30, 0
PL1_0_L:
    s_mov_b32 exec_lo, 0x1
    s_mov_b32 exec_hi, 0x0
    buffer_load_dword v28, v1, s[8:11], 0 offen sc1
    s_mov_b64 exec, -1
    s_add_u32 s30, s30, 1
    s_waitcnt vmcnt(0)
    s_add_u32 s26, s38, 1
    v_subrev_u32 v28, s26, v28
    v_cmp_le_u32 vcc, 7, v28
    s_mov_b32 s26, 0x1
    s_mov_b32 s27, 0x0
    s_and_b64 vcc, s[26:27], vcc
    s_cbranch_vccz PL1_0_C
    s_cmp_ge_u32 s30, 0x40000
    s_cbranch_scc1 PL1_0_C
    s_sleep 3
    s_branch PL1_0_L
TAG1_S:
    s_mov_b32 s30, 0
TAG1_L:
    s_sleep 8
    buffer_load_dword v31, off, s[12:15], 0 sc1
    s_add_u32 s30, s30, 1
    s_cmp_ge_u32 s30, 0x40000
    s_waitcnt vmcnt(0)
    s_cbranch_scc1 TAG1_C
    v_readfirstlane_b32 s38, v31
    s_cmp_eq_u32 s38, 0
    s_cbranch_scc1 TAG1_L
    s_branch TAG1_C
PL1_1_S:
    s_mov_b32 s30, 0
PL1_1_L:
    s_mov_b32 exec_lo, 0x1
    s_mov_b32 exec_hi, 0x0
    buffer_load_dword v28, v1, s[8:11], 0 offen sc1
    s_mov_b64 exec, -1
    s_add_u32 s30, s30, 1
    s_waitcnt vmcnt(0)
    s_add_u32 s26, s38, 1
    v_subrev_u32 v28, s26, v28
    v_cmp_le_u32 vcc, 7, v28
    s_mov_b32 s26, 0x1
    s_mov_b32 s27, 0x0
    s_and_b64 vcc, s[26:27], vcc
    s_cbranch_vccz PL1_1_C
    s_cmp_ge_u32 s30, 0x40000
    s_cbranch_scc1 PL1_1_C
    s_sleep 3
    s_branch PL1_1_L
TAG2_S:
    s_mov_b32 s30, 0
TAG2_L:
    s_sleep 8
    buffer_load_dword v31, off, s[12:15], 0 sc1
    s_add_u32 s30, s30, 1
    s_cmp_ge_u32 s30, 0x40000
    s_waitcnt vmcnt(0)
    s_cbranch_scc1 TAG2_C
    v_readfirstlane_b32 s38, v31
    s_cmp_eq_u32 s38, 0
    s_cbranch_scc1 TAG2_L
    s_branch TAG2_C
PL1_2_S:
    s_mov_b32 s30, 0
PL1_2_L:
    s_mov_b32 exec_lo, 0x1
    s_mov_b32 exec_hi, 0x0
    buffer_load_dword v28, v1, s[8:11], 0 offen sc1
    s_mov_b64 exec, -1
    s_add_u32 s30, s30, 1
    s_waitcnt vmcnt(0)
    s_add_u32 s26, s38, 1
    v_subrev_u32 v28, s26, v28
    v_cmp_le_u32 vcc, 7, v28
    s_mov_b32 s26, 0x1
    s_mov_b32 s27, 0x0
    s_and_b64 vcc, s[26:27], vcc
    s_cbranch_vccz PL1_2_C
    s_cmp_ge_u32 s30, 0x40000
    s_cbranch_scc1 PL1_2_C
    s_sleep 3
    s_branch PL1_2_L
PL3_S:
    s_mov_b32 s30, 0
PL3_L:
    s_mov_b32 exec_lo, 0x0
    s_mov_b32 exec_hi, 0xf
    buffer_load_dword v122, v1, s[8:11], 0 offen sc1
    s_mov_b64 exec, -1
    s_add_u32 s30, s30, 1
    s_waitcnt vmcnt(0)
    s_add_u32 s26, s38, 4
    v_subrev_u32 v122, s26, v122
    v_cmp_le_u32 vcc, 4, v122
    s_mov_b32 s26, 0x0
    s_mov_b32 s27, 0xf
    s_and_b64 vcc, s[26:27], vcc
    s_cbranch_vccz PL3_C
    s_cmp_ge_u32 s30, 0x40000
    s_cbranch_scc1 PL3_C
    s_sleep 3
    s_branch PL3_L
PL4_S:
    s_mov_b32 s30, 0
PL4_L:
    s_mov_b32 exec_lo, 0x0
    s_mov_b32 exec_hi, 0xf0
    buffer_load_dword v122, v1, s[8:11], 0 offen sc1
    s_mov_b64 exec, -1
    s_add_u32 s30, s30, 1
    s_waitcnt vmcnt(0)
    s_add_u32 s26, s38, 4
    v_subrev_u32 v122, s26, v122
    v_cmp_le_u32 vcc, 4, v122
    s_mov_b32 s26, 0x0
    s_mov_b32 s27, 0xf0
    s_and_b64 vcc, s[26:27], vcc
    s_cbranch_vccz PL4_C
    s_cmp_ge_u32 s30, 0x40000
    s_cbranch_scc1 PL4_C
    s_sleep 3
    s_branch PL4_L
K_FIN1:
    ds_read_b128 v[64:67], v6 offset:0
    ds_read_b128 v[68:71], v6 offset:1024
    ds_read_b128 v[72:75], v6 offset:2048
    ds_read_b128 v[76:79], v6 offset:3072
    ds_read_b128 v[80:83], v6 offset:4096
    ds_read_b128 v[84:87], v6 offset:5120
    v_exp_f32 v24, v144
    v_exp_f32 v25, v145
    v_exp_f32 v26, v148
    s_add_u32 m0, s64, 16384
    s_nop 0
    buffer_load_dwordx4 v4, s[8:11], s63 offen offset:0 sc1 lds
    v_exp_f32 v27, v149
    v_add_f32 v9, v9, v24
    v_add_f32 v9, v9, v25
    v_cvt_pk_bf16_f32 v40, v24, v25
    v_exp_f32 v28, v146
    v_exp_f32 v29, v147
    v_add_f32 v10, v10, v26
    v_add_f32 v10, v10, v27
    v_cvt_pk_bf16_f32 v44, v26, v27
    buffer_load_dwordx4 v4, s[8:11], s63 offen offset:1024 sc1 lds
    v_exp_f32 v30, v150
    v_exp_f32 v31, v151
    v_add_f32 v9, v9, v28
    v_add_f32 v9, v9, v29
    v_cvt_pk_bf16_f32 v41, v28, v29
    v_exp_f32 v24, v152
    v_exp_f32 v25, v153
    v_add_f32 v10, v10, v30
    v_add_f32 v10, v10, v31
    v_cvt_pk_bf16_f32 v45, v30, v31
    buffer_load_dwordx4 v4, s[8:11], s63 offen offset:2048 sc1 lds
    v_exp_f32 v26, v156
    v_exp_f32 v27, v157
    v_add_f32 v9, v9, v24
    v_add_f32 v9, v9, v25
    v_cvt_pk_bf16_f32 v42, v24, v25
    v_exp_f32 v28, v154
    v_exp_f32 v29, v155
    v_add_f32 v10, v10, v26
    v_add_f32 v10, v10, v27
    buffer_load_dwordx4 v4, s[8:11], s63 offen offset:3072 sc1 lds
    s_add_u32 s63, s63, 16384
    v_cvt_pk_bf16_f32 v46, v26, v27
    v_exp_f32 v30, v158
    v_exp_f32 v31, v159
    v_add_f32 v9, v9, v28
    v_add_f32 v9, v9, v29
    v_cvt_pk_bf16_f32 v43, v28, v29
    s_nop 0
    v_add_f32 v10, v10, v30
    v_add_f32 v10, v10, v31
    v_cvt_pk_bf16_f32 v47, v30, v31
    v_max_f32 v16, v9, v10
    v_cmp_lt_f32 vcc, s53, v16
    s_and_b32 s24, s3, 3
    s_and_b32 s32, s47, 0x10000
    s_xor_b32 s32, s32, 0x18000
    s_lshl_b32 s33, s3, 12
    s_add_u32 s32, s32, s33
    s_xor_b32 s33, s32, 16384
    s_lshl_b32 s34, s3, 9
    s_add_u32 s34, s34, 155648
    s_lshl_b32 s35, s24, 9
    s_add_u32 s35, s35, 155648
    s_cbranch_vccnz FIN1_R
FIN1_RB:
    s_waitcnt lgkmcnt(4)
    v_mfma_f32_16x16x32_bf16 v[192:195], v[64:67], v[56:59], v[192:195]
    ds_read_b128 v[88:91], v6 offset:6144
    v_add_f32 v11, v11, v9
    s_add_u32 m0, s69, 32768
    s_nop 0
    buffer_load_dwordx4 v4, s[8:11], s63 offen offset:0 sc1 lds
    v_mfma_f32_16x16x32_bf16 v[196:199], v[64:67], v[60:63], v[196:199]
    v_add_f32 v12, v12, v10
    v_mfma_f32_16x16x32_bf16 v[200:203], v[68:71], v[56:59], v[200:203]
    ds_read_b128 v[92:95], v6 offset:7168
    v_mov_b32 v16, v11
    s_nop 1
    v_permlane32_swap_b32 v16, v11
    s_nop 1
    v_add_f32 v11, v11, v16
    v_mfma_f32_16x16x32_bf16 v[204:207], v[68:71], v[60:63], v[204:207]
    v_mov_b32 v16, v11
    s_nop 1
    v_permlane16_swap_b32 v16, v11
    s_nop 1
    v_add_f32 v11, v11, v16
    s_waitcnt lgkmcnt(4)
    v_mfma_f32_16x16x32_bf16 v[208:211], v[72:75], v[56:59], v[208:211]
    ds_read_b128 v[64:67], v6 offset:8192
    v_mfma_f32_16x16x32_bf16 v[212:215], v[72:75], v[60:63], v[212:215]
    v_mov_b32 v17, v12
    s_nop 1
    v_permlane32_swap_b32 v17, v12
    s_nop 1
    v_add_f32 v12, v12, v17
    buffer_load_dwordx4 v4, s[8:11], s63 offen offset:1024 sc1 lds
    v_mfma_f32_16x16x32_bf16 v[216:219], v[76:79], v[56:59], v[216:219]
    ds_read_b128 v[68:71], v6 offset:9216
    v_mov_b32 v17, v12
    s_nop 1
    v_permlane16_swap_b32 v17, v12
    s_nop 1
    v_add_f32 v12, v12, v17
    v_mfma_f32_16x16x32_bf16 v[220:223], v[76:79], v[60:63], v[220:223]
    v_add_u32 v20, s32, v4
    s_waitcnt lgkmcnt(4)
    v_mfma_f32_16x16x32_bf16 v[224:227], v[80:83], v[56:59], v[224:227]
    ds_read_b128 v[72:75], v6 offset:10240
    v_add_u32 v21, s33, v4
    v_mfma_f32_16x16x32_bf16 v[228:231], v[80:83], v[60:63], v[228:231]
    v_mfma_f32_16x16x32_bf16 v[232:235], v[84:87], v[56:59], v[232:235]
    ds_read_b128 v[76:79], v6 offset:11264
    v_lshrrev_b32 v23, 1, v4
    buffer_load_dwordx4 v4, s[8:11], s63 offen offset:2048 sc1 lds
    v_mfma_f32_16x16x32_bf16 v[236:239], v[84:87], v[60:63], v[236:239]
    v_add_u32 v22, s34, v23
    s_waitcnt lgkmcnt(4)
    v_mfma_f32_16x16x32_bf16 v[240:243], v[88:91], v[56:59], v[240:243]
    ds_read_b128 v[80:83], v6 offset:12288
    v_add_u32 v23, s35, v23
    v_mfma_f32_16x16x32_bf16 v[244:247], v[88:91], v[60:63], v[244:247]
    v_mov_b32 v24, v32
    v_mfma_f32_16x16x32_bf16 v[248:251], v[92:95], v[56:59], v[248:251]
    ds_read_b128 v[84:87], v6 offset:13312
    v_mfma_f32_16x16x32_bf16 v[252:255], v[92:95], v[60:63], v[252:255]
    v_mov_b32 v25, v11
    buffer_load_dwordx4 v4, s[8:11], s63 offen offset:3072 sc1 lds
    s_add_u32 s63, s63, 16384
    s_waitcnt lgkmcnt(4)
    v_mfma_f32_16x16x32_bf16 v[192:195], v[64:67], v[40:43], v[192:195]
    ds_read_b128 v[88:91], v6 offset:14336
    ds_write_b64 v22, v[24:25]
    v_mfma_f32_16x16x32_bf16 v[196:199], v[64:67], v[44:47], v[196:199]
    v_mov_b32 v10, v36
    v_mfma_f32_16x16x32_bf16 v[200:203], v[68:71], v[40:43], v[200:203]
    ds_read_b128 v[92:95], v6 offset:15360
    s_mov_b32 s34, 0xffff0000
    s_lshl_b32 s24, s71, 13
    s_add_u32 s24, s24, 1024
    v_mfma_f32_16x16x32_bf16 v[204:207], v[68:71], v[44:47], v[204:207]
    v_add_u32 v101, s24, v101
    s_waitcnt lgkmcnt(5)
    v_mfma_f32_16x16x32_bf16 v[208:211], v[72:75], v[40:43], v[208:211]
    v_add_u32 v102, 10240, v102
    v_add_u32 v103, 10240, v103
    v_mfma_f32_16x16x32_bf16 v[212:215], v[72:75], v[44:47], v[212:215]
    v_add_u32 v104, 16384, v101
    v_mfma_f32_16x16x32_bf16 v[216:219], v[76:79], v[40:43], v[216:219]
    v_add_u32 v107, 57344, v102
    v_add_u32 v108, 57344, v103
    v_mfma_f32_16x16x32_bf16 v[220:223], v[76:79], v[44:47], v[220:223]
    s_add_u32 s24, s73, 32768
    s_waitcnt lgkmcnt(3)
    v_mfma_f32_16x16x32_bf16 v[224:227], v[80:83], v[40:43], v[224:227]
    v_add_u32 v105, s24, v101
    s_xor_b32 s24, s24, 0x10000
    v_mfma_f32_16x16x32_bf16 v[228:231], v[80:83], v[44:47], v[228:231]
    v_add_u32 v106, s24, v101
    v_mfma_f32_16x16x32_bf16 v[232:235], v[84:87], v[40:43], v[232:235]
    s_sub_u32 s24, s73, 28672
    v_add_u32 v109, s24, v102
    v_mfma_f32_16x16x32_bf16 v[236:239], v[84:87], v[44:47], v[236:239]
    v_add_u32 v110, s24, v103
    s_waitcnt lgkmcnt(1)
    v_mfma_f32_16x16x32_bf16 v[240:243], v[88:91], v[40:43], v[240:243]
    s_xor_b32 s24, s73, 0x10000
    s_sub_u32 s24, s24, 28672
    v_mfma_f32_16x16x32_bf16 v[244:247], v[88:91], v[44:47], v[244:247]
    v_add_u32 v111, s24, v102
    s_waitcnt lgkmcnt(0)
    v_mfma_f32_16x16x32_bf16 v[248:251], v[92:95], v[40:43], v[248:251]
    v_add_u32 v112, s24, v103
    v_mfma_f32_16x16x32_bf16 v[252:255], v[92:95], v[44:47], v[252:255]
    s_waitcnt vmcnt(8) lgkmcnt(0)
    s_barrier
    ds_read_b64 v[18:19], v23
    s_nop 2
    v_cvt_pk_bf16_f32 v192, v192, v193
    v_cvt_pk_bf16_f32 v193, v194, v195
    v_cvt_pk_bf16_f32 v194, v200, v201
    v_cvt_pk_bf16_f32 v195, v202, v203
    ds_write_b128 v20, v[192:195] offset:0
    v_cvt_pk_bf16_f32 v208, v208, v209
    v_cvt_pk_bf16_f32 v209, v210, v211
    v_cvt_pk_bf16_f32 v210, v216, v217
    v_cvt_pk_bf16_f32 v211, v218, v219
    ds_write_b128 v20, v[208:211] offset:1024
    v_cvt_pk_bf16_f32 v224, v224, v225
    v_cvt_pk_bf16_f32 v225, v226, v227
    v_cvt_pk_bf16_f32 v226, v232, v233
    v_cvt_pk_bf16_f32 v227, v234, v235
    ds_write_b128 v20, v[224:227] offset:2048
    v_cvt_pk_bf16_f32 v240, v240, v241
    v_cvt_pk_bf16_f32 v241, v242, v243
    v_cvt_pk_bf16_f32 v242, v248, v249
    v_cvt_pk_bf16_f32 v243, v250, v251
    ds_write_b128 v20, v[240:243] offset:3072
    ds_read_b64_tr_b16 v[40:41], v102 offset:0
    s_waitcnt lgkmcnt(4)
    v_min_f32 v9, v10, v18
    ds_read_b64_tr_b16 v[42:43], v102 offset:5120
    v_sub_f32 v10, v9, v10
    ds_read_b128 v[24:27], v101 offset:0
    v_sub_f32 v9, v9, v18
    ds_read_b64_tr_b16 v[44:45], v103 offset:32
    v_exp_f32 v10, v10
    ds_read_b64_tr_b16 v[46:47], v103 offset:5152
    v_exp_f32 v9, v9
    ds_read_b64_tr_b16 v[48:49], v102 offset:64
    s_nop 0
    ds_read_b64_tr_b16 v[50:51], v102 offset:5184
    v_mul_f32 v15, v12, v10
    ds_read_b64_tr_b16 v[52:53], v103 offset:96
    v_fma_f32 v15, v19, v9, v15
    ds_read_b64_tr_b16 v[54:55], v103 offset:5216
    v_rcp_f32 v15, v15
    ds_read_b64_tr_b16 v[56:57], v102 offset:128
    s_nop 0
    ds_read_b64_tr_b16 v[58:59], v102 offset:5248
    v_mul_f32 v15, v15, v13
    ds_read_b128 v[28:31], v101 offset:2048
    v_mul_f32 v18, v10, v15
    ds_read_b128 v[32:35], v101 offset:4096
    v_mul_f32 v19, v10, v15
    ds_read_b128 v[36:39], v101 offset:6144
    v_mul_f32 v16, v9, v15
    v_pk_mul_f32 v[196:197], v[196:197], v[18:19]
    v_pk_mul_f32 v[198:199], v[198:199], v[18:19]
    v_pk_mul_f32 v[204:205], v[204:205], v[18:19]
    v_pk_mul_f32 v[206:207], v[206:207], v[18:19]
    v_pk_mul_f32 v[212:213], v[212:213], v[18:19]
    v_pk_mul_f32 v[214:215], v[214:215], v[18:19]
    v_pk_mul_f32 v[220:221], v[220:221], v[18:19]
    v_pk_mul_f32 v[222:223], v[222:223], v[18:19]
    v_pk_mul_f32 v[228:229], v[228:229], v[18:19]
    v_pk_mul_f32 v[230:231], v[230:231], v[18:19]
    v_pk_mul_f32 v[236:237], v[236:237], v[18:19]
    v_pk_mul_f32 v[238:239], v[238:239], v[18:19]
    v_pk_mul_f32 v[244:245], v[244:245], v[18:19]
    v_pk_mul_f32 v[246:247], v[246:247], v[18:19]
    v_pk_mul_f32 v[252:253], v[252:253], v[18:19]
    v_pk_mul_f32 v[254:255], v[254:255], v[18:19]
    s_waitcnt lgkmcnt(14)
    s_barrier
    ds_read_b128 v[224:227], v21 offset:0
    ds_read_b128 v[232:235], v21 offset:1024
    ds_read_b128 v[240:243], v21 offset:2048
    ds_read_b128 v[248:251], v21 offset:3072
    s_waitcnt lgkmcnt(14)
    v_mfma_f32_16x16x32_bf16 v[128:131], v[40:43], v[24:27], 0
    s_waitcnt lgkmcnt(12)
    v_mfma_f32_16x16x32_bf16 v[132:135], v[44:47], v[24:27], 0
    s_waitcnt lgkmcnt(10)
    v_mfma_f32_16x16x32_bf16 v[136:139], v[48:51], v[24:27], 0
    s_waitcnt lgkmcnt(8)
    v_mfma_f32_16x16x32_bf16 v[140:143], v[52:55], v[24:27], 0
    s_waitcnt vmcnt(4) lgkmcnt(0)
    s_barrier
    ds_read_b64_tr_b16 v[76:77], v107 offset:0
    v_mfma_f32_16x16x32_bf16 v[144:147], v[56:59], v[24:27], 0
    ds_read_b64_tr_b16 v[78:79], v107 offset:5120
    v_lshlrev_b32 v9, 16, v224
    v_and_b32 v10, s34, v224
    v_fma_f32 v196, v9, v16, v196
    v_fma_f32 v197, v10, v16, v197
    v_lshlrev_b32 v9, 16, v225
    v_and_b32 v10, s34, v225
    v_fma_f32 v198, v9, v16, v198
    v_fma_f32 v199, v10, v16, v199
    v_mfma_f32_16x16x32_bf16 v[148:151], v[40:43], v[28:31], 0
    ds_read_b128 v[60:63], v104 offset:0
    v_lshlrev_b32 v9, 16, v226
    v_and_b32 v10, s34, v226
    v_fma_f32 v204, v9, v16, v204
    v_fma_f32 v205, v10, v16, v205
    v_lshlrev_b32 v9, 16, v227
    v_and_b32 v10, s34, v227
    v_fma_f32 v206, v9, v16, v206
    v_mfma_f32_16x16x32_bf16 v[152:155], v[44:47], v[28:31], 0
    ds_read_b64_tr_b16 v[80:81], v108 offset:32
    v_fma_f32 v207, v10, v16, v207
    v_cvt_pk_bf16_f32 v208, v196, v197
    v_cvt_pk_bf16_f32 v209, v198, v199
    v_cvt_pk_bf16_f32 v210, v204, v205
    v_cvt_pk_bf16_f32 v211, v206, v207
    buffer_store_dwordx4 v[208:211], v4, s[8:11], s57 offen offset:0 sc1
    v_lshlrev_b32 v9, 16, v232
    v_mfma_f32_16x16x32_bf16 v[156:159], v[48:51], v[28:31], 0
    ds_read_b64_tr_b16 v[82:83], v108 offset:5152
    v_and_b32 v10, s34, v232
    v_fma_f32 v212, v9, v16, v212
    v_fma_f32 v213, v10, v16, v213
    v_lshlrev_b32 v9, 16, v233
    v_and_b32 v10, s34, v233
    v_fma_f32 v214, v9, v16, v214
    v_fma_f32 v215, v10, v16, v215
    v_mfma_f32_16x16x32_bf16 v[160:163], v[52:55], v[28:31], 0
    ds_read_b64_tr_b16 v[84:85], v107 offset:64
    v_lshlrev_b32 v9, 16, v234
    v_and_b32 v10, s34, v234
    v_fma_f32 v220, v9, v16, v220
    v_fma_f32 v221, v10, v16, v221
    v_lshlrev_b32 v9, 16, v235
    v_and_b32 v10, s34, v235
    v_fma_f32 v222, v9, v16, v222
    v_mfma_f32_16x16x32_bf16 v[164:167], v[56:59], v[28:31], 0
    ds_read_b64_tr_b16 v[86:87], v107 offset:5184
    v_fma_f32 v223, v10, v16, v223
    v_cvt_pk_bf16_f32 v216, v212, v213
    v_cvt_pk_bf16_f32 v217, v214, v215
    v_cvt_pk_bf16_f32 v218, v220, v221
    v_cvt_pk_bf16_f32 v219, v222, v223
    buffer_store_dwordx4 v[216:219], v4, s[8:11], s57 offen offset:1024 sc1
    v_lshlrev_b32 v9, 16, v240
    v_mfma_f32_16x16x32_bf16 v[168:171], v[40:43], v[32:35], 0
    ds_read_b64_tr_b16 v[88:89], v108 offset:96
    v_and_b32 v10, s34, v240
    v_fma_f32 v228, v9, v16, v228
    v_fma_f32 v229, v10, v16, v229
    v_lshlrev_b32 v9, 16, v241
    v_and_b32 v10, s34, v241
    v_fma_f32 v230, v9, v16, v230
    v_fma_f32 v231, v10, v16, v231
    v_mfma_f32_16x16x32_bf16 v[172:175], v[44:47], v[32:35], 0
    ds_read_b64_tr_b16 v[90:91], v108 offset:5216
    v_lshlrev_b32 v9, 16, v242
    v_and_b32 v10, s34, v242
    v_fma_f32 v236, v9, v16, v236
    v_fma_f32 v237, v10, v16, v237
    v_lshlrev_b32 v9, 16, v243
    v_and_b32 v10, s34, v243
    v_fma_f32 v238, v9, v16, v238
    v_mfma_f32_16x16x32_bf16 v[176:179], v[48:51], v[32:35], 0
    ds_read_b64_tr_b16 v[92:93], v107 offset:128
    v_fma_f32 v239, v10, v16, v239
    v_cvt_pk_bf16_f32 v208, v228, v229
    v_cvt_pk_bf16_f32 v209, v230, v231
    v_cvt_pk_bf16_f32 v210, v236, v237
    v_cvt_pk_bf16_f32 v211, v238, v239
    s_add_u32 s57, s57, 16384
    buffer_store_dwordx4 v[208:211], v4, s[8:11], s57 offen offset:0 sc1
    v_mfma_f32_16x16x32_bf16 v[180:183], v[52:55], v[32:35], 0
    ds_read_b64_tr_b16 v[94:95], v107 offset:5248
    v_lshlrev_b32 v9, 16, v248
    v_and_b32 v10, s34, v248
    v_fma_f32 v244, v9, v16, v244
    v_fma_f32 v245, v10, v16, v245
    v_lshlrev_b32 v9, 16, v249
    v_and_b32 v10, s34, v249
    v_fma_f32 v246, v9, v16, v246
    v_mfma_f32_16x16x32_bf16 v[184:187], v[56:59], v[32:35], 0
    ds_read_b128 v[64:67], v104 offset:2048
    v_fma_f32 v247, v10, v16, v247
    v_lshlrev_b32 v9, 16, v250
    v_and_b32 v10, s34, v250
    v_fma_f32 v252, v9, v16, v252
    v_fma_f32 v253, v10, v16, v253
    v_lshlrev_b32 v9, 16, v251
    v_and_b32 v10, s34, v251
    v_mfma_f32_16x16x32_bf16 v[188:191], v[40:43], v[36:39], 0
    ds_read_b128 v[68:71], v104 offset:4096
    v_fma_f32 v254, v9, v16, v254
    v_fma_f32 v255, v10, v16, v255
    v_cvt_pk_bf16_f32 v216, v244, v245
    v_cvt_pk_bf16_f32 v217, v246, v247
    v_cvt_pk_bf16_f32 v218, v252, v253
    v_cvt_pk_bf16_f32 v219, v254, v255
    buffer_store_dwordx4 v[216:219], v4, s[8:11], s57 offen offset:1024 sc1
    v_mfma_f32_16x16x32_bf16 v[192:195], v[44:47], v[36:39], 0
    ds_read_b128 v[72:75], v104 offset:6144
    s_add_u32 m0, s70, 32768
    s_nop 0
    buffer_load_dwordx4 v4, s[8:11], s63 offen offset:0 sc1 lds
    v_mfma_f32_16x16x32_bf16 v[196:199], v[48:51], v[36:39], 0
    buffer_load_dwordx4 v4, s[8:11], s63 offen offset:1024 sc1 lds
    v_mfma_f32_16x16x32_bf16 v[200:203], v[52:55], v[36:39], 0
    buffer_load_dwordx4 v4, s[8:11], s63 offen offset:2048 sc1 lds
    v_mfma_f32_16x16x32_bf16 v[204:207], v[56:59], v[36:39], 0
    buffer_load_dwordx4 v4, s[8:11], s63 offen offset:3072 sc1 lds
    s_add_u32 s63, s63, 16384
    s_waitcnt lgkmcnt(10)
    v_mfma_f32_16x16x32_bf16 v[128:131], v[76:79], v[60:63], v[128:131]
    s_waitcnt lgkmcnt(8)
    v_mfma_f32_16x16x32_bf16 v[132:135], v[80:83], v[60:63], v[132:135]
    s_waitcnt lgkmcnt(6)
    v_mfma_f32_16x16x32_bf16 v[136:139], v[84:87], v[60:63], v[136:139]
    s_waitcnt vmcnt(8) lgkmcnt(0)
    s_barrier
    ds_read_b64_tr_b16 v[40:41], v109 offset:0
    v_mfma_f32_16x16x32_bf16 v[140:143], v[88:91], v[60:63], v[140:143]
    ds_read_b64_tr_b16 v[42:43], v109 offset:5120
    s_add_u32 m0, s64, 0
    s_nop 0
    buffer_load_dwordx4 v4, s[8:11], s63 offen offset:0 sc1 lds
    v_mfma_f32_16x16x32_bf16 v[144:147], v[92:95], v[60:63], v[144:147]
    ds_read_b128 v[24:27], v105 offset:0
    buffer_load_dwordx4 v4, s[8:11], s63 offen offset:1024 sc1 lds
    v_mfma_f32_16x16x32_bf16 v[148:151], v[76:79], v[64:67], v[148:151]
    ds_read_b64_tr_b16 v[44:45], v110 offset:32
    v_mfma_f32_16x16x32_bf16 v[152:155], v[80:83], v[64:67], v[152:155]
    ds_read_b64_tr_b16 v[46:47], v110 offset:5152
    buffer_load_dwordx4 v4, s[8:11], s63 offen offset:2048 sc1 lds
    v_mfma_f32_16x16x32_bf16 v[156:159], v[84:87], v[64:67], v[156:159]
    ds_read_b64_tr_b16 v[48:49], v109 offset:64
    v_mfma_f32_16x16x32_bf16 v[160:163], v[88:91], v[64:67], v[160:163]
    ds_read_b64_tr_b16 v[50:51], v109 offset:5184
    buffer_load_dwordx4 v4, s[8:11], s63 offen offset:3072 sc1 lds
    s_add_u32 s63, s63, 16384
    v_mfma_f32_16x16x32_bf16 v[164:167], v[92:95], v[64:67], v[164:167]
    v_mfma_f32_16x16x32_bf16 v[168:171], v[76:79], v[68:71], v[168:171]
    ds_read_b64_tr_b16 v[52:53], v110 offset:96
    s_add_u32 m0, s64, 16384
    s_nop 0
    buffer_load_dwordx4 v4, s[8:11], s63 offen offset:0 sc1 lds
    v_mfma_f32_16x16x32_bf16 v[172:175], v[80:83], v[68:71], v[172:175]
    ds_read_b64_tr_b16 v[54:55], v110 offset:5216
    buffer_load_dwordx4 v4, s[8:11], s63 offen offset:1024 sc1 lds
    v_mfma_f32_16x16x32_bf16 v[176:179], v[84:87], v[68:71], v[176:179]
    ds_read_b64_tr_b16 v[56:57], v109 offset:128
    v_mfma_f32_16x16x32_bf16 v[180:183], v[88:91], v[68:71], v[180:183]
    ds_read_b64_tr_b16 v[58:59], v109 offset:5248
    buffer_load_dwordx4 v4, s[8:11], s63 offen offset:2048 sc1 lds
    v_mfma_f32_16x16x32_bf16 v[184:187], v[92:95], v[68:71], v[184:187]
    ds_read_b128 v[28:31], v105 offset:2048
    v_mfma_f32_16x16x32_bf16 v[188:191], v[76:79], v[72:75], v[188:191]
    ds_read_b128 v[32:35], v105 offset:4096
    buffer_load_dwordx4 v4, s[8:11], s63 offen offset:3072 sc1 lds
    s_add_u32 s63, s63, 16384
    v_mfma_f32_16x16x32_bf16 v[192:195], v[80:83], v[72:75], v[192:195]
    ds_read_b128 v[36:39], v105 offset:6144
    v_mfma_f32_16x16x32_bf16 v[196:199], v[84:87], v[72:75], v[196:199]
    v_mfma_f32_16x16x32_bf16 v[200:203], v[88:91], v[72:75], v[200:203]
    v_mfma_f32_16x16x32_bf16 v[204:207], v[92:95], v[72:75], v[204:207]
    s_waitcnt lgkmcnt(10)
    v_mfma_f32_16x16x32_bf16 v[128:131], v[40:43], v[24:27], v[128:131]
    s_waitcnt lgkmcnt(8)
    v_mfma_f32_16x16x32_bf16 v[132:135], v[44:47], v[24:27], v[132:135]
    s_waitcnt lgkmcnt(6)
    v_mfma_f32_16x16x32_bf16 v[136:139], v[48:51], v[24:27], v[136:139]
    s_waitcnt vmcnt(12)
    s_waitcnt vmcnt(8) lgkmcnt(0)
    s_barrier
    ds_read_b64_tr_b16 v[76:77], v111 offset:0
    v_mfma_f32_16x16x32_bf16 v[140:143], v[52:55], v[24:27], v[140:143]
    ds_read_b64_tr_b16 v[78:79], v111 offset:5120
    s_cmp_eq_u32 s60, 3
    s_cselect_b32 s63, 0x70000000, s63
    s_add_u32 m0, s69, 32768
    s_nop 0
    buffer_load_dwordx4 v4, s[8:11], s63 offen offset:0 sc1 lds
    v_mfma_f32_16x16x32_bf16 v[144:147], v[56:59], v[24:27], v[144:147]
    ds_read_b128 v[60:63], v106 offset:0
    v_mfma_f32_16x16x32_bf16 v[148:151], v[40:43], v[28:31], v[148:151]
    ds_read_b64_tr_b16 v[80:81], v112 offset:32
    v_mfma_f32_16x16x32_bf16 v[152:155], v[44:47], v[28:31], v[152:155]
    ds_read_b64_tr_b16 v[82:83], v112 offset:5152
    buffer_load_dwordx4 v4, s[8:11], s63 offen offset:1024 sc1 lds
    v_mfma_f32_16x16x32_bf16 v[156:159], v[48:51], v[28:31], v[156:159]
    ds_read_b64_tr_b16 v[84:85], v111 offset:64
    v_mfma_f32_16x16x32_bf16 v[160:163], v[52:55], v[28:31], v[160:163]
    ds_read_b64_tr_b16 v[86:87], v111 offset:5184
    v_mfma_f32_16x16x32_bf16 v[164:167], v[56:59], v[28:31], v[164:167]
    v_mfma_f32_16x16x32_bf16 v[168:171], v[40:43], v[32:35], v[168:171]
    ds_read_b64_tr_b16 v[88:89], v112 offset:96
    buffer_load_dwordx4 v4, s[8:11], s63 offen offset:2048 sc1 lds
    v_mfma_f32_16x16x32_bf16 v[172:175], v[44:47], v[32:35], v[172:175]
    ds_read_b64_tr_b16 v[90:91], v112 offset:5216
    v_mfma_f32_16x16x32_bf16 v[176:179], v[48:51], v[32:35], v[176:179]
    ds_read_b64_tr_b16 v[92:93], v111 offset:128
    v_mfma_f32_16x16x32_bf16 v[180:183], v[52:55], v[32:35], v[180:183]
    ds_read_b64_tr_b16 v[94:95], v111 offset:5248
    buffer_load_dwordx4 v4, s[8:11], s63 offen offset:3072 sc1 lds
    s_add_u32 s63, s63, 16384
    v_mfma_f32_16x16x32_bf16 v[184:187], v[56:59], v[32:35], v[184:187]
    ds_read_b128 v[64:67], v106 offset:2048
    v_mfma_f32_16x16x32_bf16 v[188:191], v[40:43], v[36:39], v[188:191]
    ds_read_b128 v[68:71], v106 offset:4096
    v_mfma_f32_16x16x32_bf16 v[192:195], v[44:47], v[36:39], v[192:195]
    ds_read_b128 v[72:75], v106 offset:6144
    v_mfma_f32_16x16x32_bf16 v[196:199], v[48:51], v[36:39], v[196:199]
    v_mfma_f32_16x16x32_bf16 v[200:203], v[52:55], v[36:39], v[200:203]
    v_mfma_f32_16x16x32_bf16 v[204:207], v[56:59], v[36:39], v[204:207]
    s_waitcnt lgkmcnt(10)
    v_mfma_f32_16x16x32_bf16 v[128:131], v[76:79], v[60:63], v[128:131]
    s_waitcnt lgkmcnt(8)
    v_mfma_f32_16x16x32_bf16 v[132:135], v[80:83], v[60:63], v[132:135]
    s_waitcnt lgkmcnt(6)
    v_mfma_f32_16x16x32_bf16 v[136:139], v[84:87], v[60:63], v[136:139]
    s_waitcnt vmcnt(8) lgkmcnt(0)
    s_barrier
    ds_read_b64_tr_b16 v[40:41], v102 offset:0
    v_mfma_f32_16x16x32_bf16 v[140:143], v[88:91], v[60:63], v[140:143]
    ds_read_b64_tr_b16 v[42:43], v102 offset:5120
    v_mfma_f32_16x16x32_bf16 v[144:147], v[92:95], v[60:63], v[144:147]
    ds_read_b128 v[24:27], v101 offset:0
    v_mfma_f32_16x16x32_bf16 v[148:151], v[76:79], v[64:67], v[148:151]
    ds_read_b64_tr_b16 v[44:45], v103 offset:32
    v_mfma_f32_16x16x32_bf16 v[152:155], v[80:83], v[64:67], v[152:155]
    ds_read_b64_tr_b16 v[46:47], v103 offset:5152
    v_mfma_f32_16x16x32_bf16 v[156:159], v[84:87], v[64:67], v[156:159]
    ds_read_b64_tr_b16 v[48:49], v102 offset:64
    v_mfma_f32_16x16x32_bf16 v[160:163], v[88:91], v[64:67], v[160:163]
    ds_read_b64_tr_b16 v[50:51], v102 offset:5184
    v_mfma_f32_16x16x32_bf16 v[164:167], v[92:95], v[64:67], v[164:167]
    v_mfma_f32_16x16x32_bf16 v[168:171], v[76:79], v[68:71], v[168:171]
    ds_read_b64_tr_b16 v[52:53], v103 offset:96
    v_mfma_f32_16x16x32_bf16 v[172:175], v[80:83], v[68:71], v[172:175]
    ds_read_b64_tr_b16 v[54:55], v103 offset:5216
    v_mfma_f32_16x16x32_bf16 v[176:179], v[84:87], v[68:71], v[176:179]
    ds_read_b64_tr_b16 v[56:57], v102 offset:128
    v_mfma_f32_16x16x32_bf16 v[180:183], v[88:91], v[68:71], v[180:183]
    ds_read_b64_tr_b16 v[58:59], v102 offset:5248
    v_mfma_f32_16x16x32_bf16 v[184:187], v[92:95], v[68:71], v[184:187]
    ds_read_b128 v[28:31], v101 offset:2048
    v_mfma_f32_16x16x32_bf16 v[188:191], v[76:79], v[72:75], v[188:191]
    ds_read_b128 v[32:35], v101 offset:4096
    s_mov_b32 exec_lo, 0x0
    s_mov_b32 exec_hi, 0xf
    buffer_load_dword v122, v1, s[8:11], 0 offen sc1
    s_mov_b64 exec, -1
    v_mfma_f32_16x16x32_bf16 v[192:195], v[80:83], v[72:75], v[192:195]
    ds_read_b128 v[36:39], v101 offset:6144
    v_mfma_f32_16x16x32_bf16 v[196:199], v[84:87], v[72:75], v[196:199]
    v_mfma_f32_16x16x32_bf16 v[200:203], v[88:91], v[72:75], v[200:203]
    v_mfma_f32_16x16x32_bf16 v[204:207], v[92:95], v[72:75], v[204:207]
    s_waitcnt lgkmcnt(10)
    v_mfma_f32_16x16x32_bf16 v[128:131], v[40:43], v[24:27], v[128:131]
    s_waitcnt lgkmcnt(8)
    v_mfma_f32_16x16x32_bf16 v[132:135], v[44:47], v[24:27], v[132:135]
    s_waitcnt lgkmcnt(6)
    v_mfma_f32_16x16x32_bf16 v[136:139], v[48:51], v[24:27], v[136:139]
    s_waitcnt vmcnt(5) lgkmcnt(0)
    s_barrier
    ds_read_b64_tr_b16 v[76:77], v107 offset:0
    v_mfma_f32_16x16x32_bf16 v[140:143], v[52:55], v[24:27], v[140:143]
    ds_read_b64_tr_b16 v[78:79], v107 offset:5120
    v_mfma_f32_16x16x32_bf16 v[144:147], v[56:59], v[24:27], v[144:147]
    ds_read_b128 v[60:63], v104 offset:0
    v_mfma_f32_16x16x32_bf16 v[148:151], v[40:43], v[28:31], v[148:151]
    ds_read_b64_tr_b16 v[80:81], v108 offset:32
    v_mfma_f32_16x16x32_bf16 v[152:155], v[44:47], v[28:31], v[152:155]
    ds_read_b64_tr_b16 v[82:83], v108 offset:5152
    v_mfma_f32_16x16x32_bf16 v[156:159], v[48:51], v[28:31], v[156:159]
    ds_read_b64_tr_b16 v[84:85], v107 offset:64
    v_mfma_f32_16x16x32_bf16 v[160:163], v[52:55], v[28:31], v[160:163]
    ds_read_b64_tr_b16 v[86:87], v107 offset:5184
    s_waitcnt vmcnt(0)
    s_add_u32 s26, s38, 4
    v_subrev_u32 v122, s26, v122
    v_cmp_le_u32 vcc, 4, v122
    s_mov_b32 s26, 0x0
    s_mov_b32 s27, 0xf
    s_and_b64 vcc, s[26:27], vcc
    v_mfma_f32_16x16x32_bf16 v[164:167], v[56:59], v[28:31], v[164:167]
    s_cbranch_vccnz VR118
    s_add_u32 m0, s70, 32768
    s_nop 0
    buffer_load_dwordx4 v4, s[8:11], s65 offen offset:0 sc1 lds
VR118:
    v_mfma_f32_16x16x32_bf16 v[168:171], v[40:43], v[32:35], v[168:171]
    ds_read_b64_tr_b16 v[88:89], v108 offset:96
    s_cbranch_vccnz VR119
    buffer_load_dwordx4 v4, s[8:11], s65 offen offset:1024 sc1 lds
VR119:
    v_mfma_f32_16x16x32_bf16 v[172:175], v[44:47], v[32:35], v[172:175]
    ds_read_b64_tr_b16 v[90:91], v108 offset:5216
    s_cbranch_vccnz VR120
    buffer_load_dwordx4 v4, s[8:11], s65 offen offset:2048 sc1 lds
VR120:
    v_mfma_f32_16x16x32_bf16 v[176:179], v[48:51], v[32:35], v[176:179]
    ds_read_b64_tr_b16 v[92:93], v107 offset:128
    s_cbranch_vccnz VR121
    buffer_load_dwordx4 v4, s[8:11], s65 offen offset:3072 sc1 lds
    s_add_u32 s65, s65, 16384
VR121:
    v_mfma_f32_16x16x32_bf16 v[180:183], v[52:55], v[32:35], v[180:183]
    ds_read_b64_tr_b16 v[94:95], v107 offset:5248
    s_cbranch_vccnz VR122
    s_add_u32 m0, s64, 0
    s_nop 0
    buffer_load_dwordx4 v4, s[8:11], s65 offen offset:0 sc1 lds
VR122:
    v_mfma_f32_16x16x32_bf16 v[184:187], v[56:59], v[32:35], v[184:187]
    ds_read_b128 v[64:67], v104 offset:2048
    s_cbranch_vccnz VR123
    buffer_load_dwordx4 v4, s[8:11], s65 offen offset:1024 sc1 lds
VR123:
    v_mfma_f32_16x16x32_bf16 v[188:191], v[40:43], v[36:39], v[188:191]
    ds_read_b128 v[68:71], v104 offset:4096
    s_cbranch_vccnz VR124
    buffer_load_dwordx4 v4, s[8:11], s65 offen offset:2048 sc1 lds
VR124:
    v_mfma_f32_16x16x32_bf16 v[192:195], v[44:47], v[36:39], v[192:195]
    ds_read_b128 v[72:75], v104 offset:6144
    s_cbranch_vccnz VR125
    buffer_load_dwordx4 v4, s[8:11], s65 offen offset:3072 sc1 lds
    s_add_u32 s65, s65, 16384
VR125:
    v_mfma_f32_16x16x32_bf16 v[196:199], v[48:51], v[36:39], v[196:199]
    v_mfma_f32_16x16x32_bf16 v[200:203], v[52:55], v[36:39], v[200:203]
    v_mfma_f32_16x16x32_bf16 v[204:207], v[56:59], v[36:39], v[204:207]
    s_waitcnt lgkmcnt(10)
    v_mfma_f32_16x16x32_bf16 v[128:131], v[76:79], v[60:63], v[128:131]
    s_waitcnt lgkmcnt(8)
    v_mfma_f32_16x16x32_bf16 v[132:135], v[80:83], v[60:63], v[132:135]
    s_waitcnt lgkmcnt(6)
    v_mfma_f32_16x16x32_bf16 v[136:139], v[84:87], v[60:63], v[136:139]
    s_waitcnt vmcnt(9) lgkmcnt(0)
    s_cbranch_vccz VR131
    s_waitcnt vmcnt(1)
VR131:
    s_barrier
    ds_read_b64_tr_b16 v[40:41], v109 offset:0
    v_mfma_f32_16x16x32_bf16 v[140:143], v[88:91], v[60:63], v[140:143]
    ds_read_b64_tr_b16 v[42:43], v109 offset:5120
    s_cbranch_vccnz VR126
    s_add_u32 m0, s64, 16384
    s_nop 0
    buffer_load_dwordx4 v4, s[8:11], s65 offen offset:0 sc1 lds
VR126:
    v_mfma_f32_16x16x32_bf16 v[144:147], v[92:95], v[60:63], v[144:147]
    ds_read_b128 v[24:27], v105 offset:0
    v_mfma_f32_16x16x32_bf16 v[148:151], v[76:79], v[64:67], v[148:151]
    ds_read_b64_tr_b16 v[44:45], v110 offset:32
    v_mfma_f32_16x16x32_bf16 v[152:155], v[80:83], v[64:67], v[152:155]
    ds_read_b64_tr_b16 v[46:47], v110 offset:5152
    s_cbranch_vccnz VR127
    buffer_load_dwordx4 v4, s[8:11], s65 offen offset:1024 sc1 lds
VR127:
    v_mfma_f32_16x16x32_bf16 v[156:159], v[84:87], v[64:67], v[156:159]
    ds_read_b64_tr_b16 v[48:49], v109 offset:64
    v_mfma_f32_16x16x32_bf16 v[160:163], v[88:91], v[64:67], v[160:163]
    ds_read_b64_tr_b16 v[50:51], v109 offset:5184
    v_mfma_f32_16x16x32_bf16 v[164:167], v[92:95], v[64:67], v[164:167]
    v_mfma_f32_16x16x32_bf16 v[168:171], v[76:79], v[68:71], v[168:171]
    ds_read_b64_tr_b16 v[52:53], v110 offset:96
    s_cbranch_vccnz VR128
    buffer_load_dwordx4 v4, s[8:11], s65 offen offset:2048 sc1 lds
VR128:
    v_mfma_f32_16x16x32_bf16 v[172:175], v[80:83], v[68:71], v[172:175]
    ds_read_b64_tr_b16 v[54:55], v110 offset:5216
    v_mfma_f32_16x16x32_bf16 v[176:179], v[84:87], v[68:71], v[176:179]
    ds_read_b64_tr_b16 v[56:57], v109 offset:128
    v_mfma_f32_16x16x32_bf16 v[180:183], v[88:91], v[68:71], v[180:183]
    ds_read_b64_tr_b16 v[58:59], v109 offset:5248
    s_cbranch_vccnz VR129
    buffer_load_dwordx4 v4, s[8:11], s65 offen offset:3072 sc1 lds
    s_add_u32 s65, s65, 16384
VR129:
    v_mfma_f32_16x16x32_bf16 v[184:187], v[92:95], v[68:71], v[184:187]
    ds_read_b128 v[28:31], v105 offset:2048
    v_mfma_f32_16x16x32_bf16 v[188:191], v[76:79], v[72:75], v[188:191]
    ds_read_b128 v[32:35], v105 offset:4096
    v_mfma_f32_16x16x32_bf16 v[192:195], v[80:83], v[72:75], v[192:195]
    ds_read_b128 v[36:39], v105 offset:6144
    v_mfma_f32_16x16x32_bf16 v[196:199], v[84:87], v[72:75], v[196:199]
    v_mfma_f32_16x16x32_bf16 v[200:203], v[88:91], v[72:75], v[200:203]
    v_mfma_f32_16x16x32_bf16 v[204:207], v[92:95], v[72:75], v[204:207]
    s_waitcnt lgkmcnt(10)
    v_mfma_f32_16x16x32_bf16 v[128:131], v[40:43], v[24:27], v[128:131]
    s_waitcnt lgkmcnt(8)
    v_mfma_f32_16x16x32_bf16 v[132:135], v[44:47], v[24:27], v[132:135]
    s_waitcnt lgkmcnt(6)
    v_mfma_f32_16x16x32_bf16 v[136:139], v[48:51], v[24:27], v[136:139]
    s_cbranch_vccz VR130
    s_branch PL3_S
PL3_C:
    s_mov_b64 vcc, -1
    s_add_u32 m0, s70, 32768
    s_nop 0
    buffer_load_dwordx4 v4, s[8:11], s65 offen offset:0 sc1 lds
    buffer_load_dwordx4 v4, s[8:11], s65 offen offset:1024 sc1 lds
    buffer_load_dwordx4 v4, s[8:11], s65 offen offset:2048 sc1 lds
    buffer_load_dwordx4 v4, s[8:11], s65 offen offset:3072 sc1 lds
    s_add_u32 s65, s65, 16384
    s_add_u32 m0, s64, 0
    s_nop 0
    buffer_load_dwordx4 v4, s[8:11], s65 offen offset:0 sc1 lds
    buffer_load_dwordx4 v4, s[8:11], s65 offen offset:1024 sc1 lds
    buffer_load_dwordx4 v4, s[8:11], s65 offen offset:2048 sc1 lds
    buffer_load_dwordx4 v4, s[8:11], s65 offen offset:3072 sc1 lds
    s_add_u32 s65, s65, 16384
    s_add_u32 m0, s64, 16384
    s_nop 0
    buffer_load_dwordx4 v4, s[8:11], s65 offen offset:0 sc1 lds
    buffer_load_dwordx4 v4, s[8:11], s65 offen offset:1024 sc1 lds
    buffer_load_dwordx4 v4, s[8:11], s65 offen offset:2048 sc1 lds
    buffer_load_dwordx4 v4, s[8:11], s65 offen offset:3072 sc1 lds
    s_add_u32 s65, s65, 16384
VR130:
    s_waitcnt vmcnt(8) lgkmcnt(0)
    s_barrier
    ds_read_b64_tr_b16 v[76:77], v111 offset:0
    v_mfma_f32_16x16x32_bf16 v[140:143], v[52:55], v[24:27], v[140:143]
    ds_read_b64_tr_b16 v[78:79], v111 offset:5120
    s_add_u32 m0, s69, 32768
    s_nop 0
    buffer_load_dwordx4 v4, s[8:11], s65 offen offset:0 sc1 lds
    v_mfma_f32_16x16x32_bf16 v[144:147], v[56:59], v[24:27], v[144:147]
    ds_read_b128 v[60:63], v106 offset:0
    v_mfma_f32_16x16x32_bf16 v[148:151], v[40:43], v[28:31], v[148:151]
    ds_read_b64_tr_b16 v[80:81], v112 offset:32
    v_mfma_f32_16x16x32_bf16 v[152:155], v[44:47], v[28:31], v[152:155]
    ds_read_b64_tr_b16 v[82:83], v112 offset:5152
    buffer_load_dwordx4 v4, s[8:11], s65 offen offset:1024 sc1 lds
    v_mfma_f32_16x16x32_bf16 v[156:159], v[48:51], v[28:31], v[156:159]
    ds_read_b64_tr_b16 v[84:85], v111 offset:64
    v_mfma_f32_16x16x32_bf16 v[160:163], v[52:55], v[28:31], v[160:163]
    ds_read_b64_tr_b16 v[86:87], v111 offset:5184
    v_mfma_f32_16x16x32_bf16 v[164:167], v[56:59], v[28:31], v[164:167]
    v_mfma_f32_16x16x32_bf16 v[168:171], v[40:43], v[32:35], v[168:171]
    ds_read_b64_tr_b16 v[88:89], v112 offset:96
    buffer_load_dwordx4 v4, s[8:11], s65 offen offset:2048 sc1 lds
    v_mfma_f32_16x16x32_bf16 v[172:175], v[44:47], v[32:35], v[172:175]
    ds_read_b64_tr_b16 v[90:91], v112 offset:5216
    v_mfma_f32_16x16x32_bf16 v[176:179], v[48:51], v[32:35], v[176:179]
    ds_read_b64_tr_b16 v[92:93], v111 offset:128
    v_mfma_f32_16x16x32_bf16 v[180:183], v[52:55], v[32:35], v[180:183]
    ds_read_b64_tr_b16 v[94:95], v111 offset:5248
    buffer_load_dwordx4 v4, s[8:11], s65 offen offset:3072 sc1 lds
    s_add_u32 s65, s65, 16384
    v_mfma_f32_16x16x32_bf16 v[184:187], v[56:59], v[32:35], v[184:187]
    ds_read_b128 v[64:67], v106 offset:2048
    v_mfma_f32_16x16x32_bf16 v[188:191], v[40:43], v[36:39], v[188:191]
    ds_read_b128 v[68:71], v106 offset:4096
    v_mfma_f32_16x16x32_bf16 v[192:195], v[44:47], v[36:39], v[192:195]
    ds_read_b128 v[72:75], v106 offset:6144
    v_mfma_f32_16x16x32_bf16 v[196:199], v[48:51], v[36:39], v[196:199]
    v_mul_f32 v128, v128, v113
    v_mul_f32 v129, v129, v113
    v_mul_f32 v130, v130, v113
    v_mul_f32 v131, v131, v113
    v_mfma_f32_16x16x32_bf16 v[200:203], v[52:55], v[36:39], v[200:203]
    v_mul_f32 v132, v132, v113
    v_mul_f32 v133, v133, v113
    v_mul_f32 v134, v134, v113
    v_mul_f32 v135, v135, v113
    v_mfma_f32_16x16x32_bf16 v[204:207], v[56:59], v[36:39], v[204:207]
    v_mul_f32 v136, v136, v113
    v_mul_f32 v137, v137, v113
    v_mul_f32 v138, v138, v113
    v_mul_f32 v139, v139, v113
    s_waitcnt lgkmcnt(10)
    v_mfma_f32_16x16x32_bf16 v[128:131], v[76:79], v[60:63], v[128:131]
    v_mul_f32 v140, v140, v113
    v_mul_f32 v141, v141, v113
    v_mul_f32 v142, v142, v113
    v_mul_f32 v143, v143, v113
    s_waitcnt lgkmcnt(8)
    v_mfma_f32_16x16x32_bf16 v[132:135], v[80:83], v[60:63], v[132:135]
    v_mul_f32 v144, v144, v113
    v_mul_f32 v145, v145, v113
    v_mul_f32 v146, v146, v113
    v_mul_f32 v147, v147, v113
    s_waitcnt lgkmcnt(6)
    v_mfma_f32_16x16x32_bf16 v[136:139], v[84:87], v[60:63], v[136:139]
    s_waitcnt vmcnt(8) lgkmcnt(0)
    s_barrier
    ds_read_b64_tr_b16 v[40:41], v102 offset:0
    v_mul_f32 v148, v148, v114
    v_mul_f32 v149, v149, v114
    v_mul_f32 v150, v150, v114
    v_mul_f32 v151, v151, v114
    v_mfma_f32_16x16x32_bf16 v[140:143], v[88:91], v[60:63], v[140:143]
    ds_read_b64_tr_b16 v[42:43], v102 offset:5120
    s_add_u32 m0, s70, 32768
    s_nop 0
    buffer_load_dwordx4 v4, s[8:11], s65 offen offset:0 sc1 lds
    v_mul_f32 v152, v152, v114
    v_mul_f32 v153, v153, v114
    v_mul_f32 v154, v154, v114
    v_mul_f32 v155, v155, v114
    v_mfma_f32_16x16x32_bf16 v[144:147], v[92:95], v[60:63], v[144:147]
    ds_read_b128 v[24:27], v101 offset:0
    v_mul_f32 v156, v156, v114
    v_mul_f32 v157, v157, v114
    v_mul_f32 v158, v158, v114
    v_mul_f32 v159, v159, v114
    v_mfma_f32_16x16x32_bf16 v[148:151], v[76:79], v[64:67], v[148:151]
    ds_read_b64_tr_b16 v[44:45], v103 offset:32
    v_mul_f32 v160, v160, v114
    v_mul_f32 v161, v161, v114
    v_mul_f32 v162, v162, v114
    v_mul_f32 v163, v163, v114
    v_mfma_f32_16x16x32_bf16 v[152:155], v[80:83], v[64:67], v[152:155]
    ds_read_b64_tr_b16 v[46:47], v103 offset:5152
    buffer_load_dwordx4 v4, s[8:11], s65 offen offset:1024 sc1 lds
    v_mul_f32 v164, v164, v114
    v_mul_f32 v165, v165, v114
    v_mul_f32 v166, v166, v114
    v_mul_f32 v167, v167, v114
    v_mfma_f32_16x16x32_bf16 v[156:159], v[84:87], v[64:67], v[156:159]
    ds_read_b64_tr_b16 v[48:49], v102 offset:64
    v_mul_f32 v168, v168, v115
    v_mul_f32 v169, v169, v115
    v_mul_f32 v170, v170, v115
    v_mul_f32 v171, v171, v115
    v_mfma_f32_16x16x32_bf16 v[160:163], v[88:91], v[64:67], v[160:163]
    ds_read_b64_tr_b16 v[50:51], v102 offset:5184
    v_mul_f32 v172, v172, v115
    v_mul_f32 v173, v173, v115
    v_mul_f32 v174, v174, v115
    v_mul_f32 v175, v175, v115
    v_mfma_f32_16x16x32_bf16 v[164:167], v[92:95], v[64:67], v[164:167]
    v_mul_f32 v176, v176, v115
    v_mul_f32 v177, v177, v115
    v_mul_f32 v178, v178, v115
    v_mul_f32 v179, v179, v115
    v_mfma_f32_16x16x32_bf16 v[168:171], v[76:79], v[68:71], v[168:171]
    ds_read_b64_tr_b16 v[52:53], v103 offset:96
    buffer_load_dwordx4 v4, s[8:11], s65 offen offset:2048 sc1 lds
    v_mul_f32 v180, v180, v115
    v_mul_f32 v181, v181, v115
    v_mul_f32 v182, v182, v115
    v_mul_f32 v183, v183, v115
    v_mfma_f32_16x16x32_bf16 v[172:175], v[80:83], v[68:71], v[172:175]
    ds_read_b64_tr_b16 v[54:55], v103 offset:5216
    v_mul_f32 v184, v184, v115
    v_mul_f32 v185, v185, v115
    v_mul_f32 v186, v186, v115
    v_mul_f32 v187, v187, v115
    v_mfma_f32_16x16x32_bf16 v[176:179], v[84:87], v[68:71], v[176:179]
    ds_read_b64_tr_b16 v[56:57], v102 offset:128
    v_mul_f32 v188, v188, v116
    v_mul_f32 v189, v189, v116
    v_mul_f32 v190, v190, v116
    v_mul_f32 v191, v191, v116
    v_mfma_f32_16x16x32_bf16 v[180:183], v[88:91], v[68:71], v[180:183]
    ds_read_b64_tr_b16 v[58:59], v102 offset:5248
    buffer_load_dwordx4 v4, s[8:11], s65 offen offset:3072 sc1 lds
    s_add_u32 s65, s65, 16384
    v_mul_f32 v192, v192, v116
    v_mul_f32 v193, v193, v116
    v_mul_f32 v194, v194, v116
    v_mul_f32 v195, v195, v116
    v_mfma_f32_16x16x32_bf16 v[184:187], v[92:95], v[68:71], v[184:187]
    ds_read_b128 v[28:31], v101 offset:2048
    v_mul_f32 v196, v196, v116
    v_mul_f32 v197, v197, v116
    v_mul_f32 v198, v198, v116
    v_mul_f32 v199, v199, v116
    v_mfma_f32_16x16x32_bf16 v[188:191], v[76:79], v[72:75], v[188:191]
    ds_read_b128 v[32:35], v101 offset:4096
    v_mul_f32 v200, v200, v116
    v_mul_f32 v201, v201, v116
    v_mul_f32 v202, v202, v116
    v_mul_f32 v203, v203, v116
    v_mfma_f32_16x16x32_bf16 v[192:195], v[80:83], v[72:75], v[192:195]
    ds_read_b128 v[36:39], v101 offset:6144
    v_mul_f32 v204, v204, v116
    v_mul_f32 v205, v205, v116
    v_mul_f32 v206, v206, v116
    v_mul_f32 v207, v207, v116
    v_mfma_f32_16x16x32_bf16 v[196:199], v[84:87], v[72:75], v[196:199]
    v_mfma_f32_16x16x32_bf16 v[200:203], v[88:91], v[72:75], v[200:203]
    v_mfma_f32_16x16x32_bf16 v[204:207], v[92:95], v[72:75], v[204:207]
    s_waitcnt lgkmcnt(10)
    v_mfma_f32_16x16x32_bf16 v[128:131], v[40:43], v[24:27], v[128:131]
    s_waitcnt lgkmcnt(8)
    v_mfma_f32_16x16x32_bf16 v[132:135], v[44:47], v[24:27], v[132:135]
    s_waitcnt lgkmcnt(6)
    v_mfma_f32_16x16x32_bf16 v[136:139], v[48:51], v[24:27], v[136:139]
    s_waitcnt vmcnt(8) lgkmcnt(0)
    s_barrier
    ds_read_b64_tr_b16 v[76:77], v107 offset:0
    v_mfma_f32_16x16x32_bf16 v[140:143], v[52:55], v[24:27], v[140:143]
    ds_read_b64_tr_b16 v[78:79], v107 offset:5120
    s_add_u32 m0, s64, 0
    s_nop 0
    buffer_load_dwordx4 v4, s[8:11], s65 offen offset:0 sc1 lds
    v_mfma_f32_16x16x32_bf16 v[144:147], v[56:59], v[24:27], v[144:147]
    ds_read_b128 v[60:63], v104 offset:0
    v_mfma_f32_16x16x32_bf16 v[148:151], v[40:43], v[28:31], v[148:151]
    ds_read_b64_tr_b16 v[80:81], v108 offset:32
    v_mfma_f32_16x16x32_bf16 v[152:155], v[44:47], v[28:31], v[152:155]
    ds_read_b64_tr_b16 v[82:83], v108 offset:5152
    buffer_load_dwordx4 v4, s[8:11], s65 offen offset:1024 sc1 lds
    v_mfma_f32_16x16x32_bf16 v[156:159], v[48:51], v[28:31], v[156:159]
    ds_read_b64_tr_b16 v[84:85], v107 offset:64
    v_mfma_f32_16x16x32_bf16 v[160:163], v[52:55], v[28:31], v[160:163]
    ds_read_b64_tr_b16 v[86:87], v107 offset:5184
    v_mfma_f32_16x16x32_bf16 v[164:167], v[56:59], v[28:31], v[164:167]
    v_mfma_f32_16x16x32_bf16 v[168:171], v[40:43], v[32:35], v[168:171]
    ds_read_b64_tr_b16 v[88:89], v108 offset:96
    buffer_load_dwordx4 v4, s[8:11], s65 offen offset:2048 sc1 lds
    v_mfma_f32_16x16x32_bf16 v[172:175], v[44:47], v[32:35], v[172:175]
    ds_read_b64_tr_b16 v[90:91], v108 offset:5216
    v_mfma_f32_16x16x32_bf16 v[176:179], v[48:51], v[32:35], v[176:179]
    ds_read_b64_tr_b16 v[92:93], v107 offset:128
    v_mfma_f32_16x16x32_bf16 v[180:183], v[52:55], v[32:35], v[180:183]
    ds_read_b64_tr_b16 v[94:95], v107 offset:5248
    buffer_load_dwordx4 v4, s[8:11], s65 offen offset:3072 sc1 lds
    s_add_u32 s65, s65, 16384
    v_mfma_f32_16x16x32_bf16 v[184:187], v[56:59], v[32:35], v[184:187]
    ds_read_b128 v[64:67], v104 offset:2048
    v_mfma_f32_16x16x32_bf16 v[188:191], v[40:43], v[36:39], v[188:191]
    ds_read_b128 v[68:71], v104 offset:4096
    v_mfma_f32_16x16x32_bf16 v[192:195], v[44:47], v[36:39], v[192:195]
    ds_read_b128 v[72:75], v104 offset:6144
    v_mfma_f32_16x16x32_bf16 v[196:199], v[48:51], v[36:39], v[196:199]
    v_mfma_f32_16x16x32_bf16 v[200:203], v[52:55], v[36:39], v[200:203]
    v_mfma_f32_16x16x32_bf16 v[204:207], v[56:59], v[36:39], v[204:207]
    s_waitcnt lgkmcnt(10)
    v_mfma_f32_16x16x32_bf16 v[128:131], v[76:79], v[60:63], v[128:131]
    s_waitcnt lgkmcnt(8)
    v_mfma_f32_16x16x32_bf16 v[132:135], v[80:83], v[60:63], v[132:135]
    s_waitcnt lgkmcnt(6)
    v_mfma_f32_16x16x32_bf16 v[136:139], v[84:87], v[60:63], v[136:139]
    s_waitcnt vmcnt(8) lgkmcnt(0)
    s_barrier
    ds_read_b64_tr_b16 v[40:41], v109 offset:0
    v_mfma_f32_16x16x32_bf16 v[140:143], v[88:91], v[60:63], v[140:143]
    ds_read_b64_tr_b16 v[42:43], v109 offset:5120
    s_add_u32 m0, s64, 16384
    s_nop 0
    buffer_load_dwordx4 v4, s[8:11], s65 offen offset:0 sc1 lds
    v_mfma_f32_16x16x32_bf16 v[144:147], v[92:95], v[60:63], v[144:147]
    ds_read_b128 v[24:27], v105 offset:0
    v_mfma_f32_16x16x32_bf16 v[148:151], v[76:79], v[64:67], v[148:151]
    ds_read_b64_tr_b16 v[44:45], v110 offset:32
    v_mfma_f32_16x16x32_bf16 v[152:155], v[80:83], v[64:67], v[152:155]
    ds_read_b64_tr_b16 v[46:47], v110 offset:5152
    buffer_load_dwordx4 v4, s[8:11], s65 offen offset:1024 sc1 lds
    v_mfma_f32_16x16x32_bf16 v[156:159], v[84:87], v[64:67], v[156:159]
    ds_read_b64_tr_b16 v[48:49], v109 offset:64
    v_mfma_f32_16x16x32_bf16 v[160:163], v[88:91], v[64:67], v[160:163]
    ds_read_b64_tr_b16 v[50:51], v109 offset:5184
    v_mfma_f32_16x16x32_bf16 v[164:167], v[92:95], v[64:67], v[164:167]
    v_mfma_f32_16x16x32_bf16 v[168:171], v[76:79], v[68:71], v[168:171]
    ds_read_b64_tr_b16 v[52:53], v110 offset:96
    buffer_load_dwordx4 v4, s[8:11], s65 offen offset:2048 sc1 lds
    v_mfma_f32_16x16x32_bf16 v[172:175], v[80:83], v[68:71], v[172:175]
    ds_read_b64_tr_b16 v[54:55], v110 offset:5216
    v_mfma_f32_16x16x32_bf16 v[176:179], v[84:87], v[68:71], v[176:179]
    ds_read_b64_tr_b16 v[56:57], v109 offset:128
    v_mfma_f32_16x16x32_bf16 v[180:183], v[88:91], v[68:71], v[180:183]
    ds_read_b64_tr_b16 v[58:59], v109 offset:5248
    buffer_load_dwordx4 v4, s[8:11], s65 offen offset:3072 sc1 lds
    s_add_u32 s65, s65, 16384
    v_mfma_f32_16x16x32_bf16 v[184:187], v[92:95], v[68:71], v[184:187]
    ds_read_b128 v[28:31], v105 offset:2048
    v_mfma_f32_16x16x32_bf16 v[188:191], v[76:79], v[72:75], v[188:191]
    ds_read_b128 v[32:35], v105 offset:4096
    v_mfma_f32_16x16x32_bf16 v[192:195], v[80:83], v[72:75], v[192:195]
    ds_read_b128 v[36:39], v105 offset:6144
    v_mfma_f32_16x16x32_bf16 v[196:199], v[84:87], v[72:75], v[196:199]
    v_mfma_f32_16x16x32_bf16 v[200:203], v[88:91], v[72:75], v[200:203]
    v_mfma_f32_16x16x32_bf16 v[204:207], v[92:95], v[72:75], v[204:207]
    s_waitcnt lgkmcnt(10)
    v_mfma_f32_16x16x32_bf16 v[128:131], v[40:43], v[24:27], v[128:131]
    s_waitcnt lgkmcnt(8)
    v_mfma_f32_16x16x32_bf16 v[132:135], v[44:47], v[24:27], v[132:135]
    s_waitcnt lgkmcnt(6)
    v_mfma_f32_16x16x32_bf16 v[136:139], v[48:51], v[24:27], v[136:139]
    s_waitcnt vmcnt(8) lgkmcnt(0)
    s_barrier
    ds_read_b64_tr_b16 v[76:77], v111 offset:0
    v_mfma_f32_16x16x32_bf16 v[140:143], v[52:55], v[24:27], v[140:143]
    ds_read_b64_tr_b16 v[78:79], v111 offset:5120
    s_add_u32 m0, s69, 32768
    s_nop 0
    buffer_load_dwordx4 v4, s[8:11], s65 offen offset:0 sc1 lds
    v_mfma_f32_16x16x32_bf16 v[144:147], v[56:59], v[24:27], v[144:147]
    ds_read_b128 v[60:63], v106 offset:0
    v_mfma_f32_16x16x32_bf16 v[148:151], v[40:43], v[28:31], v[148:151]
    ds_read_b64_tr_b16 v[80:81], v112 offset:32
    v_mfma_f32_16x16x32_bf16 v[152:155], v[44:47], v[28:31], v[152:155]
    ds_read_b64_tr_b16 v[82:83], v112 offset:5152
    buffer_load_dwordx4 v4, s[8:11], s65 offen offset:1024 sc1 lds
    v_mfma_f32_16x16x32_bf16 v[156:159], v[48:51], v[28:31], v[156:159]
    ds_read_b64_tr_b16 v[84:85], v111 offset:64
    v_mfma_f32_16x16x32_bf16 v[160:163], v[52:55], v[28:31], v[160:163]
    ds_read_b64_tr_b16 v[86:87], v111 offset:5184
    v_mfma_f32_16x16x32_bf16 v[164:167], v[56:59], v[28:31], v[164:167]
    v_mfma_f32_16x16x32_bf16 v[168:171], v[40:43], v[32:35], v[168:171]
    ds_read_b64_tr_b16 v[88:89], v112 offset:96
    s_mov_b32 exec_lo, 0x0
    s_mov_b32 exec_hi, 0xf0
    buffer_load_dword v122, v1, s[8:11], 0 offen sc1
    s_mov_b64 exec, -1
    buffer_load_dwordx4 v4, s[8:11], s65 offen offset:2048 sc1 lds
    v_mfma_f32_16x16x32_bf16 v[172:175], v[44:47], v[32:35], v[172:175]
    ds_read_b64_tr_b16 v[90:91], v112 offset:5216
    v_mfma_f32_16x16x32_bf16 v[176:179], v[48:51], v[32:35], v[176:179]
    ds_read_b64_tr_b16 v[92:93], v111 offset:128
    v_mfma_f32_16x16x32_bf16 v[180:183], v[52:55], v[32:35], v[180:183]
    ds_read_b64_tr_b16 v[94:95], v111 offset:5248
    buffer_load_dwordx4 v4, s[8:11], s65 offen offset:3072 sc1 lds
    s_add_u32 s65, s65, 16384
    v_mfma_f32_16x16x32_bf16 v[184:187], v[56:59], v[32:35], v[184:187]
    ds_read_b128 v[64:67], v106 offset:2048
    v_mfma_f32_16x16x32_bf16 v[188:191], v[40:43], v[36:39], v[188:191]
    ds_read_b128 v[68:71], v106 offset:4096
    v_mfma_f32_16x16x32_bf16 v[192:195], v[44:47], v[36:39], v[192:195]
    ds_read_b128 v[72:75], v106 offset:6144
    v_mfma_f32_16x16x32_bf16 v[196:199], v[48:51], v[36:39], v[196:199]
    v_mfma_f32_16x16x32_bf16 v[200:203], v[52:55], v[36:39], v[200:203]
    v_mfma_f32_16x16x32_bf16 v[204:207], v[56:59], v[36:39], v[204:207]
    s_waitcnt lgkmcnt(10)
    v_mfma_f32_16x16x32_bf16 v[128:131], v[76:79], v[60:63], v[128:131]
    s_waitcnt lgkmcnt(8)
    v_mfma_f32_16x16x32_bf16 v[132:135], v[80:83], v[60:63], v[132:135]
    s_waitcnt lgkmcnt(6)
    v_mfma_f32_16x16x32_bf16 v[136:139], v[84:87], v[60:63], v[136:139]
    s_waitcnt vmcnt(9) lgkmcnt(0)
    s_barrier
    ds_read_b64_tr_b16 v[40:41], v102 offset:0
    s_waitcnt vmcnt(2)
    s_add_u32 s26, s38, 4
    v_subrev_u32 v122, s26, v122
    v_cmp_le_u32 vcc, 4, v122
    s_mov_b32 s26, 0x0
    s_mov_b32 s27, 0xf0
    s_and_b64 vcc, s[26:27], vcc
    s_cbranch_vccnz PL4_S
PL4_C:
    v_mfma_f32_16x16x32_bf16 v[140:143], v[88:91], v[60:63], v[140:143]
    ds_read_b64_tr_b16 v[42:43], v102 offset:5120
    s_add_u32 m0, s70, 32768
    s_nop 0
    buffer_load_dwordx4 v4, s[8:11], s65 offen offset:0 sc1 lds
    v_mfma_f32_16x16x32_bf16 v[144:147], v[92:95], v[60:63], v[144:147]
    ds_read_b128 v[24:27], v101 offset:0
    v_mfma_f32_16x16x32_bf16 v[148:151], v[76:79], v[64:67], v[148:151]
    ds_read_b64_tr_b16 v[44:45], v103 offset:32
    v_mfma_f32_16x16x32_bf16 v[152:155], v[80:83], v[64:67], v[152:155]
    ds_read_b64_tr_b16 v[46:47], v103 offset:5152
    buffer_load_dwordx4 v4, s[8:11], s65 offen offset:1024 sc1 lds
    v_mfma_f32_16x16x32_bf16 v[156:159], v[84:87], v[64:67], v[156:159]
    ds_read_b64_tr_b16 v[48:49], v102 offset:64
    v_mfma_f32_16x16x32_bf16 v[160:163], v[88:91], v[64:67], v[160:163]
    ds_read_b64_tr_b16 v[50:51], v102 offset:5184
    v_mfma_f32_16x16x32_bf16 v[164:167], v[92:95], v[64:67], v[164:167]
    v_mfma_f32_16x16x32_bf16 v[168:171], v[76:79], v[68:71], v[168:171]
    ds_read_b64_tr_b16 v[52:53], v103 offset:96
    buffer_load_dwordx4 v4, s[8:11], s65 offen offset:2048 sc1 lds
    v_mfma_f32_16x16x32_bf16 v[172:175], v[80:83], v[68:71], v[172:175]
    ds_read_b64_tr_b16 v[54:55], v103 offset:5216
    v_mfma_f32_16x16x32_bf16 v[176:179], v[84:87], v[68:71], v[176:179]
    ds_read_b64_tr_b16 v[56:57], v102 offset:128
    v_mfma_f32_16x16x32_bf16 v[180:183], v[88:91], v[68:71], v[180:183]
    ds_read_b64_tr_b16 v[58:59], v102 offset:5248
    buffer_load_dwordx4 v4, s[8:11], s65 offen offset:3072 sc1 lds
    s_add_u32 s65, s65, 16384
    v_mfma_f32_16x16x32_bf16 v[184:187], v[92:95], v[68:71], v[184:187]
    ds_read_b128 v[28:31], v101 offset:2048
    v_mfma_f32_16x16x32_bf16 v[188:191], v[76:79], v[72:75], v[188:191]
    ds_read_b128 v[32:35], v101 offset:4096
    v_mfma_f32_16x16x32_bf16 v[192:195], v[80:83], v[72:75], v[192:195]
    ds_read_b128 v[36:39], v101 offset:6144
    v_mfma_f32_16x16x32_bf16 v[196:199], v[84:87], v[72:75], v[196:199]
    v_mfma_f32_16x16x32_bf16 v[200:203], v[88:91], v[72:75], v[200:203]
    v_mfma_f32_16x16x32_bf16 v[204:207], v[92:95], v[72:75], v[204:207]
    s_waitcnt lgkmcnt(10)
    v_mfma_f32_16x16x32_bf16 v[128:131], v[40:43], v[24:27], v[128:131]
    s_waitcnt lgkmcnt(8)
    v_mfma_f32_16x16x32_bf16 v[132:135], v[44:47], v[24:27], v[132:135]
    s_waitcnt lgkmcnt(6)
    v_mfma_f32_16x16x32_bf16 v[136:139], v[48:51], v[24:27], v[136:139]
    s_waitcnt vmcnt(9) lgkmcnt(0)
    s_barrier
    ds_read_b64_tr_b16 v[76:77], v107 offset:0
    v_mfma_f32_16x16x32_bf16 v[140:143], v[52:55], v[24:27], v[140:143]
    ds_read_b64_tr_b16 v[78:79], v107 offset:5120
    s_add_u32 m0, s64, 0
    s_nop 0
    buffer_load_dwordx4 v4, s[8:11], s65 offen offset:0 sc1 lds
    v_mfma_f32_16x16x32_bf16 v[144:147], v[56:59], v[24:27], v[144:147]
    ds_read_b128 v[60:63], v104 offset:0
    v_mfma_f32_16x16x32_bf16 v[148:151], v[40:43], v[28:31], v[148:151]
    ds_read_b64_tr_b16 v[80:81], v108 offset:32
    v_mfma_f32_16x16x32_bf16 v[152:155], v[44:47], v[28:31], v[152:155]
    ds_read_b64_tr_b16 v[82:83], v108 offset:5152
    buffer_load_dwordx4 v4, s[8:11], s65 offen offset:1024 sc1 lds
    v_mfma_f32_16x16x32_bf16 v[156:159], v[48:51], v[28:31], v[156:159]
    ds_read_b64_tr_b16 v[84:85], v107 offset:64
    v_mfma_f32_16x16x32_bf16 v[160:163], v[52:55], v[28:31], v[160:163]
    ds_read_b64_tr_b16 v[86:87], v107 offset:5184
    v_mfma_f32_16x16x32_bf16 v[164:167], v[56:59], v[28:31], v[164:167]
    v_mfma_f32_16x16x32_bf16 v[168:171], v[40:43], v[32:35], v[168:171]
    ds_read_b64_tr_b16 v[88:89], v108 offset:96
    buffer_load_dwordx4 v4, s[8:11], s65 offen offset:2048 sc1 lds
    v_mfma_f32_16x16x32_bf16 v[172:175], v[44:47], v[32:35], v[172:175]
    ds_read_b64_tr_b16 v[90:91], v108 offset:5216
    v_mfma_f32_16x16x32_bf16 v[176:179], v[48:51], v[32:35], v[176:179]
    ds_read_b64_tr_b16 v[92:93], v107 offset:128
    v_mfma_f32_16x16x32_bf16 v[180:183], v[52:55], v[32:35], v[180:183]
    ds_read_b64_tr_b16 v[94:95], v107 offset:5248
    buffer_load_dwordx4 v4, s[8:11], s65 offen offset:3072 sc1 lds
    s_add_u32 s65, s65, 16384
    v_mfma_f32_16x16x32_bf16 v[184:187], v[56:59], v[32:35], v[184:187]
    ds_read_b128 v[64:67], v104 offset:2048
    v_mfma_f32_16x16x32_bf16 v[188:191], v[40:43], v[36:39], v[188:191]
    ds_read_b128 v[68:71], v104 offset:4096
    v_mfma_f32_16x16x32_bf16 v[192:195], v[44:47], v[36:39], v[192:195]
    ds_read_b128 v[72:75], v104 offset:6144
    v_mfma_f32_16x16x32_bf16 v[196:199], v[48:51], v[36:39], v[196:199]
    v_mfma_f32_16x16x32_bf16 v[200:203], v[52:55], v[36:39], v[200:203]
    v_mfma_f32_16x16x32_bf16 v[204:207], v[56:59], v[36:39], v[204:207]
    s_waitcnt lgkmcnt(10)
    v_mfma_f32_16x16x32_bf16 v[128:131], v[76:79], v[60:63], v[128:131]
    s_waitcnt lgkmcnt(8)
    v_mfma_f32_16x16x32_bf16 v[132:135], v[80:83], v[60:63], v[132:135]
    s_waitcnt lgkmcnt(6)
    v_mfma_f32_16x16x32_bf16 v[136:139], v[84:87], v[60:63], v[136:139]
    s_waitcnt vmcnt(8) lgkmcnt(0)
    s_barrier
    ds_read_b64_tr_b16 v[40:41], v109 offset:0
    v_mfma_f32_16x16x32_bf16 v[140:143], v[88:91], v[60:63], v[140:143]
    ds_read_b64_tr_b16 v[42:43], v109 offset:5120
    s_add_u32 m0, s64, 16384
    s_nop 0
    buffer_load_dwordx4 v4, s[8:11], s65 offen offset:0 sc1 lds
    v_mfma_f32_16x16x32_bf16 v[144:147], v[92:95], v[60:63], v[144:147]
    ds_read_b128 v[24:27], v105 offset:0
    v_mfma_f32_16x16x32_bf16 v[148:151], v[76:79], v[64:67], v[148:151]
    ds_read_b64_tr_b16 v[44:45], v110 offset:32
    v_mfma_f32_16x16x32_bf16 v[152:155], v[80:83], v[64:67], v[152:155]
    ds_read_b64_tr_b16 v[46:47], v110 offset:5152
    buffer_load_dwordx4 v4, s[8:11], s65 offen offset:1024 sc1 lds
    v_mfma_f32_16x16x32_bf16 v[156:159], v[84:87], v[64:67], v[156:159]
    ds_read_b64_tr_b16 v[48:49], v109 offset:64
    v_mfma_f32_16x16x32_bf16 v[160:163], v[88:91], v[64:67], v[160:163]
    ds_read_b64_tr_b16 v[50:51], v109 offset:5184
    v_mfma_f32_16x16x32_bf16 v[164:167], v[92:95], v[64:67], v[164:167]
    v_mfma_f32_16x16x32_bf16 v[168:171], v[76:79], v[68:71], v[168:171]
    ds_read_b64_tr_b16 v[52:53], v110 offset:96
    buffer_load_dwordx4 v4, s[8:11], s65 offen offset:2048 sc1 lds
    v_mfma_f32_16x16x32_bf16 v[172:175], v[80:83], v[68:71], v[172:175]
    ds_read_b64_tr_b16 v[54:55], v110 offset:5216
    v_mfma_f32_16x16x32_bf16 v[176:179], v[84:87], v[68:71], v[176:179]
    ds_read_b64_tr_b16 v[56:57], v109 offset:128
    v_mfma_f32_16x16x32_bf16 v[180:183], v[88:91], v[68:71], v[180:183]
    ds_read_b64_tr_b16 v[58:59], v109 offset:5248
    buffer_load_dwordx4 v4, s[8:11], s65 offen offset:3072 sc1 lds
    s_add_u32 s65, s65, 16384
    v_mfma_f32_16x16x32_bf16 v[184:187], v[92:95], v[68:71], v[184:187]
    ds_read_b128 v[28:31], v105 offset:2048
    v_mfma_f32_16x16x32_bf16 v[188:191], v[76:79], v[72:75], v[188:191]
    ds_read_b128 v[32:35], v105 offset:4096
    v_mfma_f32_16x16x32_bf16 v[192:195], v[80:83], v[72:75], v[192:195]
    ds_read_b128 v[36:39], v105 offset:6144
    v_mfma_f32_16x16x32_bf16 v[196:199], v[84:87], v[72:75], v[196:199]
    v_mfma_f32_16x16x32_bf16 v[200:203], v[88:91], v[72:75], v[200:203]
    v_mfma_f32_16x16x32_bf16 v[204:207], v[92:95], v[72:75], v[204:207]
    s_waitcnt lgkmcnt(10)
    v_mfma_f32_16x16x32_bf16 v[128:131], v[40:43], v[24:27], v[128:131]
    s_waitcnt lgkmcnt(8)
    v_mfma_f32_16x16x32_bf16 v[132:135], v[44:47], v[24:27], v[132:135]
    s_waitcnt lgkmcnt(6)
    v_mfma_f32_16x16x32_bf16 v[136:139], v[48:51], v[24:27], v[136:139]
    s_waitcnt vmcnt(8) lgkmcnt(0)
    s_barrier
    ds_read_b64_tr_b16 v[76:77], v111 offset:0
    v_mfma_f32_16x16x32_bf16 v[140:143], v[52:55], v[24:27], v[140:143]
    ds_read_b64_tr_b16 v[78:79], v111 offset:5120
    s_add_u32 m0, s69, 32768
    s_nop 0
    buffer_load_dwordx4 v4, s[8:11], s65 offen offset:0 sc1 lds
    v_mfma_f32_16x16x32_bf16 v[144:147], v[56:59], v[24:27], v[144:147]
    ds_read_b128 v[60:63], v106 offset:0
    v_mfma_f32_16x16x32_bf16 v[148:151], v[40:43], v[28:31], v[148:151]
    ds_read_b64_tr_b16 v[80:81], v112 offset:32
    v_mfma_f32_16x16x32_bf16 v[152:155], v[44:47], v[28:31], v[152:155]
    ds_read_b64_tr_b16 v[82:83], v112 offset:5152
    buffer_load_dwordx4 v4, s[8:11], s65 offen offset:1024 sc1 lds
    v_mfma_f32_16x16x32_bf16 v[156:159], v[48:51], v[28:31], v[156:159]
    ds_read_b64_tr_b16 v[84:85], v111 offset:64
    v_mfma_f32_16x16x32_bf16 v[160:163], v[52:55], v[28:31], v[160:163]
    ds_read_b64_tr_b16 v[86:87], v111 offset:5184
    v_mfma_f32_16x16x32_bf16 v[164:167], v[56:59], v[28:31], v[164:167]
    v_mfma_f32_16x16x32_bf16 v[168:171], v[40:43], v[32:35], v[168:171]
    ds_read_b64_tr_b16 v[88:89], v112 offset:96
    buffer_load_dwordx4 v4, s[8:11], s65 offen offset:2048 sc1 lds
    v_mfma_f32_16x16x32_bf16 v[172:175], v[44:47], v[32:35], v[172:175]
    ds_read_b64_tr_b16 v[90:91], v112 offset:5216
    v_mfma_f32_16x16x32_bf16 v[176:179], v[48:51], v[32:35], v[176:179]
    ds_read_b64_tr_b16 v[92:93], v111 offset:128
    v_mfma_f32_16x16x32_bf16 v[180:183], v[52:55], v[32:35], v[180:183]
    ds_read_b64_tr_b16 v[94:95], v111 offset:5248
    buffer_load_dwordx4 v4, s[8:11], s65 offen offset:3072 sc1 lds
    s_add_u32 s65, s65, 16384
    v_mfma_f32_16x16x32_bf16 v[184:187], v[56:59], v[32:35], v[184:187]
    ds_read_b128 v[64:67], v106 offset:2048
    v_mfma_f32_16x16x32_bf16 v[188:191], v[40:43], v[36:39], v[188:191]
    ds_read_b128 v[68:71], v106 offset:4096
    v_mfma_f32_16x16x32_bf16 v[192:195], v[44:47], v[36:39], v[192:195]
    ds_read_b128 v[72:75], v106 offset:6144
    v_mfma_f32_16x16x32_bf16 v[196:199], v[48:51], v[36:39], v[196:199]
    v_mfma_f32_16x16x32_bf16 v[200:203], v[52:55], v[36:39], v[200:203]
    v_mfma_f32_16x16x32_bf16 v[204:207], v[56:59], v[36:39], v[204:207]
    s_waitcnt lgkmcnt(10)
    v_mfma_f32_16x16x32_bf16 v[128:131], v[76:79], v[60:63], v[128:131]
    s_waitcnt lgkmcnt(8)
    v_mfma_f32_16x16x32_bf16 v[132:135], v[80:83], v[60:63], v[132:135]
    s_waitcnt lgkmcnt(6)
    v_mfma_f32_16x16x32_bf16 v[136:139], v[84:87], v[60:63], v[136:139]
    s_waitcnt vmcnt(8) lgkmcnt(0)
    s_barrier
    ds_read_b64_tr_b16 v[40:41], v102 offset:0
    v_mfma_f32_16x16x32_bf16 v[140:143], v[88:91], v[60:63], v[140:143]
    ds_read_b64_tr_b16 v[42:43], v102 offset:5120
    s_add_u32 m0, s70, 32768
    s_nop 0
    buffer_load_dwordx4 v4, s[8:11], s65 offen offset:0 sc1 lds
    v_mfma_f32_16x16x32_bf16 v[144:147], v[92:95], v[60:63], v[144:147]
    ds_read_b128 v[24:27], v101 offset:0
    v_mfma_f32_16x16x32_bf16 v[148:151], v[76:79], v[64:67], v[148:151]
    ds_read_b64_tr_b16 v[44:45], v103 offset:32
    v_mfma_f32_16x16x32_bf16 v[152:155], v[80:83], v[64:67], v[152:155]
    ds_read_b64_tr_b16 v[46:47], v103 offset:5152
    buffer_load_dwordx4 v4, s[8:11], s65 offen offset:1024 sc1 lds
    v_mfma_f32_16x16x32_bf16 v[156:159], v[84:87], v[64:67], v[156:159]
    ds_read_b64_tr_b16 v[48:49], v102 offset:64
    v_mfma_f32_16x16x32_bf16 v[160:163], v[88:91], v[64:67], v[160:163]
    ds_read_b64_tr_b16 v[50:51], v102 offset:5184
    v_mfma_f32_16x16x32_bf16 v[164:167], v[92:95], v[64:67], v[164:167]
    v_mfma_f32_16x16x32_bf16 v[168:171], v[76:79], v[68:71], v[168:171]
    ds_read_b64_tr_b16 v[52:53], v103 offset:96
    buffer_load_dwordx4 v4, s[8:11], s65 offen offset:2048 sc1 lds
    v_mfma_f32_16x16x32_bf16 v[172:175], v[80:83], v[68:71], v[172:175]
    ds_read_b64_tr_b16 v[54:55], v103 offset:5216
    v_mfma_f32_16x16x32_bf16 v[176:179], v[84:87], v[68:71], v[176:179]
    ds_read_b64_tr_b16 v[56:57], v102 offset:128
    v_mfma_f32_16x16x32_bf16 v[180:183], v[88:91], v[68:71], v[180:183]
    ds_read_b64_tr_b16 v[58:59], v102 offset:5248
    buffer_load_dwordx4 v4, s[8:11], s65 offen offset:3072 sc1 lds
    s_add_u32 s65, s65, 16384
    v_mfma_f32_16x16x32_bf16 v[184:187], v[92:95], v[68:71], v[184:187]
    ds_read_b128 v[28:31], v101 offset:2048
    v_mfma_f32_16x16x32_bf16 v[188:191], v[76:79], v[72:75], v[188:191]
    ds_read_b128 v[32:35], v101 offset:4096
    v_mfma_f32_16x16x32_bf16 v[192:195], v[80:83], v[72:75], v[192:195]
    ds_read_b128 v[36:39], v101 offset:6144
    v_mfma_f32_16x16x32_bf16 v[196:199], v[84:87], v[72:75], v[196:199]
    v_mfma_f32_16x16x32_bf16 v[200:203], v[88:91], v[72:75], v[200:203]
    v_mfma_f32_16x16x32_bf16 v[204:207], v[92:95], v[72:75], v[204:207]
    s_waitcnt lgkmcnt(10)
    v_mfma_f32_16x16x32_bf16 v[128:131], v[40:43], v[24:27], v[128:131]
    s_waitcnt lgkmcnt(8)
    v_mfma_f32_16x16x32_bf16 v[132:135], v[44:47], v[24:27], v[132:135]
    s_waitcnt lgkmcnt(6)
    v_mfma_f32_16x16x32_bf16 v[136:139], v[48:51], v[24:27], v[136:139]
    s_waitcnt vmcnt(8) lgkmcnt(0)
    s_barrier
    ds_read_b64_tr_b16 v[76:77], v107 offset:0
    v_mfma_f32_16x16x32_bf16 v[140:143], v[52:55], v[24:27], v[140:143]
    ds_read_b64_tr_b16 v[78:79], v107 offset:5120
    s_add_u32 m0, s64, 0
    s_nop 0
    buffer_load_dwordx4 v4, s[8:11], s65 offen offset:0 sc1 lds
    v_mfma_f32_16x16x32_bf16 v[144:147], v[56:59], v[24:27], v[144:147]
    ds_read_b128 v[60:63], v104 offset:0
    v_mfma_f32_16x16x32_bf16 v[148:151], v[40:43], v[28:31], v[148:151]
    ds_read_b64_tr_b16 v[80:81], v108 offset:32
    v_mfma_f32_16x16x32_bf16 v[152:155], v[44:47], v[28:31], v[152:155]
    ds_read_b64_tr_b16 v[82:83], v108 offset:5152
    buffer_load_dwordx4 v4, s[8:11], s65 offen offset:1024 sc1 lds
    v_mfma_f32_16x16x32_bf16 v[156:159], v[48:51], v[28:31], v[156:159]
    ds_read_b64_tr_b16 v[84:85], v107 offset:64
    v_mfma_f32_16x16x32_bf16 v[160:163], v[52:55], v[28:31], v[160:163]
    ds_read_b64_tr_b16 v[86:87], v107 offset:5184
    v_mfma_f32_16x16x32_bf16 v[164:167], v[56:59], v[28:31], v[164:167]
    v_mfma_f32_16x16x32_bf16 v[168:171], v[40:43], v[32:35], v[168:171]
    ds_read_b64_tr_b16 v[88:89], v108 offset:96
    buffer_load_dwordx4 v4, s[8:11], s65 offen offset:2048 sc1 lds
    v_mfma_f32_16x16x32_bf16 v[172:175], v[44:47], v[32:35], v[172:175]
    ds_read_b64_tr_b16 v[90:91], v108 offset:5216
    v_mfma_f32_16x16x32_bf16 v[176:179], v[48:51], v[32:35], v[176:179]
    ds_read_b64_tr_b16 v[92:93], v107 offset:128
    v_mfma_f32_16x16x32_bf16 v[180:183], v[52:55], v[32:35], v[180:183]
    ds_read_b64_tr_b16 v[94:95], v107 offset:5248
    buffer_load_dwordx4 v4, s[8:11], s65 offen offset:3072 sc1 lds
    s_add_u32 s65, s65, 16384
    v_mfma_f32_16x16x32_bf16 v[184:187], v[56:59], v[32:35], v[184:187]
    ds_read_b128 v[64:67], v104 offset:2048
    v_mfma_f32_16x16x32_bf16 v[188:191], v[40:43], v[36:39], v[188:191]
    ds_read_b128 v[68:71], v104 offset:4096
    v_mfma_f32_16x16x32_bf16 v[192:195], v[44:47], v[36:39], v[192:195]
    ds_read_b128 v[72:75], v104 offset:6144
    v_mfma_f32_16x16x32_bf16 v[196:199], v[48:51], v[36:39], v[196:199]
    v_mfma_f32_16x16x32_bf16 v[200:203], v[52:55], v[36:39], v[200:203]
    v_mfma_f32_16x16x32_bf16 v[204:207], v[56:59], v[36:39], v[204:207]
    s_waitcnt lgkmcnt(10)
    v_mfma_f32_16x16x32_bf16 v[128:131], v[76:79], v[60:63], v[128:131]
    s_waitcnt lgkmcnt(8)
    v_mfma_f32_16x16x32_bf16 v[132:135], v[80:83], v[60:63], v[132:135]
    s_waitcnt lgkmcnt(6)
    v_mfma_f32_16x16x32_bf16 v[136:139], v[84:87], v[60:63], v[136:139]
    s_waitcnt vmcnt(8) lgkmcnt(0)
    s_barrier
    ds_read_b64_tr_b16 v[40:41], v109 offset:0
    v_mfma_f32_16x16x32_bf16 v[140:143], v[88:91], v[60:63], v[140:143]
    ds_read_b64_tr_b16 v[42:43], v109 offset:5120
    s_add_u32 m0, s64, 16384
    s_nop 0
    buffer_load_dwordx4 v4, s[8:11], s65 offen offset:0 sc1 lds
    v_mfma_f32_16x16x32_bf16 v[144:147], v[92:95], v[60:63], v[144:147]
    ds_read_b128 v[24:27], v105 offset:0
    v_mfma_f32_16x16x32_bf16 v[148:151], v[76:79], v[64:67], v[148:151]
    ds_read_b64_tr_b16 v[44:45], v110 offset:32
    v_mfma_f32_16x16x32_bf16 v[152:155], v[80:83], v[64:67], v[152:155]
    ds_read_b64_tr_b16 v[46:47], v110 offset:5152
    buffer_load_dwordx4 v4, s[8:11], s65 offen offset:1024 sc1 lds
    v_mfma_f32_16x16x32_bf16 v[156:159], v[84:87], v[64:67], v[156:159]
    ds_read_b64_tr_b16 v[48:49], v109 offset:64
    v_mfma_f32_16x16x32_bf16 v[160:163], v[88:91], v[64:67], v[160:163]
    ds_read_b64_tr_b16 v[50:51], v109 offset:5184
    v_mfma_f32_16x16x32_bf16 v[164:167], v[92:95], v[64:67], v[164:167]
    v_mfma_f32_16x16x32_bf16 v[168:171], v[76:79], v[68:71], v[168:171]
    ds_read_b64_tr_b16 v[52:53], v110 offset:96
    buffer_load_dwordx4 v4, s[8:11], s65 offen offset:2048 sc1 lds
    v_mfma_f32_16x16x32_bf16 v[172:175], v[80:83], v[68:71], v[172:175]
    ds_read_b64_tr_b16 v[54:55], v110 offset:5216
    v_mfma_f32_16x16x32_bf16 v[176:179], v[84:87], v[68:71], v[176:179]
    ds_read_b64_tr_b16 v[56:57], v109 offset:128
    v_mfma_f32_16x16x32_bf16 v[180:183], v[88:91], v[68:71], v[180:183]
    ds_read_b64_tr_b16 v[58:59], v109 offset:5248
    buffer_load_dwordx4 v4, s[8:11], s65 offen offset:3072 sc1 lds
    s_add_u32 s65, s65, 16384
    v_mfma_f32_16x16x32_bf16 v[184:187], v[92:95], v[68:71], v[184:187]
    ds_read_b128 v[28:31], v105 offset:2048
    v_mfma_f32_16x16x32_bf16 v[188:191], v[76:79], v[72:75], v[188:191]
    ds_read_b128 v[32:35], v105 offset:4096
    v_mfma_f32_16x16x32_bf16 v[192:195], v[80:83], v[72:75], v[192:195]
    ds_read_b128 v[36:39], v105 offset:6144
    v_mfma_f32_16x16x32_bf16 v[196:199], v[84:87], v[72:75], v[196:199]
    v_mfma_f32_16x16x32_bf16 v[200:203], v[88:91], v[72:75], v[200:203]
    v_mfma_f32_16x16x32_bf16 v[204:207], v[92:95], v[72:75], v[204:207]
    s_waitcnt lgkmcnt(10)
    v_mfma_f32_16x16x32_bf16 v[128:131], v[40:43], v[24:27], v[128:131]
    s_waitcnt lgkmcnt(8)
    v_mfma_f32_16x16x32_bf16 v[132:135], v[44:47], v[24:27], v[132:135]
    s_waitcnt lgkmcnt(6)
    v_mfma_f32_16x16x32_bf16 v[136:139], v[48:51], v[24:27], v[136:139]
    s_waitcnt vmcnt(8) lgkmcnt(0)
    s_barrier
    ds_read_b64_tr_b16 v[76:77], v111 offset:0
    v_mfma_f32_16x16x32_bf16 v[140:143], v[52:55], v[24:27], v[140:143]
    ds_read_b64_tr_b16 v[78:79], v111 offset:5120
    s_add_u32 m0, s69, 32768
    s_nop 0
    buffer_load_dwordx4 v4, s[8:11], s65 offen offset:0 sc1 lds
    v_mfma_f32_16x16x32_bf16 v[144:147], v[56:59], v[24:27], v[144:147]
    ds_read_b128 v[60:63], v106 offset:0
    v_mfma_f32_16x16x32_bf16 v[148:151], v[40:43], v[28:31], v[148:151]
    ds_read_b64_tr_b16 v[80:81], v112 offset:32
    v_mfma_f32_16x16x32_bf16 v[152:155], v[44:47], v[28:31], v[152:155]
    ds_read_b64_tr_b16 v[82:83], v112 offset:5152
    buffer_load_dwordx4 v4, s[8:11], s65 offen offset:1024 sc1 lds
    v_mfma_f32_16x16x32_bf16 v[156:159], v[48:51], v[28:31], v[156:159]
    ds_read_b64_tr_b16 v[84:85], v111 offset:64
    v_mfma_f32_16x16x32_bf16 v[160:163], v[52:55], v[28:31], v[160:163]
    ds_read_b64_tr_b16 v[86:87], v111 offset:5184
    v_mfma_f32_16x16x32_bf16 v[164:167], v[56:59], v[28:31], v[164:167]
    v_mfma_f32_16x16x32_bf16 v[168:171], v[40:43], v[32:35], v[168:171]
    ds_read_b64_tr_b16 v[88:89], v112 offset:96
    buffer_load_dwordx4 v4, s[8:11], s65 offen offset:2048 sc1 lds
    v_mfma_f32_16x16x32_bf16 v[172:175], v[44:47], v[32:35], v[172:175]
    ds_read_b64_tr_b16 v[90:91], v112 offset:5216
    v_mfma_f32_16x16x32_bf16 v[176:179], v[48:51], v[32:35], v[176:179]
    ds_read_b64_tr_b16 v[92:93], v111 offset:128
    v_mfma_f32_16x16x32_bf16 v[180:183], v[52:55], v[32:35], v[180:183]
    ds_read_b64_tr_b16 v[94:95], v111 offset:5248
    buffer_load_dwordx4 v4, s[8:11], s65 offen offset:3072 sc1 lds
    s_add_u32 s65, s65, 16384
    v_mfma_f32_16x16x32_bf16 v[184:187], v[56:59], v[32:35], v[184:187]
    ds_read_b128 v[64:67], v106 offset:2048
    v_mfma_f32_16x16x32_bf16 v[188:191], v[40:43], v[36:39], v[188:191]
    ds_read_b128 v[68:71], v106 offset:4096
    v_mfma_f32_16x16x32_bf16 v[192:195], v[44:47], v[36:39], v[192:195]
    ds_read_b128 v[72:75], v106 offset:6144
    v_mfma_f32_16x16x32_bf16 v[196:199], v[48:51], v[36:39], v[196:199]
    v_mfma_f32_16x16x32_bf16 v[200:203], v[52:55], v[36:39], v[200:203]
    v_mfma_f32_16x16x32_bf16 v[204:207], v[56:59], v[36:39], v[204:207]
    s_waitcnt lgkmcnt(10)
    v_mfma_f32_16x16x32_bf16 v[128:131], v[76:79], v[60:63], v[128:131]
    s_waitcnt lgkmcnt(8)
    v_mfma_f32_16x16x32_bf16 v[132:135], v[80:83], v[60:63], v[132:135]
    s_waitcnt lgkmcnt(6)
    v_mfma_f32_16x16x32_bf16 v[136:139], v[84:87], v[60:63], v[136:139]
    s_waitcnt vmcnt(8) lgkmcnt(0)
    s_barrier
    ds_read_b64_tr_b16 v[40:41], v102 offset:0
    v_mfma_f32_16x16x32_bf16 v[140:143], v[88:91], v[60:63], v[140:143]
    ds_read_b64_tr_b16 v[42:43], v102 offset:5120
    v_mfma_f32_16x16x32_bf16 v[144:147], v[92:95], v[60:63], v[144:147]
    ds_read_b128 v[24:27], v101 offset:0
    v_mfma_f32_16x16x32_bf16 v[148:151], v[76:79], v[64:67], v[148:151]
    ds_read_b64_tr_b16 v[44:45], v103 offset:32
    v_mfma_f32_16x16x32_bf16 v[152:155], v[80:83], v[64:67], v[152:155]
    ds_read_b64_tr_b16 v[46:47], v103 offset:5152
    v_mfma_f32_16x16x32_bf16 v[156:159], v[84:87], v[64:67], v[156:159]
    ds_read_b64_tr_b16 v[48:49], v102 offset:64
    v_mfma_f32_16x16x32_bf16 v[160:163], v[88:91], v[64:67], v[160:163]
    ds_read_b64_tr_b16 v[50:51], v102 offset:5184
    v_mfma_f32_16x16x32_bf16 v[164:167], v[92:95], v[64:67], v[164:167]
    v_mfma_f32_16x16x32_bf16 v[168:171], v[76:79], v[68:71], v[168:171]
    ds_read_b64_tr_b16 v[52:53], v103 offset:96
    v_mfma_f32_16x16x32_bf16 v[172:175], v[80:83], v[68:71], v[172:175]
    ds_read_b64_tr_b16 v[54:55], v103 offset:5216
    v_mfma_f32_16x16x32_bf16 v[176:179], v[84:87], v[68:71], v[176:179]
    ds_read_b64_tr_b16 v[56:57], v102 offset:128
    v_mfma_f32_16x16x32_bf16 v[180:183], v[88:91], v[68:71], v[180:183]
    ds_read_b64_tr_b16 v[58:59], v102 offset:5248
    v_mfma_f32_16x16x32_bf16 v[184:187], v[92:95], v[68:71], v[184:187]
    ds_read_b128 v[28:31], v101 offset:2048
    v_mfma_f32_16x16x32_bf16 v[188:191], v[76:79], v[72:75], v[188:191]
    ds_read_b128 v[32:35], v101 offset:4096
    v_mfma_f32_16x16x32_bf16 v[192:195], v[80:83], v[72:75], v[192:195]
    ds_read_b128 v[36:39], v101 offset:6144
    v_mfma_f32_16x16x32_bf16 v[196:199], v[84:87], v[72:75], v[196:199]
    v_mfma_f32_16x16x32_bf16 v[200:203], v[88:91], v[72:75], v[200:203]
    v_mfma_f32_16x16x32_bf16 v[204:207], v[92:95], v[72:75], v[204:207]
    s_waitcnt lgkmcnt(10)
    v_mfma_f32_16x16x32_bf16 v[128:131], v[40:43], v[24:27], v[128:131]
    s_waitcnt lgkmcnt(8)
    v_mfma_f32_16x16x32_bf16 v[132:135], v[44:47], v[24:27], v[132:135]
    s_waitcnt lgkmcnt(6)
    v_mfma_f32_16x16x32_bf16 v[136:139], v[48:51], v[24:27], v[136:139]
    s_waitcnt vmcnt(4) lgkmcnt(0)
    s_barrier
    ds_read_b64_tr_b16 v[76:77], v107 offset:0
    v_mfma_f32_16x16x32_bf16 v[140:143], v[52:55], v[24:27], v[140:143]
    ds_read_b64_tr_b16 v[78:79], v107 offset:5120
    s_cmp_eq_u32 s73, 0
    s_cselect_b32 s26, 69632, 0
    s_mul_i32 s24, s3, 10240
    s_add_u32 s24, s24, s26
    v_mfma_f32_16x16x32_bf16 v[144:147], v[56:59], v[24:27], v[144:147]
    ds_read_b128 v[60:63], v104 offset:0
    v_add_u32 v117, s24, v4
    s_xor_b32 s25, s3, 4
    v_mfma_f32_16x16x32_bf16 v[148:151], v[40:43], v[28:31], v[148:151]
    ds_read_b64_tr_b16 v[80:81], v108 offset:32
    s_mul_i32 s25, s25, 10240
    s_add_u32 s25, s25, s26
    v_add_u32 v118, s25, v4
    v_mfma_f32_16x16x32_bf16 v[152:155], v[44:47], v[28:31], v[152:155]
    ds_read_b64_tr_b16 v[82:83], v108 offset:5152
    v_add_u32 v111, 0xffffd800, v109
    v_add_u32 v112, 0xffffd800, v110
    v_mfma_f32_16x16x32_bf16 v[156:159], v[48:51], v[28:31], v[156:159]
    ds_read_b64_tr_b16 v[84:85], v107 offset:64
    s_lshl_b32 s66, s61, 2
    s_add_u32 s66, s66, s62
    s_mul_i32 s66, s66, 122880
    v_mfma_f32_16x16x32_bf16 v[160:163], v[52:55], v[28:31], v[160:163]
    ds_read_b64_tr_b16 v[86:87], v107 offset:5184
    s_and_b32 s24, s3, 3
    s_mul_i32 s24, s24, 2560
    v_mfma_f32_16x16x32_bf16 v[164:167], v[56:59], v[28:31], v[164:167]
    s_add_u32 s66, s66, s24
    s_add_u32 s66, s66, 0x4000000
    s_mov_b32 s68, 0xffff0000
    v_mfma_f32_16x16x32_bf16 v[168:171], v[40:43], v[32:35], v[168:171]
    ds_read_b64_tr_b16 v[88:89], v108 offset:96
    s_lshl_b32 s24, s61, 7
    s_lshl_b32 s65, s71, 6
    v_mfma_f32_16x16x32_bf16 v[172:175], v[44:47], v[32:35], v[172:175]
    ds_read_b64_tr_b16 v[90:91], v108 offset:5216
    s_add_u32 s24, s24, s65
    s_lshl_b32 s65, s60, 4
    s_add_u32 s24, s24, s65
    v_mfma_f32_16x16x32_bf16 v[176:179], v[48:51], v[32:35], v[176:179]
    ds_read_b64_tr_b16 v[92:93], v107 offset:128
    s_mul_i32 s24, s24, 1280
    s_mul_i32 s65, s62, 320
    v_mfma_f32_16x16x32_bf16 v[180:183], v[52:55], v[32:35], v[180:183]
    ds_read_b64_tr_b16 v[94:95], v107 offset:5248
    s_add_u32 s24, s24, s65
    s_mul_i32 s65, s72, 160
    s_add_u32 s65, s24, s65
    v_mfma_f32_16x16x32_bf16 v[184:187], v[56:59], v[32:35], v[184:187]
    ds_read_b128 v[64:67], v104 offset:2048
    v_lshrrev_b32 v125, 1, v4
    v_mul_u32_u24 v123, 1280, v2
    v_mfma_f32_16x16x32_bf16 v[188:191], v[40:43], v[36:39], v[188:191]
    ds_read_b128 v[68:71], v104 offset:4096
    v_and_b32 v124, 1, v3
    v_lshlrev_b32 v124, 5, v124
    v_lshrrev_b32 v119, 1, v3
    v_mfma_f32_16x16x32_bf16 v[192:195], v[44:47], v[36:39], v[192:195]
    ds_read_b128 v[72:75], v104 offset:6144
    v_lshl_add_u32 v124, v119, 4, v124
    v_add_u32 v124, v123, v124
    v_mfma_f32_16x16x32_bf16 v[196:199], v[48:51], v[36:39], v[196:199]
    v_lshl_add_u32 v123, v3, 3, v123
    s_mov_b32 s76, s42
    s_and_b32 s77, s43, 0xffff
    v_mfma_f32_16x16x32_bf16 v[200:203], v[52:55], v[36:39], v[200:203]
    s_mov_b32 s78, 0x280000
    s_mov_b32 s79, 0x20000
    v_mfma_f32_16x16x32_bf16 v[204:207], v[56:59], v[36:39], v[204:207]
    s_waitcnt lgkmcnt(10)
    v_mfma_f32_16x16x32_bf16 v[128:131], v[76:79], v[60:63], v[128:131]
    s_waitcnt lgkmcnt(8)
    v_mfma_f32_16x16x32_bf16 v[132:135], v[80:83], v[60:63], v[132:135]
    s_waitcnt lgkmcnt(6)
    v_mfma_f32_16x16x32_bf16 v[136:139], v[84:87], v[60:63], v[136:139]
    s_waitcnt vmcnt(0) lgkmcnt(0)
    s_barrier
    ds_read_b64_tr_b16 v[40:41], v109 offset:0
    ds_read_b64_tr_b16 v[42:43], v109 offset:5120
    v_mfma_f32_16x16x32_bf16 v[140:143], v[88:91], v[60:63], v[140:143]
    ds_read_b128 v[24:27], v105 offset:4096
    v_mfma_f32_16x16x32_bf16 v[144:147], v[92:95], v[60:63], v[144:147]
    ds_read_b64_tr_b16 v[44:45], v110 offset:32
    ds_read_b64_tr_b16 v[46:47], v110 offset:5152
    v_mfma_f32_16x16x32_bf16 v[148:151], v[76:79], v[64:67], v[148:151]
    ds_read_b64_tr_b16 v[48:49], v109 offset:64
    v_mfma_f32_16x16x32_bf16 v[152:155], v[80:83], v[64:67], v[152:155]
    ds_read_b64_tr_b16 v[50:51], v109 offset:5184
    ds_read_b64_tr_b16 v[52:53], v110 offset:96
    v_mfma_f32_16x16x32_bf16 v[156:159], v[84:87], v[64:67], v[156:159]
    ds_read_b64_tr_b16 v[54:55], v110 offset:5216
    ds_write_b128 v117, v[128:131] offset:0
    v_mfma_f32_16x16x32_bf16 v[160:163], v[88:91], v[64:67], v[160:163]
    ds_read_b64_tr_b16 v[56:57], v109 offset:128
    ds_read_b64_tr_b16 v[58:59], v109 offset:5248
    ds_write_b128 v117, v[132:135] offset:1024
    v_mfma_f32_16x16x32_bf16 v[164:167], v[92:95], v[64:67], v[164:167]
    ds_read_b128 v[28:31], v105 offset:3072
    ds_write_b128 v117, v[136:139] offset:2048
    v_mfma_f32_16x16x32_bf16 v[168:171], v[76:79], v[68:71], v[168:171]
    ds_read_b64_tr_b16 v[228:229], v111 offset:0
    ds_read_b64_tr_b16 v[230:231], v111 offset:5120
    ds_write_b128 v117, v[140:143] offset:3072
    v_mfma_f32_16x16x32_bf16 v[172:175], v[80:83], v[68:71], v[172:175]
    ds_read_b64_tr_b16 v[232:233], v112 offset:32
    ds_write_b128 v117, v[144:147] offset:4096
    v_mfma_f32_16x16x32_bf16 v[176:179], v[84:87], v[68:71], v[176:179]
    ds_read_b64_tr_b16 v[234:235], v112 offset:5152
    ds_read_b64_tr_b16 v[236:237], v111 offset:64
    v_mfma_f32_16x16x32_bf16 v[180:183], v[88:91], v[68:71], v[180:183]
    ds_read_b64_tr_b16 v[238:239], v111 offset:5184
    ds_write_b128 v117, v[148:151] offset:5120
    v_mfma_f32_16x16x32_bf16 v[184:187], v[92:95], v[68:71], v[184:187]
    ds_read_b64_tr_b16 v[240:241], v112 offset:96
    ds_read_b64_tr_b16 v[242:243], v112 offset:5216
    ds_write_b128 v117, v[152:155] offset:6144
    v_mfma_f32_16x16x32_bf16 v[188:191], v[76:79], v[72:75], v[188:191]
    ds_read_b64_tr_b16 v[244:245], v111 offset:128
    ds_write_b128 v117, v[156:159] offset:7168
    v_mfma_f32_16x16x32_bf16 v[192:195], v[80:83], v[72:75], v[192:195]
    ds_read_b64_tr_b16 v[246:247], v111 offset:5248
    ds_read_b128 v[32:35], v105 offset:6144
    ds_write_b128 v117, v[160:163] offset:8192
    v_mfma_f32_16x16x32_bf16 v[196:199], v[84:87], v[72:75], v[196:199]
    ds_read_b128 v[36:39], v105 offset:5120
    ds_write_b128 v117, v[164:167] offset:9216
    v_mfma_f32_16x16x32_bf16 v[200:203], v[88:91], v[72:75], v[200:203]
    v_mfma_f32_16x16x32_bf16 v[204:207], v[92:95], v[72:75], v[204:207]
    s_waitcnt lgkmcnt(15)
    v_mfma_f32_16x16x32_bf16 v[168:171], v[40:43], v[24:27], v[168:171]
    v_mfma_f32_16x16x32_bf16 v[172:175], v[44:47], v[24:27], v[172:175]
    v_mfma_f32_16x16x32_bf16 v[176:179], v[48:51], v[24:27], v[176:179]
    s_waitcnt lgkmcnt(0)
    s_barrier
    ds_read_b128 v[208:211], v118 offset:0
    ds_read_b128 v[212:215], v118 offset:1024
    v_mfma_f32_16x16x32_bf16 v[180:183], v[52:55], v[24:27], v[180:183]
    ds_read_b128 v[216:219], v118 offset:2048
    ds_read_b128 v[220:223], v118 offset:3072
    s_sub_u32 s24, s60, 3
    s_and_b32 s24, s24, 3
    s_mul_i32 s24, s24, 10240
    s_add_u32 s24, s24, s66
    s_add_u32 s24, s24, 61440
    s_cmp_eq_u32 s60, 2
    s_cselect_b64 s[80:81], 0, -1
    v_mfma_f32_16x16x32_bf16 v[184:187], v[56:59], v[24:27], v[184:187]
    ds_read_b128 v[224:227], v118 offset:4096
    ds_read_b128 v[128:131], v118 offset:5120
    v_mfma_f32_16x16x32_bf16 v[168:171], v[228:231], v[28:31], v[168:171]
    ds_read_b128 v[132:135], v118 offset:6144
    ds_read_b128 v[136:139], v118 offset:7168
    v_mfma_f32_16x16x32_bf16 v[172:175], v[232:235], v[28:31], v[172:175]
    ds_read_b128 v[140:143], v118 offset:8192
    ds_read_b128 v[144:147], v118 offset:9216
    v_mfma_f32_16x16x32_bf16 v[176:179], v[236:239], v[28:31], v[176:179]
    v_mfma_f32_16x16x32_bf16 v[180:183], v[240:243], v[28:31], v[180:183]
    v_mfma_f32_16x16x32_bf16 v[184:187], v[244:247], v[28:31], v[184:187]
    s_waitcnt lgkmcnt(8)
    v_add_f32 v168, v168, v208
    v_add_f32 v169, v169, v209
    v_add_f32 v170, v170, v210
    v_add_f32 v171, v171, v211
    v_mfma_f32_16x16x32_bf16 v[188:191], v[40:43], v[32:35], v[188:191]
    v_add_f32 v172, v172, v212
    v_add_f32 v173, v173, v213
    v_add_f32 v174, v174, v214
    v_add_f32 v175, v175, v215
    v_mfma_f32_16x16x32_bf16 v[192:195], v[44:47], v[32:35], v[192:195]
    s_waitcnt lgkmcnt(6)
    v_add_f32 v176, v176, v216
    v_add_f32 v177, v177, v217
    v_add_f32 v178, v178, v218
    v_add_f32 v179, v179, v219
    v_cvt_pk_bf16_f32 v60, v168, v169
    v_cvt_pk_bf16_f32 v61, v170, v171
    v_cvt_pk_bf16_f32 v62, v172, v173
    v_cvt_pk_bf16_f32 v63, v174, v175
    s_mov_b64 exec, s[80:81]
    buffer_store_dwordx4 v[60:63], v4, s[8:11], s24 offen offset:0 sc1
    s_mov_b64 exec, -1
    v_mfma_f32_16x16x32_bf16 v[196:199], v[48:51], v[32:35], v[196:199]
    v_add_f32 v180, v180, v220
    v_add_f32 v181, v181, v221
    v_add_f32 v182, v182, v222
    v_add_f32 v183, v183, v223
    s_waitcnt lgkmcnt(3)
    v_add_f32 v188, v188, v128
    v_add_f32 v189, v189, v129
    v_add_f32 v190, v190, v130
    v_add_f32 v191, v191, v131
    v_mfma_f32_16x16x32_bf16 v[200:203], v[52:55], v[32:35], v[200:203]
    v_add_f32 v184, v184, v224
    v_add_f32 v185, v185, v225
    v_add_f32 v186, v186, v226
    v_add_f32 v187, v187, v227
    v_add_f32 v192, v192, v132
    v_add_f32 v193, v193, v133
    v_add_f32 v194, v194, v134
    v_add_f32 v195, v195, v135
    v_cvt_pk_bf16_f32 v64, v176, v177
    v_cvt_pk_bf16_f32 v65, v178, v179
    v_cvt_pk_bf16_f32 v66, v180, v181
    v_cvt_pk_bf16_f32 v67, v182, v183
    s_mov_b64 exec, s[80:81]
    buffer_store_dwordx4 v[64:67], v4, s[8:11], s24 offen offset:1024 sc1
    s_mov_b64 exec, -1
    v_mfma_f32_16x16x32_bf16 v[204:207], v[56:59], v[32:35], v[204:207]
    s_waitcnt lgkmcnt(1)
    v_add_f32 v196, v196, v136
    v_add_f32 v197, v197, v137
    v_add_f32 v198, v198, v138
    v_add_f32 v199, v199, v139
    v_cvt_pk_bf16_f32 v68, v184, v185
    v_cvt_pk_bf16_f32 v69, v186, v187
    s_mov_b64 exec, s[80:81]
    buffer_store_dwordx2 v[68:69], v125, s[8:11], s24 offen offset:2048 sc1
    s_mov_b64 exec, -1
    v_mfma_f32_16x16x32_bf16 v[188:191], v[228:231], v[36:39], v[188:191]
    v_add_f32 v200, v200, v140
    v_add_f32 v201, v201, v141
    v_add_f32 v202, v202, v142
    v_add_f32 v203, v203, v143
    v_mfma_f32_16x16x32_bf16 v[192:195], v[232:235], v[36:39], v[192:195]
    s_waitcnt lgkmcnt(0)
    v_add_f32 v204, v204, v144
    v_add_f32 v205, v205, v145
    v_add_f32 v206, v206, v146
    v_add_f32 v207, v207, v147
    v_mfma_f32_16x16x32_bf16 v[196:199], v[236:239], v[36:39], v[196:199]
    v_mfma_f32_16x16x32_bf16 v[200:203], v[240:243], v[36:39], v[200:203]
    v_mfma_f32_16x16x32_bf16 v[204:207], v[244:247], v[36:39], v[204:207]
    s_setprio 2
    s_nop 7
    s_cmp_eq_u32 s60, 3
    s_cbranch_scc1 P3_S3
    s_sub_u32 s24, s60, 4
    s_and_b32 s24, s24, 3
    s_mul_i32 s24, s24, 10240
    s_add_u32 s24, s24, s66
    s_add_u32 s24, s24, 92160
    v_cvt_pk_bf16_f32 v72, v188, v189
    v_cvt_pk_bf16_f32 v73, v190, v191
    v_cvt_pk_bf16_f32 v74, v192, v193
    v_cvt_pk_bf16_f32 v75, v194, v195
    buffer_store_dwordx4 v[72:75], v4, s[8:11], s24 offen offset:0 sc1
    v_cvt_pk_bf16_f32 v76, v196, v197
    v_cvt_pk_bf16_f32 v77, v198, v199
    v_cvt_pk_bf16_f32 v78, v200, v201
    v_cvt_pk_bf16_f32 v79, v202, v203
    buffer_store_dwordx4 v[76:79], v4, s[8:11], s24 offen offset:1024 sc1
    v_cvt_pk_bf16_f32 v80, v204, v205
    v_cvt_pk_bf16_f32 v81, v206, v207
    buffer_store_dwordx2 v[80:81], v125, s[8:11], s24 offen offset:2048 sc1
P3_S3:
    s_lshr_b32 s24, s60, 1
    s_cmp_lg_u32 s24, 1
    s_cbranch_scc1 K_END
    s_bitcmp0_b32 s60, 0
    s_cbranch_scc1 P3_R1
    v_mov_b64 v[168:169], v[188:189]
    v_mov_b64 v[170:171], v[190:191]
    v_mov_b64 v[172:173], v[192:193]
    v_mov_b64 v[174:175], v[194:195]
    v_mov_b64 v[176:177], v[196:197]
    v_mov_b64 v[178:179], v[198:199]
    v_mov_b64 v[180:181], v[200:201]
    v_mov_b64 v[182:183], v[202:203]
    v_mov_b64 v[184:185], v[204:205]
    v_mov_b64 v[186:187], v[206:207]
P3_R1:
    s_mul_i32 s24, s60, 30720
    s_add_u32 s66, s66, s24
    s_add_u32 s25, s66, 10240
    s_add_u32 s26, s66, 20480
    s_mov_b32 s67, 0
    s_mov_b32 s24, 0
    buffer_load_dwordx4 v[24:27], v4, s[8:11], s66 offen offset:0 sc1
    buffer_load_dwordx4 v[28:31], v4, s[8:11], s66 offen offset:1024 sc1
    buffer_load_dwordx2 v[32:33], v125, s[8:11], s66 offen offset:2048 sc1
    buffer_load_dwordx4 v[36:39], v4, s[8:11], s25 offen offset:0 sc1
    buffer_load_dwordx4 v[40:43], v4, s[8:11], s25 offen offset:1024 sc1
    buffer_load_dwordx2 v[44:45], v125, s[8:11], s25 offen offset:2048 sc1
    buffer_load_dwordx4 v[48:51], v4, s[8:11], s26 offen offset:0 sc1
    buffer_load_dwordx4 v[52:55], v4, s[8:11], s26 offen offset:1024 sc1
    buffer_load_dwordx2 v[56:57], v125, s[8:11], s26 offen offset:2048 sc1
P3_P1:
    s_waitcnt vmcnt(0)
    s_bitcmp1_b32 s24, 0
    s_cbranch_scc1 P3_P1_N0
    v_max3_u32 v119, v24, v25, v26
    v_max3_u32 v119, v119, v27, v28
    v_max3_u32 v119, v119, v29, v30
    v_max3_u32 v119, v119, v31, v32
    v_max_u32 v119, v119, v33
    v_cmp_eq_u32 vcc, -1, v119
    s_cbranch_vccnz P3_P1_R0
    v_lshlrev_b32 v208, 16, v24
    v_and_b32 v209, s68, v24
    v_lshlrev_b32 v210, 16, v25
    v_and_b32 v211, s68, v25
    v_lshlrev_b32 v212, 16, v26
    v_and_b32 v213, s68, v26
    v_lshlrev_b32 v214, 16, v27
    v_and_b32 v215, s68, v27
    v_lshlrev_b32 v216, 16, v28
    v_and_b32 v217, s68, v28
    v_lshlrev_b32 v218, 16, v29
    v_and_b32 v219, s68, v29
    v_lshlrev_b32 v220, 16, v30
    v_and_b32 v221, s68, v30
    v_lshlrev_b32 v222, 16, v31
    v_and_b32 v223, s68, v31
    v_lshlrev_b32 v224, 16, v32
    v_and_b32 v225, s68, v32
    v_lshlrev_b32 v226, 16, v33
    v_and_b32 v227, s68, v33
    v_pk_add_f32 v[168:169], v[168:169], v[208:209]
    v_pk_add_f32 v[170:171], v[170:171], v[210:211]
    v_pk_add_f32 v[172:173], v[172:173], v[212:213]
    v_pk_add_f32 v[174:175], v[174:175], v[214:215]
    v_pk_add_f32 v[176:177], v[176:177], v[216:217]
    v_pk_add_f32 v[178:179], v[178:179], v[218:219]
    v_pk_add_f32 v[180:181], v[180:181], v[220:221]
    v_pk_add_f32 v[182:183], v[182:183], v[222:223]
    v_pk_add_f32 v[184:185], v[184:185], v[224:225]
    v_pk_add_f32 v[186:187], v[186:187], v[226:227]
    s_bitset1_b32 s24, 0
    s_branch P3_P1_N0
P3_P1_R0:
    buffer_load_dwordx4 v[24:27], v4, s[8:11], s66 offen offset:0 sc1
    buffer_load_dwordx4 v[28:31], v4, s[8:11], s66 offen offset:1024 sc1
    buffer_load_dwordx2 v[32:33], v125, s[8:11], s66 offen offset:2048 sc1
P3_P1_N0:
    s_bitcmp1_b32 s24, 1
    s_cbranch_scc1 P3_P1_N1
    v_max3_u32 v119, v36, v37, v38
    v_max3_u32 v119, v119, v39, v40
    v_max3_u32 v119, v119, v41, v42
    v_max3_u32 v119, v119, v43, v44
    v_max_u32 v119, v119, v45
    v_cmp_eq_u32 vcc, -1, v119
    s_cbranch_vccnz P3_P1_R1
    v_lshlrev_b32 v228, 16, v36
    v_and_b32 v229, s68, v36
    v_lshlrev_b32 v230, 16, v37
    v_and_b32 v231, s68, v37
    v_lshlrev_b32 v232, 16, v38
    v_and_b32 v233, s68, v38
    v_lshlrev_b32 v234, 16, v39
    v_and_b32 v235, s68, v39
    v_lshlrev_b32 v236, 16, v40
    v_and_b32 v237, s68, v40
    v_lshlrev_b32 v238, 16, v41
    v_and_b32 v239, s68, v41
    v_lshlrev_b32 v240, 16, v42
    v_and_b32 v241, s68, v42
    v_lshlrev_b32 v242, 16, v43
    v_and_b32 v243, s68, v43
    v_lshlrev_b32 v244, 16, v44
    v_and_b32 v245, s68, v44
    v_lshlrev_b32 v246, 16, v45
    v_and_b32 v247, s68, v45
    v_pk_add_f32 v[168:169], v[168:169], v[228:229]
    v_pk_add_f32 v[170:171], v[170:171], v[230:231]
    v_pk_add_f32 v[172:173], v[172:173], v[232:233]
    v_pk_add_f32 v[174:175], v[174:175], v[234:235]
    v_pk_add_f32 v[176:177], v[176:177], v[236:237]
    v_pk_add_f32 v[178:179], v[178:179], v[238:239]
    v_pk_add_f32 v[180:181], v[180:181], v[240:241]
    v_pk_add_f32 v[182:183], v[182:183], v[242:243]
    v_pk_add_f32 v[184:185], v[184:185], v[244:245]
    v_pk_add_f32 v[186:187], v[186:187], v[246:247]
    s_bitset1_b32 s24, 1
    s_branch P3_P1_N1
P3_P1_R1:
    buffer_load_dwordx4 v[36:39], v4, s[8:11], s25 offen offset:0 sc1
    buffer_load_dwordx4 v[40:43], v4, s[8:11], s25 offen offset:1024 sc1
    buffer_load_dwordx2 v[44:45], v125, s[8:11], s25 offen offset:2048 sc1
P3_P1_N1:
    s_bitcmp1_b32 s24, 2
    s_cbranch_scc1 P3_P1_N2
    v_max3_u32 v119, v48, v49, v50
    v_max3_u32 v119, v119, v51, v52
    v_max3_u32 v119, v119, v53, v54
    v_max3_u32 v119, v119, v55, v56
    v_max_u32 v119, v119, v57
    v_cmp_eq_u32 vcc, -1, v119
    s_cbranch_vccnz P3_P1_R2
    v_lshlrev_b32 v128, 16, v48
    v_and_b32 v129, s68, v48
    v_lshlrev_b32 v130, 16, v49
    v_and_b32 v131, s68, v49
    v_lshlrev_b32 v132, 16, v50
    v_and_b32 v133, s68, v50
    v_lshlrev_b32 v134, 16, v51
    v_and_b32 v135, s68, v51
    v_lshlrev_b32 v136, 16, v52
    v_and_b32 v137, s68, v52
    v_lshlrev_b32 v138, 16, v53
    v_and_b32 v139, s68, v53
    v_lshlrev_b32 v140, 16, v54
    v_and_b32 v141, s68, v54
    v_lshlrev_b32 v142, 16, v55
    v_and_b32 v143, s68, v55
    v_lshlrev_b32 v144, 16, v56
    v_and_b32 v145, s68, v56
    v_lshlrev_b32 v146, 16, v57
    v_and_b32 v147, s68, v57
    v_pk_add_f32 v[168:169], v[168:169], v[128:129]
    v_pk_add_f32 v[170:171], v[170:171], v[130:131]
    v_pk_add_f32 v[172:173], v[172:173], v[132:133]
    v_pk_add_f32 v[174:175], v[174:175], v[134:135]
    v_pk_add_f32 v[176:177], v[176:177], v[136:137]
    v_pk_add_f32 v[178:179], v[178:179], v[138:139]
    v_pk_add_f32 v[180:181], v[180:181], v[140:141]
    v_pk_add_f32 v[182:183], v[182:183], v[142:143]
    v_pk_add_f32 v[184:185], v[184:185], v[144:145]
    v_pk_add_f32 v[186:187], v[186:187], v[146:147]
    s_bitset1_b32 s24, 2
    s_branch P3_P1_N2
P3_P1_R2:
    buffer_load_dwordx4 v[48:51], v4, s[8:11], s26 offen offset:0 sc1
    buffer_load_dwordx4 v[52:55], v4, s[8:11], s26 offen offset:1024 sc1
    buffer_load_dwordx2 v[56:57], v125, s[8:11], s26 offen offset:2048 sc1
P3_P1_N2:
    s_cmp_eq_u32 s24, 7
    s_cbranch_scc1 P3_P1_GO
    s_add_u32 s67, s67, 1
    s_cmp_lt_u32 s67, 0x20000
    s_cbranch_scc1 P3_P1
    s_waitcnt vmcnt(0)
P3_P1_GO:
    v_cvt_pk_bf16_f32 v60, v168, v169
    v_cvt_pk_bf16_f32 v61, v170, v171
    v_cvt_pk_bf16_f32 v62, v172, v173
    v_cvt_pk_bf16_f32 v63, v174, v175
    v_cvt_pk_bf16_f32 v64, v176, v177
    v_cvt_pk_bf16_f32 v65, v178, v179
    v_cvt_pk_bf16_f32 v66, v180, v181
    v_cvt_pk_bf16_f32 v67, v182, v183
    v_cvt_pk_bf16_f32 v68, v184, v185
    v_cvt_pk_bf16_f32 v69, v186, v187
    s_nop 1
    v_permlane16_swap_b32 v60, v62
    v_permlane16_swap_b32 v61, v63
    v_permlane16_swap_b32 v64, v66
    v_permlane16_swap_b32 v65, v67
    s_nop 1
    buffer_store_dwordx4 v[60:63], v124, s[76:79], s65 offen nt
    buffer_store_dwordx4 v[64:67], v124, s[76:79], s65 offen offset:64 nt
    buffer_store_dwordx2 v[68:69], v123, s[76:79], s65 offen offset:128 nt
    s_branch K_END
K_END:
    s_endpgm
.section .rodata,"a"
.p2align 6
.amdhsa_kernel gated_mix__compressed_kv_cla__geglu_ffn__prompt_kernel
  .amdhsa_next_free_vgpr 256
  .amdhsa_next_free_sgpr 102
  .amdhsa_accum_offset 256
  .amdhsa_group_segment_fixed_size 0
  .amdhsa_kernarg_size 112
  .amdhsa_user_sgpr_count 2
  .amdhsa_user_sgpr_kernarg_segment_ptr 1
  .amdhsa_system_sgpr_workgroup_id_x 1
.end_amdhsa_kernel
.p2align 7
P3_TBL:
.long 0,2880,5792,8640,16,2896,5808,8656,32,2912,5760,8672,48,2928,5776,8688
.long 64,2944,5856,8704,80,2960,5872,8720,96,2976,5824,8736,112,2992,5840,8752
.long 128,3008,5920,9728,144,3024,5936,9744,160,3040,5888,9760,176,3056,5904,9776
.long 192,3072,6944,9792,208,3088,6960,9808,224,3104,6912,9824,240,3120,6928,9840
.long 256,4128,7008,9856,272,4144,7024,9872,288,4096,6976,9888,304,4112,6992,9904
.long 1280,4192,7072,9920,1296,4208,7088,9936,1312,4160,7040,9952,1328,4176,7056,9968
.long 1344,4256,7136,9984,1360,4272,7152,10000,1376,4224,7104,10016,1392,4240,7120,10032
.long 1408,4320,7200,11008,1424,4336,7216,11024,1440,4288,7168,11040,1456,4304,7184,11056
.long 1472,4384,8192,11072,1488,4400,8208,11088,1504,4352,8224,11104,1520,4368,8240,11120
.long 1536,5408,8256,11136,1552,5424,8272,11152,1568,5376,8288,11168,1584,5392,8304,11184
.long 2560,5472,8320,11200,2576,5488,8336,11216,2592,5440,8352,11232,2608,5456,8368,11248
.long 2624,5536,8384,11264,2640,5552,8400,11280,2656,5504,8416,11296,2672,5520,8432,11312
.long 2688,5600,8448,12320,2704,5616,8464,12336,2720,5568,8480,12288,2736,5584,8496,12304
.long 2752,5664,9472,12384,2768,5680,9488,12400,2784,5632,9504,12352,2800,5648,9520,12368
.long 2816,6688,9536,12448,2832,6704,9552,12464,2848,6656,9568,12416,2864,6672,9584,12432
.long 3840,6752,9600,12512,3856,6768,9616,12528,3872,6720,9632,12480,3888,6736,9648,12496
.long 15648,0,77824,77824,15664,16,77832,77832,15616,32,77840,77840,15632,48,77848,77848
.long 16672,64,78144,78144,16688,80,78152,78152,16640,96,78160,78160,16656,112,78168,78168
.long 16736,128,78464,78464,16752,144,78472,78472,16704,160,78480,78480,16720,176,78488,78488
.long 16800,192,78784,78784,16816,208,78792,78792,16768,224,78800,78800,16784,240,78808,78808
.long 16864,256,79136,79072,16880,272,79144,79080,16832,288,79152,79088,16848,304,79160,79096
.long 16928,320,79456,79392,16944,336,79464,79400,16896,352,79472,79408,16912,368,79480,79416
.long 17952,384,79776,79712,17968,400,79784,79720,17920,416,79792,79728,17936,432,79800,79736
.long 18016,448,80096,80032,18032,464,80104,80040,17984,480,80112,80048,18000,496,80120,80056
.long 18080,512,80384,80384,18096,528,80392,80392,18048,544,80400,80400,18064,560,80408,80408
.long 18144,576,80704,80704,18160,592,80712,80712,18112,608,80720,80720,18128,624,80728,80728
.long 18208,640,81024,81024,18224,656,81032,81032,18176,672,81040,81040,18192,688,81048,81048
.long 19232,704,81344,81344,19248,720,81352,81352,19200,736,81360,81360,19216,752,81368,81368
.long 19296,768,81696,81632,19312,784,81704,81640,19264,800,81712,81648,19280,816,81720,81656
.long 19360,832,82016,81952,19376,848,82024,81960,19328,864,82032,81968,19344,880,82040,81976
.long 19424,896,82336,82272,19440,912,82344,82280,19392,928,82352,82288,19408,944,82360,82296
.long 19488,960,82656,82592,19504,976,82664,82600,19456,992,82672,82608,19472,1008,82680,82616
.long 15648,0,77984,77984,15664,16,77992,77992,15616,32,78000,78000,15632,48,78008,78008
.long 16672,64,78304,78304,16688,80,78312,78312,16640,96,78320,78320,16656,112,78328,78328
.long 16736,128,78624,78624,16752,144,78632,78632,16704,160,78640,78640,16720,176,78648,78648
.long 16800,192,78944,78944,16816,208,78952,78952,16768,224,78960,78960,16784,240,78968,78968
.long 16864,256,79232,79296,16880,272,79240,79304,16832,288,79248,79312,16848,304,79256,79320
.long 16928,320,79552,79616,16944,336,79560,79624,16896,352,79568,79632,16912,368,79576,79640
.long 17952,384,79872,79936,17968,400,79880,79944,17920,416,79888,79952,17936,432,79896,79960
.long 18016,448,80192,80256,18032,464,80200,80264,17984,480,80208,80272,18000,496,80216,80280
.long 18080,512,80544,80544,18096,528,80552,80552,18048,544,80560,80560,18064,560,80568,80568
.long 18144,576,80864,80864,18160,592,80872,80872,18112,608,80880,80880,18128,624,80888,80888
.long 18208,640,81184,81184,18224,656,81192,81192,18176,672,81200,81200,18192,688,81208,81208
.long 19232,704,81504,81504,19248,720,81512,81512,19200,736,81520,81520,19216,752,81528,81528
.long 19296,768,81792,81856,19312,784,81800,81864,19264,800,81808,81872,19280,816,81816,81880
.long 19360,832,82112,82176,19376,848,82120,82184,19328,864,82128,82192,19344,880,82136,82200
.long 19424,896,82432,82496,19440,912,82440,82504,19392,928,82448,82512,19408,944,82456,82520
.long 19488,960,82752,82816,19504,976,82760,82824,19456,992,82768,82832,19472,1008,82776,82840
```
